```python
import torch

def _softmax(x, axis=-1):
    return torch.softmax(x, dim=axis)
def _gelu(x):
    return torch.nn.functional.gelu(x, approximate="tanh")
def _silu(x):
    return torch.nn.functional.silu(x)
def _sigmoid(x):
    return torch.sigmoid(x)
def _layernorm(x, axis=-1, eps=1e-5):
    m = x.mean(dim=axis, keepdim=True)
    v = x.var(dim=axis, keepdim=True, unbiased=False)
    return (x - m) / torch.sqrt(v + eps)
def _scatter_add(tgt, idx, src, axis=0):
    return tgt.clone().index_add_(axis, idx, src)
def _segment_sum(src, seg, n):
    out = torch.zeros((n,) + src.shape[1:], dtype=src.dtype)
    return out.index_add_(0, seg, src)
def _pad(x, pw):
    flat = tuple(v for pair in reversed(pw) for v in pair)
    return torch.nn.functional.pad(x, flat)

kernel_name = 'recurrent_scan__compressed_kv_cla__moe_arch_mod__prompt'

def setup_inputs():

    _w = (lambda a: (lambda t: t.to(torch.bfloat16) if t.is_floating_point() else t)(torch.as_tensor(a)))
    def _A_setup():
        B, H, Sq, Sk, D, M = 1, 32, 2048, 2048, 128, 512
        Dc = 4 * D
        return {
            "x": _w((lambda *s: torch.randn(*s, dtype=torch.bfloat16) * 0.05)(B, Sq, M)),
            "c_kv": _w((lambda *s: torch.randn(*s, dtype=torch.bfloat16) * 0.2)(B, Sk, Dc)),
            "w_q": _w((lambda *s: torch.randn(*s, dtype=torch.bfloat16) * 3.2)(M, H, D) * (M ** -0.5)),
            "w_uk": _w((lambda *s: torch.randn(*s, dtype=torch.bfloat16) * 3.2)(Dc, H, D) * (Dc ** -0.5)),
            "w_uv": _w((lambda *s: torch.randn(*s, dtype=torch.bfloat16) * 0.2)(Dc, H, D) * (Dc ** -0.5)),
            "w_o": _w((lambda *s: torch.randn(*s, dtype=torch.bfloat16) * 0.2)(H, D, M) * ((H * D) ** -0.5)),
        }
    _A_in = _A_setup()

    def _B_setup():
        B, S, D, F, C = 1, 2048, 512, 1792, 1
        return {
            "x": _w((lambda *s: torch.randn(*s, dtype=torch.bfloat16) * 0.05)(B, S, D)),
            "w_r": _w((lambda *s: torch.randn(*s, dtype=torch.bfloat16) * 1.6)(D)),
            "w_gate": _w((lambda *s: torch.randn(*s, dtype=torch.bfloat16) * 0.2)(D, F)),
            "w_up": _w((lambda *s: torch.randn(*s, dtype=torch.bfloat16) * 0.2)(D, F)),
            "w_down": _w((lambda *s: torch.randn(*s, dtype=torch.bfloat16) * 0.2)(F, D)),
        }
    _B_in = _B_setup()

    return {
        "A_x": _A_in["x"],
        "A_c_kv": _A_in["c_kv"],
        "A_w_q": _A_in["w_q"],
        "A_w_uk": _A_in["w_uk"],
        "A_w_uv": _A_in["w_uv"],
        "A_w_o": _A_in["w_o"],
        "B_x": _B_in["x"],
        "B_w_r": _B_in["w_r"],
        "B_w_gate": _B_in["w_gate"],
        "B_w_up": _B_in["w_up"],
        "B_w_down": _B_in["w_down"],
    }

def reference(A_x, A_c_kv, A_w_q, A_w_uk, A_w_uv, A_w_o, B_x, B_w_r, B_w_gate, B_w_up, B_w_down):
    def _A_ref(x, c_kv, w_q, w_uk, w_uv, w_o):
        B, Sq, M = x.shape[0], x.shape[1], x.shape[2]
        Sk = c_kv.shape[1]
        H, D = w_q.shape[1], w_q.shape[2]
        q = torch.einsum("bqm,mhd->bhqd", x, w_q)
        k = torch.einsum("bkc,chd->bhkd", c_kv, w_uk)
        v = torch.einsum("bkc,chd->bhkd", c_kv, w_uv)
        scores = torch.einsum("bhqd,bhkd->bhqk", q, k) * (D ** -0.5)
        off = Sk - Sq
        qi = torch.arange(Sq)[:, None]
        kj = torch.arange(Sk)[None, :]
        cmask = kj <= (qi + off)
        scores = torch.where(cmask[None, None], scores, -1e9)
        p = _softmax(scores, axis=-1)
        ctx = torch.einsum("bhqk,bhkd->bhqd", p, v)
        return torch.einsum("bhqd,hdm->bqm", ctx, w_o)

    def _B_ref(x, w_r, w_gate, w_up, w_down):
        B, S, D = x.shape
        C = 1
        r = x @ w_r
        idx = torch.argsort(-r, axis=-1)[:, :C]
        idx_e = (lambda x, n, axis: torch.repeat_interleave(x, n, dim=axis))(idx.reshape(B, C, 1), D, axis=2)
        x_sel = (lambda x, i, axis: torch.take_along_dim(x, i, dim=axis))(x, idx_e, axis=1)
        g = _silu(x_sel @ w_gate)
        u = x_sel @ w_up
        y = (g * u) @ w_down
        r_sel = _sigmoid((lambda x, i, axis: torch.take_along_dim(x, i, dim=axis))(r, idx, axis=1))
        y = y * r_sel.reshape(B, C, 1)
        b_off = (torch.arange(B) * S).reshape(B, 1)
        flat_idx = (idx + b_off).reshape(B * C)
        zero = (x * 0.0).reshape(B * S, D)
        upd = _scatter_add(zero, flat_idx, y.reshape(B * C, D), axis=0)
        return x + upd.reshape(B, S, D)

    x = A_x
    xn = _layernorm(x, axis=-1)
    s = _A_ref(xn, A_c_kv, A_w_q, A_w_uk, A_w_uv, A_w_o)
    g = _silu(_B_ref(xn, B_w_r, B_w_gate, B_w_up, B_w_down))
    return x + s * g
```

```asm
; @launch grid=(256,1,1) block=(256,1,1) lds=163840
.amdgcn_target "amdgcn-amd-amdhsa--gfx950"
.text
.globl recurrent_scan__compressed_kv_cla__moe_arch_mod__prompt_kernel
.p2align 8
.type recurrent_scan__compressed_kv_cla__moe_arch_mod__prompt_kernel,@function
recurrent_scan__compressed_kv_cla__moe_arch_mod__prompt_kernel:
M_START:
s_cmp_ge_u32 s2, 256
s_cbranch_scc1 M_END
s_load_dwordx4 s[4:7], s[0:1], 0
s_load_dwordx8 s[60:67], s[0:1], 16
s_load_dwordx2 s[68:69], s[0:1], 56
s_load_dwordx4 s[72:75], s[0:1], 96
s_load_dwordx8 s[88:95], s[0:1], 64
s_getpc_b64 s[46:47]
M_PC:
s_lshr_b32 s43, s2, 3
s_lshl_b32 s48, s43, 12
v_and_b32 v26, 31, v0
v_lshlrev_b32 v26, 7, v26
v_add_u32 v26, s48, v26
v_min_u32 v26, M_CODE_END-M_PC-4, v26
global_load_dword a253, v26, s[46:47]
v_and_b32 v1, 63, v0
v_lshrrev_b32 v2, 6, v0
v_lshlrev_b32 v3, 4, v1
v_readfirstlane_b32 s3, v2
s_and_b32 s42, s2, 7
s_and_b32 s44, s43, 3
s_lshl_b32 s45, s42, 2
s_add_u32 s44, s44, s45
s_lshr_b32 s45, s43, 2
v_lshrrev_b32 v20, 3, v1
v_and_b32 v21, 6, v20
v_and_b32 v22, 7, v1
v_xor_b32 v21, v21, v22
v_lshlrev_b32 v21, 4, v21
v_lshl_add_u32 v4, v20, 10, v21
v_add_u32 v5, 7168, v4
v_add_u32 v6, 14336, v4
v_add_u32 v7, 21504, v4
v_lshrrev_b32 v20, 4, v1
v_and_b32 v22, 15, v1
v_lshlrev_b32 v21, 1, v20
v_xor_b32 v21, v21, v22
v_lshlrev_b32 v21, 4, v21
v_lshl_add_u32 v8, v20, 13, v21
v_add_u32 v9, 31744, v8
v_xor_b32 v10, 0x80, v8
v_add_u32 v11, 95232, v10
v_add_u32 v10, 63488, v10
s_lshl_b32 s46, s2, 3
s_lshl_b32 s47, s3, 1
s_add_u32 s46, s46, s47
s_lshl_b32 s49, s46, 10
s_lshl_b32 s50, s45, 18
s_lshl_b32 s47, s3, 16
s_add_u32 s50, s50, s47
s_add_u32 s51, s50, 32768
s_and_b32 s47, s3, 1
s_lshl_b32 s52, s47, 18
s_lshl_b32 s47, s44, 8
s_add_u32 s52, s52, s47
s_add_u32 s53, s52, 131072
s_lshl_b32 s54, s3, 13
s_mov_b32 s55, s54
s_waitcnt lgkmcnt(0)
s_mov_b32 s8, s4
s_and_b32 s9, s5, 0xffff
s_mov_b32 s10, 0x200000
s_mov_b32 s11, 0x20000
s_mov_b32 s24, s68
s_and_b32 s25, s69, 0xffff
s_mov_b32 s26, 0x400
s_mov_b32 s27, 0x20000
buffer_load_dwordx4 v[32:35], v3, s[8:11], s49 offen
buffer_load_dwordx4 v[36:39], v3, s[8:11], s49 offen offset:1024
buffer_load_dwordx4 v[40:43], v3, s[24:27], 0 offen
s_mov_b32 s12, s6
s_and_b32 s13, s7, 0xffff
s_mov_b32 s14, 0x200000
s_mov_b32 s15, 0x20000
s_cmp_ge_u32 s3, 2
s_cselect_b32 s62, s64, s62
s_cselect_b32 s63, s65, s63
s_mov_b32 s16, s62
s_and_b32 s17, s63, 0xffff
s_mov_b32 s18, 0x400000
s_mov_b32 s19, 0x20000
s_mov_b32 s20, s66
s_and_b32 s21, s67, 0xffff
s_mov_b32 s22, 0x400000
s_mov_b32 s23, 0x20000
s_add_u32 m0, s55, 0
s_mov_b32 s28, s74
s_and_b32 s29, s75, 0xffff
s_mov_b32 s30, 0x4400000
s_mov_b32 s31, 0x20000
buffer_load_dwordx4 v4, s[12:15], s50 offen offset:0 lds
s_mov_b32 s32, s60
s_and_b32 s33, s61, 0xffff
s_mov_b32 s34, 0x400000
s_mov_b32 s35, 0x20000
buffer_load_dwordx4 v5, s[12:15], s50 offen offset:1024 lds
s_mov_b32 s36, s72
s_and_b32 s37, s73, 0xffff
s_mov_b32 s38, 0x100
s_mov_b32 s39, 0x20000
buffer_load_dwordx4 v6, s[12:15], s50 offen offset:2048 lds
s_and_b32 s59, s3, 1
s_lshr_b32 s58, s3, 1
v_lshrrev_b32 v24, 4, v1
v_and_b32 v25, 6, v1
buffer_load_dwordx4 v7, s[12:15], s50 offen offset:3072 lds
v_xor_b32 v25, v25, v24
v_lshlrev_b32 v25, 4, v25
v_and_b32 v26, 15, v1
v_lshl_add_u32 v12, v26, 7, v25
s_add_u32 m0, s55, 32768
s_lshl_b32 s47, s58, 14
v_add_u32 v12, s47, v12
v_xor_b32 v13, 64, v12
v_bfe_u32 v25, v1, 2, 2
buffer_load_dwordx4 v8, s[16:19], s52 offen offset:0 lds
v_and_b32 v26, 3, v1
v_lshl_add_u32 v27, v24, 3, v25
v_lshlrev_b32 v27, 8, v27
v_lshl_add_u32 v27, v26, 3, v27
buffer_load_dwordx4 v9, s[16:19], s52 offen offset:1024 lds
v_and_b32 v28, 1, v24
v_lshl_add_u32 v28, v28, 2, v25
v_lshl_add_u32 v27, v28, 5, v27
s_lshl_b32 s47, s59, 14
buffer_load_dwordx4 v10, s[16:19], s52 offen offset:2048 lds
s_add_u32 s47, s47, 32768
v_add_u32 v14, s47, v27
v_xor_b32 v15, 32, v14
v_xor_b32 v16, 64, v14
buffer_load_dwordx4 v11, s[16:19], s52 offen offset:3072 lds
v_xor_b32 v17, 96, v14
v_xor_b32 v18, 128, v14
v_xor_b32 v19, 160, v14
v_xor_b32 v20, 192, v14
s_add_u32 m0, s55, 4096
v_xor_b32 v21, 224, v14
s_sub_u32 s71, 0x10000, s47
v_lshl_add_u32 v27, v24, 2, v25
v_and_b32 v28, 6, v27
buffer_load_dwordx4 v4, s[12:15], s51 offen offset:0 lds
v_xor_b32 v28, v28, v26
v_lshlrev_b32 v28, 4, v28
v_lshl_add_u32 v22, v27, 7, v28
s_add_u32 s57, s54, 0x20000
buffer_load_dwordx4 v5, s[12:15], s51 offen offset:1024 lds
v_add_u32 v22, s57, v22
v_xor_b32 v23, 64, v22
s_lshl_b32 s76, s3, 5
s_add_u32 s76, s76, 0x21000
buffer_load_dwordx4 v6, s[12:15], s51 offen offset:2048 lds
s_lshr_b32 s68, s2, 1
s_lshl_b32 s68, s68, 14
s_and_b32 s47, s2, 1
s_lshl_b32 s47, s47, 7
buffer_load_dwordx4 v7, s[12:15], s51 offen offset:3072 lds
s_add_u32 s68, s68, s47
s_lshl_b32 s47, s3, 12
s_add_u32 s68, s68, s47
s_sub_u32 s77, 0xffff, s46
s_add_u32 m0, s55, 36864
s_sub_u32 s78, 0xfffe, s46
s_lshl_b32 s79, s46, 1
s_add_u32 s79, s79, 2097152
v_cmp_eq_u32 vcc, 0, v0
buffer_load_dwordx4 v8, s[16:19], s53 offen offset:0 lds
v_mov_b32 v30, 0x40000000
s_getreg_b32 s70, hwreg(HW_REG_XCC_ID)
v_cndmask_b32 v30, v30, 0, vcc
s_and_b32 s70, s70, 15
buffer_load_dwordx4 v9, s[16:19], s53 offen offset:1024 lds
s_or_b32 s70, s70, 16
v_mov_b32 v31, s70
s_lshl_b32 s47, s3, 30
v_lshlrev_b32 v2, 2, v1
buffer_load_dwordx4 v10, s[16:19], s53 offen offset:2048 lds
v_or_b32 v2, s47, v2
s_sub_u32 s96, 0, s3
s_ashr_i32 s96, s96, 31
s_mov_b32 s97, s96
buffer_load_dwordx4 v11, s[16:19], s53 offen offset:3072 lds
s_lshl_b32 s56, s44, 5
s_add_u32 s56, s56, 2752512
s_lshl_b32 s47, s45, 2
s_add_u32 s98, s56, s47
s_lshl_b32 s47, s44, 2
s_add_u32 s47, s47, 2753536
s_lshl_b32 s48, s45, 7
s_add_u32 s99, s47, s48
s_sub_u32 s100, s47, s48
s_add_u32 s100, s100, 1920
s_lshl_b32 s101, s2, 2
s_add_u32 s101, s101, 2756608
v_mov_b32 v29, 0
buffer_store_dword v29, v30, s[28:31], s98 offen sc1
buffer_store_dword v29, v30, s[28:31], s99 offen sc1
buffer_store_dword v29, v30, s[28:31], s100 offen sc1
buffer_store_dword v29, v30, s[28:31], s101 offen sc1
v_lshrrev_b32 v26, 3, v1
v_and_b32 v27, 7, v1
v_lshlrev_b32 v27, 7, v27
v_lshl_add_u32 v29, v26, 13, v27
v_cmp_gt_u32 vcc, 32, v1
v_mov_b32 v27, 0x40000000
s_nop 0
v_cndmask_b32 v29, v27, v29, vcc
s_cmp_eq_u32 s3, 3
s_cselect_b32 s24, s32, s16
s_cselect_b32 s25, s33, s17
s_cselect_b32 s49, 0xffe00000, 0
s_cselect_b32 s48, 0, 0x80000
s_mul_i32 s60, s43, 32768
s_lshl_b32 s47, s42, 10
s_add_u32 s60, s60, s47
s_add_u32 s60, s60, s49
s_add_u32 s60, s60, s48
s_mov_b32 s67, 1048576
s_mov_b32 s26, 0x400000
v_add_u32 v28, s60, v29
v_add_u32 v29, s67, v28
s_cmp_eq_u32 s3, 0
s_cbranch_scc0 M_T1
s_mov_b32 s24, s12
s_mov_b32 s25, s13
s_mov_b32 s26, 0x200000
s_lshl_b32 s60, s2, 13
v_lshlrev_b32 v28, 7, v1
v_add_u32 v28, s60, v28
s_lshl_b32 s60, s43, 16
s_add_u32 s60, s60, 384
v_lshlrev_b32 v29, 10, v1
v_add_u32 v29, s60, v29
s_mov_b32 s67, 128
M_T1:
s_waitcnt vmcnt(20)
s_lshr_b32 s66, s2, 1
s_and_b32 s49, s2, 1
s_lshl_b32 s49, s49, 8
s_lshl_b32 s47, s3, 6
s_add_u32 s49, s49, s47
s_lshl_b32 s47, s66, 15
s_lshl_b32 s48, s49, 1
s_add_u32 s65, s47, s48
s_mul_i32 s47, s49, 8192
s_lshl_b32 s48, s66, 10
s_add_u32 s66, s47, s48
s_add_u32 s66, s66, 4194304
v_lshlrev_b32 v48, 16, v32
v_and_b32 v49, 0xffff0000, v32
v_lshlrev_b32 v50, 16, v33
v_and_b32 v51, 0xffff0000, v33
v_lshlrev_b32 v52, 16, v34
v_and_b32 v53, 0xffff0000, v34
v_lshlrev_b32 v54, 16, v35
v_and_b32 v55, 0xffff0000, v35
s_add_u32 s50, s50, 128
v_lshlrev_b32 v56, 16, v36
v_and_b32 v57, 0xffff0000, v36
v_lshlrev_b32 v58, 16, v37
v_and_b32 v59, 0xffff0000, v37
v_lshlrev_b32 v60, 16, v38
v_and_b32 v61, 0xffff0000, v38
v_lshlrev_b32 v62, 16, v39
v_and_b32 v63, 0xffff0000, v39
s_add_u32 s51, s51, 128
v_lshlrev_b32 v64, 16, v40
v_and_b32 v65, 0xffff0000, v40
v_lshlrev_b32 v66, 16, v41
v_and_b32 v67, 0xffff0000, v41
v_lshlrev_b32 v68, 16, v42
v_and_b32 v69, 0xffff0000, v42
v_lshlrev_b32 v70, 16, v43
v_and_b32 v71, 0xffff0000, v43
s_add_u32 s52, s52, 0x80000
v_add_f32 v72, v48, v49
v_add_f32 v72, v72, v50
v_add_f32 v72, v72, v51
v_add_f32 v72, v72, v52
v_add_f32 v72, v72, v53
v_add_f32 v72, v72, v54
v_add_f32 v72, v72, v55
v_add_f32 v73, v56, v57
s_add_u32 s53, s53, 0x80000
v_add_f32 v73, v73, v58
v_add_f32 v73, v73, v59
v_add_f32 v73, v73, v60
v_add_f32 v73, v73, v61
v_add_f32 v73, v73, v62
v_add_f32 v73, v73, v63
s_nop 1
v_add_f32_dpp v72, v72, v72 row_ror:8 row_mask:0xf bank_mask:0xf
s_xor_b32 s55, s55, 0x10000
v_add_f32_dpp v73, v73, v73 row_ror:8 row_mask:0xf bank_mask:0xf
s_nop 1
v_add_f32_dpp v72, v72, v72 row_ror:4 row_mask:0xf bank_mask:0xf
v_add_f32_dpp v73, v73, v73 row_ror:4 row_mask:0xf bank_mask:0xf
s_nop 1
v_add_f32_dpp v72, v72, v72 row_ror:2 row_mask:0xf bank_mask:0xf
v_add_f32_dpp v73, v73, v73 row_ror:2 row_mask:0xf bank_mask:0xf
s_nop 1
s_add_u32 m0, s55, 0
v_add_f32_dpp v72, v72, v72 row_ror:1 row_mask:0xf bank_mask:0xf
v_add_f32_dpp v73, v73, v73 row_ror:1 row_mask:0xf bank_mask:0xf
v_mov_b32 v74, v72
v_mov_b32 v75, v73
s_nop 1
v_permlane16_swap_b32 v72, v74
v_permlane16_swap_b32 v73, v75
v_add_f32 v72, v72, v74
buffer_load_dwordx4 v4, s[12:15], s50 offen offset:0 lds
v_add_f32 v73, v73, v75
v_mov_b32 v74, v72
v_mov_b32 v75, v73
s_nop 1
v_permlane32_swap_b32 v72, v74
v_permlane32_swap_b32 v73, v75
v_add_f32 v72, v72, v74
v_add_f32 v73, v73, v75
buffer_load_dwordx4 v5, s[12:15], s50 offen offset:1024 lds
v_mul_f32 v72, 0x3b000000, v72
v_cvt_pk_bf16_f32 v76, v72, v72
v_and_b32 v76, 0xffff0000, v76
v_sub_f32 v80, v48, v72
v_sub_f32 v81, v49, v72
v_sub_f32 v82, v50, v72
v_sub_f32 v83, v51, v72
v_sub_f32 v84, v52, v72
buffer_load_dwordx4 v6, s[12:15], s50 offen offset:2048 lds
v_sub_f32 v85, v53, v72
v_sub_f32 v86, v54, v72
v_sub_f32 v87, v55, v72
v_mul_f32 v72, v80, v80
v_fmac_f32 v72, v81, v81
v_fmac_f32 v72, v82, v82
v_fmac_f32 v72, v83, v83
v_fmac_f32 v72, v84, v84
buffer_load_dwordx4 v7, s[12:15], s50 offen offset:3072 lds
v_fmac_f32 v72, v85, v85
v_fmac_f32 v72, v86, v86
v_fmac_f32 v72, v87, v87
v_mul_f32 v73, 0x3b000000, v73
v_cvt_pk_bf16_f32 v77, v73, v73
v_and_b32 v77, 0xffff0000, v77
v_sub_f32 v88, v56, v73
v_sub_f32 v89, v57, v73
s_add_u32 m0, s55, 32768
v_sub_f32 v90, v58, v73
v_sub_f32 v91, v59, v73
v_sub_f32 v92, v60, v73
v_sub_f32 v93, v61, v73
v_sub_f32 v94, v62, v73
v_sub_f32 v95, v63, v73
v_mul_f32 v73, v88, v88
v_fmac_f32 v73, v89, v89
buffer_load_dwordx4 v8, s[16:19], s52 offen offset:0 lds
v_fmac_f32 v73, v90, v90
v_fmac_f32 v73, v91, v91
v_fmac_f32 v73, v92, v92
v_fmac_f32 v73, v93, v93
v_fmac_f32 v73, v94, v94
v_fmac_f32 v73, v95, v95
s_nop 1
v_add_f32_dpp v72, v72, v72 row_ror:8 row_mask:0xf bank_mask:0xf
buffer_load_dwordx4 v9, s[16:19], s52 offen offset:1024 lds
v_add_f32_dpp v73, v73, v73 row_ror:8 row_mask:0xf bank_mask:0xf
s_nop 1
v_add_f32_dpp v72, v72, v72 row_ror:4 row_mask:0xf bank_mask:0xf
v_add_f32_dpp v73, v73, v73 row_ror:4 row_mask:0xf bank_mask:0xf
s_nop 1
v_add_f32_dpp v72, v72, v72 row_ror:2 row_mask:0xf bank_mask:0xf
v_add_f32_dpp v73, v73, v73 row_ror:2 row_mask:0xf bank_mask:0xf
s_nop 1
buffer_load_dwordx4 v10, s[16:19], s52 offen offset:2048 lds
v_add_f32_dpp v72, v72, v72 row_ror:1 row_mask:0xf bank_mask:0xf
v_add_f32_dpp v73, v73, v73 row_ror:1 row_mask:0xf bank_mask:0xf
v_mov_b32 v74, v72
v_mov_b32 v75, v73
s_nop 1
v_permlane16_swap_b32 v72, v74
v_permlane16_swap_b32 v73, v75
v_add_f32 v72, v72, v74
buffer_load_dwordx4 v11, s[16:19], s52 offen offset:3072 lds
v_add_f32 v73, v73, v75
v_mov_b32 v74, v72
v_mov_b32 v75, v73
s_nop 1
v_permlane32_swap_b32 v72, v74
v_permlane32_swap_b32 v73, v75
v_add_f32 v72, v72, v74
v_add_f32 v73, v73, v75
s_add_u32 m0, s55, 4096
v_mul_f32 v72, 0x3b000000, v72
v_cvt_pk_bf16_f32 v72, v72, v72
v_and_b32 v72, 0xffff0000, v72
v_add_f32 v72, 0x3727c5ac, v72
v_cvt_pk_bf16_f32 v72, v72, v72
v_and_b32 v72, 0xffff0000, v72
v_sqrt_f32 v72, v72
s_nop 0
buffer_load_dwordx4 v4, s[12:15], s51 offen offset:0 lds
v_cvt_pk_bf16_f32 v72, v72, v72
v_and_b32 v72, 0xffff0000, v72
v_rcp_f32 v74, v72
v_sub_f32 v80, v48, v76
v_sub_f32 v81, v49, v76
v_sub_f32 v82, v50, v76
v_sub_f32 v83, v51, v76
v_sub_f32 v84, v52, v76
buffer_load_dwordx4 v5, s[12:15], s51 offen offset:1024 lds
v_sub_f32 v85, v53, v76
v_sub_f32 v86, v54, v76
v_sub_f32 v87, v55, v76
v_cvt_pk_bf16_f32 v96, v80, v81
v_cvt_pk_bf16_f32 v97, v82, v83
v_cvt_pk_bf16_f32 v98, v84, v85
v_cvt_pk_bf16_f32 v99, v86, v87
v_lshlrev_b32 v80, 16, v96
buffer_load_dwordx4 v6, s[12:15], s51 offen offset:2048 lds
v_and_b32 v81, 0xffff0000, v96
v_lshlrev_b32 v82, 16, v97
v_and_b32 v83, 0xffff0000, v97
v_lshlrev_b32 v84, 16, v98
v_and_b32 v85, 0xffff0000, v98
v_lshlrev_b32 v86, 16, v99
v_and_b32 v87, 0xffff0000, v99
v_mul_f32 v48, v80, v74
buffer_load_dwordx4 v7, s[12:15], s51 offen offset:3072 lds
v_mul_f32 v49, v81, v74
v_mul_f32 v50, v82, v74
v_mul_f32 v51, v83, v74
v_mul_f32 v52, v84, v74
v_mul_f32 v53, v85, v74
v_mul_f32 v54, v86, v74
v_mul_f32 v55, v87, v74
v_fma_f32 v80, -v48, v72, v80
s_add_u32 m0, s55, 36864
v_fma_f32 v81, -v49, v72, v81
v_fma_f32 v82, -v50, v72, v82
v_fma_f32 v83, -v51, v72, v83
v_fma_f32 v84, -v52, v72, v84
v_fma_f32 v85, -v53, v72, v85
v_fma_f32 v86, -v54, v72, v86
v_fma_f32 v87, -v55, v72, v87
v_fmac_f32 v48, v80, v74
buffer_load_dwordx4 v8, s[16:19], s53 offen offset:0 lds
v_fmac_f32 v49, v81, v74
v_fmac_f32 v50, v82, v74
v_fmac_f32 v51, v83, v74
v_fmac_f32 v52, v84, v74
v_fmac_f32 v53, v85, v74
v_fmac_f32 v54, v86, v74
v_fmac_f32 v55, v87, v74
v_cvt_pk_bf16_f32 v100, v48, v49
buffer_load_dwordx4 v9, s[16:19], s53 offen offset:1024 lds
v_cvt_pk_bf16_f32 v101, v50, v51
v_cvt_pk_bf16_f32 v102, v52, v53
v_cvt_pk_bf16_f32 v103, v54, v55
v_lshlrev_b32 v80, 16, v100
v_and_b32 v81, 0xffff0000, v100
v_lshlrev_b32 v82, 16, v101
v_and_b32 v83, 0xffff0000, v101
v_lshlrev_b32 v84, 16, v102
buffer_load_dwordx4 v10, s[16:19], s53 offen offset:2048 lds
v_and_b32 v85, 0xffff0000, v102
v_lshlrev_b32 v86, 16, v103
v_and_b32 v87, 0xffff0000, v103
v_mul_f32 v72, v80, v64
v_fmac_f32 v72, v81, v65
v_fmac_f32 v72, v82, v66
v_fmac_f32 v72, v83, v67
v_fmac_f32 v72, v84, v68
buffer_load_dwordx4 v11, s[16:19], s53 offen offset:3072 lds
v_fmac_f32 v72, v85, v69
v_fmac_f32 v72, v86, v70
v_fmac_f32 v72, v87, v71
v_mul_f32 v73, 0x3b000000, v73
v_cvt_pk_bf16_f32 v73, v73, v73
v_and_b32 v73, 0xffff0000, v73
v_add_f32 v73, 0x3727c5ac, v73
v_cvt_pk_bf16_f32 v73, v73, v73
s_add_u32 s50, s50, 128
v_and_b32 v73, 0xffff0000, v73
v_sqrt_f32 v73, v73
s_nop 0
v_cvt_pk_bf16_f32 v73, v73, v73
v_and_b32 v73, 0xffff0000, v73
v_rcp_f32 v75, v73
v_sub_f32 v88, v56, v77
v_sub_f32 v89, v57, v77
s_add_u32 s51, s51, 128
v_sub_f32 v90, v58, v77
v_sub_f32 v91, v59, v77
v_sub_f32 v92, v60, v77
v_sub_f32 v93, v61, v77
v_sub_f32 v94, v62, v77
v_sub_f32 v95, v63, v77
v_cvt_pk_bf16_f32 v96, v88, v89
v_cvt_pk_bf16_f32 v97, v90, v91
s_add_u32 s52, s52, 0x80000
v_cvt_pk_bf16_f32 v98, v92, v93
v_cvt_pk_bf16_f32 v99, v94, v95
v_lshlrev_b32 v88, 16, v96
v_and_b32 v89, 0xffff0000, v96
v_lshlrev_b32 v90, 16, v97
v_and_b32 v91, 0xffff0000, v97
v_lshlrev_b32 v92, 16, v98
v_and_b32 v93, 0xffff0000, v98
s_add_u32 s53, s53, 0x80000
v_lshlrev_b32 v94, 16, v99
v_and_b32 v95, 0xffff0000, v99
v_mul_f32 v56, v88, v75
v_mul_f32 v57, v89, v75
v_mul_f32 v58, v90, v75
v_mul_f32 v59, v91, v75
v_mul_f32 v60, v92, v75
v_mul_f32 v61, v93, v75
s_xor_b32 s55, s55, 0x10000
v_mul_f32 v62, v94, v75
v_mul_f32 v63, v95, v75
v_fma_f32 v88, -v56, v73, v88
v_fma_f32 v89, -v57, v73, v89
v_fma_f32 v90, -v58, v73, v90
v_fma_f32 v91, -v59, v73, v91
v_fma_f32 v92, -v60, v73, v92
v_fma_f32 v93, -v61, v73, v93
v_fma_f32 v94, -v62, v73, v94
v_fma_f32 v95, -v63, v73, v95
v_fmac_f32 v56, v88, v75
v_fmac_f32 v57, v89, v75
v_fmac_f32 v58, v90, v75
v_fmac_f32 v59, v91, v75
v_fmac_f32 v60, v92, v75
v_fmac_f32 v61, v93, v75
v_fmac_f32 v62, v94, v75
v_fmac_f32 v63, v95, v75
v_cvt_pk_bf16_f32 v104, v56, v57
v_cvt_pk_bf16_f32 v105, v58, v59
v_cvt_pk_bf16_f32 v106, v60, v61
v_cvt_pk_bf16_f32 v107, v62, v63
v_lshlrev_b32 v88, 16, v104
v_and_b32 v89, 0xffff0000, v104
v_lshlrev_b32 v90, 16, v105
v_and_b32 v91, 0xffff0000, v105
v_lshlrev_b32 v92, 16, v106
v_and_b32 v93, 0xffff0000, v106
v_lshlrev_b32 v94, 16, v107
v_and_b32 v95, 0xffff0000, v107
v_mul_f32 v73, v88, v64
v_fmac_f32 v73, v89, v65
v_fmac_f32 v73, v90, v66
v_fmac_f32 v73, v91, v67
v_fmac_f32 v73, v92, v68
v_fmac_f32 v73, v93, v69
v_fmac_f32 v73, v94, v70
v_fmac_f32 v73, v95, v71
v_lshrrev_b32 v24, 4, v1
v_and_b32 v25, 15, v1
v_lshlrev_b32 v25, 7, v25
v_lshl_add_u32 v24, v24, 13, v25
v_add_u32 v24, s76, v24
ds_write_b128 v24, v[100:103]
ds_write_b128 v24, v[104:107] offset:16
s_nop 1
v_add_f32_dpp v72, v72, v72 row_ror:8 row_mask:0xf bank_mask:0xf
v_add_f32_dpp v73, v73, v73 row_ror:8 row_mask:0xf bank_mask:0xf
s_nop 1
v_add_f32_dpp v72, v72, v72 row_ror:4 row_mask:0xf bank_mask:0xf
v_add_f32_dpp v73, v73, v73 row_ror:4 row_mask:0xf bank_mask:0xf
s_nop 1
v_add_f32_dpp v72, v72, v72 row_ror:2 row_mask:0xf bank_mask:0xf
v_add_f32_dpp v73, v73, v73 row_ror:2 row_mask:0xf bank_mask:0xf
s_nop 1
v_add_f32_dpp v72, v72, v72 row_ror:1 row_mask:0xf bank_mask:0xf
v_add_f32_dpp v73, v73, v73 row_ror:1 row_mask:0xf bank_mask:0xf
v_mov_b32 v74, v72
v_mov_b32 v75, v73
s_nop 1
v_permlane16_swap_b32 v72, v74
v_permlane16_swap_b32 v73, v75
v_add_f32 v72, v72, v74
v_add_f32 v73, v73, v75
v_mov_b32 v74, v72
v_mov_b32 v75, v73
s_nop 1
v_permlane32_swap_b32 v72, v74
v_permlane32_swap_b32 v73, v75
v_add_f32 v72, v72, v74
v_add_f32 v73, v73, v75
v_cvt_pk_bf16_f32 v72, v72, v72
v_ashrrev_i32 v74, 31, v72
v_or_b32 v74, 0x80000000, v74
v_xor_b32 v72, v72, v74
v_and_b32 v72, 0xffff0000, v72
v_or_b32 v72, s77, v72
v_cvt_pk_bf16_f32 v73, v73, v73
v_ashrrev_i32 v75, 31, v73
v_or_b32 v75, 0x80000000, v75
v_xor_b32 v73, v73, v75
v_and_b32 v73, 0xffff0000, v73
v_or_b32 v73, s78, v73
v_cmp_eq_u32 vcc, 0, v1
v_mov_b32 v24, 0x40000000
s_nop 0
v_cndmask_b32 v24, v24, 0, vcc
v_max_u32 v72, v72, v73
buffer_store_dword v72, v24, s[28:31], s79 offen sc1
s_mul_i32 s47, s43, 11
s_lshr_b32 s47, s47, 5
s_mul_i32 s47, s47, 3
s_sub_u32 s73, s43, s47
s_add_u32 s73, s73, 1
v_lshrrev_b32 v24, 3, v1
v_and_b32 v25, 7, v1
v_lshlrev_b32 v25, 4, v25
v_lshl_add_u32 v24, v24, 8, v25
v_add_u32 v25, s57, v3
buffer_load_dword a252, v28, s[24:27], 0 offen
s_mov_b32 s69, s65
s_add_u32 s60, s65, 24576
s_mov_b32 s75, s57
s_lshl_b32 s62, s44, 19
s_lshl_b32 s47, s45, 16
s_add_u32 s62, s62, s47
s_lshl_b32 s47, s58, 15
s_add_u32 s62, s62, s47
s_cmp_eq_u32 s59, 0
s_cselect_b32 s47, 16777216, 0
s_cselect_b32 s48, 0, 33554432
s_cselect_b32 s63, 4096, 0
s_cselect_b32 s49, 0, 1024
s_cselect_b32 s64, 0xffff9400, 0
s_cselect_b32 s65, 0, 1024
s_add_u32 s62, s62, s47
s_add_u32 s62, s62, s48
s_add_u32 s63, s63, s49
s_add_u32 s64, s64, s65
s_lshl_b32 s72, s3, 18
s_lshl_b32 s47, s44, 8
s_add_u32 s72, s72, s47
s_mov_b32 s61, 4
s_waitcnt vmcnt(22) lgkmcnt(0)
s_barrier
ds_read_b128 a[160:163], v25 offset:4096
ds_read_b128 a[164:167], v25 offset:5120
s_cmp_eq_u32 s59, 0
s_cbranch_scc0 M_V
ds_read_b128 a[0:3], v12 offset:0
ds_read_b64_tr_b16 a[32:33], v14 offset:0
ds_read_b64_tr_b16 a[34:35], v14 offset:1024
ds_read_b128 a[4:7], v12 offset:2048
ds_read_b64_tr_b16 a[36:37], v15 offset:0
ds_read_b64_tr_b16 a[38:39], v15 offset:1024
ds_read_b128 a[8:11], v12 offset:4096
ds_read_b64_tr_b16 a[40:41], v16 offset:0
ds_read_b64_tr_b16 a[42:43], v16 offset:1024
ds_read_b128 a[12:15], v12 offset:6144
ds_read_b64_tr_b16 a[44:45], v17 offset:0
ds_read_b64_tr_b16 a[46:47], v17 offset:1024
ds_read_b128 a[16:19], v12 offset:8192
ds_read_b64_tr_b16 a[48:49], v18 offset:0
ds_read_b64_tr_b16 a[50:51], v18 offset:1024
ds_read_b128 a[20:23], v12 offset:10240
ds_read_b64_tr_b16 a[52:53], v19 offset:0
ds_read_b64_tr_b16 a[54:55], v19 offset:1024
ds_read_b128 a[24:27], v12 offset:12288
ds_read_b64_tr_b16 a[56:57], v20 offset:0
ds_read_b64_tr_b16 a[58:59], v20 offset:1024
ds_read_b128 a[28:31], v12 offset:14336
ds_read_b64_tr_b16 a[60:61], v21 offset:0
ds_read_b64_tr_b16 a[62:63], v21 offset:1024
s_waitcnt lgkmcnt(0)
v_mfma_f32_16x16x32_bf16 v[32:35], a[32:35], a[0:3], 0
ds_read_b128 a[64:67], v13 offset:0
v_mfma_f32_16x16x32_bf16 v[36:39], a[32:35], a[4:7], 0
ds_read_b64_tr_b16 a[96:97], v14 offset:8192
v_mfma_f32_16x16x32_bf16 v[40:43], a[32:35], a[8:11], 0
ds_read_b64_tr_b16 a[98:99], v14 offset:9216
v_mfma_f32_16x16x32_bf16 v[44:47], a[32:35], a[12:15], 0
ds_read_b128 a[68:71], v13 offset:2048
v_mfma_f32_16x16x32_bf16 v[48:51], a[32:35], a[16:19], 0
ds_read_b64_tr_b16 a[100:101], v15 offset:8192
v_mfma_f32_16x16x32_bf16 v[52:55], a[32:35], a[20:23], 0
buffer_store_dwordx4 a[160:163], v24, s[28:31], s68 offen sc1
v_mfma_f32_16x16x32_bf16 v[56:59], a[32:35], a[24:27], 0
v_mfma_f32_16x16x32_bf16 v[60:63], a[32:35], a[28:31], 0
ds_read_b64_tr_b16 a[102:103], v15 offset:9216
v_mfma_f32_16x16x32_bf16 v[64:67], a[36:39], a[0:3], 0
v_mfma_f32_16x16x32_bf16 v[68:71], a[36:39], a[4:7], 0
ds_read_b128 a[72:75], v13 offset:4096
v_mfma_f32_16x16x32_bf16 v[72:75], a[36:39], a[8:11], 0
ds_read_b64_tr_b16 a[104:105], v16 offset:8192
v_mfma_f32_16x16x32_bf16 v[76:79], a[36:39], a[12:15], 0
v_mfma_f32_16x16x32_bf16 v[80:83], a[36:39], a[16:19], 0
ds_read_b64_tr_b16 a[106:107], v16 offset:9216
v_mfma_f32_16x16x32_bf16 v[84:87], a[36:39], a[20:23], 0
buffer_store_dwordx4 a[164:167], v24, s[28:31], s68 offen offset:2048 sc1
v_mfma_f32_16x16x32_bf16 v[88:91], a[36:39], a[24:27], 0
v_mfma_f32_16x16x32_bf16 v[92:95], a[36:39], a[28:31], 0
ds_read_b128 a[76:79], v13 offset:6144
v_mfma_f32_16x16x32_bf16 v[96:99], a[40:43], a[0:3], 0
ds_read_b64_tr_b16 a[108:109], v17 offset:8192
v_mfma_f32_16x16x32_bf16 v[100:103], a[40:43], a[4:7], 0
v_mfma_f32_16x16x32_bf16 v[104:107], a[40:43], a[8:11], 0
ds_read_b64_tr_b16 a[110:111], v17 offset:9216
v_mfma_f32_16x16x32_bf16 v[108:111], a[40:43], a[12:15], 0
ds_read_b128 a[80:83], v13 offset:8192
v_mfma_f32_16x16x32_bf16 v[112:115], a[40:43], a[16:19], 0
v_mfma_f32_16x16x32_bf16 v[116:119], a[40:43], a[20:23], 0
ds_read_b64_tr_b16 a[112:113], v18 offset:8192
v_mfma_f32_16x16x32_bf16 v[120:123], a[40:43], a[24:27], 0
v_mfma_f32_16x16x32_bf16 v[124:127], a[40:43], a[28:31], 0
ds_read_b64_tr_b16 a[114:115], v18 offset:9216
v_mfma_f32_16x16x32_bf16 v[128:131], a[44:47], a[0:3], 0
ds_read_b128 a[84:87], v13 offset:10240
v_mfma_f32_16x16x32_bf16 v[132:135], a[44:47], a[4:7], 0
v_mfma_f32_16x16x32_bf16 v[136:139], a[44:47], a[8:11], 0
ds_read_b64_tr_b16 a[116:117], v19 offset:8192
v_mfma_f32_16x16x32_bf16 v[140:143], a[44:47], a[12:15], 0
ds_read_b64_tr_b16 a[118:119], v19 offset:9216
v_mfma_f32_16x16x32_bf16 v[144:147], a[44:47], a[16:19], 0
v_mfma_f32_16x16x32_bf16 v[148:151], a[44:47], a[20:23], 0
ds_read_b128 a[88:91], v13 offset:12288
v_mfma_f32_16x16x32_bf16 v[152:155], a[44:47], a[24:27], 0
ds_read_b64_tr_b16 a[120:121], v20 offset:8192
v_mfma_f32_16x16x32_bf16 v[156:159], a[44:47], a[28:31], 0
v_mfma_f32_16x16x32_bf16 v[160:163], a[48:51], a[0:3], 0
ds_read_b64_tr_b16 a[122:123], v20 offset:9216
v_mfma_f32_16x16x32_bf16 v[164:167], a[48:51], a[4:7], 0
ds_read_b128 a[92:95], v13 offset:14336
v_mfma_f32_16x16x32_bf16 v[168:171], a[48:51], a[8:11], 0
v_mfma_f32_16x16x32_bf16 v[172:175], a[48:51], a[12:15], 0
ds_read_b64_tr_b16 a[124:125], v21 offset:8192
v_mfma_f32_16x16x32_bf16 v[176:179], a[48:51], a[16:19], 0
ds_read_b64_tr_b16 a[126:127], v21 offset:9216
v_mfma_f32_16x16x32_bf16 v[180:183], a[48:51], a[20:23], 0
v_mfma_f32_16x16x32_bf16 v[184:187], a[48:51], a[24:27], 0
v_mfma_f32_16x16x32_bf16 v[188:191], a[48:51], a[28:31], 0
v_mfma_f32_16x16x32_bf16 v[192:195], a[52:55], a[0:3], 0
v_mfma_f32_16x16x32_bf16 v[196:199], a[52:55], a[4:7], 0
buffer_load_dword a252, v29, s[24:27], 0 offen
v_mfma_f32_16x16x32_bf16 v[200:203], a[52:55], a[8:11], 0
v_mfma_f32_16x16x32_bf16 v[204:207], a[52:55], a[12:15], 0
v_add_u32 v29, s67, v29
v_mfma_f32_16x16x32_bf16 v[208:211], a[52:55], a[16:19], 0
v_mfma_f32_16x16x32_bf16 v[212:215], a[52:55], a[20:23], 0
v_mfma_f32_16x16x32_bf16 v[216:219], a[52:55], a[24:27], 0
v_xor_b32 v12, 0x10000, v12
v_xor_b32 v13, 0x10000, v13
v_mfma_f32_16x16x32_bf16 v[220:223], a[52:55], a[28:31], 0
v_xor_b32 v14, 0x10000, v14
v_mfma_f32_16x16x32_bf16 v[224:227], a[56:59], a[0:3], 0
v_mfma_f32_16x16x32_bf16 v[228:231], a[56:59], a[4:7], 0
v_xor_b32 v15, 0x10000, v15
v_mfma_f32_16x16x32_bf16 v[232:235], a[56:59], a[8:11], 0
v_xor_b32 v16, 0x10000, v16
v_mfma_f32_16x16x32_bf16 v[236:239], a[56:59], a[12:15], 0
v_mfma_f32_16x16x32_bf16 v[240:243], a[56:59], a[16:19], 0
v_xor_b32 v17, 0x10000, v17
v_mfma_f32_16x16x32_bf16 v[244:247], a[56:59], a[20:23], 0
v_xor_b32 v18, 0x10000, v18
v_mfma_f32_16x16x32_bf16 v[248:251], a[56:59], a[24:27], 0
v_mfma_f32_16x16x32_bf16 v[252:255], a[56:59], a[28:31], 0
v_xor_b32 v19, 0x10000, v19
v_mfma_f32_16x16x32_bf16 a[128:131], a[60:63], a[0:3], 0
v_mfma_f32_16x16x32_bf16 a[132:135], a[60:63], a[4:7], 0
v_xor_b32 v20, 0x10000, v20
v_mfma_f32_16x16x32_bf16 a[136:139], a[60:63], a[8:11], 0
v_xor_b32 v21, 0x10000, v21
v_mfma_f32_16x16x32_bf16 a[140:143], a[60:63], a[12:15], 0
v_mfma_f32_16x16x32_bf16 a[144:147], a[60:63], a[16:19], 0
v_mfma_f32_16x16x32_bf16 a[148:151], a[60:63], a[20:23], 0
v_mfma_f32_16x16x32_bf16 a[152:155], a[60:63], a[24:27], 0
v_mfma_f32_16x16x32_bf16 a[156:159], a[60:63], a[28:31], 0
s_waitcnt vmcnt(5) lgkmcnt(0)
s_barrier
v_mfma_f32_16x16x32_bf16 v[32:35], a[96:99], a[64:67], v[32:35]
ds_read_b128 a[0:3], v12 offset:0
s_add_u32 m0, s55, 0
v_mfma_f32_16x16x32_bf16 v[36:39], a[96:99], a[68:71], v[36:39]
buffer_load_dwordx4 v4, s[12:15], s50 offen offset:0 lds
v_mfma_f32_16x16x32_bf16 v[40:43], a[96:99], a[72:75], v[40:43]
ds_read_b64_tr_b16 a[32:33], v14 offset:0
v_mfma_f32_16x16x32_bf16 v[44:47], a[96:99], a[76:79], v[44:47]
ds_read_b64_tr_b16 a[34:35], v14 offset:1024
v_mfma_f32_16x16x32_bf16 v[48:51], a[96:99], a[80:83], v[48:51]
buffer_load_dwordx4 v5, s[12:15], s50 offen offset:1024 lds
v_mfma_f32_16x16x32_bf16 v[52:55], a[96:99], a[84:87], v[52:55]
ds_read_b128 a[4:7], v12 offset:2048
v_mfma_f32_16x16x32_bf16 v[56:59], a[96:99], a[88:91], v[56:59]
ds_read_b64_tr_b16 a[36:37], v15 offset:0
v_mfma_f32_16x16x32_bf16 v[60:63], a[96:99], a[92:95], v[60:63]
ds_read_b64_tr_b16 a[38:39], v15 offset:1024
v_mfma_f32_16x16x32_bf16 v[64:67], a[100:103], a[64:67], v[64:67]
buffer_load_dwordx4 v6, s[12:15], s50 offen offset:2048 lds
v_mfma_f32_16x16x32_bf16 v[68:71], a[100:103], a[68:71], v[68:71]
v_mfma_f32_16x16x32_bf16 v[72:75], a[100:103], a[72:75], v[72:75]
ds_read_b128 a[8:11], v12 offset:4096
v_mfma_f32_16x16x32_bf16 v[76:79], a[100:103], a[76:79], v[76:79]
ds_read_b64_tr_b16 a[40:41], v16 offset:0
v_mfma_f32_16x16x32_bf16 v[80:83], a[100:103], a[80:83], v[80:83]
buffer_load_dwordx4 v7, s[12:15], s50 offen offset:3072 lds
v_mfma_f32_16x16x32_bf16 v[84:87], a[100:103], a[84:87], v[84:87]
ds_read_b64_tr_b16 a[42:43], v16 offset:1024
v_mfma_f32_16x16x32_bf16 v[88:91], a[100:103], a[88:91], v[88:91]
ds_read_b128 a[12:15], v12 offset:6144
v_mfma_f32_16x16x32_bf16 v[92:95], a[100:103], a[92:95], v[92:95]
s_add_u32 m0, s55, 32768
v_mfma_f32_16x16x32_bf16 v[96:99], a[104:107], a[64:67], v[96:99]
buffer_load_dwordx4 v8, s[16:19], s52 offen offset:0 lds
v_mfma_f32_16x16x32_bf16 v[100:103], a[104:107], a[68:71], v[100:103]
v_mfma_f32_16x16x32_bf16 v[104:107], a[104:107], a[72:75], v[104:107]
ds_read_b64_tr_b16 a[44:45], v17 offset:0
v_mfma_f32_16x16x32_bf16 v[108:111], a[104:107], a[76:79], v[108:111]
buffer_load_dwordx4 v9, s[16:19], s52 offen offset:1024 lds
v_mfma_f32_16x16x32_bf16 v[112:115], a[104:107], a[80:83], v[112:115]
ds_read_b64_tr_b16 a[46:47], v17 offset:1024
v_mfma_f32_16x16x32_bf16 v[116:119], a[104:107], a[84:87], v[116:119]
ds_read_b128 a[16:19], v12 offset:8192
v_mfma_f32_16x16x32_bf16 v[120:123], a[104:107], a[88:91], v[120:123]
ds_read_b64_tr_b16 a[48:49], v18 offset:0
v_mfma_f32_16x16x32_bf16 v[124:127], a[104:107], a[92:95], v[124:127]
buffer_load_dwordx4 v10, s[16:19], s52 offen offset:2048 lds
v_mfma_f32_16x16x32_bf16 v[128:131], a[108:111], a[64:67], v[128:131]
ds_read_b64_tr_b16 a[50:51], v18 offset:1024
v_mfma_f32_16x16x32_bf16 v[132:135], a[108:111], a[68:71], v[132:135]
ds_read_b128 a[20:23], v12 offset:10240
v_mfma_f32_16x16x32_bf16 v[136:139], a[108:111], a[72:75], v[136:139]
v_mfma_f32_16x16x32_bf16 v[140:143], a[108:111], a[76:79], v[140:143]
buffer_load_dwordx4 v11, s[16:19], s52 offen offset:3072 lds
v_mfma_f32_16x16x32_bf16 v[144:147], a[108:111], a[80:83], v[144:147]
ds_read_b64_tr_b16 a[52:53], v19 offset:0
v_mfma_f32_16x16x32_bf16 v[148:151], a[108:111], a[84:87], v[148:151]
ds_read_b64_tr_b16 a[54:55], v19 offset:1024
v_mfma_f32_16x16x32_bf16 v[152:155], a[108:111], a[88:91], v[152:155]
s_add_u32 m0, s55, 4096
v_mfma_f32_16x16x32_bf16 v[156:159], a[108:111], a[92:95], v[156:159]
buffer_load_dwordx4 v4, s[12:15], s51 offen offset:0 lds
v_mfma_f32_16x16x32_bf16 v[160:163], a[112:115], a[64:67], v[160:163]
ds_read_b128 a[24:27], v12 offset:12288
v_mfma_f32_16x16x32_bf16 v[164:167], a[112:115], a[68:71], v[164:167]
ds_read_b64_tr_b16 a[56:57], v20 offset:0
v_mfma_f32_16x16x32_bf16 v[168:171], a[112:115], a[72:75], v[168:171]
buffer_load_dwordx4 v5, s[12:15], s51 offen offset:1024 lds
v_mfma_f32_16x16x32_bf16 v[172:175], a[112:115], a[76:79], v[172:175]
v_mfma_f32_16x16x32_bf16 v[176:179], a[112:115], a[80:83], v[176:179]
ds_read_b64_tr_b16 a[58:59], v20 offset:1024
v_mfma_f32_16x16x32_bf16 v[180:183], a[112:115], a[84:87], v[180:183]
ds_read_b128 a[28:31], v12 offset:14336
v_mfma_f32_16x16x32_bf16 v[184:187], a[112:115], a[88:91], v[184:187]
buffer_load_dwordx4 v6, s[12:15], s51 offen offset:2048 lds
v_mfma_f32_16x16x32_bf16 v[188:191], a[112:115], a[92:95], v[188:191]
ds_read_b64_tr_b16 a[60:61], v21 offset:0
v_mfma_f32_16x16x32_bf16 v[192:195], a[116:119], a[64:67], v[192:195]
ds_read_b64_tr_b16 a[62:63], v21 offset:1024
v_mfma_f32_16x16x32_bf16 v[196:199], a[116:119], a[68:71], v[196:199]
v_mfma_f32_16x16x32_bf16 v[200:203], a[116:119], a[72:75], v[200:203]
buffer_load_dwordx4 v7, s[12:15], s51 offen offset:3072 lds
v_mfma_f32_16x16x32_bf16 v[204:207], a[116:119], a[76:79], v[204:207]
v_mfma_f32_16x16x32_bf16 v[208:211], a[116:119], a[80:83], v[208:211]
v_mfma_f32_16x16x32_bf16 v[212:215], a[116:119], a[84:87], v[212:215]
s_add_u32 m0, s55, 36864
v_mfma_f32_16x16x32_bf16 v[216:219], a[116:119], a[88:91], v[216:219]
buffer_load_dwordx4 v8, s[16:19], s53 offen offset:0 lds
v_mfma_f32_16x16x32_bf16 v[220:223], a[116:119], a[92:95], v[220:223]
v_mfma_f32_16x16x32_bf16 v[224:227], a[120:123], a[64:67], v[224:227]
v_mfma_f32_16x16x32_bf16 v[228:231], a[120:123], a[68:71], v[228:231]
buffer_load_dwordx4 v9, s[16:19], s53 offen offset:1024 lds
v_mfma_f32_16x16x32_bf16 v[232:235], a[120:123], a[72:75], v[232:235]
v_mfma_f32_16x16x32_bf16 v[236:239], a[120:123], a[76:79], v[236:239]
v_mfma_f32_16x16x32_bf16 v[240:243], a[120:123], a[80:83], v[240:243]
v_mfma_f32_16x16x32_bf16 v[244:247], a[120:123], a[84:87], v[244:247]
buffer_load_dwordx4 v10, s[16:19], s53 offen offset:2048 lds
v_mfma_f32_16x16x32_bf16 v[248:251], a[120:123], a[88:91], v[248:251]
v_mfma_f32_16x16x32_bf16 v[252:255], a[120:123], a[92:95], v[252:255]
v_mfma_f32_16x16x32_bf16 a[128:131], a[124:127], a[64:67], a[128:131]
v_mfma_f32_16x16x32_bf16 a[132:135], a[124:127], a[68:71], a[132:135]
buffer_load_dwordx4 v11, s[16:19], s53 offen offset:3072 lds
v_mfma_f32_16x16x32_bf16 a[136:139], a[124:127], a[72:75], a[136:139]
v_mfma_f32_16x16x32_bf16 a[140:143], a[124:127], a[76:79], a[140:143]
v_mfma_f32_16x16x32_bf16 a[144:147], a[124:127], a[80:83], a[144:147]
v_mfma_f32_16x16x32_bf16 a[148:151], a[124:127], a[84:87], a[148:151]
s_add_u32 s50, s50, 128
s_add_u32 s51, s51, 128
v_mfma_f32_16x16x32_bf16 a[152:155], a[124:127], a[88:91], a[152:155]
s_add_u32 s52, s52, 0x80000
s_add_u32 s53, s53, 0x80000
v_mfma_f32_16x16x32_bf16 a[156:159], a[124:127], a[92:95], a[156:159]
s_xor_b32 s55, s55, 0x10000
.p2align 6
M_LOOPK:
s_waitcnt lgkmcnt(0)
v_mfma_f32_16x16x32_bf16 v[32:35], a[32:35], a[0:3], v[32:35]
ds_read_b128 a[64:67], v13 offset:0
v_mfma_f32_16x16x32_bf16 v[36:39], a[32:35], a[4:7], v[36:39]
ds_read_b64_tr_b16 a[96:97], v14 offset:8192
v_mfma_f32_16x16x32_bf16 v[40:43], a[32:35], a[8:11], v[40:43]
ds_read_b64_tr_b16 a[98:99], v14 offset:9216
v_mfma_f32_16x16x32_bf16 v[44:47], a[32:35], a[12:15], v[44:47]
ds_read_b128 a[68:71], v13 offset:2048
v_mfma_f32_16x16x32_bf16 v[48:51], a[32:35], a[16:19], v[48:51]
ds_read_b64_tr_b16 a[100:101], v15 offset:8192
v_mfma_f32_16x16x32_bf16 v[52:55], a[32:35], a[20:23], v[52:55]
ds_read_b64_tr_b16 a[102:103], v15 offset:9216
v_mfma_f32_16x16x32_bf16 v[56:59], a[32:35], a[24:27], v[56:59]
ds_read_b128 a[72:75], v13 offset:4096
v_mfma_f32_16x16x32_bf16 v[60:63], a[32:35], a[28:31], v[60:63]
v_mfma_f32_16x16x32_bf16 v[64:67], a[36:39], a[0:3], v[64:67]
ds_read_b64_tr_b16 a[104:105], v16 offset:8192
v_mfma_f32_16x16x32_bf16 v[68:71], a[36:39], a[4:7], v[68:71]
ds_read_b64_tr_b16 a[106:107], v16 offset:9216
v_mfma_f32_16x16x32_bf16 v[72:75], a[36:39], a[8:11], v[72:75]
v_mfma_f32_16x16x32_bf16 v[76:79], a[36:39], a[12:15], v[76:79]
ds_read_b128 a[76:79], v13 offset:6144
v_mfma_f32_16x16x32_bf16 v[80:83], a[36:39], a[16:19], v[80:83]
ds_read_b64_tr_b16 a[108:109], v17 offset:8192
v_mfma_f32_16x16x32_bf16 v[84:87], a[36:39], a[20:23], v[84:87]
ds_read_b64_tr_b16 a[110:111], v17 offset:9216
v_mfma_f32_16x16x32_bf16 v[88:91], a[36:39], a[24:27], v[88:91]
v_mfma_f32_16x16x32_bf16 v[92:95], a[36:39], a[28:31], v[92:95]
ds_read_b128 a[80:83], v13 offset:8192
v_mfma_f32_16x16x32_bf16 v[96:99], a[40:43], a[0:3], v[96:99]
ds_read_b64_tr_b16 a[112:113], v18 offset:8192
v_mfma_f32_16x16x32_bf16 v[100:103], a[40:43], a[4:7], v[100:103]
ds_read_b64_tr_b16 a[114:115], v18 offset:9216
v_mfma_f32_16x16x32_bf16 v[104:107], a[40:43], a[8:11], v[104:107]
v_mfma_f32_16x16x32_bf16 v[108:111], a[40:43], a[12:15], v[108:111]
ds_read_b128 a[84:87], v13 offset:10240
v_mfma_f32_16x16x32_bf16 v[112:115], a[40:43], a[16:19], v[112:115]
ds_read_b64_tr_b16 a[116:117], v19 offset:8192
v_mfma_f32_16x16x32_bf16 v[116:119], a[40:43], a[20:23], v[116:119]
v_mfma_f32_16x16x32_bf16 v[120:123], a[40:43], a[24:27], v[120:123]
ds_read_b64_tr_b16 a[118:119], v19 offset:9216
v_mfma_f32_16x16x32_bf16 v[124:127], a[40:43], a[28:31], v[124:127]
ds_read_b128 a[88:91], v13 offset:12288
v_mfma_f32_16x16x32_bf16 v[128:131], a[44:47], a[0:3], v[128:131]
ds_read_b64_tr_b16 a[120:121], v20 offset:8192
v_mfma_f32_16x16x32_bf16 v[132:135], a[44:47], a[4:7], v[132:135]
v_mfma_f32_16x16x32_bf16 v[136:139], a[44:47], a[8:11], v[136:139]
ds_read_b64_tr_b16 a[122:123], v20 offset:9216
v_mfma_f32_16x16x32_bf16 v[140:143], a[44:47], a[12:15], v[140:143]
ds_read_b128 a[92:95], v13 offset:14336
v_mfma_f32_16x16x32_bf16 v[144:147], a[44:47], a[16:19], v[144:147]
s_mov_b32 m0, s75
v_mfma_f32_16x16x32_bf16 v[148:151], a[44:47], a[20:23], v[148:151]
v_mfma_f32_16x16x32_bf16 v[152:155], a[44:47], a[24:27], v[152:155]
buffer_load_dwordx4 v4, s[20:23], s69 offen lds
v_mfma_f32_16x16x32_bf16 v[156:159], a[44:47], a[28:31], v[156:159]
ds_read_b64_tr_b16 a[124:125], v21 offset:8192
v_mfma_f32_16x16x32_bf16 v[160:163], a[48:51], a[0:3], v[160:163]
s_add_u32 s75, s75, 1024
v_mfma_f32_16x16x32_bf16 v[164:167], a[48:51], a[4:7], v[164:167]
v_mfma_f32_16x16x32_bf16 v[168:171], a[48:51], a[8:11], v[168:171]
s_add_u32 s69, s69, 8192
v_mfma_f32_16x16x32_bf16 v[172:175], a[48:51], a[12:15], v[172:175]
ds_read_b64_tr_b16 a[126:127], v21 offset:9216
v_mfma_f32_16x16x32_bf16 v[176:179], a[48:51], a[16:19], v[176:179]
s_min_u32 s69, s69, s60
v_mfma_f32_16x16x32_bf16 v[180:183], a[48:51], a[20:23], v[180:183]
v_mfma_f32_16x16x32_bf16 v[184:187], a[48:51], a[24:27], v[184:187]
v_mfma_f32_16x16x32_bf16 v[188:191], a[48:51], a[28:31], v[188:191]
v_mfma_f32_16x16x32_bf16 v[192:195], a[52:55], a[0:3], v[192:195]
v_mfma_f32_16x16x32_bf16 v[196:199], a[52:55], a[4:7], v[196:199]
buffer_load_dword a252, v29, s[24:27], 0 offen
v_mfma_f32_16x16x32_bf16 v[200:203], a[52:55], a[8:11], v[200:203]
s_cmp_eq_u32 s61, s73
s_cselect_b32 s74, 0, 0x40000000
v_mfma_f32_16x16x32_bf16 v[204:207], a[52:55], a[12:15], v[204:207]
v_add_u32 v29, s67, v29
v_mfma_f32_16x16x32_bf16 v[208:211], a[52:55], a[16:19], v[208:211]
v_or_b32 v28, s74, v30
v_mfma_f32_16x16x32_bf16 v[212:215], a[52:55], a[20:23], v[212:215]
buffer_store_byte v31, v28, s[36:39], s2 offen sc1
v_mfma_f32_16x16x32_bf16 v[216:219], a[52:55], a[24:27], v[216:219]
v_xor_b32 v12, 0x10000, v12
v_xor_b32 v13, 0x10000, v13
v_mfma_f32_16x16x32_bf16 v[220:223], a[52:55], a[28:31], v[220:223]
v_xor_b32 v14, 0x10000, v14
v_mfma_f32_16x16x32_bf16 v[224:227], a[56:59], a[0:3], v[224:227]
v_mfma_f32_16x16x32_bf16 v[228:231], a[56:59], a[4:7], v[228:231]
v_xor_b32 v15, 0x10000, v15
v_mfma_f32_16x16x32_bf16 v[232:235], a[56:59], a[8:11], v[232:235]
v_xor_b32 v16, 0x10000, v16
v_mfma_f32_16x16x32_bf16 v[236:239], a[56:59], a[12:15], v[236:239]
v_mfma_f32_16x16x32_bf16 v[240:243], a[56:59], a[16:19], v[240:243]
v_xor_b32 v17, 0x10000, v17
v_mfma_f32_16x16x32_bf16 v[244:247], a[56:59], a[20:23], v[244:247]
v_xor_b32 v18, 0x10000, v18
v_mfma_f32_16x16x32_bf16 v[248:251], a[56:59], a[24:27], v[248:251]
v_mfma_f32_16x16x32_bf16 v[252:255], a[56:59], a[28:31], v[252:255]
v_xor_b32 v19, 0x10000, v19
v_mfma_f32_16x16x32_bf16 a[128:131], a[60:63], a[0:3], a[128:131]
v_mfma_f32_16x16x32_bf16 a[132:135], a[60:63], a[4:7], a[132:135]
v_xor_b32 v20, 0x10000, v20
v_mfma_f32_16x16x32_bf16 a[136:139], a[60:63], a[8:11], a[136:139]
v_xor_b32 v21, 0x10000, v21
v_mfma_f32_16x16x32_bf16 a[140:143], a[60:63], a[12:15], a[140:143]
v_mfma_f32_16x16x32_bf16 a[144:147], a[60:63], a[16:19], a[144:147]
v_mfma_f32_16x16x32_bf16 a[148:151], a[60:63], a[20:23], a[148:151]
v_mfma_f32_16x16x32_bf16 a[152:155], a[60:63], a[24:27], a[152:155]
v_mfma_f32_16x16x32_bf16 a[156:159], a[60:63], a[28:31], a[156:159]
s_waitcnt vmcnt(3) lgkmcnt(0)
s_barrier
v_mfma_f32_16x16x32_bf16 v[32:35], a[96:99], a[64:67], v[32:35]
ds_read_b128 a[0:3], v12 offset:0
s_add_u32 m0, s55, 0
v_mfma_f32_16x16x32_bf16 v[36:39], a[96:99], a[68:71], v[36:39]
buffer_load_dwordx4 v4, s[12:15], s50 offen offset:0 lds
v_mfma_f32_16x16x32_bf16 v[40:43], a[96:99], a[72:75], v[40:43]
ds_read_b64_tr_b16 a[32:33], v14 offset:0
v_mfma_f32_16x16x32_bf16 v[44:47], a[96:99], a[76:79], v[44:47]
ds_read_b64_tr_b16 a[34:35], v14 offset:1024
v_mfma_f32_16x16x32_bf16 v[48:51], a[96:99], a[80:83], v[48:51]
buffer_load_dwordx4 v5, s[12:15], s50 offen offset:1024 lds
v_mfma_f32_16x16x32_bf16 v[52:55], a[96:99], a[84:87], v[52:55]
ds_read_b128 a[4:7], v12 offset:2048
v_mfma_f32_16x16x32_bf16 v[56:59], a[96:99], a[88:91], v[56:59]
ds_read_b64_tr_b16 a[36:37], v15 offset:0
v_mfma_f32_16x16x32_bf16 v[60:63], a[96:99], a[92:95], v[60:63]
ds_read_b64_tr_b16 a[38:39], v15 offset:1024
v_mfma_f32_16x16x32_bf16 v[64:67], a[100:103], a[64:67], v[64:67]
buffer_load_dwordx4 v6, s[12:15], s50 offen offset:2048 lds
v_mfma_f32_16x16x32_bf16 v[68:71], a[100:103], a[68:71], v[68:71]
v_mfma_f32_16x16x32_bf16 v[72:75], a[100:103], a[72:75], v[72:75]
ds_read_b128 a[8:11], v12 offset:4096
v_mfma_f32_16x16x32_bf16 v[76:79], a[100:103], a[76:79], v[76:79]
ds_read_b64_tr_b16 a[40:41], v16 offset:0
v_mfma_f32_16x16x32_bf16 v[80:83], a[100:103], a[80:83], v[80:83]
buffer_load_dwordx4 v7, s[12:15], s50 offen offset:3072 lds
v_mfma_f32_16x16x32_bf16 v[84:87], a[100:103], a[84:87], v[84:87]
ds_read_b64_tr_b16 a[42:43], v16 offset:1024
v_mfma_f32_16x16x32_bf16 v[88:91], a[100:103], a[88:91], v[88:91]
ds_read_b128 a[12:15], v12 offset:6144
v_mfma_f32_16x16x32_bf16 v[92:95], a[100:103], a[92:95], v[92:95]
s_add_u32 m0, s55, 32768
v_mfma_f32_16x16x32_bf16 v[96:99], a[104:107], a[64:67], v[96:99]
buffer_load_dwordx4 v8, s[16:19], s52 offen offset:0 lds
v_mfma_f32_16x16x32_bf16 v[100:103], a[104:107], a[68:71], v[100:103]
v_mfma_f32_16x16x32_bf16 v[104:107], a[104:107], a[72:75], v[104:107]
ds_read_b64_tr_b16 a[44:45], v17 offset:0
v_mfma_f32_16x16x32_bf16 v[108:111], a[104:107], a[76:79], v[108:111]
buffer_load_dwordx4 v9, s[16:19], s52 offen offset:1024 lds
v_mfma_f32_16x16x32_bf16 v[112:115], a[104:107], a[80:83], v[112:115]
ds_read_b64_tr_b16 a[46:47], v17 offset:1024
v_mfma_f32_16x16x32_bf16 v[116:119], a[104:107], a[84:87], v[116:119]
ds_read_b128 a[16:19], v12 offset:8192
v_mfma_f32_16x16x32_bf16 v[120:123], a[104:107], a[88:91], v[120:123]
ds_read_b64_tr_b16 a[48:49], v18 offset:0
v_mfma_f32_16x16x32_bf16 v[124:127], a[104:107], a[92:95], v[124:127]
buffer_load_dwordx4 v10, s[16:19], s52 offen offset:2048 lds
v_mfma_f32_16x16x32_bf16 v[128:131], a[108:111], a[64:67], v[128:131]
ds_read_b64_tr_b16 a[50:51], v18 offset:1024
v_mfma_f32_16x16x32_bf16 v[132:135], a[108:111], a[68:71], v[132:135]
ds_read_b128 a[20:23], v12 offset:10240
v_mfma_f32_16x16x32_bf16 v[136:139], a[108:111], a[72:75], v[136:139]
v_mfma_f32_16x16x32_bf16 v[140:143], a[108:111], a[76:79], v[140:143]
buffer_load_dwordx4 v11, s[16:19], s52 offen offset:3072 lds
v_mfma_f32_16x16x32_bf16 v[144:147], a[108:111], a[80:83], v[144:147]
ds_read_b64_tr_b16 a[52:53], v19 offset:0
v_mfma_f32_16x16x32_bf16 v[148:151], a[108:111], a[84:87], v[148:151]
ds_read_b64_tr_b16 a[54:55], v19 offset:1024
v_mfma_f32_16x16x32_bf16 v[152:155], a[108:111], a[88:91], v[152:155]
s_add_u32 m0, s55, 4096
v_mfma_f32_16x16x32_bf16 v[156:159], a[108:111], a[92:95], v[156:159]
buffer_load_dwordx4 v4, s[12:15], s51 offen offset:0 lds
v_mfma_f32_16x16x32_bf16 v[160:163], a[112:115], a[64:67], v[160:163]
ds_read_b128 a[24:27], v12 offset:12288
v_mfma_f32_16x16x32_bf16 v[164:167], a[112:115], a[68:71], v[164:167]
ds_read_b64_tr_b16 a[56:57], v20 offset:0
v_mfma_f32_16x16x32_bf16 v[168:171], a[112:115], a[72:75], v[168:171]
buffer_load_dwordx4 v5, s[12:15], s51 offen offset:1024 lds
v_mfma_f32_16x16x32_bf16 v[172:175], a[112:115], a[76:79], v[172:175]
v_mfma_f32_16x16x32_bf16 v[176:179], a[112:115], a[80:83], v[176:179]
ds_read_b64_tr_b16 a[58:59], v20 offset:1024
v_mfma_f32_16x16x32_bf16 v[180:183], a[112:115], a[84:87], v[180:183]
ds_read_b128 a[28:31], v12 offset:14336
v_mfma_f32_16x16x32_bf16 v[184:187], a[112:115], a[88:91], v[184:187]
buffer_load_dwordx4 v6, s[12:15], s51 offen offset:2048 lds
v_mfma_f32_16x16x32_bf16 v[188:191], a[112:115], a[92:95], v[188:191]
ds_read_b64_tr_b16 a[60:61], v21 offset:0
v_mfma_f32_16x16x32_bf16 v[192:195], a[116:119], a[64:67], v[192:195]
ds_read_b64_tr_b16 a[62:63], v21 offset:1024
v_mfma_f32_16x16x32_bf16 v[196:199], a[116:119], a[68:71], v[196:199]
v_mfma_f32_16x16x32_bf16 v[200:203], a[116:119], a[72:75], v[200:203]
buffer_load_dwordx4 v7, s[12:15], s51 offen offset:3072 lds
v_mfma_f32_16x16x32_bf16 v[204:207], a[116:119], a[76:79], v[204:207]
v_mfma_f32_16x16x32_bf16 v[208:211], a[116:119], a[80:83], v[208:211]
v_mfma_f32_16x16x32_bf16 v[212:215], a[116:119], a[84:87], v[212:215]
s_add_u32 m0, s55, 36864
v_mfma_f32_16x16x32_bf16 v[216:219], a[116:119], a[88:91], v[216:219]
buffer_load_dwordx4 v8, s[16:19], s53 offen offset:0 lds
v_mfma_f32_16x16x32_bf16 v[220:223], a[116:119], a[92:95], v[220:223]
v_mfma_f32_16x16x32_bf16 v[224:227], a[120:123], a[64:67], v[224:227]
v_mfma_f32_16x16x32_bf16 v[228:231], a[120:123], a[68:71], v[228:231]
buffer_load_dwordx4 v9, s[16:19], s53 offen offset:1024 lds
v_mfma_f32_16x16x32_bf16 v[232:235], a[120:123], a[72:75], v[232:235]
v_mfma_f32_16x16x32_bf16 v[236:239], a[120:123], a[76:79], v[236:239]
v_mfma_f32_16x16x32_bf16 v[240:243], a[120:123], a[80:83], v[240:243]
v_mfma_f32_16x16x32_bf16 v[244:247], a[120:123], a[84:87], v[244:247]
buffer_load_dwordx4 v10, s[16:19], s53 offen offset:2048 lds
v_mfma_f32_16x16x32_bf16 v[248:251], a[120:123], a[88:91], v[248:251]
v_mfma_f32_16x16x32_bf16 v[252:255], a[120:123], a[92:95], v[252:255]
v_mfma_f32_16x16x32_bf16 a[128:131], a[124:127], a[64:67], a[128:131]
v_mfma_f32_16x16x32_bf16 a[132:135], a[124:127], a[68:71], a[132:135]
buffer_load_dwordx4 v11, s[16:19], s53 offen offset:3072 lds
v_mfma_f32_16x16x32_bf16 a[136:139], a[124:127], a[72:75], a[136:139]
v_mfma_f32_16x16x32_bf16 a[140:143], a[124:127], a[76:79], a[140:143]
v_mfma_f32_16x16x32_bf16 a[144:147], a[124:127], a[80:83], a[144:147]
v_mfma_f32_16x16x32_bf16 a[148:151], a[124:127], a[84:87], a[148:151]
s_add_u32 s50, s50, 128
s_add_u32 s51, s51, 128
v_mfma_f32_16x16x32_bf16 a[152:155], a[124:127], a[88:91], a[152:155]
s_add_u32 s52, s52, 0x80000
s_add_u32 s53, s53, 0x80000
v_mfma_f32_16x16x32_bf16 a[156:159], a[124:127], a[92:95], a[156:159]
s_xor_b32 s55, s55, 0x10000
s_add_u32 s61, s61, -1
s_cbranch_scc1 M_LOOPK
s_waitcnt lgkmcnt(0)
v_mfma_f32_16x16x32_bf16 v[32:35], a[32:35], a[0:3], v[32:35]
ds_read_b64_tr_b16 a[160:161], v22 offset:0
ds_read_b64_tr_b16 a[162:163], v22 offset:2048
v_mfma_f32_16x16x32_bf16 v[36:39], a[32:35], a[4:7], v[36:39]
ds_read_b64_tr_b16 a[164:165], v22 offset:8
ds_read_b64_tr_b16 a[166:167], v22 offset:2056
v_mfma_f32_16x16x32_bf16 v[40:43], a[32:35], a[8:11], v[40:43]
buffer_load_dword v28, v2, s[36:39], 0 offen sc1
ds_read_b64_tr_b16 a[168:169], v23 offset:0
ds_read_b64_tr_b16 a[170:171], v23 offset:2048
v_mfma_f32_16x16x32_bf16 v[44:47], a[32:35], a[12:15], v[44:47]
ds_read_b64_tr_b16 a[172:173], v23 offset:8
ds_read_b64_tr_b16 a[174:175], v23 offset:2056
v_mfma_f32_16x16x32_bf16 v[48:51], a[32:35], a[16:19], v[48:51]
v_mfma_f32_16x16x32_bf16 v[52:55], a[32:35], a[20:23], v[52:55]
v_mfma_f32_16x16x32_bf16 v[56:59], a[32:35], a[24:27], v[56:59]
ds_read_b128 a[64:67], v13 offset:0
ds_read_b64_tr_b16 a[96:97], v14 offset:8192
v_mfma_f32_16x16x32_bf16 v[60:63], a[32:35], a[28:31], v[60:63]
ds_read_b64_tr_b16 a[98:99], v14 offset:9216
ds_read_b128 a[68:71], v13 offset:2048
v_mfma_f32_16x16x32_bf16 v[64:67], a[36:39], a[0:3], v[64:67]
ds_read_b64_tr_b16 a[100:101], v15 offset:8192
v_mfma_f32_16x16x32_bf16 v[68:71], a[36:39], a[4:7], v[68:71]
ds_read_b64_tr_b16 a[102:103], v15 offset:9216
v_mfma_f32_16x16x32_bf16 v[72:75], a[36:39], a[8:11], v[72:75]
ds_read_b128 a[72:75], v13 offset:4096
v_mfma_f32_16x16x32_bf16 v[76:79], a[36:39], a[12:15], v[76:79]
s_waitcnt lgkmcnt(6)
v_mfma_f32_16x16x32_bf16 v[80:83], a[36:39], a[16:19], v[80:83]
ds_read_b64_tr_b16 a[104:105], v16 offset:8192
v_mfma_f32_16x16x32_bf16 v[84:87], a[36:39], a[20:23], v[84:87]
buffer_store_dwordx4 a[160:163], v3, s[28:31], s66 offen sc1
v_mfma_f32_16x16x32_bf16 v[88:91], a[36:39], a[24:27], v[88:91]
ds_read_b64_tr_b16 a[106:107], v16 offset:9216
v_mfma_f32_16x16x32_bf16 v[92:95], a[36:39], a[28:31], v[92:95]
ds_read_b128 a[76:79], v13 offset:6144
v_mfma_f32_16x16x32_bf16 v[96:99], a[40:43], a[0:3], v[96:99]
s_add_u32 s66, s66, 131072
v_mfma_f32_16x16x32_bf16 v[100:103], a[40:43], a[4:7], v[100:103]
buffer_store_dwordx4 a[164:167], v3, s[28:31], s66 offen sc1
v_mfma_f32_16x16x32_bf16 v[104:107], a[40:43], a[8:11], v[104:107]
ds_read_b64_tr_b16 a[108:109], v17 offset:8192
v_mfma_f32_16x16x32_bf16 v[108:111], a[40:43], a[12:15], v[108:111]
ds_read_b64_tr_b16 a[110:111], v17 offset:9216
v_mfma_f32_16x16x32_bf16 v[112:115], a[40:43], a[16:19], v[112:115]
s_add_u32 s66, s66, 131072
v_mfma_f32_16x16x32_bf16 v[116:119], a[40:43], a[20:23], v[116:119]
buffer_store_dwordx4 a[168:171], v3, s[28:31], s66 offen sc1
v_mfma_f32_16x16x32_bf16 v[120:123], a[40:43], a[24:27], v[120:123]
ds_read_b128 a[80:83], v13 offset:8192
v_mfma_f32_16x16x32_bf16 v[124:127], a[40:43], a[28:31], v[124:127]
ds_read_b64_tr_b16 a[112:113], v18 offset:8192
v_mfma_f32_16x16x32_bf16 v[128:131], a[44:47], a[0:3], v[128:131]
s_add_u32 s66, s66, 131072
v_mfma_f32_16x16x32_bf16 v[132:135], a[44:47], a[4:7], v[132:135]
buffer_store_dwordx4 a[172:175], v3, s[28:31], s66 offen sc1
v_mfma_f32_16x16x32_bf16 v[136:139], a[44:47], a[8:11], v[136:139]
ds_read_b64_tr_b16 a[114:115], v18 offset:9216
v_mfma_f32_16x16x32_bf16 v[140:143], a[44:47], a[12:15], v[140:143]
ds_read_b128 a[84:87], v13 offset:10240
v_mfma_f32_16x16x32_bf16 v[144:147], a[44:47], a[16:19], v[144:147]
s_add_u32 m0, s54, 131072
s_add_u32 s73, s72, 0
v_mfma_f32_16x16x32_bf16 v[148:151], a[44:47], a[20:23], v[148:151]
buffer_load_dwordx4 v8, s[32:35], s73 offen offset:0 lds
v_mfma_f32_16x16x32_bf16 v[152:155], a[44:47], a[24:27], v[152:155]
v_mfma_f32_16x16x32_bf16 v[156:159], a[44:47], a[28:31], v[156:159]
ds_read_b64_tr_b16 a[116:117], v19 offset:8192
v_mfma_f32_16x16x32_bf16 v[160:163], a[48:51], a[0:3], v[160:163]
ds_read_b64_tr_b16 a[118:119], v19 offset:9216
v_mfma_f32_16x16x32_bf16 v[164:167], a[48:51], a[4:7], v[164:167]
buffer_load_dwordx4 v9, s[32:35], s73 offen offset:1024 lds
v_mfma_f32_16x16x32_bf16 v[168:171], a[48:51], a[8:11], v[168:171]
ds_read_b128 a[88:91], v13 offset:12288
v_mfma_f32_16x16x32_bf16 v[172:175], a[48:51], a[12:15], v[172:175]
ds_read_b64_tr_b16 a[120:121], v20 offset:8192
v_mfma_f32_16x16x32_bf16 v[176:179], a[48:51], a[16:19], v[176:179]
ds_read_b64_tr_b16 a[122:123], v20 offset:9216
v_mfma_f32_16x16x32_bf16 v[180:183], a[48:51], a[20:23], v[180:183]
buffer_load_dwordx4 v10, s[32:35], s73 offen offset:2048 lds
v_mfma_f32_16x16x32_bf16 v[184:187], a[48:51], a[24:27], v[184:187]
ds_read_b128 a[92:95], v13 offset:14336
v_mfma_f32_16x16x32_bf16 v[188:191], a[48:51], a[28:31], v[188:191]
ds_read_b64_tr_b16 a[124:125], v21 offset:8192
v_mfma_f32_16x16x32_bf16 v[192:195], a[52:55], a[0:3], v[192:195]
ds_read_b64_tr_b16 a[126:127], v21 offset:9216
v_mfma_f32_16x16x32_bf16 v[196:199], a[52:55], a[4:7], v[196:199]
buffer_load_dwordx4 v11, s[32:35], s73 offen offset:3072 lds
v_mfma_f32_16x16x32_bf16 v[200:203], a[52:55], a[8:11], v[200:203]
v_mfma_f32_16x16x32_bf16 v[204:207], a[52:55], a[12:15], v[204:207]
v_mfma_f32_16x16x32_bf16 v[208:211], a[52:55], a[16:19], v[208:211]
s_add_u32 m0, s54, 135168
s_add_u32 s73, s72, 131072
v_mfma_f32_16x16x32_bf16 v[212:215], a[52:55], a[20:23], v[212:215]
buffer_load_dwordx4 v8, s[32:35], s73 offen offset:0 lds
v_mfma_f32_16x16x32_bf16 v[216:219], a[52:55], a[24:27], v[216:219]
v_xor_b32 v12, 0x10000, v12
v_xor_b32 v13, 0x10000, v13
v_mfma_f32_16x16x32_bf16 v[220:223], a[52:55], a[28:31], v[220:223]
v_xor_b32 v14, 0x10000, v14
v_mfma_f32_16x16x32_bf16 v[224:227], a[56:59], a[0:3], v[224:227]
v_xor_b32 v15, 0x10000, v15
v_mfma_f32_16x16x32_bf16 v[228:231], a[56:59], a[4:7], v[228:231]
buffer_load_dwordx4 v9, s[32:35], s73 offen offset:1024 lds
v_mfma_f32_16x16x32_bf16 v[232:235], a[56:59], a[8:11], v[232:235]
v_xor_b32 v16, 0x10000, v16
v_mfma_f32_16x16x32_bf16 v[236:239], a[56:59], a[12:15], v[236:239]
v_mfma_f32_16x16x32_bf16 v[240:243], a[56:59], a[16:19], v[240:243]
v_xor_b32 v17, 0x10000, v17
v_mfma_f32_16x16x32_bf16 v[244:247], a[56:59], a[20:23], v[244:247]
buffer_load_dwordx4 v10, s[32:35], s73 offen offset:2048 lds
v_mfma_f32_16x16x32_bf16 v[248:251], a[56:59], a[24:27], v[248:251]
v_xor_b32 v18, 0x10000, v18
v_mfma_f32_16x16x32_bf16 v[252:255], a[56:59], a[28:31], v[252:255]
v_xor_b32 v19, 0x10000, v19
v_mfma_f32_16x16x32_bf16 a[128:131], a[60:63], a[0:3], a[128:131]
v_mfma_f32_16x16x32_bf16 a[132:135], a[60:63], a[4:7], a[132:135]
buffer_load_dwordx4 v11, s[32:35], s73 offen offset:3072 lds
v_mfma_f32_16x16x32_bf16 a[136:139], a[60:63], a[8:11], a[136:139]
v_xor_b32 v20, 0x10000, v20
v_mfma_f32_16x16x32_bf16 a[140:143], a[60:63], a[12:15], a[140:143]
v_xor_b32 v21, 0x10000, v21
v_mfma_f32_16x16x32_bf16 a[144:147], a[60:63], a[16:19], a[144:147]
v_mfma_f32_16x16x32_bf16 a[148:151], a[60:63], a[20:23], a[148:151]
v_mfma_f32_16x16x32_bf16 a[152:155], a[60:63], a[24:27], a[152:155]
v_mfma_f32_16x16x32_bf16 a[156:159], a[60:63], a[28:31], a[156:159]
s_waitcnt vmcnt(12) lgkmcnt(0)
v_and_b32 v29, 0x10101010, v28
v_cmp_eq_u32 vcc, 0x10101010, v29
s_or_b64 vcc, vcc, s[96:97]
s_cmp_eq_u64 vcc, -1
s_cbranch_scc0 M_SPINLNK
M_SRETLNK:
s_barrier
v_mfma_f32_16x16x32_bf16 v[32:35], a[96:99], a[64:67], v[32:35]
s_add_u32 m0, s54, 0
s_add_u32 s73, s72, 1048576
v_mfma_f32_16x16x32_bf16 v[36:39], a[96:99], a[68:71], v[36:39]
buffer_load_dwordx4 v8, s[32:35], s73 offen offset:0 lds
v_mfma_f32_16x16x32_bf16 v[40:43], a[96:99], a[72:75], v[40:43]
ds_read_b128 a[0:3], v12 offset:0
v_mfma_f32_16x16x32_bf16 v[44:47], a[96:99], a[76:79], v[44:47]
ds_read_b64_tr_b16 a[32:33], v14 offset:0
v_mfma_f32_16x16x32_bf16 v[48:51], a[96:99], a[80:83], v[48:51]
buffer_load_dwordx4 v9, s[32:35], s73 offen offset:1024 lds
v_mfma_f32_16x16x32_bf16 v[52:55], a[96:99], a[84:87], v[52:55]
ds_read_b64_tr_b16 a[34:35], v14 offset:1024
v_mfma_f32_16x16x32_bf16 v[56:59], a[96:99], a[88:91], v[56:59]
ds_read_b128 a[4:7], v12 offset:2048
v_mfma_f32_16x16x32_bf16 v[60:63], a[96:99], a[92:95], v[60:63]
ds_read_b64_tr_b16 a[36:37], v15 offset:0
v_mfma_f32_16x16x32_bf16 v[64:67], a[100:103], a[64:67], v[64:67]
buffer_load_dwordx4 v10, s[32:35], s73 offen offset:2048 lds
v_mfma_f32_16x16x32_bf16 v[68:71], a[100:103], a[68:71], v[68:71]
ds_read_b64_tr_b16 a[38:39], v15 offset:1024
v_mfma_f32_16x16x32_bf16 v[72:75], a[100:103], a[72:75], v[72:75]
ds_read_b128 a[8:11], v12 offset:4096
v_mfma_f32_16x16x32_bf16 v[76:79], a[100:103], a[76:79], v[76:79]
ds_read_b64_tr_b16 a[40:41], v16 offset:0
v_mfma_f32_16x16x32_bf16 v[80:83], a[100:103], a[80:83], v[80:83]
buffer_load_dwordx4 v11, s[32:35], s73 offen offset:3072 lds
v_mfma_f32_16x16x32_bf16 v[84:87], a[100:103], a[84:87], v[84:87]
ds_read_b64_tr_b16 a[42:43], v16 offset:1024
v_mfma_f32_16x16x32_bf16 v[88:91], a[100:103], a[88:91], v[88:91]
ds_read_b128 a[12:15], v12 offset:6144
v_mfma_f32_16x16x32_bf16 v[92:95], a[100:103], a[92:95], v[92:95]
s_add_u32 m0, s54, 4096
s_add_u32 s73, s72, 1179648
v_mfma_f32_16x16x32_bf16 v[96:99], a[104:107], a[64:67], v[96:99]
buffer_load_dwordx4 v8, s[32:35], s73 offen offset:0 lds
v_mfma_f32_16x16x32_bf16 v[100:103], a[104:107], a[68:71], v[100:103]
v_mfma_f32_16x16x32_bf16 v[104:107], a[104:107], a[72:75], v[104:107]
ds_read_b64_tr_b16 a[44:45], v17 offset:0
v_mfma_f32_16x16x32_bf16 v[108:111], a[104:107], a[76:79], v[108:111]
ds_read_b64_tr_b16 a[46:47], v17 offset:1024
v_mfma_f32_16x16x32_bf16 v[112:115], a[104:107], a[80:83], v[112:115]
buffer_load_dwordx4 v9, s[32:35], s73 offen offset:1024 lds
v_mfma_f32_16x16x32_bf16 v[116:119], a[104:107], a[84:87], v[116:119]
ds_read_b128 a[16:19], v12 offset:8192
v_mfma_f32_16x16x32_bf16 v[120:123], a[104:107], a[88:91], v[120:123]
v_mfma_f32_16x16x32_bf16 v[124:127], a[104:107], a[92:95], v[124:127]
ds_read_b64_tr_b16 a[48:49], v18 offset:0
v_mfma_f32_16x16x32_bf16 v[128:131], a[108:111], a[64:67], v[128:131]
buffer_load_dwordx4 v10, s[32:35], s73 offen offset:2048 lds
v_mfma_f32_16x16x32_bf16 v[132:135], a[108:111], a[68:71], v[132:135]
ds_read_b64_tr_b16 a[50:51], v18 offset:1024
v_mfma_f32_16x16x32_bf16 v[136:139], a[108:111], a[72:75], v[136:139]
ds_read_b128 a[20:23], v12 offset:10240
v_mfma_f32_16x16x32_bf16 v[140:143], a[108:111], a[76:79], v[140:143]
ds_read_b64_tr_b16 a[52:53], v19 offset:0
v_mfma_f32_16x16x32_bf16 v[144:147], a[108:111], a[80:83], v[144:147]
buffer_load_dwordx4 v11, s[32:35], s73 offen offset:3072 lds
v_mfma_f32_16x16x32_bf16 v[148:151], a[108:111], a[84:87], v[148:151]
ds_read_b64_tr_b16 a[54:55], v19 offset:1024
v_mfma_f32_16x16x32_bf16 v[152:155], a[108:111], a[88:91], v[152:155]
ds_read_b128 a[24:27], v12 offset:12288
v_mfma_f32_16x16x32_bf16 v[156:159], a[108:111], a[92:95], v[156:159]
s_add_u32 m0, s54, 32768
s_add_u32 s73, s72, 2097152
v_mfma_f32_16x16x32_bf16 v[160:163], a[112:115], a[64:67], v[160:163]
buffer_load_dwordx4 v8, s[32:35], s73 offen offset:0 lds
v_mfma_f32_16x16x32_bf16 v[164:167], a[112:115], a[68:71], v[164:167]
v_mfma_f32_16x16x32_bf16 v[168:171], a[112:115], a[72:75], v[168:171]
ds_read_b64_tr_b16 a[56:57], v20 offset:0
v_mfma_f32_16x16x32_bf16 v[172:175], a[112:115], a[76:79], v[172:175]
buffer_load_dwordx4 v9, s[32:35], s73 offen offset:1024 lds
v_mfma_f32_16x16x32_bf16 v[176:179], a[112:115], a[80:83], v[176:179]
ds_read_b64_tr_b16 a[58:59], v20 offset:1024
v_mfma_f32_16x16x32_bf16 v[180:183], a[112:115], a[84:87], v[180:183]
ds_read_b128 a[28:31], v12 offset:14336
v_mfma_f32_16x16x32_bf16 v[184:187], a[112:115], a[88:91], v[184:187]
ds_read_b64_tr_b16 a[60:61], v21 offset:0
v_mfma_f32_16x16x32_bf16 v[188:191], a[112:115], a[92:95], v[188:191]
buffer_load_dwordx4 v10, s[32:35], s73 offen offset:2048 lds
v_mfma_f32_16x16x32_bf16 v[192:195], a[116:119], a[64:67], v[192:195]
ds_read_b64_tr_b16 a[62:63], v21 offset:1024
s_sub_u32 s48, 15, s45
v_mfma_f32_16x16x32_bf16 v[196:199], a[116:119], a[68:71], v[196:199]
s_lshl_b32 s48, s48, 3
s_mov_b32 s47, s3
v_mfma_f32_16x16x32_bf16 v[200:203], a[116:119], a[72:75], v[200:203]
s_add_u32 s75, s48, s47
s_lshl_b32 s48, s45, 3
v_mfma_f32_16x16x32_bf16 v[204:207], a[116:119], a[76:79], v[204:207]
buffer_load_dwordx4 v11, s[32:35], s73 offen offset:3072 lds
v_mfma_f32_16x16x32_bf16 v[208:211], a[116:119], a[80:83], v[208:211]
s_add_u32 s76, s48, s47
s_lshl_b32 s47, s75, 14
v_mfma_f32_16x16x32_bf16 v[212:215], a[116:119], a[84:87], v[212:215]
v_add_u32 v4, s47, v3
v_mfma_f32_16x16x32_bf16 v[216:219], a[116:119], a[88:91], v[216:219]
s_add_u32 m0, s54, 36864
s_add_u32 s73, s72, 2228224
v_mfma_f32_16x16x32_bf16 v[220:223], a[116:119], a[92:95], v[220:223]
buffer_load_dwordx4 v8, s[32:35], s73 offen offset:0 lds
v_mfma_f32_16x16x32_bf16 v[224:227], a[120:123], a[64:67], v[224:227]
v_add_u32 v5, 0x10000, v4
s_lshl_b32 s48, s76, 14
v_mfma_f32_16x16x32_bf16 v[228:231], a[120:123], a[68:71], v[228:231]
v_add_u32 v6, s48, v3
v_mfma_f32_16x16x32_bf16 v[232:235], a[120:123], a[72:75], v[232:235]
v_add_u32 v7, 0x10000, v6
s_mov_b32 s68, 4096
v_mfma_f32_16x16x32_bf16 v[236:239], a[120:123], a[76:79], v[236:239]
buffer_load_dwordx4 v9, s[32:35], s73 offen offset:1024 lds
v_mfma_f32_16x16x32_bf16 v[240:243], a[120:123], a[80:83], v[240:243]
s_mov_b32 s69, 8192
v_mfma_f32_16x16x32_bf16 v[244:247], a[120:123], a[84:87], v[244:247]
s_mov_b32 s74, 12288
s_and_b32 s47, s42, 3
v_mfma_f32_16x16x32_bf16 v[248:251], a[120:123], a[88:91], v[248:251]
s_lshl_b32 s47, s47, 3
v_mfma_f32_16x16x32_bf16 v[252:255], a[120:123], a[92:95], v[252:255]
buffer_load_dwordx4 v10, s[32:35], s73 offen offset:2048 lds
v_bfe_u32 v29, v28, s47, 8
v_mfma_f32_16x16x32_bf16 a[128:131], a[124:127], a[64:67], a[128:131]
s_and_b32 s47, s43, 3
v_mfma_f32_16x16x32_bf16 a[132:135], a[124:127], a[68:71], a[132:135]
s_lshl_b32 s47, s47, 1
s_lshr_b32 s48, s42, 2
v_mfma_f32_16x16x32_bf16 a[136:139], a[124:127], a[72:75], a[136:139]
s_add_u32 s47, s47, s48
v_mfma_f32_16x16x32_bf16 a[140:143], a[124:127], a[76:79], a[140:143]
buffer_load_dwordx4 v11, s[32:35], s73 offen offset:3072 lds
v_cmp_eq_u32 s[78:79], s70, v29
v_mfma_f32_16x16x32_bf16 a[144:147], a[124:127], a[80:83], a[144:147]
s_lshl_b32 s77, 0x01010101, s47
v_mfma_f32_16x16x32_bf16 a[148:151], a[124:127], a[84:87], a[148:151]
v_mfma_f32_16x16x32_bf16 a[152:155], a[124:127], a[88:91], a[152:155]
v_mfma_f32_16x16x32_bf16 a[156:159], a[124:127], a[92:95], a[156:159]
s_waitcnt lgkmcnt(0)
v_mfma_f32_16x16x32_bf16 v[32:35], a[32:35], a[0:3], v[32:35]
ds_read_b128 a[64:67], v13 offset:0
ds_read_b64_tr_b16 a[96:97], v14 offset:8192
v_mfma_f32_16x16x32_bf16 v[36:39], a[32:35], a[4:7], v[36:39]
buffer_load_dwordx4 a[160:163], v4, s[28:31], 0 offen offset:0 sc1
v_mfma_f32_16x16x32_bf16 v[40:43], a[32:35], a[8:11], v[40:43]
ds_read_b64_tr_b16 a[98:99], v14 offset:9216
v_mfma_f32_16x16x32_bf16 v[44:47], a[32:35], a[12:15], v[44:47]
ds_read_b128 a[68:71], v13 offset:2048
v_mfma_f32_16x16x32_bf16 v[48:51], a[32:35], a[16:19], v[48:51]
buffer_load_dwordx4 a[164:167], v5, s[28:31], 0 offen offset:0 sc1
v_mfma_f32_16x16x32_bf16 v[52:55], a[32:35], a[20:23], v[52:55]
ds_read_b64_tr_b16 a[100:101], v15 offset:8192
v_mfma_f32_16x16x32_bf16 v[56:59], a[32:35], a[24:27], v[56:59]
ds_read_b64_tr_b16 a[102:103], v15 offset:9216
v_mfma_f32_16x16x32_bf16 v[60:63], a[32:35], a[28:31], v[60:63]
ds_read_b128 a[72:75], v13 offset:4096
v_mfma_f32_16x16x32_bf16 v[64:67], a[36:39], a[0:3], v[64:67]
buffer_load_dwordx4 a[168:171], v6, s[28:31], 0 offen offset:0 sc1
v_mfma_f32_16x16x32_bf16 v[68:71], a[36:39], a[4:7], v[68:71]
v_mfma_f32_16x16x32_bf16 v[72:75], a[36:39], a[8:11], v[72:75]
ds_read_b64_tr_b16 a[104:105], v16 offset:8192
v_mfma_f32_16x16x32_bf16 v[76:79], a[36:39], a[12:15], v[76:79]
ds_read_b64_tr_b16 a[106:107], v16 offset:9216
v_mfma_f32_16x16x32_bf16 v[80:83], a[36:39], a[16:19], v[80:83]
buffer_load_dwordx4 a[172:175], v7, s[28:31], 0 offen offset:0 sc1
v_mfma_f32_16x16x32_bf16 v[84:87], a[36:39], a[20:23], v[84:87]
ds_read_b128 a[76:79], v13 offset:6144
v_mfma_f32_16x16x32_bf16 v[88:91], a[36:39], a[24:27], v[88:91]
ds_read_b64_tr_b16 a[108:109], v17 offset:8192
v_mfma_f32_16x16x32_bf16 v[92:95], a[36:39], a[28:31], v[92:95]
ds_read_b64_tr_b16 a[110:111], v17 offset:9216
v_mfma_f32_16x16x32_bf16 v[96:99], a[40:43], a[0:3], v[96:99]
buffer_load_dwordx4 a[176:179], v4, s[28:31], 0 offen offset:1024 sc1
v_mfma_f32_16x16x32_bf16 v[100:103], a[40:43], a[4:7], v[100:103]
v_mfma_f32_16x16x32_bf16 v[104:107], a[40:43], a[8:11], v[104:107]
ds_read_b128 a[80:83], v13 offset:8192
v_mfma_f32_16x16x32_bf16 v[108:111], a[40:43], a[12:15], v[108:111]
ds_read_b64_tr_b16 a[112:113], v18 offset:8192
v_mfma_f32_16x16x32_bf16 v[112:115], a[40:43], a[16:19], v[112:115]
buffer_load_dwordx4 a[180:183], v5, s[28:31], 0 offen offset:1024 sc1
v_mfma_f32_16x16x32_bf16 v[116:119], a[40:43], a[20:23], v[116:119]
ds_read_b64_tr_b16 a[114:115], v18 offset:9216
v_mfma_f32_16x16x32_bf16 v[120:123], a[40:43], a[24:27], v[120:123]
ds_read_b128 a[84:87], v13 offset:10240
v_mfma_f32_16x16x32_bf16 v[124:127], a[40:43], a[28:31], v[124:127]
ds_read_b64_tr_b16 a[116:117], v19 offset:8192
v_mfma_f32_16x16x32_bf16 v[128:131], a[44:47], a[0:3], v[128:131]
buffer_load_dwordx4 a[184:187], v6, s[28:31], 0 offen offset:1024 sc1
v_mfma_f32_16x16x32_bf16 v[132:135], a[44:47], a[4:7], v[132:135]
v_mfma_f32_16x16x32_bf16 v[136:139], a[44:47], a[8:11], v[136:139]
ds_read_b64_tr_b16 a[118:119], v19 offset:9216
v_mfma_f32_16x16x32_bf16 v[140:143], a[44:47], a[12:15], v[140:143]
ds_read_b128 a[88:91], v13 offset:12288
v_mfma_f32_16x16x32_bf16 v[144:147], a[44:47], a[16:19], v[144:147]
buffer_load_dwordx4 a[188:191], v7, s[28:31], 0 offen offset:1024 sc1
v_mfma_f32_16x16x32_bf16 v[148:151], a[44:47], a[20:23], v[148:151]
ds_read_b64_tr_b16 a[120:121], v20 offset:8192
v_mfma_f32_16x16x32_bf16 v[152:155], a[44:47], a[24:27], v[152:155]
ds_read_b64_tr_b16 a[122:123], v20 offset:9216
v_mfma_f32_16x16x32_bf16 v[156:159], a[44:47], a[28:31], v[156:159]
ds_read_b128 a[92:95], v13 offset:14336
v_mfma_f32_16x16x32_bf16 v[160:163], a[48:51], a[0:3], v[160:163]
buffer_load_dwordx4 a[192:195], v4, s[28:31], 0 offen offset:2048 sc1
v_mfma_f32_16x16x32_bf16 v[164:167], a[48:51], a[4:7], v[164:167]
v_mfma_f32_16x16x32_bf16 v[168:171], a[48:51], a[8:11], v[168:171]
ds_read_b64_tr_b16 a[124:125], v21 offset:8192
v_mfma_f32_16x16x32_bf16 v[172:175], a[48:51], a[12:15], v[172:175]
buffer_load_dwordx4 a[196:199], v5, s[28:31], 0 offen offset:2048 sc1
v_mfma_f32_16x16x32_bf16 v[176:179], a[48:51], a[16:19], v[176:179]
ds_read_b64_tr_b16 a[126:127], v21 offset:9216
v_mfma_f32_16x16x32_bf16 v[180:183], a[48:51], a[20:23], v[180:183]
v_mfma_f32_16x16x32_bf16 v[184:187], a[48:51], a[24:27], v[184:187]
v_mfma_f32_16x16x32_bf16 v[188:191], a[48:51], a[28:31], v[188:191]
buffer_load_dwordx4 a[200:203], v6, s[28:31], 0 offen offset:2048 sc1
v_mfma_f32_16x16x32_bf16 v[192:195], a[52:55], a[0:3], v[192:195]
v_mfma_f32_16x16x32_bf16 v[196:199], a[52:55], a[4:7], v[196:199]
v_mfma_f32_16x16x32_bf16 v[200:203], a[52:55], a[8:11], v[200:203]
v_mfma_f32_16x16x32_bf16 v[204:207], a[52:55], a[12:15], v[204:207]
buffer_load_dwordx4 a[204:207], v7, s[28:31], 0 offen offset:2048 sc1
v_mfma_f32_16x16x32_bf16 v[208:211], a[52:55], a[16:19], v[208:211]
v_mfma_f32_16x16x32_bf16 v[212:215], a[52:55], a[20:23], v[212:215]
v_mfma_f32_16x16x32_bf16 v[216:219], a[52:55], a[24:27], v[216:219]
v_add_u32 v14, s71, v14
v_add_u32 v15, s71, v15
v_mfma_f32_16x16x32_bf16 v[220:223], a[52:55], a[28:31], v[220:223]
buffer_load_dwordx4 a[208:211], v4, s[28:31], 0 offen offset:3072 sc1
v_mfma_f32_16x16x32_bf16 v[224:227], a[56:59], a[0:3], v[224:227]
v_add_u32 v16, s71, v16
v_mfma_f32_16x16x32_bf16 v[228:231], a[56:59], a[4:7], v[228:231]
v_add_u32 v17, s71, v17
v_mfma_f32_16x16x32_bf16 v[232:235], a[56:59], a[8:11], v[232:235]
v_mfma_f32_16x16x32_bf16 v[236:239], a[56:59], a[12:15], v[236:239]
buffer_load_dwordx4 a[212:215], v5, s[28:31], 0 offen offset:3072 sc1
v_mfma_f32_16x16x32_bf16 v[240:243], a[56:59], a[16:19], v[240:243]
v_add_u32 v18, s71, v18
v_mfma_f32_16x16x32_bf16 v[244:247], a[56:59], a[20:23], v[244:247]
v_add_u32 v19, s71, v19
v_mfma_f32_16x16x32_bf16 v[248:251], a[56:59], a[24:27], v[248:251]
v_mfma_f32_16x16x32_bf16 v[252:255], a[56:59], a[28:31], v[252:255]
buffer_load_dwordx4 a[216:219], v6, s[28:31], 0 offen offset:3072 sc1
v_mfma_f32_16x16x32_bf16 a[128:131], a[60:63], a[0:3], a[128:131]
v_add_u32 v20, s71, v20
v_mfma_f32_16x16x32_bf16 a[132:135], a[60:63], a[4:7], a[132:135]
v_add_u32 v21, s71, v21
v_mfma_f32_16x16x32_bf16 a[136:139], a[60:63], a[8:11], a[136:139]
v_mfma_f32_16x16x32_bf16 a[140:143], a[60:63], a[12:15], a[140:143]
buffer_load_dwordx4 a[220:223], v7, s[28:31], 0 offen offset:3072 sc1
v_mfma_f32_16x16x32_bf16 a[144:147], a[60:63], a[16:19], a[144:147]
v_mfma_f32_16x16x32_bf16 a[148:151], a[60:63], a[20:23], a[148:151]
v_mfma_f32_16x16x32_bf16 a[152:155], a[60:63], a[24:27], a[152:155]
v_mfma_f32_16x16x32_bf16 a[156:159], a[60:63], a[28:31], a[156:159]
s_waitcnt vmcnt(32) lgkmcnt(0)
s_barrier
v_mfma_f32_16x16x32_bf16 v[32:35], a[96:99], a[64:67], v[32:35]
s_add_u32 m0, s54, 98304
s_add_u32 s73, s72, 3145728
v_mfma_f32_16x16x32_bf16 v[36:39], a[96:99], a[68:71], v[36:39]
buffer_load_dwordx4 v8, s[32:35], s73 offen offset:0 lds
ds_read_b64_tr_b16 a[0:1], v14 offset:0
v_mfma_f32_16x16x32_bf16 v[40:43], a[96:99], a[72:75], v[40:43]
ds_read_b64_tr_b16 a[2:3], v14 offset:1024
v_mfma_f32_16x16x32_bf16 v[44:47], a[96:99], a[76:79], v[44:47]
ds_read_b64_tr_b16 a[4:5], v15 offset:0
ds_read_b64_tr_b16 a[6:7], v15 offset:1024
v_mfma_f32_16x16x32_bf16 v[48:51], a[96:99], a[80:83], v[48:51]
buffer_load_dwordx4 v9, s[32:35], s73 offen offset:1024 lds
v_mfma_f32_16x16x32_bf16 v[52:55], a[96:99], a[84:87], v[52:55]
ds_read_b64_tr_b16 a[8:9], v16 offset:0
v_mfma_f32_16x16x32_bf16 v[56:59], a[96:99], a[88:91], v[56:59]
ds_read_b64_tr_b16 a[10:11], v16 offset:1024
v_mfma_f32_16x16x32_bf16 v[60:63], a[96:99], a[92:95], v[60:63]
ds_read_b64_tr_b16 a[12:13], v17 offset:0
ds_read_b64_tr_b16 a[14:15], v17 offset:1024
v_mfma_f32_16x16x32_bf16 v[64:67], a[100:103], a[64:67], v[64:67]
buffer_load_dwordx4 v10, s[32:35], s73 offen offset:2048 lds
v_mfma_f32_16x16x32_bf16 v[68:71], a[100:103], a[68:71], v[68:71]
ds_read_b64_tr_b16 a[16:17], v18 offset:0
v_mfma_f32_16x16x32_bf16 v[72:75], a[100:103], a[72:75], v[72:75]
ds_read_b64_tr_b16 a[18:19], v18 offset:1024
v_mfma_f32_16x16x32_bf16 v[76:79], a[100:103], a[76:79], v[76:79]
ds_read_b64_tr_b16 a[20:21], v19 offset:0
ds_read_b64_tr_b16 a[22:23], v19 offset:1024
v_mfma_f32_16x16x32_bf16 v[80:83], a[100:103], a[80:83], v[80:83]
buffer_load_dwordx4 v11, s[32:35], s73 offen offset:3072 lds
v_mfma_f32_16x16x32_bf16 v[84:87], a[100:103], a[84:87], v[84:87]
ds_read_b64_tr_b16 a[24:25], v20 offset:0
v_mfma_f32_16x16x32_bf16 v[88:91], a[100:103], a[88:91], v[88:91]
ds_read_b64_tr_b16 a[26:27], v20 offset:1024
v_mfma_f32_16x16x32_bf16 v[92:95], a[100:103], a[92:95], v[92:95]
s_add_u32 m0, s54, 102400
s_add_u32 s73, s72, 3276800
v_mfma_f32_16x16x32_bf16 v[96:99], a[104:107], a[64:67], v[96:99]
buffer_load_dwordx4 v8, s[32:35], s73 offen offset:0 lds
v_mfma_f32_16x16x32_bf16 v[100:103], a[104:107], a[68:71], v[100:103]
ds_read_b64_tr_b16 a[28:29], v21 offset:0
v_mfma_f32_16x16x32_bf16 v[104:107], a[104:107], a[72:75], v[104:107]
ds_read_b64_tr_b16 a[30:31], v21 offset:1024
v_mfma_f32_16x16x32_bf16 v[108:111], a[104:107], a[76:79], v[108:111]
v_mfma_f32_16x16x32_bf16 v[112:115], a[104:107], a[80:83], v[112:115]
buffer_load_dwordx4 v9, s[32:35], s73 offen offset:1024 lds
v_mfma_f32_16x16x32_bf16 v[116:119], a[104:107], a[84:87], v[116:119]
v_cvt_pk_bf16_f32 v32, v32, v33
v_cvt_pk_bf16_f32 v33, v34, v35
v_cvt_pk_bf16_f32 v34, v64, v65
v_mfma_f32_16x16x32_bf16 v[120:123], a[104:107], a[88:91], v[120:123]
v_cvt_pk_bf16_f32 v35, v66, v67
v_cvt_pk_bf16_f32 v36, v36, v37
v_cvt_pk_bf16_f32 v37, v38, v39
v_mfma_f32_16x16x32_bf16 v[124:127], a[104:107], a[92:95], v[124:127]
v_cvt_pk_bf16_f32 v38, v68, v69
v_cvt_pk_bf16_f32 v39, v70, v71
v_mfma_f32_16x16x32_bf16 v[128:131], a[108:111], a[64:67], v[128:131]
buffer_load_dwordx4 v10, s[32:35], s73 offen offset:2048 lds
v_cvt_pk_bf16_f32 v40, v40, v41
v_cvt_pk_bf16_f32 v41, v42, v43
v_mfma_f32_16x16x32_bf16 v[132:135], a[108:111], a[68:71], v[132:135]
v_cvt_pk_bf16_f32 v42, v72, v73
v_cvt_pk_bf16_f32 v43, v74, v75
v_mfma_f32_16x16x32_bf16 v[136:139], a[108:111], a[72:75], v[136:139]
v_cvt_pk_bf16_f32 v44, v44, v45
v_cvt_pk_bf16_f32 v45, v46, v47
v_mfma_f32_16x16x32_bf16 v[140:143], a[108:111], a[76:79], v[140:143]
v_cvt_pk_bf16_f32 v46, v76, v77
v_cvt_pk_bf16_f32 v47, v78, v79
v_mfma_f32_16x16x32_bf16 v[144:147], a[108:111], a[80:83], v[144:147]
buffer_load_dwordx4 v11, s[32:35], s73 offen offset:3072 lds
v_cvt_pk_bf16_f32 v48, v48, v49
v_cvt_pk_bf16_f32 v49, v50, v51
v_mfma_f32_16x16x32_bf16 v[148:151], a[108:111], a[84:87], v[148:151]
v_cvt_pk_bf16_f32 v50, v80, v81
v_cvt_pk_bf16_f32 v51, v82, v83
v_mfma_f32_16x16x32_bf16 v[152:155], a[108:111], a[88:91], v[152:155]
v_cvt_pk_bf16_f32 v52, v52, v53
v_cvt_pk_bf16_f32 v53, v54, v55
v_mfma_f32_16x16x32_bf16 v[156:159], a[108:111], a[92:95], v[156:159]
v_cvt_pk_bf16_f32 v54, v84, v85
v_cvt_pk_bf16_f32 v55, v86, v87
v_mfma_f32_16x16x32_bf16 v[160:163], a[112:115], a[64:67], v[160:163]
buffer_load_dwordx4 a[224:227], v4, s[28:31], s68 offen offset:0 sc1
v_cvt_pk_bf16_f32 v56, v56, v57
v_cvt_pk_bf16_f32 v57, v58, v59
v_mfma_f32_16x16x32_bf16 v[164:167], a[112:115], a[68:71], v[164:167]
v_cvt_pk_bf16_f32 v58, v88, v89
v_cvt_pk_bf16_f32 v59, v90, v91
v_mfma_f32_16x16x32_bf16 v[168:171], a[112:115], a[72:75], v[168:171]
v_cvt_pk_bf16_f32 v60, v60, v61
v_cvt_pk_bf16_f32 v61, v62, v63
v_mfma_f32_16x16x32_bf16 v[172:175], a[112:115], a[76:79], v[172:175]
buffer_load_dwordx4 a[228:231], v5, s[28:31], s68 offen offset:0 sc1
v_cvt_pk_bf16_f32 v62, v92, v93
v_mfma_f32_16x16x32_bf16 v[176:179], a[112:115], a[80:83], v[176:179]
v_cvt_pk_bf16_f32 v63, v94, v95
v_mfma_f32_16x16x32_bf16 v[180:183], a[112:115], a[84:87], v[180:183]
v_cvt_pk_bf16_f32 v96, v96, v97
v_cvt_pk_bf16_f32 v97, v98, v99
v_cvt_pk_bf16_f32 v98, v128, v129
v_mfma_f32_16x16x32_bf16 v[184:187], a[112:115], a[88:91], v[184:187]
v_cvt_pk_bf16_f32 v99, v130, v131
v_cvt_pk_bf16_f32 v100, v100, v101
v_cvt_pk_bf16_f32 v101, v102, v103
v_mfma_f32_16x16x32_bf16 v[188:191], a[112:115], a[92:95], v[188:191]
buffer_load_dwordx4 a[232:235], v6, s[28:31], s68 offen offset:0 sc1
v_cvt_pk_bf16_f32 v102, v132, v133
v_mfma_f32_16x16x32_bf16 v[192:195], a[116:119], a[64:67], v[192:195]
v_cvt_pk_bf16_f32 v103, v134, v135
v_cvt_pk_bf16_f32 v104, v104, v105
v_cvt_pk_bf16_f32 v105, v106, v107
v_mfma_f32_16x16x32_bf16 v[196:199], a[116:119], a[68:71], v[196:199]
v_cvt_pk_bf16_f32 v106, v136, v137
v_cvt_pk_bf16_f32 v107, v138, v139
v_mfma_f32_16x16x32_bf16 v[200:203], a[116:119], a[72:75], v[200:203]
v_cvt_pk_bf16_f32 v108, v108, v109
v_cvt_pk_bf16_f32 v109, v110, v111
v_mfma_f32_16x16x32_bf16 v[204:207], a[116:119], a[76:79], v[204:207]
buffer_load_dwordx4 a[236:239], v7, s[28:31], s68 offen offset:0 sc1
v_cvt_pk_bf16_f32 v110, v140, v141
v_cvt_pk_bf16_f32 v111, v142, v143
v_mfma_f32_16x16x32_bf16 v[208:211], a[116:119], a[80:83], v[208:211]
v_cvt_pk_bf16_f32 v112, v112, v113
v_cvt_pk_bf16_f32 v113, v114, v115
v_mfma_f32_16x16x32_bf16 v[212:215], a[116:119], a[84:87], v[212:215]
v_cvt_pk_bf16_f32 v114, v144, v145
v_cvt_pk_bf16_f32 v115, v146, v147
v_mfma_f32_16x16x32_bf16 v[216:219], a[116:119], a[88:91], v[216:219]
v_cvt_pk_bf16_f32 v116, v116, v117
v_cvt_pk_bf16_f32 v117, v118, v119
v_cvt_pk_bf16_f32 v118, v148, v149
v_mfma_f32_16x16x32_bf16 v[220:223], a[116:119], a[92:95], v[220:223]
buffer_store_dwordx4 v[32:35], v3, s[28:31], s62 offen
v_cvt_pk_bf16_f32 v119, v150, v151
v_mfma_f32_16x16x32_bf16 v[224:227], a[120:123], a[64:67], v[224:227]
v_cvt_pk_bf16_f32 v120, v120, v121
v_cvt_pk_bf16_f32 v121, v122, v123
v_mfma_f32_16x16x32_bf16 v[228:231], a[120:123], a[68:71], v[228:231]
v_cvt_pk_bf16_f32 v122, v152, v153
v_cvt_pk_bf16_f32 v123, v154, v155
v_cvt_pk_bf16_f32 v124, v124, v125
v_mfma_f32_16x16x32_bf16 v[232:235], a[120:123], a[72:75], v[232:235]
s_add_u32 s62, s62, s63
v_cvt_pk_bf16_f32 v125, v126, v127
v_mfma_f32_16x16x32_bf16 v[236:239], a[120:123], a[76:79], v[236:239]
buffer_store_dwordx4 v[36:39], v3, s[28:31], s62 offen
v_cvt_pk_bf16_f32 v126, v156, v157
v_mfma_f32_16x16x32_bf16 v[240:243], a[120:123], a[80:83], v[240:243]
v_cvt_pk_bf16_f32 v127, v158, v159
v_mfma_f32_16x16x32_bf16 v[244:247], a[120:123], a[84:87], v[244:247]
v_cvt_pk_bf16_f32 v160, v160, v161
v_cvt_pk_bf16_f32 v161, v162, v163
v_cvt_pk_bf16_f32 v162, v192, v193
v_cvt_pk_bf16_f32 v163, v194, v195
v_mfma_f32_16x16x32_bf16 v[248:251], a[120:123], a[88:91], v[248:251]
s_add_u32 s62, s62, s63
v_cvt_pk_bf16_f32 v164, v164, v165
v_cvt_pk_bf16_f32 v165, v166, v167
v_cvt_pk_bf16_f32 v166, v196, v197
v_mfma_f32_16x16x32_bf16 v[252:255], a[120:123], a[92:95], v[252:255]
buffer_store_dwordx4 v[40:43], v3, s[28:31], s62 offen
v_cvt_pk_bf16_f32 v167, v198, v199
v_cvt_pk_bf16_f32 v168, v168, v169
v_mfma_f32_16x16x32_bf16 a[128:131], a[124:127], a[64:67], a[128:131]
v_cvt_pk_bf16_f32 v169, v170, v171
v_cvt_pk_bf16_f32 v170, v200, v201
v_cvt_pk_bf16_f32 v171, v202, v203
v_cvt_pk_bf16_f32 v172, v172, v173
v_mfma_f32_16x16x32_bf16 a[132:135], a[124:127], a[68:71], a[132:135]
v_cvt_pk_bf16_f32 v173, v174, v175
v_cvt_pk_bf16_f32 v174, v204, v205
v_cvt_pk_bf16_f32 v175, v206, v207
v_mfma_f32_16x16x32_bf16 a[136:139], a[124:127], a[72:75], a[136:139]
s_add_u32 s62, s62, s63
v_cvt_pk_bf16_f32 v176, v176, v177
v_cvt_pk_bf16_f32 v177, v178, v179
v_mfma_f32_16x16x32_bf16 a[140:143], a[124:127], a[76:79], a[140:143]
buffer_store_dwordx4 v[44:47], v3, s[28:31], s62 offen
v_cvt_pk_bf16_f32 v178, v208, v209
v_cvt_pk_bf16_f32 v179, v210, v211
v_mfma_f32_16x16x32_bf16 a[144:147], a[124:127], a[80:83], a[144:147]
v_cvt_pk_bf16_f32 v180, v180, v181
v_cvt_pk_bf16_f32 v181, v182, v183
v_cvt_pk_bf16_f32 v182, v212, v213
v_cvt_pk_bf16_f32 v183, v214, v215
v_mfma_f32_16x16x32_bf16 a[148:151], a[124:127], a[84:87], a[148:151]
v_cvt_pk_bf16_f32 v184, v184, v185
v_cvt_pk_bf16_f32 v185, v186, v187
v_cvt_pk_bf16_f32 v186, v216, v217
v_mfma_f32_16x16x32_bf16 a[152:155], a[124:127], a[88:91], a[152:155]
v_cvt_pk_bf16_f32 v187, v218, v219
v_cvt_pk_bf16_f32 v188, v188, v189
v_cvt_pk_bf16_f32 v189, v190, v191
v_mfma_f32_16x16x32_bf16 a[156:159], a[124:127], a[92:95], a[156:159]
v_cvt_pk_bf16_f32 v190, v220, v221
v_cvt_pk_bf16_f32 v191, v222, v223
s_branch M_Q
M_V:
ds_read_b128 a[0:3], v12 offset:0
ds_read_b64_tr_b16 a[32:33], v14 offset:0
ds_read_b64_tr_b16 a[34:35], v14 offset:1024
ds_read_b128 a[4:7], v12 offset:2048
ds_read_b64_tr_b16 a[36:37], v15 offset:0
ds_read_b64_tr_b16 a[38:39], v15 offset:1024
ds_read_b128 a[8:11], v12 offset:4096
ds_read_b64_tr_b16 a[40:41], v16 offset:0
ds_read_b64_tr_b16 a[42:43], v16 offset:1024
ds_read_b128 a[12:15], v12 offset:6144
ds_read_b64_tr_b16 a[44:45], v17 offset:0
ds_read_b64_tr_b16 a[46:47], v17 offset:1024
ds_read_b128 a[16:19], v12 offset:8192
ds_read_b64_tr_b16 a[48:49], v18 offset:0
ds_read_b64_tr_b16 a[50:51], v18 offset:1024
ds_read_b128 a[20:23], v12 offset:10240
ds_read_b64_tr_b16 a[52:53], v19 offset:0
ds_read_b64_tr_b16 a[54:55], v19 offset:1024
ds_read_b128 a[24:27], v12 offset:12288
ds_read_b64_tr_b16 a[56:57], v20 offset:0
ds_read_b64_tr_b16 a[58:59], v20 offset:1024
ds_read_b128 a[28:31], v12 offset:14336
ds_read_b64_tr_b16 a[60:61], v21 offset:0
ds_read_b64_tr_b16 a[62:63], v21 offset:1024
s_waitcnt lgkmcnt(0)
v_mfma_f32_16x16x32_bf16 v[32:35], a[0:3], a[32:35], 0
ds_read_b128 a[64:67], v13 offset:0
v_mfma_f32_16x16x32_bf16 v[36:39], a[0:3], a[36:39], 0
ds_read_b64_tr_b16 a[96:97], v14 offset:8192
v_mfma_f32_16x16x32_bf16 v[40:43], a[0:3], a[40:43], 0
ds_read_b64_tr_b16 a[98:99], v14 offset:9216
v_mfma_f32_16x16x32_bf16 v[44:47], a[0:3], a[44:47], 0
ds_read_b128 a[68:71], v13 offset:2048
v_mfma_f32_16x16x32_bf16 v[48:51], a[0:3], a[48:51], 0
ds_read_b64_tr_b16 a[100:101], v15 offset:8192
v_mfma_f32_16x16x32_bf16 v[52:55], a[0:3], a[52:55], 0
buffer_store_dwordx4 a[160:163], v24, s[28:31], s68 offen sc1
v_mfma_f32_16x16x32_bf16 v[56:59], a[0:3], a[56:59], 0
v_mfma_f32_16x16x32_bf16 v[60:63], a[0:3], a[60:63], 0
ds_read_b64_tr_b16 a[102:103], v15 offset:9216
v_mfma_f32_16x16x32_bf16 v[64:67], a[4:7], a[32:35], 0
v_mfma_f32_16x16x32_bf16 v[68:71], a[4:7], a[36:39], 0
ds_read_b128 a[72:75], v13 offset:4096
v_mfma_f32_16x16x32_bf16 v[72:75], a[4:7], a[40:43], 0
ds_read_b64_tr_b16 a[104:105], v16 offset:8192
v_mfma_f32_16x16x32_bf16 v[76:79], a[4:7], a[44:47], 0
v_mfma_f32_16x16x32_bf16 v[80:83], a[4:7], a[48:51], 0
ds_read_b64_tr_b16 a[106:107], v16 offset:9216
v_mfma_f32_16x16x32_bf16 v[84:87], a[4:7], a[52:55], 0
buffer_store_dwordx4 a[164:167], v24, s[28:31], s68 offen offset:2048 sc1
v_mfma_f32_16x16x32_bf16 v[88:91], a[4:7], a[56:59], 0
v_mfma_f32_16x16x32_bf16 v[92:95], a[4:7], a[60:63], 0
ds_read_b128 a[76:79], v13 offset:6144
v_mfma_f32_16x16x32_bf16 v[96:99], a[8:11], a[32:35], 0
ds_read_b64_tr_b16 a[108:109], v17 offset:8192
v_mfma_f32_16x16x32_bf16 v[100:103], a[8:11], a[36:39], 0
v_mfma_f32_16x16x32_bf16 v[104:107], a[8:11], a[40:43], 0
ds_read_b64_tr_b16 a[110:111], v17 offset:9216
v_mfma_f32_16x16x32_bf16 v[108:111], a[8:11], a[44:47], 0
ds_read_b128 a[80:83], v13 offset:8192
v_mfma_f32_16x16x32_bf16 v[112:115], a[8:11], a[48:51], 0
v_mfma_f32_16x16x32_bf16 v[116:119], a[8:11], a[52:55], 0
ds_read_b64_tr_b16 a[112:113], v18 offset:8192
v_mfma_f32_16x16x32_bf16 v[120:123], a[8:11], a[56:59], 0
v_mfma_f32_16x16x32_bf16 v[124:127], a[8:11], a[60:63], 0
ds_read_b64_tr_b16 a[114:115], v18 offset:9216
v_mfma_f32_16x16x32_bf16 v[128:131], a[12:15], a[32:35], 0
ds_read_b128 a[84:87], v13 offset:10240
v_mfma_f32_16x16x32_bf16 v[132:135], a[12:15], a[36:39], 0
v_mfma_f32_16x16x32_bf16 v[136:139], a[12:15], a[40:43], 0
ds_read_b64_tr_b16 a[116:117], v19 offset:8192
v_mfma_f32_16x16x32_bf16 v[140:143], a[12:15], a[44:47], 0
ds_read_b64_tr_b16 a[118:119], v19 offset:9216
v_mfma_f32_16x16x32_bf16 v[144:147], a[12:15], a[48:51], 0
v_mfma_f32_16x16x32_bf16 v[148:151], a[12:15], a[52:55], 0
ds_read_b128 a[88:91], v13 offset:12288
v_mfma_f32_16x16x32_bf16 v[152:155], a[12:15], a[56:59], 0
ds_read_b64_tr_b16 a[120:121], v20 offset:8192
v_mfma_f32_16x16x32_bf16 v[156:159], a[12:15], a[60:63], 0
v_mfma_f32_16x16x32_bf16 v[160:163], a[16:19], a[32:35], 0
ds_read_b64_tr_b16 a[122:123], v20 offset:9216
v_mfma_f32_16x16x32_bf16 v[164:167], a[16:19], a[36:39], 0
ds_read_b128 a[92:95], v13 offset:14336
v_mfma_f32_16x16x32_bf16 v[168:171], a[16:19], a[40:43], 0
v_mfma_f32_16x16x32_bf16 v[172:175], a[16:19], a[44:47], 0
ds_read_b64_tr_b16 a[124:125], v21 offset:8192
v_mfma_f32_16x16x32_bf16 v[176:179], a[16:19], a[48:51], 0
ds_read_b64_tr_b16 a[126:127], v21 offset:9216
v_mfma_f32_16x16x32_bf16 v[180:183], a[16:19], a[52:55], 0
v_mfma_f32_16x16x32_bf16 v[184:187], a[16:19], a[56:59], 0
v_mfma_f32_16x16x32_bf16 v[188:191], a[16:19], a[60:63], 0
v_mfma_f32_16x16x32_bf16 v[192:195], a[20:23], a[32:35], 0
v_mfma_f32_16x16x32_bf16 v[196:199], a[20:23], a[36:39], 0
buffer_load_dword a252, v29, s[24:27], 0 offen
v_mfma_f32_16x16x32_bf16 v[200:203], a[20:23], a[40:43], 0
v_mfma_f32_16x16x32_bf16 v[204:207], a[20:23], a[44:47], 0
v_add_u32 v29, s67, v29
v_mfma_f32_16x16x32_bf16 v[208:211], a[20:23], a[48:51], 0
v_mfma_f32_16x16x32_bf16 v[212:215], a[20:23], a[52:55], 0
v_mfma_f32_16x16x32_bf16 v[216:219], a[20:23], a[56:59], 0
v_xor_b32 v12, 0x10000, v12
v_xor_b32 v13, 0x10000, v13
v_mfma_f32_16x16x32_bf16 v[220:223], a[20:23], a[60:63], 0
v_xor_b32 v14, 0x10000, v14
v_mfma_f32_16x16x32_bf16 v[224:227], a[24:27], a[32:35], 0
v_mfma_f32_16x16x32_bf16 v[228:231], a[24:27], a[36:39], 0
v_xor_b32 v15, 0x10000, v15
v_mfma_f32_16x16x32_bf16 v[232:235], a[24:27], a[40:43], 0
v_xor_b32 v16, 0x10000, v16
v_mfma_f32_16x16x32_bf16 v[236:239], a[24:27], a[44:47], 0
v_mfma_f32_16x16x32_bf16 v[240:243], a[24:27], a[48:51], 0
v_xor_b32 v17, 0x10000, v17
v_mfma_f32_16x16x32_bf16 v[244:247], a[24:27], a[52:55], 0
v_xor_b32 v18, 0x10000, v18
v_mfma_f32_16x16x32_bf16 v[248:251], a[24:27], a[56:59], 0
v_mfma_f32_16x16x32_bf16 v[252:255], a[24:27], a[60:63], 0
v_xor_b32 v19, 0x10000, v19
v_mfma_f32_16x16x32_bf16 a[128:131], a[28:31], a[32:35], 0
v_mfma_f32_16x16x32_bf16 a[132:135], a[28:31], a[36:39], 0
v_xor_b32 v20, 0x10000, v20
v_mfma_f32_16x16x32_bf16 a[136:139], a[28:31], a[40:43], 0
v_xor_b32 v21, 0x10000, v21
v_mfma_f32_16x16x32_bf16 a[140:143], a[28:31], a[44:47], 0
v_mfma_f32_16x16x32_bf16 a[144:147], a[28:31], a[48:51], 0
v_mfma_f32_16x16x32_bf16 a[148:151], a[28:31], a[52:55], 0
v_mfma_f32_16x16x32_bf16 a[152:155], a[28:31], a[56:59], 0
v_mfma_f32_16x16x32_bf16 a[156:159], a[28:31], a[60:63], 0
s_waitcnt vmcnt(5) lgkmcnt(0)
s_barrier
v_mfma_f32_16x16x32_bf16 v[32:35], a[64:67], a[96:99], v[32:35]
ds_read_b128 a[0:3], v12 offset:0
s_add_u32 m0, s55, 0
v_mfma_f32_16x16x32_bf16 v[36:39], a[64:67], a[100:103], v[36:39]
buffer_load_dwordx4 v4, s[12:15], s50 offen offset:0 lds
v_mfma_f32_16x16x32_bf16 v[40:43], a[64:67], a[104:107], v[40:43]
ds_read_b64_tr_b16 a[32:33], v14 offset:0
v_mfma_f32_16x16x32_bf16 v[44:47], a[64:67], a[108:111], v[44:47]
ds_read_b64_tr_b16 a[34:35], v14 offset:1024
v_mfma_f32_16x16x32_bf16 v[48:51], a[64:67], a[112:115], v[48:51]
buffer_load_dwordx4 v5, s[12:15], s50 offen offset:1024 lds
v_mfma_f32_16x16x32_bf16 v[52:55], a[64:67], a[116:119], v[52:55]
ds_read_b128 a[4:7], v12 offset:2048
v_mfma_f32_16x16x32_bf16 v[56:59], a[64:67], a[120:123], v[56:59]
ds_read_b64_tr_b16 a[36:37], v15 offset:0
v_mfma_f32_16x16x32_bf16 v[60:63], a[64:67], a[124:127], v[60:63]
ds_read_b64_tr_b16 a[38:39], v15 offset:1024
v_mfma_f32_16x16x32_bf16 v[64:67], a[68:71], a[96:99], v[64:67]
buffer_load_dwordx4 v6, s[12:15], s50 offen offset:2048 lds
v_mfma_f32_16x16x32_bf16 v[68:71], a[68:71], a[100:103], v[68:71]
v_mfma_f32_16x16x32_bf16 v[72:75], a[68:71], a[104:107], v[72:75]
ds_read_b128 a[8:11], v12 offset:4096
v_mfma_f32_16x16x32_bf16 v[76:79], a[68:71], a[108:111], v[76:79]
ds_read_b64_tr_b16 a[40:41], v16 offset:0
v_mfma_f32_16x16x32_bf16 v[80:83], a[68:71], a[112:115], v[80:83]
buffer_load_dwordx4 v7, s[12:15], s50 offen offset:3072 lds
v_mfma_f32_16x16x32_bf16 v[84:87], a[68:71], a[116:119], v[84:87]
ds_read_b64_tr_b16 a[42:43], v16 offset:1024
v_mfma_f32_16x16x32_bf16 v[88:91], a[68:71], a[120:123], v[88:91]
ds_read_b128 a[12:15], v12 offset:6144
v_mfma_f32_16x16x32_bf16 v[92:95], a[68:71], a[124:127], v[92:95]
s_add_u32 m0, s55, 32768
v_mfma_f32_16x16x32_bf16 v[96:99], a[72:75], a[96:99], v[96:99]
buffer_load_dwordx4 v8, s[16:19], s52 offen offset:0 lds
v_mfma_f32_16x16x32_bf16 v[100:103], a[72:75], a[100:103], v[100:103]
v_mfma_f32_16x16x32_bf16 v[104:107], a[72:75], a[104:107], v[104:107]
ds_read_b64_tr_b16 a[44:45], v17 offset:0
v_mfma_f32_16x16x32_bf16 v[108:111], a[72:75], a[108:111], v[108:111]
buffer_load_dwordx4 v9, s[16:19], s52 offen offset:1024 lds
v_mfma_f32_16x16x32_bf16 v[112:115], a[72:75], a[112:115], v[112:115]
ds_read_b64_tr_b16 a[46:47], v17 offset:1024
v_mfma_f32_16x16x32_bf16 v[116:119], a[72:75], a[116:119], v[116:119]
ds_read_b128 a[16:19], v12 offset:8192
v_mfma_f32_16x16x32_bf16 v[120:123], a[72:75], a[120:123], v[120:123]
ds_read_b64_tr_b16 a[48:49], v18 offset:0
v_mfma_f32_16x16x32_bf16 v[124:127], a[72:75], a[124:127], v[124:127]
buffer_load_dwordx4 v10, s[16:19], s52 offen offset:2048 lds
v_mfma_f32_16x16x32_bf16 v[128:131], a[76:79], a[96:99], v[128:131]
ds_read_b64_tr_b16 a[50:51], v18 offset:1024
v_mfma_f32_16x16x32_bf16 v[132:135], a[76:79], a[100:103], v[132:135]
ds_read_b128 a[20:23], v12 offset:10240
v_mfma_f32_16x16x32_bf16 v[136:139], a[76:79], a[104:107], v[136:139]
v_mfma_f32_16x16x32_bf16 v[140:143], a[76:79], a[108:111], v[140:143]
buffer_load_dwordx4 v11, s[16:19], s52 offen offset:3072 lds
v_mfma_f32_16x16x32_bf16 v[144:147], a[76:79], a[112:115], v[144:147]
ds_read_b64_tr_b16 a[52:53], v19 offset:0
v_mfma_f32_16x16x32_bf16 v[148:151], a[76:79], a[116:119], v[148:151]
ds_read_b64_tr_b16 a[54:55], v19 offset:1024
v_mfma_f32_16x16x32_bf16 v[152:155], a[76:79], a[120:123], v[152:155]
s_add_u32 m0, s55, 4096
v_mfma_f32_16x16x32_bf16 v[156:159], a[76:79], a[124:127], v[156:159]
buffer_load_dwordx4 v4, s[12:15], s51 offen offset:0 lds
v_mfma_f32_16x16x32_bf16 v[160:163], a[80:83], a[96:99], v[160:163]
ds_read_b128 a[24:27], v12 offset:12288
v_mfma_f32_16x16x32_bf16 v[164:167], a[80:83], a[100:103], v[164:167]
ds_read_b64_tr_b16 a[56:57], v20 offset:0
v_mfma_f32_16x16x32_bf16 v[168:171], a[80:83], a[104:107], v[168:171]
buffer_load_dwordx4 v5, s[12:15], s51 offen offset:1024 lds
v_mfma_f32_16x16x32_bf16 v[172:175], a[80:83], a[108:111], v[172:175]
v_mfma_f32_16x16x32_bf16 v[176:179], a[80:83], a[112:115], v[176:179]
ds_read_b64_tr_b16 a[58:59], v20 offset:1024
v_mfma_f32_16x16x32_bf16 v[180:183], a[80:83], a[116:119], v[180:183]
ds_read_b128 a[28:31], v12 offset:14336
v_mfma_f32_16x16x32_bf16 v[184:187], a[80:83], a[120:123], v[184:187]
buffer_load_dwordx4 v6, s[12:15], s51 offen offset:2048 lds
v_mfma_f32_16x16x32_bf16 v[188:191], a[80:83], a[124:127], v[188:191]
ds_read_b64_tr_b16 a[60:61], v21 offset:0
v_mfma_f32_16x16x32_bf16 v[192:195], a[84:87], a[96:99], v[192:195]
ds_read_b64_tr_b16 a[62:63], v21 offset:1024
v_mfma_f32_16x16x32_bf16 v[196:199], a[84:87], a[100:103], v[196:199]
v_mfma_f32_16x16x32_bf16 v[200:203], a[84:87], a[104:107], v[200:203]
buffer_load_dwordx4 v7, s[12:15], s51 offen offset:3072 lds
v_mfma_f32_16x16x32_bf16 v[204:207], a[84:87], a[108:111], v[204:207]
v_mfma_f32_16x16x32_bf16 v[208:211], a[84:87], a[112:115], v[208:211]
v_mfma_f32_16x16x32_bf16 v[212:215], a[84:87], a[116:119], v[212:215]
s_add_u32 m0, s55, 36864
v_mfma_f32_16x16x32_bf16 v[216:219], a[84:87], a[120:123], v[216:219]
buffer_load_dwordx4 v8, s[16:19], s53 offen offset:0 lds
v_mfma_f32_16x16x32_bf16 v[220:223], a[84:87], a[124:127], v[220:223]
v_mfma_f32_16x16x32_bf16 v[224:227], a[88:91], a[96:99], v[224:227]
v_mfma_f32_16x16x32_bf16 v[228:231], a[88:91], a[100:103], v[228:231]
buffer_load_dwordx4 v9, s[16:19], s53 offen offset:1024 lds
v_mfma_f32_16x16x32_bf16 v[232:235], a[88:91], a[104:107], v[232:235]
v_mfma_f32_16x16x32_bf16 v[236:239], a[88:91], a[108:111], v[236:239]
v_mfma_f32_16x16x32_bf16 v[240:243], a[88:91], a[112:115], v[240:243]
v_mfma_f32_16x16x32_bf16 v[244:247], a[88:91], a[116:119], v[244:247]
buffer_load_dwordx4 v10, s[16:19], s53 offen offset:2048 lds
v_mfma_f32_16x16x32_bf16 v[248:251], a[88:91], a[120:123], v[248:251]
v_mfma_f32_16x16x32_bf16 v[252:255], a[88:91], a[124:127], v[252:255]
v_mfma_f32_16x16x32_bf16 a[128:131], a[92:95], a[96:99], a[128:131]
v_mfma_f32_16x16x32_bf16 a[132:135], a[92:95], a[100:103], a[132:135]
buffer_load_dwordx4 v11, s[16:19], s53 offen offset:3072 lds
v_mfma_f32_16x16x32_bf16 a[136:139], a[92:95], a[104:107], a[136:139]
v_mfma_f32_16x16x32_bf16 a[140:143], a[92:95], a[108:111], a[140:143]
v_mfma_f32_16x16x32_bf16 a[144:147], a[92:95], a[112:115], a[144:147]
v_mfma_f32_16x16x32_bf16 a[148:151], a[92:95], a[116:119], a[148:151]
s_add_u32 s50, s50, 128
s_add_u32 s51, s51, 128
v_mfma_f32_16x16x32_bf16 a[152:155], a[92:95], a[120:123], a[152:155]
s_add_u32 s52, s52, 0x80000
s_add_u32 s53, s53, 0x80000
v_mfma_f32_16x16x32_bf16 a[156:159], a[92:95], a[124:127], a[156:159]
s_xor_b32 s55, s55, 0x10000
.p2align 6
M_LOOPV:
s_waitcnt lgkmcnt(0)
v_mfma_f32_16x16x32_bf16 v[32:35], a[0:3], a[32:35], v[32:35]
ds_read_b128 a[64:67], v13 offset:0
v_mfma_f32_16x16x32_bf16 v[36:39], a[0:3], a[36:39], v[36:39]
ds_read_b64_tr_b16 a[96:97], v14 offset:8192
v_mfma_f32_16x16x32_bf16 v[40:43], a[0:3], a[40:43], v[40:43]
ds_read_b64_tr_b16 a[98:99], v14 offset:9216
v_mfma_f32_16x16x32_bf16 v[44:47], a[0:3], a[44:47], v[44:47]
ds_read_b128 a[68:71], v13 offset:2048
v_mfma_f32_16x16x32_bf16 v[48:51], a[0:3], a[48:51], v[48:51]
ds_read_b64_tr_b16 a[100:101], v15 offset:8192
v_mfma_f32_16x16x32_bf16 v[52:55], a[0:3], a[52:55], v[52:55]
ds_read_b64_tr_b16 a[102:103], v15 offset:9216
v_mfma_f32_16x16x32_bf16 v[56:59], a[0:3], a[56:59], v[56:59]
ds_read_b128 a[72:75], v13 offset:4096
v_mfma_f32_16x16x32_bf16 v[60:63], a[0:3], a[60:63], v[60:63]
v_mfma_f32_16x16x32_bf16 v[64:67], a[4:7], a[32:35], v[64:67]
ds_read_b64_tr_b16 a[104:105], v16 offset:8192
v_mfma_f32_16x16x32_bf16 v[68:71], a[4:7], a[36:39], v[68:71]
ds_read_b64_tr_b16 a[106:107], v16 offset:9216
v_mfma_f32_16x16x32_bf16 v[72:75], a[4:7], a[40:43], v[72:75]
v_mfma_f32_16x16x32_bf16 v[76:79], a[4:7], a[44:47], v[76:79]
ds_read_b128 a[76:79], v13 offset:6144
v_mfma_f32_16x16x32_bf16 v[80:83], a[4:7], a[48:51], v[80:83]
ds_read_b64_tr_b16 a[108:109], v17 offset:8192
v_mfma_f32_16x16x32_bf16 v[84:87], a[4:7], a[52:55], v[84:87]
ds_read_b64_tr_b16 a[110:111], v17 offset:9216
v_mfma_f32_16x16x32_bf16 v[88:91], a[4:7], a[56:59], v[88:91]
v_mfma_f32_16x16x32_bf16 v[92:95], a[4:7], a[60:63], v[92:95]
ds_read_b128 a[80:83], v13 offset:8192
v_mfma_f32_16x16x32_bf16 v[96:99], a[8:11], a[32:35], v[96:99]
ds_read_b64_tr_b16 a[112:113], v18 offset:8192
v_mfma_f32_16x16x32_bf16 v[100:103], a[8:11], a[36:39], v[100:103]
ds_read_b64_tr_b16 a[114:115], v18 offset:9216
v_mfma_f32_16x16x32_bf16 v[104:107], a[8:11], a[40:43], v[104:107]
v_mfma_f32_16x16x32_bf16 v[108:111], a[8:11], a[44:47], v[108:111]
ds_read_b128 a[84:87], v13 offset:10240
v_mfma_f32_16x16x32_bf16 v[112:115], a[8:11], a[48:51], v[112:115]
ds_read_b64_tr_b16 a[116:117], v19 offset:8192
v_mfma_f32_16x16x32_bf16 v[116:119], a[8:11], a[52:55], v[116:119]
v_mfma_f32_16x16x32_bf16 v[120:123], a[8:11], a[56:59], v[120:123]
ds_read_b64_tr_b16 a[118:119], v19 offset:9216
v_mfma_f32_16x16x32_bf16 v[124:127], a[8:11], a[60:63], v[124:127]
ds_read_b128 a[88:91], v13 offset:12288
v_mfma_f32_16x16x32_bf16 v[128:131], a[12:15], a[32:35], v[128:131]
ds_read_b64_tr_b16 a[120:121], v20 offset:8192
v_mfma_f32_16x16x32_bf16 v[132:135], a[12:15], a[36:39], v[132:135]
v_mfma_f32_16x16x32_bf16 v[136:139], a[12:15], a[40:43], v[136:139]
ds_read_b64_tr_b16 a[122:123], v20 offset:9216
v_mfma_f32_16x16x32_bf16 v[140:143], a[12:15], a[44:47], v[140:143]
ds_read_b128 a[92:95], v13 offset:14336
v_mfma_f32_16x16x32_bf16 v[144:147], a[12:15], a[48:51], v[144:147]
s_mov_b32 m0, s75
v_mfma_f32_16x16x32_bf16 v[148:151], a[12:15], a[52:55], v[148:151]
v_mfma_f32_16x16x32_bf16 v[152:155], a[12:15], a[56:59], v[152:155]
buffer_load_dwordx4 v4, s[20:23], s69 offen lds
v_mfma_f32_16x16x32_bf16 v[156:159], a[12:15], a[60:63], v[156:159]
ds_read_b64_tr_b16 a[124:125], v21 offset:8192
v_mfma_f32_16x16x32_bf16 v[160:163], a[16:19], a[32:35], v[160:163]
s_add_u32 s75, s75, 1024
v_mfma_f32_16x16x32_bf16 v[164:167], a[16:19], a[36:39], v[164:167]
v_mfma_f32_16x16x32_bf16 v[168:171], a[16:19], a[40:43], v[168:171]
s_add_u32 s69, s69, 8192
v_mfma_f32_16x16x32_bf16 v[172:175], a[16:19], a[44:47], v[172:175]
ds_read_b64_tr_b16 a[126:127], v21 offset:9216
v_mfma_f32_16x16x32_bf16 v[176:179], a[16:19], a[48:51], v[176:179]
s_min_u32 s69, s69, s60
v_mfma_f32_16x16x32_bf16 v[180:183], a[16:19], a[52:55], v[180:183]
v_mfma_f32_16x16x32_bf16 v[184:187], a[16:19], a[56:59], v[184:187]
v_mfma_f32_16x16x32_bf16 v[188:191], a[16:19], a[60:63], v[188:191]
v_mfma_f32_16x16x32_bf16 v[192:195], a[20:23], a[32:35], v[192:195]
v_mfma_f32_16x16x32_bf16 v[196:199], a[20:23], a[36:39], v[196:199]
buffer_load_dword a252, v29, s[24:27], 0 offen
v_mfma_f32_16x16x32_bf16 v[200:203], a[20:23], a[40:43], v[200:203]
s_cmp_eq_u32 s61, s73
s_cselect_b32 s74, 0, 0x40000000
v_mfma_f32_16x16x32_bf16 v[204:207], a[20:23], a[44:47], v[204:207]
v_add_u32 v29, s67, v29
v_mfma_f32_16x16x32_bf16 v[208:211], a[20:23], a[48:51], v[208:211]
v_or_b32 v28, s74, v30
v_mfma_f32_16x16x32_bf16 v[212:215], a[20:23], a[52:55], v[212:215]
buffer_store_byte v31, v28, s[36:39], s2 offen sc1
v_mfma_f32_16x16x32_bf16 v[216:219], a[20:23], a[56:59], v[216:219]
v_xor_b32 v12, 0x10000, v12
v_xor_b32 v13, 0x10000, v13
v_mfma_f32_16x16x32_bf16 v[220:223], a[20:23], a[60:63], v[220:223]
v_xor_b32 v14, 0x10000, v14
v_mfma_f32_16x16x32_bf16 v[224:227], a[24:27], a[32:35], v[224:227]
v_mfma_f32_16x16x32_bf16 v[228:231], a[24:27], a[36:39], v[228:231]
v_xor_b32 v15, 0x10000, v15
v_mfma_f32_16x16x32_bf16 v[232:235], a[24:27], a[40:43], v[232:235]
v_xor_b32 v16, 0x10000, v16
v_mfma_f32_16x16x32_bf16 v[236:239], a[24:27], a[44:47], v[236:239]
v_mfma_f32_16x16x32_bf16 v[240:243], a[24:27], a[48:51], v[240:243]
v_xor_b32 v17, 0x10000, v17
v_mfma_f32_16x16x32_bf16 v[244:247], a[24:27], a[52:55], v[244:247]
v_xor_b32 v18, 0x10000, v18
v_mfma_f32_16x16x32_bf16 v[248:251], a[24:27], a[56:59], v[248:251]
v_mfma_f32_16x16x32_bf16 v[252:255], a[24:27], a[60:63], v[252:255]
v_xor_b32 v19, 0x10000, v19
v_mfma_f32_16x16x32_bf16 a[128:131], a[28:31], a[32:35], a[128:131]
v_mfma_f32_16x16x32_bf16 a[132:135], a[28:31], a[36:39], a[132:135]
v_xor_b32 v20, 0x10000, v20
v_mfma_f32_16x16x32_bf16 a[136:139], a[28:31], a[40:43], a[136:139]
v_xor_b32 v21, 0x10000, v21
v_mfma_f32_16x16x32_bf16 a[140:143], a[28:31], a[44:47], a[140:143]
v_mfma_f32_16x16x32_bf16 a[144:147], a[28:31], a[48:51], a[144:147]
v_mfma_f32_16x16x32_bf16 a[148:151], a[28:31], a[52:55], a[148:151]
v_mfma_f32_16x16x32_bf16 a[152:155], a[28:31], a[56:59], a[152:155]
v_mfma_f32_16x16x32_bf16 a[156:159], a[28:31], a[60:63], a[156:159]
s_waitcnt vmcnt(3) lgkmcnt(0)
s_barrier
v_mfma_f32_16x16x32_bf16 v[32:35], a[64:67], a[96:99], v[32:35]
ds_read_b128 a[0:3], v12 offset:0
s_add_u32 m0, s55, 0
v_mfma_f32_16x16x32_bf16 v[36:39], a[64:67], a[100:103], v[36:39]
buffer_load_dwordx4 v4, s[12:15], s50 offen offset:0 lds
v_mfma_f32_16x16x32_bf16 v[40:43], a[64:67], a[104:107], v[40:43]
ds_read_b64_tr_b16 a[32:33], v14 offset:0
v_mfma_f32_16x16x32_bf16 v[44:47], a[64:67], a[108:111], v[44:47]
ds_read_b64_tr_b16 a[34:35], v14 offset:1024
v_mfma_f32_16x16x32_bf16 v[48:51], a[64:67], a[112:115], v[48:51]
buffer_load_dwordx4 v5, s[12:15], s50 offen offset:1024 lds
v_mfma_f32_16x16x32_bf16 v[52:55], a[64:67], a[116:119], v[52:55]
ds_read_b128 a[4:7], v12 offset:2048
v_mfma_f32_16x16x32_bf16 v[56:59], a[64:67], a[120:123], v[56:59]
ds_read_b64_tr_b16 a[36:37], v15 offset:0
v_mfma_f32_16x16x32_bf16 v[60:63], a[64:67], a[124:127], v[60:63]
ds_read_b64_tr_b16 a[38:39], v15 offset:1024
v_mfma_f32_16x16x32_bf16 v[64:67], a[68:71], a[96:99], v[64:67]
buffer_load_dwordx4 v6, s[12:15], s50 offen offset:2048 lds
v_mfma_f32_16x16x32_bf16 v[68:71], a[68:71], a[100:103], v[68:71]
v_mfma_f32_16x16x32_bf16 v[72:75], a[68:71], a[104:107], v[72:75]
ds_read_b128 a[8:11], v12 offset:4096
v_mfma_f32_16x16x32_bf16 v[76:79], a[68:71], a[108:111], v[76:79]
ds_read_b64_tr_b16 a[40:41], v16 offset:0
v_mfma_f32_16x16x32_bf16 v[80:83], a[68:71], a[112:115], v[80:83]
buffer_load_dwordx4 v7, s[12:15], s50 offen offset:3072 lds
v_mfma_f32_16x16x32_bf16 v[84:87], a[68:71], a[116:119], v[84:87]
ds_read_b64_tr_b16 a[42:43], v16 offset:1024
v_mfma_f32_16x16x32_bf16 v[88:91], a[68:71], a[120:123], v[88:91]
ds_read_b128 a[12:15], v12 offset:6144
v_mfma_f32_16x16x32_bf16 v[92:95], a[68:71], a[124:127], v[92:95]
s_add_u32 m0, s55, 32768
v_mfma_f32_16x16x32_bf16 v[96:99], a[72:75], a[96:99], v[96:99]
buffer_load_dwordx4 v8, s[16:19], s52 offen offset:0 lds
v_mfma_f32_16x16x32_bf16 v[100:103], a[72:75], a[100:103], v[100:103]
v_mfma_f32_16x16x32_bf16 v[104:107], a[72:75], a[104:107], v[104:107]
ds_read_b64_tr_b16 a[44:45], v17 offset:0
v_mfma_f32_16x16x32_bf16 v[108:111], a[72:75], a[108:111], v[108:111]
buffer_load_dwordx4 v9, s[16:19], s52 offen offset:1024 lds
v_mfma_f32_16x16x32_bf16 v[112:115], a[72:75], a[112:115], v[112:115]
ds_read_b64_tr_b16 a[46:47], v17 offset:1024
v_mfma_f32_16x16x32_bf16 v[116:119], a[72:75], a[116:119], v[116:119]
ds_read_b128 a[16:19], v12 offset:8192
v_mfma_f32_16x16x32_bf16 v[120:123], a[72:75], a[120:123], v[120:123]
ds_read_b64_tr_b16 a[48:49], v18 offset:0
v_mfma_f32_16x16x32_bf16 v[124:127], a[72:75], a[124:127], v[124:127]
buffer_load_dwordx4 v10, s[16:19], s52 offen offset:2048 lds
v_mfma_f32_16x16x32_bf16 v[128:131], a[76:79], a[96:99], v[128:131]
ds_read_b64_tr_b16 a[50:51], v18 offset:1024
v_mfma_f32_16x16x32_bf16 v[132:135], a[76:79], a[100:103], v[132:135]
ds_read_b128 a[20:23], v12 offset:10240
v_mfma_f32_16x16x32_bf16 v[136:139], a[76:79], a[104:107], v[136:139]
v_mfma_f32_16x16x32_bf16 v[140:143], a[76:79], a[108:111], v[140:143]
buffer_load_dwordx4 v11, s[16:19], s52 offen offset:3072 lds
v_mfma_f32_16x16x32_bf16 v[144:147], a[76:79], a[112:115], v[144:147]
ds_read_b64_tr_b16 a[52:53], v19 offset:0
v_mfma_f32_16x16x32_bf16 v[148:151], a[76:79], a[116:119], v[148:151]
ds_read_b64_tr_b16 a[54:55], v19 offset:1024
v_mfma_f32_16x16x32_bf16 v[152:155], a[76:79], a[120:123], v[152:155]
s_add_u32 m0, s55, 4096
v_mfma_f32_16x16x32_bf16 v[156:159], a[76:79], a[124:127], v[156:159]
buffer_load_dwordx4 v4, s[12:15], s51 offen offset:0 lds
v_mfma_f32_16x16x32_bf16 v[160:163], a[80:83], a[96:99], v[160:163]
ds_read_b128 a[24:27], v12 offset:12288
v_mfma_f32_16x16x32_bf16 v[164:167], a[80:83], a[100:103], v[164:167]
ds_read_b64_tr_b16 a[56:57], v20 offset:0
v_mfma_f32_16x16x32_bf16 v[168:171], a[80:83], a[104:107], v[168:171]
buffer_load_dwordx4 v5, s[12:15], s51 offen offset:1024 lds
v_mfma_f32_16x16x32_bf16 v[172:175], a[80:83], a[108:111], v[172:175]
v_mfma_f32_16x16x32_bf16 v[176:179], a[80:83], a[112:115], v[176:179]
ds_read_b64_tr_b16 a[58:59], v20 offset:1024
v_mfma_f32_16x16x32_bf16 v[180:183], a[80:83], a[116:119], v[180:183]
ds_read_b128 a[28:31], v12 offset:14336
v_mfma_f32_16x16x32_bf16 v[184:187], a[80:83], a[120:123], v[184:187]
buffer_load_dwordx4 v6, s[12:15], s51 offen offset:2048 lds
v_mfma_f32_16x16x32_bf16 v[188:191], a[80:83], a[124:127], v[188:191]
ds_read_b64_tr_b16 a[60:61], v21 offset:0
v_mfma_f32_16x16x32_bf16 v[192:195], a[84:87], a[96:99], v[192:195]
ds_read_b64_tr_b16 a[62:63], v21 offset:1024
v_mfma_f32_16x16x32_bf16 v[196:199], a[84:87], a[100:103], v[196:199]
v_mfma_f32_16x16x32_bf16 v[200:203], a[84:87], a[104:107], v[200:203]
buffer_load_dwordx4 v7, s[12:15], s51 offen offset:3072 lds
v_mfma_f32_16x16x32_bf16 v[204:207], a[84:87], a[108:111], v[204:207]
v_mfma_f32_16x16x32_bf16 v[208:211], a[84:87], a[112:115], v[208:211]
v_mfma_f32_16x16x32_bf16 v[212:215], a[84:87], a[116:119], v[212:215]
s_add_u32 m0, s55, 36864
v_mfma_f32_16x16x32_bf16 v[216:219], a[84:87], a[120:123], v[216:219]
buffer_load_dwordx4 v8, s[16:19], s53 offen offset:0 lds
v_mfma_f32_16x16x32_bf16 v[220:223], a[84:87], a[124:127], v[220:223]
v_mfma_f32_16x16x32_bf16 v[224:227], a[88:91], a[96:99], v[224:227]
v_mfma_f32_16x16x32_bf16 v[228:231], a[88:91], a[100:103], v[228:231]
buffer_load_dwordx4 v9, s[16:19], s53 offen offset:1024 lds
v_mfma_f32_16x16x32_bf16 v[232:235], a[88:91], a[104:107], v[232:235]
v_mfma_f32_16x16x32_bf16 v[236:239], a[88:91], a[108:111], v[236:239]
v_mfma_f32_16x16x32_bf16 v[240:243], a[88:91], a[112:115], v[240:243]
v_mfma_f32_16x16x32_bf16 v[244:247], a[88:91], a[116:119], v[244:247]
buffer_load_dwordx4 v10, s[16:19], s53 offen offset:2048 lds
v_mfma_f32_16x16x32_bf16 v[248:251], a[88:91], a[120:123], v[248:251]
v_mfma_f32_16x16x32_bf16 v[252:255], a[88:91], a[124:127], v[252:255]
v_mfma_f32_16x16x32_bf16 a[128:131], a[92:95], a[96:99], a[128:131]
v_mfma_f32_16x16x32_bf16 a[132:135], a[92:95], a[100:103], a[132:135]
buffer_load_dwordx4 v11, s[16:19], s53 offen offset:3072 lds
v_mfma_f32_16x16x32_bf16 a[136:139], a[92:95], a[104:107], a[136:139]
v_mfma_f32_16x16x32_bf16 a[140:143], a[92:95], a[108:111], a[140:143]
v_mfma_f32_16x16x32_bf16 a[144:147], a[92:95], a[112:115], a[144:147]
v_mfma_f32_16x16x32_bf16 a[148:151], a[92:95], a[116:119], a[148:151]
s_add_u32 s50, s50, 128
s_add_u32 s51, s51, 128
v_mfma_f32_16x16x32_bf16 a[152:155], a[92:95], a[120:123], a[152:155]
s_add_u32 s52, s52, 0x80000
s_add_u32 s53, s53, 0x80000
v_mfma_f32_16x16x32_bf16 a[156:159], a[92:95], a[124:127], a[156:159]
s_xor_b32 s55, s55, 0x10000
s_add_u32 s61, s61, -1
s_cbranch_scc1 M_LOOPV
s_waitcnt lgkmcnt(0)
v_mfma_f32_16x16x32_bf16 v[32:35], a[0:3], a[32:35], v[32:35]
ds_read_b64_tr_b16 a[160:161], v22 offset:0
ds_read_b64_tr_b16 a[162:163], v22 offset:2048
v_mfma_f32_16x16x32_bf16 v[36:39], a[0:3], a[36:39], v[36:39]
ds_read_b64_tr_b16 a[164:165], v22 offset:8
ds_read_b64_tr_b16 a[166:167], v22 offset:2056
v_mfma_f32_16x16x32_bf16 v[40:43], a[0:3], a[40:43], v[40:43]
buffer_load_dword v28, v2, s[36:39], 0 offen sc1
ds_read_b64_tr_b16 a[168:169], v23 offset:0
ds_read_b64_tr_b16 a[170:171], v23 offset:2048
v_mfma_f32_16x16x32_bf16 v[44:47], a[0:3], a[44:47], v[44:47]
ds_read_b64_tr_b16 a[172:173], v23 offset:8
ds_read_b64_tr_b16 a[174:175], v23 offset:2056
v_mfma_f32_16x16x32_bf16 v[48:51], a[0:3], a[48:51], v[48:51]
v_mfma_f32_16x16x32_bf16 v[52:55], a[0:3], a[52:55], v[52:55]
v_mfma_f32_16x16x32_bf16 v[56:59], a[0:3], a[56:59], v[56:59]
ds_read_b128 a[64:67], v13 offset:0
ds_read_b64_tr_b16 a[96:97], v14 offset:8192
v_mfma_f32_16x16x32_bf16 v[60:63], a[0:3], a[60:63], v[60:63]
ds_read_b64_tr_b16 a[98:99], v14 offset:9216
ds_read_b128 a[68:71], v13 offset:2048
v_mfma_f32_16x16x32_bf16 v[64:67], a[4:7], a[32:35], v[64:67]
ds_read_b64_tr_b16 a[100:101], v15 offset:8192
v_mfma_f32_16x16x32_bf16 v[68:71], a[4:7], a[36:39], v[68:71]
ds_read_b64_tr_b16 a[102:103], v15 offset:9216
v_mfma_f32_16x16x32_bf16 v[72:75], a[4:7], a[40:43], v[72:75]
ds_read_b128 a[72:75], v13 offset:4096
v_mfma_f32_16x16x32_bf16 v[76:79], a[4:7], a[44:47], v[76:79]
s_waitcnt lgkmcnt(6)
v_mfma_f32_16x16x32_bf16 v[80:83], a[4:7], a[48:51], v[80:83]
ds_read_b64_tr_b16 a[104:105], v16 offset:8192
v_mfma_f32_16x16x32_bf16 v[84:87], a[4:7], a[52:55], v[84:87]
buffer_store_dwordx4 a[160:163], v3, s[28:31], s66 offen sc1
v_mfma_f32_16x16x32_bf16 v[88:91], a[4:7], a[56:59], v[88:91]
ds_read_b64_tr_b16 a[106:107], v16 offset:9216
v_mfma_f32_16x16x32_bf16 v[92:95], a[4:7], a[60:63], v[92:95]
ds_read_b128 a[76:79], v13 offset:6144
v_mfma_f32_16x16x32_bf16 v[96:99], a[8:11], a[32:35], v[96:99]
s_add_u32 s66, s66, 131072
v_mfma_f32_16x16x32_bf16 v[100:103], a[8:11], a[36:39], v[100:103]
buffer_store_dwordx4 a[164:167], v3, s[28:31], s66 offen sc1
v_mfma_f32_16x16x32_bf16 v[104:107], a[8:11], a[40:43], v[104:107]
ds_read_b64_tr_b16 a[108:109], v17 offset:8192
v_mfma_f32_16x16x32_bf16 v[108:111], a[8:11], a[44:47], v[108:111]
ds_read_b64_tr_b16 a[110:111], v17 offset:9216
v_mfma_f32_16x16x32_bf16 v[112:115], a[8:11], a[48:51], v[112:115]
s_add_u32 s66, s66, 131072
v_mfma_f32_16x16x32_bf16 v[116:119], a[8:11], a[52:55], v[116:119]
buffer_store_dwordx4 a[168:171], v3, s[28:31], s66 offen sc1
v_mfma_f32_16x16x32_bf16 v[120:123], a[8:11], a[56:59], v[120:123]
ds_read_b128 a[80:83], v13 offset:8192
v_mfma_f32_16x16x32_bf16 v[124:127], a[8:11], a[60:63], v[124:127]
ds_read_b64_tr_b16 a[112:113], v18 offset:8192
v_mfma_f32_16x16x32_bf16 v[128:131], a[12:15], a[32:35], v[128:131]
s_add_u32 s66, s66, 131072
v_mfma_f32_16x16x32_bf16 v[132:135], a[12:15], a[36:39], v[132:135]
buffer_store_dwordx4 a[172:175], v3, s[28:31], s66 offen sc1
v_mfma_f32_16x16x32_bf16 v[136:139], a[12:15], a[40:43], v[136:139]
ds_read_b64_tr_b16 a[114:115], v18 offset:9216
v_mfma_f32_16x16x32_bf16 v[140:143], a[12:15], a[44:47], v[140:143]
ds_read_b128 a[84:87], v13 offset:10240
v_mfma_f32_16x16x32_bf16 v[144:147], a[12:15], a[48:51], v[144:147]
s_add_u32 m0, s54, 131072
s_add_u32 s73, s72, 0
v_mfma_f32_16x16x32_bf16 v[148:151], a[12:15], a[52:55], v[148:151]
buffer_load_dwordx4 v8, s[32:35], s73 offen offset:0 lds
v_mfma_f32_16x16x32_bf16 v[152:155], a[12:15], a[56:59], v[152:155]
v_mfma_f32_16x16x32_bf16 v[156:159], a[12:15], a[60:63], v[156:159]
ds_read_b64_tr_b16 a[116:117], v19 offset:8192
v_mfma_f32_16x16x32_bf16 v[160:163], a[16:19], a[32:35], v[160:163]
ds_read_b64_tr_b16 a[118:119], v19 offset:9216
v_mfma_f32_16x16x32_bf16 v[164:167], a[16:19], a[36:39], v[164:167]
buffer_load_dwordx4 v9, s[32:35], s73 offen offset:1024 lds
v_mfma_f32_16x16x32_bf16 v[168:171], a[16:19], a[40:43], v[168:171]
ds_read_b128 a[88:91], v13 offset:12288
v_mfma_f32_16x16x32_bf16 v[172:175], a[16:19], a[44:47], v[172:175]
ds_read_b64_tr_b16 a[120:121], v20 offset:8192
v_mfma_f32_16x16x32_bf16 v[176:179], a[16:19], a[48:51], v[176:179]
ds_read_b64_tr_b16 a[122:123], v20 offset:9216
v_mfma_f32_16x16x32_bf16 v[180:183], a[16:19], a[52:55], v[180:183]
buffer_load_dwordx4 v10, s[32:35], s73 offen offset:2048 lds
v_mfma_f32_16x16x32_bf16 v[184:187], a[16:19], a[56:59], v[184:187]
ds_read_b128 a[92:95], v13 offset:14336
v_mfma_f32_16x16x32_bf16 v[188:191], a[16:19], a[60:63], v[188:191]
ds_read_b64_tr_b16 a[124:125], v21 offset:8192
v_mfma_f32_16x16x32_bf16 v[192:195], a[20:23], a[32:35], v[192:195]
ds_read_b64_tr_b16 a[126:127], v21 offset:9216
v_mfma_f32_16x16x32_bf16 v[196:199], a[20:23], a[36:39], v[196:199]
buffer_load_dwordx4 v11, s[32:35], s73 offen offset:3072 lds
v_mfma_f32_16x16x32_bf16 v[200:203], a[20:23], a[40:43], v[200:203]
v_mfma_f32_16x16x32_bf16 v[204:207], a[20:23], a[44:47], v[204:207]
v_mfma_f32_16x16x32_bf16 v[208:211], a[20:23], a[48:51], v[208:211]
s_add_u32 m0, s54, 135168
s_add_u32 s73, s72, 131072
v_mfma_f32_16x16x32_bf16 v[212:215], a[20:23], a[52:55], v[212:215]
buffer_load_dwordx4 v8, s[32:35], s73 offen offset:0 lds
v_mfma_f32_16x16x32_bf16 v[216:219], a[20:23], a[56:59], v[216:219]
v_xor_b32 v12, 0x10000, v12
v_xor_b32 v13, 0x10000, v13
v_mfma_f32_16x16x32_bf16 v[220:223], a[20:23], a[60:63], v[220:223]
v_xor_b32 v14, 0x10000, v14
v_mfma_f32_16x16x32_bf16 v[224:227], a[24:27], a[32:35], v[224:227]
v_xor_b32 v15, 0x10000, v15
v_mfma_f32_16x16x32_bf16 v[228:231], a[24:27], a[36:39], v[228:231]
buffer_load_dwordx4 v9, s[32:35], s73 offen offset:1024 lds
v_mfma_f32_16x16x32_bf16 v[232:235], a[24:27], a[40:43], v[232:235]
v_xor_b32 v16, 0x10000, v16
v_mfma_f32_16x16x32_bf16 v[236:239], a[24:27], a[44:47], v[236:239]
v_mfma_f32_16x16x32_bf16 v[240:243], a[24:27], a[48:51], v[240:243]
v_xor_b32 v17, 0x10000, v17
v_mfma_f32_16x16x32_bf16 v[244:247], a[24:27], a[52:55], v[244:247]
buffer_load_dwordx4 v10, s[32:35], s73 offen offset:2048 lds
v_mfma_f32_16x16x32_bf16 v[248:251], a[24:27], a[56:59], v[248:251]
v_xor_b32 v18, 0x10000, v18
v_mfma_f32_16x16x32_bf16 v[252:255], a[24:27], a[60:63], v[252:255]
v_xor_b32 v19, 0x10000, v19
v_mfma_f32_16x16x32_bf16 a[128:131], a[28:31], a[32:35], a[128:131]
v_mfma_f32_16x16x32_bf16 a[132:135], a[28:31], a[36:39], a[132:135]
buffer_load_dwordx4 v11, s[32:35], s73 offen offset:3072 lds
v_mfma_f32_16x16x32_bf16 a[136:139], a[28:31], a[40:43], a[136:139]
v_xor_b32 v20, 0x10000, v20
v_mfma_f32_16x16x32_bf16 a[140:143], a[28:31], a[44:47], a[140:143]
v_xor_b32 v21, 0x10000, v21
v_mfma_f32_16x16x32_bf16 a[144:147], a[28:31], a[48:51], a[144:147]
v_mfma_f32_16x16x32_bf16 a[148:151], a[28:31], a[52:55], a[148:151]
v_mfma_f32_16x16x32_bf16 a[152:155], a[28:31], a[56:59], a[152:155]
v_mfma_f32_16x16x32_bf16 a[156:159], a[28:31], a[60:63], a[156:159]
s_waitcnt vmcnt(12) lgkmcnt(0)
v_and_b32 v29, 0x10101010, v28
v_cmp_eq_u32 vcc, 0x10101010, v29
s_or_b64 vcc, vcc, s[96:97]
s_cmp_eq_u64 vcc, -1
s_cbranch_scc0 M_SPINLNV
M_SRETLNV:
s_barrier
v_mfma_f32_16x16x32_bf16 v[32:35], a[64:67], a[96:99], v[32:35]
s_add_u32 m0, s54, 0
s_add_u32 s73, s72, 1048576
v_mfma_f32_16x16x32_bf16 v[36:39], a[64:67], a[100:103], v[36:39]
buffer_load_dwordx4 v8, s[32:35], s73 offen offset:0 lds
v_mfma_f32_16x16x32_bf16 v[40:43], a[64:67], a[104:107], v[40:43]
ds_read_b128 a[0:3], v12 offset:0
v_mfma_f32_16x16x32_bf16 v[44:47], a[64:67], a[108:111], v[44:47]
ds_read_b64_tr_b16 a[32:33], v14 offset:0
v_mfma_f32_16x16x32_bf16 v[48:51], a[64:67], a[112:115], v[48:51]
buffer_load_dwordx4 v9, s[32:35], s73 offen offset:1024 lds
v_mfma_f32_16x16x32_bf16 v[52:55], a[64:67], a[116:119], v[52:55]
ds_read_b64_tr_b16 a[34:35], v14 offset:1024
v_mfma_f32_16x16x32_bf16 v[56:59], a[64:67], a[120:123], v[56:59]
ds_read_b128 a[4:7], v12 offset:2048
v_mfma_f32_16x16x32_bf16 v[60:63], a[64:67], a[124:127], v[60:63]
ds_read_b64_tr_b16 a[36:37], v15 offset:0
v_mfma_f32_16x16x32_bf16 v[64:67], a[68:71], a[96:99], v[64:67]
buffer_load_dwordx4 v10, s[32:35], s73 offen offset:2048 lds
v_mfma_f32_16x16x32_bf16 v[68:71], a[68:71], a[100:103], v[68:71]
ds_read_b64_tr_b16 a[38:39], v15 offset:1024
v_mfma_f32_16x16x32_bf16 v[72:75], a[68:71], a[104:107], v[72:75]
ds_read_b128 a[8:11], v12 offset:4096
v_mfma_f32_16x16x32_bf16 v[76:79], a[68:71], a[108:111], v[76:79]
ds_read_b64_tr_b16 a[40:41], v16 offset:0
v_mfma_f32_16x16x32_bf16 v[80:83], a[68:71], a[112:115], v[80:83]
buffer_load_dwordx4 v11, s[32:35], s73 offen offset:3072 lds
v_mfma_f32_16x16x32_bf16 v[84:87], a[68:71], a[116:119], v[84:87]
ds_read_b64_tr_b16 a[42:43], v16 offset:1024
v_mfma_f32_16x16x32_bf16 v[88:91], a[68:71], a[120:123], v[88:91]
ds_read_b128 a[12:15], v12 offset:6144
v_mfma_f32_16x16x32_bf16 v[92:95], a[68:71], a[124:127], v[92:95]
s_add_u32 m0, s54, 4096
s_add_u32 s73, s72, 1179648
v_mfma_f32_16x16x32_bf16 v[96:99], a[72:75], a[96:99], v[96:99]
buffer_load_dwordx4 v8, s[32:35], s73 offen offset:0 lds
v_mfma_f32_16x16x32_bf16 v[100:103], a[72:75], a[100:103], v[100:103]
v_mfma_f32_16x16x32_bf16 v[104:107], a[72:75], a[104:107], v[104:107]
ds_read_b64_tr_b16 a[44:45], v17 offset:0
v_mfma_f32_16x16x32_bf16 v[108:111], a[72:75], a[108:111], v[108:111]
ds_read_b64_tr_b16 a[46:47], v17 offset:1024
v_mfma_f32_16x16x32_bf16 v[112:115], a[72:75], a[112:115], v[112:115]
buffer_load_dwordx4 v9, s[32:35], s73 offen offset:1024 lds
v_mfma_f32_16x16x32_bf16 v[116:119], a[72:75], a[116:119], v[116:119]
ds_read_b128 a[16:19], v12 offset:8192
v_mfma_f32_16x16x32_bf16 v[120:123], a[72:75], a[120:123], v[120:123]
v_mfma_f32_16x16x32_bf16 v[124:127], a[72:75], a[124:127], v[124:127]
ds_read_b64_tr_b16 a[48:49], v18 offset:0
v_mfma_f32_16x16x32_bf16 v[128:131], a[76:79], a[96:99], v[128:131]
buffer_load_dwordx4 v10, s[32:35], s73 offen offset:2048 lds
v_mfma_f32_16x16x32_bf16 v[132:135], a[76:79], a[100:103], v[132:135]
ds_read_b64_tr_b16 a[50:51], v18 offset:1024
v_mfma_f32_16x16x32_bf16 v[136:139], a[76:79], a[104:107], v[136:139]
ds_read_b128 a[20:23], v12 offset:10240
v_mfma_f32_16x16x32_bf16 v[140:143], a[76:79], a[108:111], v[140:143]
ds_read_b64_tr_b16 a[52:53], v19 offset:0
v_mfma_f32_16x16x32_bf16 v[144:147], a[76:79], a[112:115], v[144:147]
buffer_load_dwordx4 v11, s[32:35], s73 offen offset:3072 lds
v_mfma_f32_16x16x32_bf16 v[148:151], a[76:79], a[116:119], v[148:151]
ds_read_b64_tr_b16 a[54:55], v19 offset:1024
v_mfma_f32_16x16x32_bf16 v[152:155], a[76:79], a[120:123], v[152:155]
ds_read_b128 a[24:27], v12 offset:12288
v_mfma_f32_16x16x32_bf16 v[156:159], a[76:79], a[124:127], v[156:159]
s_add_u32 m0, s54, 32768
s_add_u32 s73, s72, 2097152
v_mfma_f32_16x16x32_bf16 v[160:163], a[80:83], a[96:99], v[160:163]
buffer_load_dwordx4 v8, s[32:35], s73 offen offset:0 lds
v_mfma_f32_16x16x32_bf16 v[164:167], a[80:83], a[100:103], v[164:167]
v_mfma_f32_16x16x32_bf16 v[168:171], a[80:83], a[104:107], v[168:171]
ds_read_b64_tr_b16 a[56:57], v20 offset:0
v_mfma_f32_16x16x32_bf16 v[172:175], a[80:83], a[108:111], v[172:175]
buffer_load_dwordx4 v9, s[32:35], s73 offen offset:1024 lds
v_mfma_f32_16x16x32_bf16 v[176:179], a[80:83], a[112:115], v[176:179]
ds_read_b64_tr_b16 a[58:59], v20 offset:1024
v_mfma_f32_16x16x32_bf16 v[180:183], a[80:83], a[116:119], v[180:183]
ds_read_b128 a[28:31], v12 offset:14336
v_mfma_f32_16x16x32_bf16 v[184:187], a[80:83], a[120:123], v[184:187]
ds_read_b64_tr_b16 a[60:61], v21 offset:0
v_mfma_f32_16x16x32_bf16 v[188:191], a[80:83], a[124:127], v[188:191]
buffer_load_dwordx4 v10, s[32:35], s73 offen offset:2048 lds
v_mfma_f32_16x16x32_bf16 v[192:195], a[84:87], a[96:99], v[192:195]
ds_read_b64_tr_b16 a[62:63], v21 offset:1024
s_sub_u32 s48, 15, s45
v_mfma_f32_16x16x32_bf16 v[196:199], a[84:87], a[100:103], v[196:199]
s_lshl_b32 s48, s48, 3
s_mov_b32 s47, s3
v_mfma_f32_16x16x32_bf16 v[200:203], a[84:87], a[104:107], v[200:203]
s_add_u32 s75, s48, s47
s_lshl_b32 s48, s45, 3
v_mfma_f32_16x16x32_bf16 v[204:207], a[84:87], a[108:111], v[204:207]
buffer_load_dwordx4 v11, s[32:35], s73 offen offset:3072 lds
v_mfma_f32_16x16x32_bf16 v[208:211], a[84:87], a[112:115], v[208:211]
s_add_u32 s76, s48, s47
s_lshl_b32 s47, s75, 14
v_mfma_f32_16x16x32_bf16 v[212:215], a[84:87], a[116:119], v[212:215]
v_add_u32 v4, s47, v3
v_mfma_f32_16x16x32_bf16 v[216:219], a[84:87], a[120:123], v[216:219]
s_add_u32 m0, s54, 36864
s_add_u32 s73, s72, 2228224
v_mfma_f32_16x16x32_bf16 v[220:223], a[84:87], a[124:127], v[220:223]
buffer_load_dwordx4 v8, s[32:35], s73 offen offset:0 lds
v_mfma_f32_16x16x32_bf16 v[224:227], a[88:91], a[96:99], v[224:227]
v_add_u32 v5, 0x10000, v4
s_lshl_b32 s48, s76, 14
v_mfma_f32_16x16x32_bf16 v[228:231], a[88:91], a[100:103], v[228:231]
v_add_u32 v6, s48, v3
v_mfma_f32_16x16x32_bf16 v[232:235], a[88:91], a[104:107], v[232:235]
v_add_u32 v7, 0x10000, v6
s_mov_b32 s68, 4096
v_mfma_f32_16x16x32_bf16 v[236:239], a[88:91], a[108:111], v[236:239]
buffer_load_dwordx4 v9, s[32:35], s73 offen offset:1024 lds
v_mfma_f32_16x16x32_bf16 v[240:243], a[88:91], a[112:115], v[240:243]
s_mov_b32 s69, 8192
v_mfma_f32_16x16x32_bf16 v[244:247], a[88:91], a[116:119], v[244:247]
s_mov_b32 s74, 12288
s_and_b32 s47, s42, 3
v_mfma_f32_16x16x32_bf16 v[248:251], a[88:91], a[120:123], v[248:251]
s_lshl_b32 s47, s47, 3
v_mfma_f32_16x16x32_bf16 v[252:255], a[88:91], a[124:127], v[252:255]
buffer_load_dwordx4 v10, s[32:35], s73 offen offset:2048 lds
v_bfe_u32 v29, v28, s47, 8
v_mfma_f32_16x16x32_bf16 a[128:131], a[92:95], a[96:99], a[128:131]
s_and_b32 s47, s43, 3
v_mfma_f32_16x16x32_bf16 a[132:135], a[92:95], a[100:103], a[132:135]
s_lshl_b32 s47, s47, 1
s_lshr_b32 s48, s42, 2
v_mfma_f32_16x16x32_bf16 a[136:139], a[92:95], a[104:107], a[136:139]
s_add_u32 s47, s47, s48
v_mfma_f32_16x16x32_bf16 a[140:143], a[92:95], a[108:111], a[140:143]
buffer_load_dwordx4 v11, s[32:35], s73 offen offset:3072 lds
v_cmp_eq_u32 s[78:79], s70, v29
v_mfma_f32_16x16x32_bf16 a[144:147], a[92:95], a[112:115], a[144:147]
s_lshl_b32 s77, 0x01010101, s47
v_mfma_f32_16x16x32_bf16 a[148:151], a[92:95], a[116:119], a[148:151]
v_mfma_f32_16x16x32_bf16 a[152:155], a[92:95], a[120:123], a[152:155]
v_mfma_f32_16x16x32_bf16 a[156:159], a[92:95], a[124:127], a[156:159]
s_waitcnt lgkmcnt(0)
v_mfma_f32_16x16x32_bf16 v[32:35], a[0:3], a[32:35], v[32:35]
ds_read_b128 a[64:67], v13 offset:0
ds_read_b64_tr_b16 a[96:97], v14 offset:8192
v_mfma_f32_16x16x32_bf16 v[36:39], a[0:3], a[36:39], v[36:39]
buffer_load_dwordx4 a[160:163], v4, s[28:31], 0 offen offset:0 sc1
v_mfma_f32_16x16x32_bf16 v[40:43], a[0:3], a[40:43], v[40:43]
ds_read_b64_tr_b16 a[98:99], v14 offset:9216
v_mfma_f32_16x16x32_bf16 v[44:47], a[0:3], a[44:47], v[44:47]
ds_read_b128 a[68:71], v13 offset:2048
v_mfma_f32_16x16x32_bf16 v[48:51], a[0:3], a[48:51], v[48:51]
buffer_load_dwordx4 a[164:167], v5, s[28:31], 0 offen offset:0 sc1
v_mfma_f32_16x16x32_bf16 v[52:55], a[0:3], a[52:55], v[52:55]
ds_read_b64_tr_b16 a[100:101], v15 offset:8192
v_mfma_f32_16x16x32_bf16 v[56:59], a[0:3], a[56:59], v[56:59]
ds_read_b64_tr_b16 a[102:103], v15 offset:9216
v_mfma_f32_16x16x32_bf16 v[60:63], a[0:3], a[60:63], v[60:63]
ds_read_b128 a[72:75], v13 offset:4096
v_mfma_f32_16x16x32_bf16 v[64:67], a[4:7], a[32:35], v[64:67]
buffer_load_dwordx4 a[168:171], v6, s[28:31], 0 offen offset:0 sc1
v_mfma_f32_16x16x32_bf16 v[68:71], a[4:7], a[36:39], v[68:71]
v_mfma_f32_16x16x32_bf16 v[72:75], a[4:7], a[40:43], v[72:75]
ds_read_b64_tr_b16 a[104:105], v16 offset:8192
v_mfma_f32_16x16x32_bf16 v[76:79], a[4:7], a[44:47], v[76:79]
ds_read_b64_tr_b16 a[106:107], v16 offset:9216
v_mfma_f32_16x16x32_bf16 v[80:83], a[4:7], a[48:51], v[80:83]
buffer_load_dwordx4 a[172:175], v7, s[28:31], 0 offen offset:0 sc1
v_mfma_f32_16x16x32_bf16 v[84:87], a[4:7], a[52:55], v[84:87]
ds_read_b128 a[76:79], v13 offset:6144
v_mfma_f32_16x16x32_bf16 v[88:91], a[4:7], a[56:59], v[88:91]
ds_read_b64_tr_b16 a[108:109], v17 offset:8192
v_mfma_f32_16x16x32_bf16 v[92:95], a[4:7], a[60:63], v[92:95]
ds_read_b64_tr_b16 a[110:111], v17 offset:9216
v_mfma_f32_16x16x32_bf16 v[96:99], a[8:11], a[32:35], v[96:99]
buffer_load_dwordx4 a[176:179], v4, s[28:31], 0 offen offset:1024 sc1
v_mfma_f32_16x16x32_bf16 v[100:103], a[8:11], a[36:39], v[100:103]
v_mfma_f32_16x16x32_bf16 v[104:107], a[8:11], a[40:43], v[104:107]
ds_read_b128 a[80:83], v13 offset:8192
v_mfma_f32_16x16x32_bf16 v[108:111], a[8:11], a[44:47], v[108:111]
ds_read_b64_tr_b16 a[112:113], v18 offset:8192
v_mfma_f32_16x16x32_bf16 v[112:115], a[8:11], a[48:51], v[112:115]
buffer_load_dwordx4 a[180:183], v5, s[28:31], 0 offen offset:1024 sc1
v_mfma_f32_16x16x32_bf16 v[116:119], a[8:11], a[52:55], v[116:119]
ds_read_b64_tr_b16 a[114:115], v18 offset:9216
v_mfma_f32_16x16x32_bf16 v[120:123], a[8:11], a[56:59], v[120:123]
ds_read_b128 a[84:87], v13 offset:10240
v_mfma_f32_16x16x32_bf16 v[124:127], a[8:11], a[60:63], v[124:127]
ds_read_b64_tr_b16 a[116:117], v19 offset:8192
v_mfma_f32_16x16x32_bf16 v[128:131], a[12:15], a[32:35], v[128:131]
buffer_load_dwordx4 a[184:187], v6, s[28:31], 0 offen offset:1024 sc1
v_mfma_f32_16x16x32_bf16 v[132:135], a[12:15], a[36:39], v[132:135]
v_mfma_f32_16x16x32_bf16 v[136:139], a[12:15], a[40:43], v[136:139]
ds_read_b64_tr_b16 a[118:119], v19 offset:9216
v_mfma_f32_16x16x32_bf16 v[140:143], a[12:15], a[44:47], v[140:143]
ds_read_b128 a[88:91], v13 offset:12288
v_mfma_f32_16x16x32_bf16 v[144:147], a[12:15], a[48:51], v[144:147]
buffer_load_dwordx4 a[188:191], v7, s[28:31], 0 offen offset:1024 sc1
v_mfma_f32_16x16x32_bf16 v[148:151], a[12:15], a[52:55], v[148:151]
ds_read_b64_tr_b16 a[120:121], v20 offset:8192
v_mfma_f32_16x16x32_bf16 v[152:155], a[12:15], a[56:59], v[152:155]
ds_read_b64_tr_b16 a[122:123], v20 offset:9216
v_mfma_f32_16x16x32_bf16 v[156:159], a[12:15], a[60:63], v[156:159]
ds_read_b128 a[92:95], v13 offset:14336
v_mfma_f32_16x16x32_bf16 v[160:163], a[16:19], a[32:35], v[160:163]
buffer_load_dwordx4 a[192:195], v4, s[28:31], 0 offen offset:2048 sc1
v_mfma_f32_16x16x32_bf16 v[164:167], a[16:19], a[36:39], v[164:167]
v_mfma_f32_16x16x32_bf16 v[168:171], a[16:19], a[40:43], v[168:171]
ds_read_b64_tr_b16 a[124:125], v21 offset:8192
v_mfma_f32_16x16x32_bf16 v[172:175], a[16:19], a[44:47], v[172:175]
buffer_load_dwordx4 a[196:199], v5, s[28:31], 0 offen offset:2048 sc1
v_mfma_f32_16x16x32_bf16 v[176:179], a[16:19], a[48:51], v[176:179]
ds_read_b64_tr_b16 a[126:127], v21 offset:9216
v_mfma_f32_16x16x32_bf16 v[180:183], a[16:19], a[52:55], v[180:183]
v_mfma_f32_16x16x32_bf16 v[184:187], a[16:19], a[56:59], v[184:187]
v_mfma_f32_16x16x32_bf16 v[188:191], a[16:19], a[60:63], v[188:191]
buffer_load_dwordx4 a[200:203], v6, s[28:31], 0 offen offset:2048 sc1
v_mfma_f32_16x16x32_bf16 v[192:195], a[20:23], a[32:35], v[192:195]
v_mfma_f32_16x16x32_bf16 v[196:199], a[20:23], a[36:39], v[196:199]
v_mfma_f32_16x16x32_bf16 v[200:203], a[20:23], a[40:43], v[200:203]
v_mfma_f32_16x16x32_bf16 v[204:207], a[20:23], a[44:47], v[204:207]
buffer_load_dwordx4 a[204:207], v7, s[28:31], 0 offen offset:2048 sc1
v_mfma_f32_16x16x32_bf16 v[208:211], a[20:23], a[48:51], v[208:211]
v_mfma_f32_16x16x32_bf16 v[212:215], a[20:23], a[52:55], v[212:215]
v_mfma_f32_16x16x32_bf16 v[216:219], a[20:23], a[56:59], v[216:219]
v_add_u32 v14, s71, v14
v_add_u32 v15, s71, v15
v_mfma_f32_16x16x32_bf16 v[220:223], a[20:23], a[60:63], v[220:223]
buffer_load_dwordx4 a[208:211], v4, s[28:31], 0 offen offset:3072 sc1
v_mfma_f32_16x16x32_bf16 v[224:227], a[24:27], a[32:35], v[224:227]
v_add_u32 v16, s71, v16
v_mfma_f32_16x16x32_bf16 v[228:231], a[24:27], a[36:39], v[228:231]
v_add_u32 v17, s71, v17
v_mfma_f32_16x16x32_bf16 v[232:235], a[24:27], a[40:43], v[232:235]
v_mfma_f32_16x16x32_bf16 v[236:239], a[24:27], a[44:47], v[236:239]
buffer_load_dwordx4 a[212:215], v5, s[28:31], 0 offen offset:3072 sc1
v_mfma_f32_16x16x32_bf16 v[240:243], a[24:27], a[48:51], v[240:243]
v_add_u32 v18, s71, v18
v_mfma_f32_16x16x32_bf16 v[244:247], a[24:27], a[52:55], v[244:247]
v_add_u32 v19, s71, v19
v_mfma_f32_16x16x32_bf16 v[248:251], a[24:27], a[56:59], v[248:251]
v_mfma_f32_16x16x32_bf16 v[252:255], a[24:27], a[60:63], v[252:255]
buffer_load_dwordx4 a[216:219], v6, s[28:31], 0 offen offset:3072 sc1
v_mfma_f32_16x16x32_bf16 a[128:131], a[28:31], a[32:35], a[128:131]
v_add_u32 v20, s71, v20
v_mfma_f32_16x16x32_bf16 a[132:135], a[28:31], a[36:39], a[132:135]
v_add_u32 v21, s71, v21
v_mfma_f32_16x16x32_bf16 a[136:139], a[28:31], a[40:43], a[136:139]
v_mfma_f32_16x16x32_bf16 a[140:143], a[28:31], a[44:47], a[140:143]
buffer_load_dwordx4 a[220:223], v7, s[28:31], 0 offen offset:3072 sc1
v_mfma_f32_16x16x32_bf16 a[144:147], a[28:31], a[48:51], a[144:147]
v_mfma_f32_16x16x32_bf16 a[148:151], a[28:31], a[52:55], a[148:151]
v_mfma_f32_16x16x32_bf16 a[152:155], a[28:31], a[56:59], a[152:155]
v_mfma_f32_16x16x32_bf16 a[156:159], a[28:31], a[60:63], a[156:159]
s_waitcnt vmcnt(32) lgkmcnt(0)
s_barrier
v_mfma_f32_16x16x32_bf16 v[32:35], a[64:67], a[96:99], v[32:35]
s_add_u32 m0, s54, 98304
s_add_u32 s73, s72, 3145728
v_mfma_f32_16x16x32_bf16 v[36:39], a[64:67], a[100:103], v[36:39]
buffer_load_dwordx4 v8, s[32:35], s73 offen offset:0 lds
ds_read_b64_tr_b16 a[0:1], v14 offset:0
v_mfma_f32_16x16x32_bf16 v[40:43], a[64:67], a[104:107], v[40:43]
ds_read_b64_tr_b16 a[2:3], v14 offset:1024
v_mfma_f32_16x16x32_bf16 v[44:47], a[64:67], a[108:111], v[44:47]
ds_read_b64_tr_b16 a[4:5], v15 offset:0
ds_read_b64_tr_b16 a[6:7], v15 offset:1024
v_mfma_f32_16x16x32_bf16 v[48:51], a[64:67], a[112:115], v[48:51]
buffer_load_dwordx4 v9, s[32:35], s73 offen offset:1024 lds
v_mfma_f32_16x16x32_bf16 v[52:55], a[64:67], a[116:119], v[52:55]
ds_read_b64_tr_b16 a[8:9], v16 offset:0
v_mfma_f32_16x16x32_bf16 v[56:59], a[64:67], a[120:123], v[56:59]
ds_read_b64_tr_b16 a[10:11], v16 offset:1024
v_mfma_f32_16x16x32_bf16 v[60:63], a[64:67], a[124:127], v[60:63]
ds_read_b64_tr_b16 a[12:13], v17 offset:0
ds_read_b64_tr_b16 a[14:15], v17 offset:1024
v_mfma_f32_16x16x32_bf16 v[64:67], a[68:71], a[96:99], v[64:67]
buffer_load_dwordx4 v10, s[32:35], s73 offen offset:2048 lds
v_mfma_f32_16x16x32_bf16 v[68:71], a[68:71], a[100:103], v[68:71]
ds_read_b64_tr_b16 a[16:17], v18 offset:0
v_mfma_f32_16x16x32_bf16 v[72:75], a[68:71], a[104:107], v[72:75]
ds_read_b64_tr_b16 a[18:19], v18 offset:1024
v_mfma_f32_16x16x32_bf16 v[76:79], a[68:71], a[108:111], v[76:79]
ds_read_b64_tr_b16 a[20:21], v19 offset:0
ds_read_b64_tr_b16 a[22:23], v19 offset:1024
v_mfma_f32_16x16x32_bf16 v[80:83], a[68:71], a[112:115], v[80:83]
buffer_load_dwordx4 v11, s[32:35], s73 offen offset:3072 lds
v_mfma_f32_16x16x32_bf16 v[84:87], a[68:71], a[116:119], v[84:87]
ds_read_b64_tr_b16 a[24:25], v20 offset:0
v_mfma_f32_16x16x32_bf16 v[88:91], a[68:71], a[120:123], v[88:91]
ds_read_b64_tr_b16 a[26:27], v20 offset:1024
v_mfma_f32_16x16x32_bf16 v[92:95], a[68:71], a[124:127], v[92:95]
s_add_u32 m0, s54, 102400
s_add_u32 s73, s72, 3276800
v_mfma_f32_16x16x32_bf16 v[96:99], a[72:75], a[96:99], v[96:99]
buffer_load_dwordx4 v8, s[32:35], s73 offen offset:0 lds
v_mfma_f32_16x16x32_bf16 v[100:103], a[72:75], a[100:103], v[100:103]
ds_read_b64_tr_b16 a[28:29], v21 offset:0
v_mfma_f32_16x16x32_bf16 v[104:107], a[72:75], a[104:107], v[104:107]
ds_read_b64_tr_b16 a[30:31], v21 offset:1024
v_mfma_f32_16x16x32_bf16 v[108:111], a[72:75], a[108:111], v[108:111]
v_mfma_f32_16x16x32_bf16 v[112:115], a[72:75], a[112:115], v[112:115]
buffer_load_dwordx4 v9, s[32:35], s73 offen offset:1024 lds
v_mfma_f32_16x16x32_bf16 v[116:119], a[72:75], a[116:119], v[116:119]
v_cvt_pk_bf16_f32 v32, v32, v33
v_cvt_pk_bf16_f32 v33, v34, v35
v_cvt_pk_bf16_f32 v34, v64, v65
v_mfma_f32_16x16x32_bf16 v[120:123], a[72:75], a[120:123], v[120:123]
v_cvt_pk_bf16_f32 v35, v66, v67
v_cvt_pk_bf16_f32 v36, v36, v37
v_cvt_pk_bf16_f32 v37, v38, v39
v_mfma_f32_16x16x32_bf16 v[124:127], a[72:75], a[124:127], v[124:127]
v_cvt_pk_bf16_f32 v38, v68, v69
v_cvt_pk_bf16_f32 v39, v70, v71
v_mfma_f32_16x16x32_bf16 v[128:131], a[76:79], a[96:99], v[128:131]
buffer_load_dwordx4 v10, s[32:35], s73 offen offset:2048 lds
v_cvt_pk_bf16_f32 v40, v40, v41
v_cvt_pk_bf16_f32 v41, v42, v43
v_mfma_f32_16x16x32_bf16 v[132:135], a[76:79], a[100:103], v[132:135]
v_cvt_pk_bf16_f32 v42, v72, v73
v_cvt_pk_bf16_f32 v43, v74, v75
v_mfma_f32_16x16x32_bf16 v[136:139], a[76:79], a[104:107], v[136:139]
v_cvt_pk_bf16_f32 v44, v44, v45
v_cvt_pk_bf16_f32 v45, v46, v47
v_mfma_f32_16x16x32_bf16 v[140:143], a[76:79], a[108:111], v[140:143]
v_cvt_pk_bf16_f32 v46, v76, v77
v_cvt_pk_bf16_f32 v47, v78, v79
v_mfma_f32_16x16x32_bf16 v[144:147], a[76:79], a[112:115], v[144:147]
buffer_load_dwordx4 v11, s[32:35], s73 offen offset:3072 lds
v_cvt_pk_bf16_f32 v48, v48, v49
v_cvt_pk_bf16_f32 v49, v50, v51
v_mfma_f32_16x16x32_bf16 v[148:151], a[76:79], a[116:119], v[148:151]
v_cvt_pk_bf16_f32 v50, v80, v81
v_cvt_pk_bf16_f32 v51, v82, v83
v_mfma_f32_16x16x32_bf16 v[152:155], a[76:79], a[120:123], v[152:155]
v_cvt_pk_bf16_f32 v52, v52, v53
v_cvt_pk_bf16_f32 v53, v54, v55
v_mfma_f32_16x16x32_bf16 v[156:159], a[76:79], a[124:127], v[156:159]
v_cvt_pk_bf16_f32 v54, v84, v85
v_cvt_pk_bf16_f32 v55, v86, v87
v_mfma_f32_16x16x32_bf16 v[160:163], a[80:83], a[96:99], v[160:163]
buffer_load_dwordx4 a[224:227], v4, s[28:31], s68 offen offset:0 sc1
v_cvt_pk_bf16_f32 v56, v56, v57
v_cvt_pk_bf16_f32 v57, v58, v59
v_mfma_f32_16x16x32_bf16 v[164:167], a[80:83], a[100:103], v[164:167]
v_cvt_pk_bf16_f32 v58, v88, v89
v_cvt_pk_bf16_f32 v59, v90, v91
v_mfma_f32_16x16x32_bf16 v[168:171], a[80:83], a[104:107], v[168:171]
v_cvt_pk_bf16_f32 v60, v60, v61
v_cvt_pk_bf16_f32 v61, v62, v63
v_mfma_f32_16x16x32_bf16 v[172:175], a[80:83], a[108:111], v[172:175]
buffer_load_dwordx4 a[228:231], v5, s[28:31], s68 offen offset:0 sc1
v_cvt_pk_bf16_f32 v62, v92, v93
v_mfma_f32_16x16x32_bf16 v[176:179], a[80:83], a[112:115], v[176:179]
v_cvt_pk_bf16_f32 v63, v94, v95
v_mfma_f32_16x16x32_bf16 v[180:183], a[80:83], a[116:119], v[180:183]
v_cvt_pk_bf16_f32 v96, v96, v97
v_cvt_pk_bf16_f32 v97, v98, v99
v_cvt_pk_bf16_f32 v98, v128, v129
v_mfma_f32_16x16x32_bf16 v[184:187], a[80:83], a[120:123], v[184:187]
v_cvt_pk_bf16_f32 v99, v130, v131
v_cvt_pk_bf16_f32 v100, v100, v101
v_cvt_pk_bf16_f32 v101, v102, v103
v_mfma_f32_16x16x32_bf16 v[188:191], a[80:83], a[124:127], v[188:191]
buffer_load_dwordx4 a[232:235], v6, s[28:31], s68 offen offset:0 sc1
v_cvt_pk_bf16_f32 v102, v132, v133
v_mfma_f32_16x16x32_bf16 v[192:195], a[84:87], a[96:99], v[192:195]
v_cvt_pk_bf16_f32 v103, v134, v135
v_cvt_pk_bf16_f32 v104, v104, v105
v_cvt_pk_bf16_f32 v105, v106, v107
v_mfma_f32_16x16x32_bf16 v[196:199], a[84:87], a[100:103], v[196:199]
v_cvt_pk_bf16_f32 v106, v136, v137
v_cvt_pk_bf16_f32 v107, v138, v139
v_mfma_f32_16x16x32_bf16 v[200:203], a[84:87], a[104:107], v[200:203]
v_cvt_pk_bf16_f32 v108, v108, v109
v_cvt_pk_bf16_f32 v109, v110, v111
v_mfma_f32_16x16x32_bf16 v[204:207], a[84:87], a[108:111], v[204:207]
buffer_load_dwordx4 a[236:239], v7, s[28:31], s68 offen offset:0 sc1
v_cvt_pk_bf16_f32 v110, v140, v141
v_cvt_pk_bf16_f32 v111, v142, v143
v_mfma_f32_16x16x32_bf16 v[208:211], a[84:87], a[112:115], v[208:211]
v_cvt_pk_bf16_f32 v112, v112, v113
v_cvt_pk_bf16_f32 v113, v114, v115
v_mfma_f32_16x16x32_bf16 v[212:215], a[84:87], a[116:119], v[212:215]
v_cvt_pk_bf16_f32 v114, v144, v145
v_cvt_pk_bf16_f32 v115, v146, v147
v_mfma_f32_16x16x32_bf16 v[216:219], a[84:87], a[120:123], v[216:219]
v_cvt_pk_bf16_f32 v116, v116, v117
v_cvt_pk_bf16_f32 v117, v118, v119
v_cvt_pk_bf16_f32 v118, v148, v149
v_mfma_f32_16x16x32_bf16 v[220:223], a[84:87], a[124:127], v[220:223]
buffer_store_dwordx4 v[32:35], v3, s[28:31], s62 offen
v_cvt_pk_bf16_f32 v119, v150, v151
v_mfma_f32_16x16x32_bf16 v[224:227], a[88:91], a[96:99], v[224:227]
v_cvt_pk_bf16_f32 v120, v120, v121
v_cvt_pk_bf16_f32 v121, v122, v123
v_mfma_f32_16x16x32_bf16 v[228:231], a[88:91], a[100:103], v[228:231]
v_cvt_pk_bf16_f32 v122, v152, v153
v_cvt_pk_bf16_f32 v123, v154, v155
v_cvt_pk_bf16_f32 v124, v124, v125
v_mfma_f32_16x16x32_bf16 v[232:235], a[88:91], a[104:107], v[232:235]
s_add_u32 s62, s62, s63
v_cvt_pk_bf16_f32 v125, v126, v127
v_mfma_f32_16x16x32_bf16 v[236:239], a[88:91], a[108:111], v[236:239]
buffer_store_dwordx4 v[36:39], v3, s[28:31], s62 offen
v_cvt_pk_bf16_f32 v126, v156, v157
v_mfma_f32_16x16x32_bf16 v[240:243], a[88:91], a[112:115], v[240:243]
v_cvt_pk_bf16_f32 v127, v158, v159
v_mfma_f32_16x16x32_bf16 v[244:247], a[88:91], a[116:119], v[244:247]
v_cvt_pk_bf16_f32 v160, v160, v161
v_cvt_pk_bf16_f32 v161, v162, v163
v_cvt_pk_bf16_f32 v162, v192, v193
v_cvt_pk_bf16_f32 v163, v194, v195
v_mfma_f32_16x16x32_bf16 v[248:251], a[88:91], a[120:123], v[248:251]
s_add_u32 s62, s62, s63
v_cvt_pk_bf16_f32 v164, v164, v165
v_cvt_pk_bf16_f32 v165, v166, v167
v_cvt_pk_bf16_f32 v166, v196, v197
v_mfma_f32_16x16x32_bf16 v[252:255], a[88:91], a[124:127], v[252:255]
buffer_store_dwordx4 v[40:43], v3, s[28:31], s62 offen
v_cvt_pk_bf16_f32 v167, v198, v199
v_cvt_pk_bf16_f32 v168, v168, v169
v_mfma_f32_16x16x32_bf16 a[128:131], a[92:95], a[96:99], a[128:131]
v_cvt_pk_bf16_f32 v169, v170, v171
v_cvt_pk_bf16_f32 v170, v200, v201
v_cvt_pk_bf16_f32 v171, v202, v203
v_cvt_pk_bf16_f32 v172, v172, v173
v_mfma_f32_16x16x32_bf16 a[132:135], a[92:95], a[100:103], a[132:135]
v_cvt_pk_bf16_f32 v173, v174, v175
v_cvt_pk_bf16_f32 v174, v204, v205
v_cvt_pk_bf16_f32 v175, v206, v207
v_mfma_f32_16x16x32_bf16 a[136:139], a[92:95], a[104:107], a[136:139]
s_add_u32 s62, s62, s63
v_cvt_pk_bf16_f32 v176, v176, v177
v_cvt_pk_bf16_f32 v177, v178, v179
v_mfma_f32_16x16x32_bf16 a[140:143], a[92:95], a[108:111], a[140:143]
buffer_store_dwordx4 v[44:47], v3, s[28:31], s62 offen
v_cvt_pk_bf16_f32 v178, v208, v209
v_cvt_pk_bf16_f32 v179, v210, v211
v_mfma_f32_16x16x32_bf16 a[144:147], a[92:95], a[112:115], a[144:147]
v_cvt_pk_bf16_f32 v180, v180, v181
v_cvt_pk_bf16_f32 v181, v182, v183
v_cvt_pk_bf16_f32 v182, v212, v213
v_cvt_pk_bf16_f32 v183, v214, v215
v_mfma_f32_16x16x32_bf16 a[148:151], a[92:95], a[116:119], a[148:151]
v_cvt_pk_bf16_f32 v184, v184, v185
v_cvt_pk_bf16_f32 v185, v186, v187
v_cvt_pk_bf16_f32 v186, v216, v217
v_mfma_f32_16x16x32_bf16 a[152:155], a[92:95], a[120:123], a[152:155]
v_cvt_pk_bf16_f32 v187, v218, v219
v_cvt_pk_bf16_f32 v188, v188, v189
v_cvt_pk_bf16_f32 v189, v190, v191
v_mfma_f32_16x16x32_bf16 a[156:159], a[92:95], a[124:127], a[156:159]
v_cvt_pk_bf16_f32 v190, v220, v221
v_cvt_pk_bf16_f32 v191, v222, v223
M_Q:
s_cmp_lt_u32 s45, 2
s_cbranch_scc0 M_QL
s_waitcnt vmcnt(28) lgkmcnt(0)
v_mfma_f32_16x16x32_bf16 v[64:67], a[0:3], a[160:163], 0
ds_read_b64_tr_b16 a[32:33], v14 offset:8192
ds_read_b64_tr_b16 a[34:35], v14 offset:9216
v_mfma_f32_16x16x32_bf16 v[68:71], a[4:7], a[160:163], 0
buffer_load_dwordx4 a[240:243], v4, s[28:31], s68 offen offset:1024 sc1
ds_read_b64_tr_b16 a[36:37], v15 offset:8192
v_mfma_f32_16x16x32_bf16 v[72:75], a[8:11], a[160:163], 0
ds_read_b64_tr_b16 a[38:39], v15 offset:9216
v_accvgpr_read_b32 v24, a128
v_accvgpr_read_b32 v25, a129
v_accvgpr_read_b32 v26, a130
v_accvgpr_read_b32 v27, a131
v_mfma_f32_16x16x32_bf16 v[76:79], a[12:15], a[160:163], 0
s_add_u32 s62, s62, s63
v_cvt_pk_bf16_f32 v224, v224, v225
v_cvt_pk_bf16_f32 v225, v226, v227
v_cvt_pk_bf16_f32 v226, v24, v25
v_cvt_pk_bf16_f32 v227, v26, v27
v_mfma_f32_16x16x32_bf16 v[80:83], a[16:19], a[160:163], 0
buffer_store_dwordx4 v[48:51], v3, s[28:31], s62 offen
v_accvgpr_read_b32 v24, a132
v_accvgpr_read_b32 v25, a133
v_accvgpr_read_b32 v26, a134
v_mfma_f32_16x16x32_bf16 v[84:87], a[20:23], a[160:163], 0
ds_read_b64_tr_b16 a[40:41], v16 offset:8192
v_accvgpr_read_b32 v27, a135
v_cvt_pk_bf16_f32 v228, v228, v229
v_cvt_pk_bf16_f32 v229, v230, v231
v_mfma_f32_16x16x32_bf16 v[88:91], a[24:27], a[160:163], 0
ds_read_b64_tr_b16 a[42:43], v16 offset:9216
v_cvt_pk_bf16_f32 v230, v24, v25
v_cvt_pk_bf16_f32 v231, v26, v27
v_accvgpr_read_b32 v24, a136
v_mfma_f32_16x16x32_bf16 v[92:95], a[28:31], a[160:163], 0
ds_read_b64_tr_b16 a[44:45], v17 offset:8192
v_accvgpr_read_b32 v25, a137
v_accvgpr_read_b32 v26, a138
v_accvgpr_read_b32 v27, a139
v_mfma_f32_16x16x32_bf16 v[128:131], a[0:3], a[164:167], 0
buffer_load_dwordx4 a[244:247], v5, s[28:31], s68 offen offset:1024 sc1
v_cvt_pk_bf16_f32 v232, v232, v233
v_cvt_pk_bf16_f32 v233, v234, v235
v_cvt_pk_bf16_f32 v234, v24, v25
v_mfma_f32_16x16x32_bf16 v[132:135], a[4:7], a[164:167], 0
ds_read_b64_tr_b16 a[46:47], v17 offset:9216
v_cvt_pk_bf16_f32 v235, v26, v27
v_accvgpr_read_b32 v24, a140
v_accvgpr_read_b32 v25, a141
v_mfma_f32_16x16x32_bf16 v[136:139], a[8:11], a[164:167], 0
ds_read_b64_tr_b16 a[48:49], v18 offset:8192
v_accvgpr_read_b32 v26, a142
v_accvgpr_read_b32 v27, a143
v_cvt_pk_bf16_f32 v236, v236, v237
v_mfma_f32_16x16x32_bf16 v[140:143], a[12:15], a[164:167], 0
s_add_u32 s62, s62, s63
v_cvt_pk_bf16_f32 v237, v238, v239
v_cvt_pk_bf16_f32 v238, v24, v25
v_cvt_pk_bf16_f32 v239, v26, v27
v_mfma_f32_16x16x32_bf16 v[144:147], a[16:19], a[164:167], 0
buffer_store_dwordx4 v[52:55], v3, s[28:31], s62 offen
v_accvgpr_read_b32 v24, a144
v_accvgpr_read_b32 v25, a145
v_accvgpr_read_b32 v26, a146
v_mfma_f32_16x16x32_bf16 v[148:151], a[20:23], a[164:167], 0
ds_read_b64_tr_b16 a[50:51], v18 offset:9216
v_accvgpr_read_b32 v27, a147
v_cvt_pk_bf16_f32 v240, v240, v241
v_cvt_pk_bf16_f32 v241, v242, v243
v_mfma_f32_16x16x32_bf16 v[152:155], a[24:27], a[164:167], 0
ds_read_b64_tr_b16 a[52:53], v19 offset:8192
v_cvt_pk_bf16_f32 v242, v24, v25
v_cvt_pk_bf16_f32 v243, v26, v27
v_accvgpr_read_b32 v24, a148
v_mfma_f32_16x16x32_bf16 v[156:159], a[28:31], a[164:167], 0
ds_read_b64_tr_b16 a[54:55], v19 offset:9216
v_accvgpr_read_b32 v25, a149
v_accvgpr_read_b32 v26, a150
v_accvgpr_read_b32 v27, a151
v_mfma_f32_16x16x32_bf16 v[192:195], a[0:3], a[168:171], 0
buffer_load_dwordx4 a[248:251], v6, s[28:31], s68 offen offset:1024 sc1
v_cvt_pk_bf16_f32 v244, v244, v245
v_cvt_pk_bf16_f32 v245, v246, v247
v_cvt_pk_bf16_f32 v246, v24, v25
v_mfma_f32_16x16x32_bf16 v[196:199], a[4:7], a[168:171], 0
ds_read_b64_tr_b16 a[56:57], v20 offset:8192
v_cvt_pk_bf16_f32 v247, v26, v27
v_accvgpr_read_b32 v24, a152
v_accvgpr_read_b32 v25, a153
v_mfma_f32_16x16x32_bf16 v[200:203], a[8:11], a[168:171], 0
ds_read_b64_tr_b16 a[58:59], v20 offset:9216
v_accvgpr_read_b32 v26, a154
v_accvgpr_read_b32 v27, a155
v_cvt_pk_bf16_f32 v248, v248, v249
v_mfma_f32_16x16x32_bf16 v[204:207], a[12:15], a[168:171], 0
s_add_u32 s62, s62, s63
v_cvt_pk_bf16_f32 v249, v250, v251
v_cvt_pk_bf16_f32 v250, v24, v25
v_cvt_pk_bf16_f32 v251, v26, v27
v_mfma_f32_16x16x32_bf16 v[208:211], a[16:19], a[168:171], 0
buffer_store_dwordx4 v[56:59], v3, s[28:31], s62 offen
v_accvgpr_read_b32 v24, a156
v_accvgpr_read_b32 v25, a157
v_accvgpr_read_b32 v26, a158
v_mfma_f32_16x16x32_bf16 v[212:215], a[20:23], a[168:171], 0
ds_read_b64_tr_b16 a[60:61], v21 offset:8192
v_accvgpr_read_b32 v27, a159
v_cvt_pk_bf16_f32 v252, v252, v253
v_cvt_pk_bf16_f32 v253, v254, v255
v_mfma_f32_16x16x32_bf16 v[216:219], a[24:27], a[168:171], 0
ds_read_b64_tr_b16 a[62:63], v21 offset:9216
v_cvt_pk_bf16_f32 v254, v24, v25
v_cvt_pk_bf16_f32 v255, v26, v27
v_mfma_f32_16x16x32_bf16 v[220:223], a[28:31], a[168:171], 0
v_mfma_f32_16x16x32_bf16 a[128:131], a[0:3], a[172:175], 0
buffer_load_dwordx4 a[252:255], v7, s[28:31], s68 offen offset:1024 sc1
v_mfma_f32_16x16x32_bf16 a[132:135], a[4:7], a[172:175], 0
v_mfma_f32_16x16x32_bf16 a[136:139], a[8:11], a[172:175], 0
v_mfma_f32_16x16x32_bf16 a[140:143], a[12:15], a[172:175], 0
s_add_u32 s62, s62, s63
v_mfma_f32_16x16x32_bf16 a[144:147], a[16:19], a[172:175], 0
buffer_store_dwordx4 v[60:63], v3, s[28:31], s62 offen
v_mfma_f32_16x16x32_bf16 a[148:151], a[20:23], a[172:175], 0
v_mfma_f32_16x16x32_bf16 a[152:155], a[24:27], a[172:175], 0
v_mfma_f32_16x16x32_bf16 a[156:159], a[28:31], a[172:175], 0
s_waitcnt vmcnt(32) lgkmcnt(0)
v_mfma_f32_16x16x32_bf16 v[64:67], a[32:35], a[176:179], v[64:67]
ds_read_b64_tr_b16 a[0:1], v14 offset:16384
ds_read_b64_tr_b16 a[2:3], v14 offset:17408
v_mfma_f32_16x16x32_bf16 v[128:131], a[32:35], a[180:183], v[128:131]
buffer_load_dwordx4 a[64:67], v4, s[28:31], s68 offen offset:2048 sc1
ds_read_b64_tr_b16 a[4:5], v15 offset:16384
v_mfma_f32_16x16x32_bf16 v[192:195], a[32:35], a[184:187], v[192:195]
ds_read_b64_tr_b16 a[6:7], v15 offset:17408
v_mfma_f32_16x16x32_bf16 a[128:131], a[32:35], a[188:191], a[128:131]
s_add_u32 s62, s62, s64
v_mfma_f32_16x16x32_bf16 v[68:71], a[36:39], a[176:179], v[68:71]
buffer_store_dwordx4 v[96:99], v3, s[28:31], s62 offen
v_mfma_f32_16x16x32_bf16 v[132:135], a[36:39], a[180:183], v[132:135]
ds_read_b64_tr_b16 a[8:9], v16 offset:16384
v_mfma_f32_16x16x32_bf16 v[196:199], a[36:39], a[184:187], v[196:199]
ds_read_b64_tr_b16 a[10:11], v16 offset:17408
v_mfma_f32_16x16x32_bf16 a[132:135], a[36:39], a[188:191], a[132:135]
ds_read_b64_tr_b16 a[12:13], v17 offset:16384
v_mfma_f32_16x16x32_bf16 v[72:75], a[40:43], a[176:179], v[72:75]
buffer_load_dwordx4 a[68:71], v5, s[28:31], s68 offen offset:2048 sc1
v_mfma_f32_16x16x32_bf16 v[136:139], a[40:43], a[180:183], v[136:139]
ds_read_b64_tr_b16 a[14:15], v17 offset:17408
v_mfma_f32_16x16x32_bf16 v[200:203], a[40:43], a[184:187], v[200:203]
ds_read_b64_tr_b16 a[16:17], v18 offset:16384
v_mfma_f32_16x16x32_bf16 a[136:139], a[40:43], a[188:191], a[136:139]
s_add_u32 s62, s62, s63
v_mfma_f32_16x16x32_bf16 v[76:79], a[44:47], a[176:179], v[76:79]
buffer_store_dwordx4 v[100:103], v3, s[28:31], s62 offen
v_mfma_f32_16x16x32_bf16 v[140:143], a[44:47], a[180:183], v[140:143]
ds_read_b64_tr_b16 a[18:19], v18 offset:17408
v_mfma_f32_16x16x32_bf16 v[204:207], a[44:47], a[184:187], v[204:207]
ds_read_b64_tr_b16 a[20:21], v19 offset:16384
v_mfma_f32_16x16x32_bf16 a[140:143], a[44:47], a[188:191], a[140:143]
ds_read_b64_tr_b16 a[22:23], v19 offset:17408
v_mfma_f32_16x16x32_bf16 v[80:83], a[48:51], a[176:179], v[80:83]
buffer_load_dwordx4 a[72:75], v6, s[28:31], s68 offen offset:2048 sc1
v_mfma_f32_16x16x32_bf16 v[144:147], a[48:51], a[180:183], v[144:147]
ds_read_b64_tr_b16 a[24:25], v20 offset:16384
v_mfma_f32_16x16x32_bf16 v[208:211], a[48:51], a[184:187], v[208:211]
ds_read_b64_tr_b16 a[26:27], v20 offset:17408
v_mfma_f32_16x16x32_bf16 a[144:147], a[48:51], a[188:191], a[144:147]
s_add_u32 s62, s62, s63
v_mfma_f32_16x16x32_bf16 v[84:87], a[52:55], a[176:179], v[84:87]
buffer_store_dwordx4 v[104:107], v3, s[28:31], s62 offen
v_mfma_f32_16x16x32_bf16 v[148:151], a[52:55], a[180:183], v[148:151]
ds_read_b64_tr_b16 a[28:29], v21 offset:16384
v_mfma_f32_16x16x32_bf16 v[212:215], a[52:55], a[184:187], v[212:215]
ds_read_b64_tr_b16 a[30:31], v21 offset:17408
v_mfma_f32_16x16x32_bf16 a[148:151], a[52:55], a[188:191], a[148:151]
v_mfma_f32_16x16x32_bf16 v[88:91], a[56:59], a[176:179], v[88:91]
buffer_load_dwordx4 a[76:79], v7, s[28:31], s68 offen offset:2048 sc1
v_mfma_f32_16x16x32_bf16 v[152:155], a[56:59], a[180:183], v[152:155]
v_mfma_f32_16x16x32_bf16 v[216:219], a[56:59], a[184:187], v[216:219]
v_mfma_f32_16x16x32_bf16 a[152:155], a[56:59], a[188:191], a[152:155]
s_add_u32 s62, s62, s63
v_mfma_f32_16x16x32_bf16 v[92:95], a[60:63], a[176:179], v[92:95]
buffer_store_dwordx4 v[108:111], v3, s[28:31], s62 offen
s_and_b32 s78, s78, s79
s_or_b32 s78, s78, s96
v_mfma_f32_16x16x32_bf16 v[156:159], a[60:63], a[180:183], v[156:159]
v_mfma_f32_16x16x32_bf16 v[220:223], a[60:63], a[184:187], v[220:223]
s_and_b32 s78, s78, s77
s_xor_b32 s65, s78, s77
v_mfma_f32_16x16x32_bf16 a[156:159], a[60:63], a[188:191], a[156:159]
s_waitcnt vmcnt(36) lgkmcnt(0)
v_mfma_f32_16x16x32_bf16 v[64:67], a[0:3], a[192:195], v[64:67]
ds_read_b64_tr_b16 a[32:33], v14 offset:24576
ds_read_b64_tr_b16 a[34:35], v14 offset:25600
v_mfma_f32_16x16x32_bf16 v[128:131], a[0:3], a[196:199], v[128:131]
buffer_load_dwordx4 a[80:83], v4, s[28:31], s68 offen offset:3072 sc1
ds_read_b64_tr_b16 a[36:37], v15 offset:24576
v_mfma_f32_16x16x32_bf16 v[192:195], a[0:3], a[200:203], v[192:195]
ds_read_b64_tr_b16 a[38:39], v15 offset:25600
v_mfma_f32_16x16x32_bf16 a[128:131], a[0:3], a[204:207], a[128:131]
s_add_u32 s62, s62, s63
v_mfma_f32_16x16x32_bf16 v[68:71], a[4:7], a[192:195], v[68:71]
buffer_store_dwordx4 v[112:115], v3, s[28:31], s62 offen
v_mfma_f32_16x16x32_bf16 v[132:135], a[4:7], a[196:199], v[132:135]
ds_read_b64_tr_b16 a[40:41], v16 offset:24576
v_mfma_f32_16x16x32_bf16 v[196:199], a[4:7], a[200:203], v[196:199]
ds_read_b64_tr_b16 a[42:43], v16 offset:25600
v_mfma_f32_16x16x32_bf16 a[132:135], a[4:7], a[204:207], a[132:135]
ds_read_b64_tr_b16 a[44:45], v17 offset:24576
v_mfma_f32_16x16x32_bf16 v[72:75], a[8:11], a[192:195], v[72:75]
buffer_load_dwordx4 a[84:87], v5, s[28:31], s68 offen offset:3072 sc1
v_mfma_f32_16x16x32_bf16 v[136:139], a[8:11], a[196:199], v[136:139]
ds_read_b64_tr_b16 a[46:47], v17 offset:25600
v_mfma_f32_16x16x32_bf16 v[200:203], a[8:11], a[200:203], v[200:203]
ds_read_b64_tr_b16 a[48:49], v18 offset:24576
v_mfma_f32_16x16x32_bf16 a[136:139], a[8:11], a[204:207], a[136:139]
s_add_u32 s62, s62, s63
v_mfma_f32_16x16x32_bf16 v[76:79], a[12:15], a[192:195], v[76:79]
buffer_store_dwordx4 v[116:119], v3, s[28:31], s62 offen
v_mfma_f32_16x16x32_bf16 v[140:143], a[12:15], a[196:199], v[140:143]
ds_read_b64_tr_b16 a[50:51], v18 offset:25600
v_mfma_f32_16x16x32_bf16 v[204:207], a[12:15], a[200:203], v[204:207]
ds_read_b64_tr_b16 a[52:53], v19 offset:24576
v_mfma_f32_16x16x32_bf16 a[140:143], a[12:15], a[204:207], a[140:143]
ds_read_b64_tr_b16 a[54:55], v19 offset:25600
v_mfma_f32_16x16x32_bf16 v[80:83], a[16:19], a[192:195], v[80:83]
buffer_load_dwordx4 a[88:91], v6, s[28:31], s68 offen offset:3072 sc1
v_mfma_f32_16x16x32_bf16 v[144:147], a[16:19], a[196:199], v[144:147]
ds_read_b64_tr_b16 a[56:57], v20 offset:24576
v_mfma_f32_16x16x32_bf16 v[208:211], a[16:19], a[200:203], v[208:211]
ds_read_b64_tr_b16 a[58:59], v20 offset:25600
v_mfma_f32_16x16x32_bf16 a[144:147], a[16:19], a[204:207], a[144:147]
s_add_u32 s62, s62, s63
v_mfma_f32_16x16x32_bf16 v[84:87], a[20:23], a[192:195], v[84:87]
buffer_store_dwordx4 v[120:123], v3, s[28:31], s62 offen
v_mfma_f32_16x16x32_bf16 v[148:151], a[20:23], a[196:199], v[148:151]
ds_read_b64_tr_b16 a[60:61], v21 offset:24576
v_mfma_f32_16x16x32_bf16 v[212:215], a[20:23], a[200:203], v[212:215]
ds_read_b64_tr_b16 a[62:63], v21 offset:25600
v_mfma_f32_16x16x32_bf16 a[148:151], a[20:23], a[204:207], a[148:151]
v_mfma_f32_16x16x32_bf16 v[88:91], a[24:27], a[192:195], v[88:91]
buffer_load_dwordx4 a[92:95], v7, s[28:31], s68 offen offset:3072 sc1
v_mfma_f32_16x16x32_bf16 v[152:155], a[24:27], a[196:199], v[152:155]
v_mfma_f32_16x16x32_bf16 v[216:219], a[24:27], a[200:203], v[216:219]
v_mfma_f32_16x16x32_bf16 a[152:155], a[24:27], a[204:207], a[152:155]
s_add_u32 s62, s62, s63
v_mfma_f32_16x16x32_bf16 v[92:95], a[28:31], a[192:195], v[92:95]
buffer_store_dwordx4 v[124:127], v3, s[28:31], s62 offen
v_mfma_f32_16x16x32_bf16 v[156:159], a[28:31], a[196:199], v[156:159]
v_mfma_f32_16x16x32_bf16 v[220:223], a[28:31], a[200:203], v[220:223]
v_mfma_f32_16x16x32_bf16 a[156:159], a[28:31], a[204:207], a[156:159]
s_waitcnt vmcnt(40) lgkmcnt(0)
s_barrier
s_waitcnt vmcnt(40) lgkmcnt(0)
v_mfma_f32_16x16x32_bf16 v[64:67], a[32:35], a[208:211], v[64:67]
v_add_u32 v14, 0xfffe0000, v14
v_add_u32 v15, 0xfffe0000, v15
v_add_u32 v16, 0xfffe0000, v16
v_mfma_f32_16x16x32_bf16 v[128:131], a[32:35], a[212:215], v[128:131]
buffer_load_dwordx4 a[96:99], v4, s[28:31], s69 offen offset:0 sc1
v_add_u32 v17, 0xfffe0000, v17
v_add_u32 v18, 0xfffe0000, v18
v_mfma_f32_16x16x32_bf16 v[192:195], a[32:35], a[216:219], v[192:195]
v_add_u32 v19, 0xfffe0000, v19
v_add_u32 v20, 0xfffe0000, v20
v_add_u32 v21, 0xfffe0000, v21
v_mfma_f32_16x16x32_bf16 a[128:131], a[32:35], a[220:223], a[128:131]
s_add_u32 s62, s62, s64
v_mfma_f32_16x16x32_bf16 v[68:71], a[36:39], a[208:211], v[68:71]
buffer_store_dwordx4 v[160:163], v3, s[28:31], s62 offen
v_mfma_f32_16x16x32_bf16 v[132:135], a[36:39], a[212:215], v[132:135]
ds_read_b64_tr_b16 a[0:1], v14 offset:0
ds_read_b64_tr_b16 a[2:3], v14 offset:1024
v_mfma_f32_16x16x32_bf16 v[196:199], a[36:39], a[216:219], v[196:199]
ds_read_b64_tr_b16 a[4:5], v15 offset:0
ds_read_b64_tr_b16 a[6:7], v15 offset:1024
v_mfma_f32_16x16x32_bf16 a[132:135], a[36:39], a[220:223], a[132:135]
ds_read_b64_tr_b16 a[8:9], v16 offset:0
v_mfma_f32_16x16x32_bf16 v[72:75], a[40:43], a[208:211], v[72:75]
buffer_load_dwordx4 a[100:103], v5, s[28:31], s69 offen offset:0 sc1
v_mfma_f32_16x16x32_bf16 v[136:139], a[40:43], a[212:215], v[136:139]
ds_read_b64_tr_b16 a[10:11], v16 offset:1024
v_mfma_f32_16x16x32_bf16 v[200:203], a[40:43], a[216:219], v[200:203]
ds_read_b64_tr_b16 a[12:13], v17 offset:0
v_mfma_f32_16x16x32_bf16 a[136:139], a[40:43], a[220:223], a[136:139]
ds_read_b64_tr_b16 a[14:15], v17 offset:1024
s_add_u32 s62, s62, s63
v_mfma_f32_16x16x32_bf16 v[76:79], a[44:47], a[208:211], v[76:79]
buffer_store_dwordx4 v[164:167], v3, s[28:31], s62 offen
v_mfma_f32_16x16x32_bf16 v[140:143], a[44:47], a[212:215], v[140:143]
ds_read_b64_tr_b16 a[16:17], v18 offset:0
v_mfma_f32_16x16x32_bf16 v[204:207], a[44:47], a[216:219], v[204:207]
ds_read_b64_tr_b16 a[18:19], v18 offset:1024
v_mfma_f32_16x16x32_bf16 a[140:143], a[44:47], a[220:223], a[140:143]
ds_read_b64_tr_b16 a[20:21], v19 offset:0
v_mfma_f32_16x16x32_bf16 v[80:83], a[48:51], a[208:211], v[80:83]
buffer_load_dwordx4 a[104:107], v6, s[28:31], s69 offen offset:0 sc1
v_mfma_f32_16x16x32_bf16 v[144:147], a[48:51], a[212:215], v[144:147]
ds_read_b64_tr_b16 a[22:23], v19 offset:1024
ds_read_b64_tr_b16 a[24:25], v20 offset:0
v_mfma_f32_16x16x32_bf16 v[208:211], a[48:51], a[216:219], v[208:211]
ds_read_b64_tr_b16 a[26:27], v20 offset:1024
v_mfma_f32_16x16x32_bf16 a[144:147], a[48:51], a[220:223], a[144:147]
s_add_u32 s62, s62, s63
v_mfma_f32_16x16x32_bf16 v[84:87], a[52:55], a[208:211], v[84:87]
buffer_store_dwordx4 v[168:171], v3, s[28:31], s62 offen
v_mfma_f32_16x16x32_bf16 v[148:151], a[52:55], a[212:215], v[148:151]
ds_read_b64_tr_b16 a[28:29], v21 offset:0
v_mfma_f32_16x16x32_bf16 v[212:215], a[52:55], a[216:219], v[212:215]
ds_read_b64_tr_b16 a[30:31], v21 offset:1024
v_mfma_f32_16x16x32_bf16 a[148:151], a[52:55], a[220:223], a[148:151]
v_mfma_f32_16x16x32_bf16 v[88:91], a[56:59], a[208:211], v[88:91]
buffer_load_dwordx4 a[108:111], v7, s[28:31], s69 offen offset:0 sc1
v_mfma_f32_16x16x32_bf16 v[152:155], a[56:59], a[212:215], v[152:155]
v_mfma_f32_16x16x32_bf16 v[216:219], a[56:59], a[216:219], v[216:219]
v_mfma_f32_16x16x32_bf16 a[152:155], a[56:59], a[220:223], a[152:155]
s_add_u32 s62, s62, s63
v_mfma_f32_16x16x32_bf16 v[92:95], a[60:63], a[208:211], v[92:95]
buffer_store_dwordx4 v[172:175], v3, s[28:31], s62 offen
v_mfma_f32_16x16x32_bf16 v[156:159], a[60:63], a[212:215], v[156:159]
v_mfma_f32_16x16x32_bf16 v[220:223], a[60:63], a[216:219], v[220:223]
v_mfma_f32_16x16x32_bf16 a[156:159], a[60:63], a[220:223], a[156:159]
s_waitcnt vmcnt(36) lgkmcnt(0)
v_mfma_f32_16x16x32_bf16 v[64:67], a[0:3], a[224:227], v[64:67]
ds_read_b64_tr_b16 a[32:33], v14 offset:8192
ds_read_b64_tr_b16 a[34:35], v14 offset:9216
v_mfma_f32_16x16x32_bf16 v[128:131], a[0:3], a[228:231], v[128:131]
buffer_load_dwordx4 a[112:115], v4, s[28:31], s69 offen offset:1024 sc1
ds_read_b64_tr_b16 a[36:37], v15 offset:8192
v_mfma_f32_16x16x32_bf16 v[192:195], a[0:3], a[232:235], v[192:195]
ds_read_b64_tr_b16 a[38:39], v15 offset:9216
v_mfma_f32_16x16x32_bf16 a[128:131], a[0:3], a[236:239], a[128:131]
s_add_u32 s62, s62, s63
v_mfma_f32_16x16x32_bf16 v[68:71], a[4:7], a[224:227], v[68:71]
buffer_store_dwordx4 v[176:179], v3, s[28:31], s62 offen
v_mfma_f32_16x16x32_bf16 v[132:135], a[4:7], a[228:231], v[132:135]
ds_read_b64_tr_b16 a[40:41], v16 offset:8192
v_mfma_f32_16x16x32_bf16 v[196:199], a[4:7], a[232:235], v[196:199]
ds_read_b64_tr_b16 a[42:43], v16 offset:9216
v_mfma_f32_16x16x32_bf16 a[132:135], a[4:7], a[236:239], a[132:135]
ds_read_b64_tr_b16 a[44:45], v17 offset:8192
v_mfma_f32_16x16x32_bf16 v[72:75], a[8:11], a[224:227], v[72:75]
buffer_load_dwordx4 a[116:119], v5, s[28:31], s69 offen offset:1024 sc1
v_mfma_f32_16x16x32_bf16 v[136:139], a[8:11], a[228:231], v[136:139]
ds_read_b64_tr_b16 a[46:47], v17 offset:9216
v_mfma_f32_16x16x32_bf16 v[200:203], a[8:11], a[232:235], v[200:203]
ds_read_b64_tr_b16 a[48:49], v18 offset:8192
v_mfma_f32_16x16x32_bf16 a[136:139], a[8:11], a[236:239], a[136:139]
s_add_u32 s62, s62, s63
v_mfma_f32_16x16x32_bf16 v[76:79], a[12:15], a[224:227], v[76:79]
buffer_store_dwordx4 v[180:183], v3, s[28:31], s62 offen
v_mfma_f32_16x16x32_bf16 v[140:143], a[12:15], a[228:231], v[140:143]
ds_read_b64_tr_b16 a[50:51], v18 offset:9216
v_mfma_f32_16x16x32_bf16 v[204:207], a[12:15], a[232:235], v[204:207]
ds_read_b64_tr_b16 a[52:53], v19 offset:8192
v_mfma_f32_16x16x32_bf16 a[140:143], a[12:15], a[236:239], a[140:143]
ds_read_b64_tr_b16 a[54:55], v19 offset:9216
v_mfma_f32_16x16x32_bf16 v[80:83], a[16:19], a[224:227], v[80:83]
buffer_load_dwordx4 a[120:123], v6, s[28:31], s69 offen offset:1024 sc1
v_mfma_f32_16x16x32_bf16 v[144:147], a[16:19], a[228:231], v[144:147]
ds_read_b64_tr_b16 a[56:57], v20 offset:8192
v_mfma_f32_16x16x32_bf16 v[208:211], a[16:19], a[232:235], v[208:211]
ds_read_b64_tr_b16 a[58:59], v20 offset:9216
v_mfma_f32_16x16x32_bf16 a[144:147], a[16:19], a[236:239], a[144:147]
s_add_u32 s62, s62, s63
v_mfma_f32_16x16x32_bf16 v[84:87], a[20:23], a[224:227], v[84:87]
buffer_store_dwordx4 v[184:187], v3, s[28:31], s62 offen
v_mfma_f32_16x16x32_bf16 v[148:151], a[20:23], a[228:231], v[148:151]
ds_read_b64_tr_b16 a[60:61], v21 offset:8192
v_mfma_f32_16x16x32_bf16 v[212:215], a[20:23], a[232:235], v[212:215]
ds_read_b64_tr_b16 a[62:63], v21 offset:9216
v_mfma_f32_16x16x32_bf16 a[148:151], a[20:23], a[236:239], a[148:151]
v_mfma_f32_16x16x32_bf16 v[88:91], a[24:27], a[224:227], v[88:91]
buffer_load_dwordx4 a[124:127], v7, s[28:31], s69 offen offset:1024 sc1
v_mfma_f32_16x16x32_bf16 v[152:155], a[24:27], a[228:231], v[152:155]
v_mfma_f32_16x16x32_bf16 v[216:219], a[24:27], a[232:235], v[216:219]
v_mfma_f32_16x16x32_bf16 a[152:155], a[24:27], a[236:239], a[152:155]
s_add_u32 s62, s62, s63
v_mfma_f32_16x16x32_bf16 v[92:95], a[28:31], a[224:227], v[92:95]
buffer_store_dwordx4 v[188:191], v3, s[28:31], s62 offen
v_mfma_f32_16x16x32_bf16 v[156:159], a[28:31], a[228:231], v[156:159]
v_mfma_f32_16x16x32_bf16 v[220:223], a[28:31], a[232:235], v[220:223]
v_mfma_f32_16x16x32_bf16 a[156:159], a[28:31], a[236:239], a[156:159]
s_waitcnt vmcnt(33) lgkmcnt(0)
v_mfma_f32_16x16x32_bf16 v[64:67], a[32:35], a[240:243], v[64:67]
ds_read_b64_tr_b16 a[0:1], v14 offset:16384
ds_read_b64_tr_b16 a[2:3], v14 offset:17408
v_mfma_f32_16x16x32_bf16 v[128:131], a[32:35], a[244:247], v[128:131]
buffer_load_dwordx4 a[160:163], v4, s[28:31], s69 offen offset:2048 sc1
ds_read_b64_tr_b16 a[4:5], v15 offset:16384
v_mfma_f32_16x16x32_bf16 v[192:195], a[32:35], a[248:251], v[192:195]
ds_read_b64_tr_b16 a[6:7], v15 offset:17408
v_mfma_f32_16x16x32_bf16 a[128:131], a[32:35], a[252:255], a[128:131]
s_add_u32 s62, s62, s64
v_mfma_f32_16x16x32_bf16 v[68:71], a[36:39], a[240:243], v[68:71]
buffer_store_dwordx4 v[224:227], v3, s[28:31], s62 offen
v_mfma_f32_16x16x32_bf16 v[132:135], a[36:39], a[244:247], v[132:135]
ds_read_b64_tr_b16 a[8:9], v16 offset:16384
v_mfma_f32_16x16x32_bf16 v[196:199], a[36:39], a[248:251], v[196:199]
ds_read_b64_tr_b16 a[10:11], v16 offset:17408
v_mfma_f32_16x16x32_bf16 a[132:135], a[36:39], a[252:255], a[132:135]
ds_read_b64_tr_b16 a[12:13], v17 offset:16384
v_mfma_f32_16x16x32_bf16 v[72:75], a[40:43], a[240:243], v[72:75]
buffer_load_dwordx4 a[164:167], v5, s[28:31], s69 offen offset:2048 sc1
v_mfma_f32_16x16x32_bf16 v[136:139], a[40:43], a[244:247], v[136:139]
ds_read_b64_tr_b16 a[14:15], v17 offset:17408
v_mfma_f32_16x16x32_bf16 v[200:203], a[40:43], a[248:251], v[200:203]
ds_read_b64_tr_b16 a[16:17], v18 offset:16384
v_mfma_f32_16x16x32_bf16 a[136:139], a[40:43], a[252:255], a[136:139]
s_add_u32 s62, s62, s63
v_mfma_f32_16x16x32_bf16 v[76:79], a[44:47], a[240:243], v[76:79]
buffer_store_dwordx4 v[228:231], v3, s[28:31], s62 offen
v_mfma_f32_16x16x32_bf16 v[140:143], a[44:47], a[244:247], v[140:143]
ds_read_b64_tr_b16 a[18:19], v18 offset:17408
v_mfma_f32_16x16x32_bf16 v[204:207], a[44:47], a[248:251], v[204:207]
ds_read_b64_tr_b16 a[20:21], v19 offset:16384
v_mfma_f32_16x16x32_bf16 a[140:143], a[44:47], a[252:255], a[140:143]
ds_read_b64_tr_b16 a[22:23], v19 offset:17408
v_mfma_f32_16x16x32_bf16 v[80:83], a[48:51], a[240:243], v[80:83]
buffer_load_dwordx4 a[168:171], v6, s[28:31], s69 offen offset:2048 sc1
v_mfma_f32_16x16x32_bf16 v[144:147], a[48:51], a[244:247], v[144:147]
ds_read_b64_tr_b16 a[24:25], v20 offset:16384
v_mfma_f32_16x16x32_bf16 v[208:211], a[48:51], a[248:251], v[208:211]
ds_read_b64_tr_b16 a[26:27], v20 offset:17408
v_mfma_f32_16x16x32_bf16 a[144:147], a[48:51], a[252:255], a[144:147]
s_add_u32 s62, s62, s63
v_mfma_f32_16x16x32_bf16 v[84:87], a[52:55], a[240:243], v[84:87]
buffer_store_dwordx4 v[232:235], v3, s[28:31], s62 offen
v_mfma_f32_16x16x32_bf16 v[148:151], a[52:55], a[244:247], v[148:151]
ds_read_b64_tr_b16 a[28:29], v21 offset:16384
v_mfma_f32_16x16x32_bf16 v[212:215], a[52:55], a[248:251], v[212:215]
ds_read_b64_tr_b16 a[30:31], v21 offset:17408
v_mfma_f32_16x16x32_bf16 a[148:151], a[52:55], a[252:255], a[148:151]
v_mfma_f32_16x16x32_bf16 v[88:91], a[56:59], a[240:243], v[88:91]
buffer_load_dwordx4 a[172:175], v7, s[28:31], s69 offen offset:2048 sc1
v_mfma_f32_16x16x32_bf16 v[152:155], a[56:59], a[244:247], v[152:155]
v_mfma_f32_16x16x32_bf16 v[216:219], a[56:59], a[248:251], v[216:219]
v_mfma_f32_16x16x32_bf16 a[152:155], a[56:59], a[252:255], a[152:155]
s_add_u32 s62, s62, s63
v_mfma_f32_16x16x32_bf16 v[92:95], a[60:63], a[240:243], v[92:95]
buffer_store_dwordx4 v[236:239], v3, s[28:31], s62 offen
v_mfma_f32_16x16x32_bf16 v[156:159], a[60:63], a[244:247], v[156:159]
v_mfma_f32_16x16x32_bf16 v[220:223], a[60:63], a[248:251], v[220:223]
v_mfma_f32_16x16x32_bf16 a[156:159], a[60:63], a[252:255], a[156:159]
s_waitcnt vmcnt(33) lgkmcnt(0)
v_mfma_f32_16x16x32_bf16 v[64:67], a[0:3], a[64:67], v[64:67]
ds_read_b64_tr_b16 a[32:33], v14 offset:24576
ds_read_b64_tr_b16 a[34:35], v14 offset:25600
v_mfma_f32_16x16x32_bf16 v[128:131], a[0:3], a[68:71], v[128:131]
buffer_load_dwordx4 a[176:179], v4, s[28:31], s69 offen offset:3072 sc1
ds_read_b64_tr_b16 a[36:37], v15 offset:24576
v_mfma_f32_16x16x32_bf16 v[192:195], a[0:3], a[72:75], v[192:195]
ds_read_b64_tr_b16 a[38:39], v15 offset:25600
v_mfma_f32_16x16x32_bf16 a[128:131], a[0:3], a[76:79], a[128:131]
s_add_u32 s62, s62, s63
v_mfma_f32_16x16x32_bf16 v[68:71], a[4:7], a[64:67], v[68:71]
buffer_store_dwordx4 v[240:243], v3, s[28:31], s62 offen
v_mfma_f32_16x16x32_bf16 v[132:135], a[4:7], a[68:71], v[132:135]
ds_read_b64_tr_b16 a[40:41], v16 offset:24576
v_mfma_f32_16x16x32_bf16 v[196:199], a[4:7], a[72:75], v[196:199]
ds_read_b64_tr_b16 a[42:43], v16 offset:25600
v_mfma_f32_16x16x32_bf16 a[132:135], a[4:7], a[76:79], a[132:135]
ds_read_b64_tr_b16 a[44:45], v17 offset:24576
v_mfma_f32_16x16x32_bf16 v[72:75], a[8:11], a[64:67], v[72:75]
buffer_load_dwordx4 a[180:183], v5, s[28:31], s69 offen offset:3072 sc1
v_mfma_f32_16x16x32_bf16 v[136:139], a[8:11], a[68:71], v[136:139]
ds_read_b64_tr_b16 a[46:47], v17 offset:25600
v_mfma_f32_16x16x32_bf16 v[200:203], a[8:11], a[72:75], v[200:203]
ds_read_b64_tr_b16 a[48:49], v18 offset:24576
v_mfma_f32_16x16x32_bf16 a[136:139], a[8:11], a[76:79], a[136:139]
s_add_u32 s62, s62, s63
v_mfma_f32_16x16x32_bf16 v[76:79], a[12:15], a[64:67], v[76:79]
buffer_store_dwordx4 v[244:247], v3, s[28:31], s62 offen
v_mfma_f32_16x16x32_bf16 v[140:143], a[12:15], a[68:71], v[140:143]
ds_read_b64_tr_b16 a[50:51], v18 offset:25600
v_mfma_f32_16x16x32_bf16 v[204:207], a[12:15], a[72:75], v[204:207]
ds_read_b64_tr_b16 a[52:53], v19 offset:24576
v_mfma_f32_16x16x32_bf16 a[140:143], a[12:15], a[76:79], a[140:143]
ds_read_b64_tr_b16 a[54:55], v19 offset:25600
v_mfma_f32_16x16x32_bf16 v[80:83], a[16:19], a[64:67], v[80:83]
buffer_load_dwordx4 a[184:187], v6, s[28:31], s69 offen offset:3072 sc1
v_mfma_f32_16x16x32_bf16 v[144:147], a[16:19], a[68:71], v[144:147]
ds_read_b64_tr_b16 a[56:57], v20 offset:24576
v_mfma_f32_16x16x32_bf16 v[208:211], a[16:19], a[72:75], v[208:211]
ds_read_b64_tr_b16 a[58:59], v20 offset:25600
v_mfma_f32_16x16x32_bf16 a[144:147], a[16:19], a[76:79], a[144:147]
s_add_u32 s62, s62, s63
v_mfma_f32_16x16x32_bf16 v[84:87], a[20:23], a[64:67], v[84:87]
buffer_store_dwordx4 v[248:251], v3, s[28:31], s62 offen
v_mfma_f32_16x16x32_bf16 v[148:151], a[20:23], a[68:71], v[148:151]
ds_read_b64_tr_b16 a[60:61], v21 offset:24576
v_mfma_f32_16x16x32_bf16 v[212:215], a[20:23], a[72:75], v[212:215]
ds_read_b64_tr_b16 a[62:63], v21 offset:25600
v_mfma_f32_16x16x32_bf16 a[148:151], a[20:23], a[76:79], a[148:151]
v_mfma_f32_16x16x32_bf16 v[88:91], a[24:27], a[64:67], v[88:91]
buffer_load_dwordx4 a[188:191], v7, s[28:31], s69 offen offset:3072 sc1
v_mfma_f32_16x16x32_bf16 v[152:155], a[24:27], a[68:71], v[152:155]
v_mfma_f32_16x16x32_bf16 v[216:219], a[24:27], a[72:75], v[216:219]
v_mfma_f32_16x16x32_bf16 a[152:155], a[24:27], a[76:79], a[152:155]
s_add_u32 s62, s62, s63
v_mfma_f32_16x16x32_bf16 v[92:95], a[28:31], a[64:67], v[92:95]
buffer_store_dwordx4 v[252:255], v3, s[28:31], s62 offen
v_mfma_f32_16x16x32_bf16 v[156:159], a[28:31], a[68:71], v[156:159]
v_mfma_f32_16x16x32_bf16 v[220:223], a[28:31], a[72:75], v[220:223]
v_mfma_f32_16x16x32_bf16 a[156:159], a[28:31], a[76:79], a[156:159]
s_waitcnt vmcnt(40) lgkmcnt(0)
s_barrier
s_waitcnt vmcnt(33) lgkmcnt(0)
v_mfma_f32_16x16x32_bf16 v[64:67], a[32:35], a[80:83], v[64:67]
ds_read_b64_tr_b16 a[0:1], v14 offset:32768
ds_read_b64_tr_b16 a[2:3], v14 offset:33792
v_mfma_f32_16x16x32_bf16 v[128:131], a[32:35], a[84:87], v[128:131]
buffer_load_dwordx4 a[192:195], v4, s[28:31], s74 offen offset:0 sc1
v_mfma_f32_16x16x32_bf16 v[192:195], a[32:35], a[88:91], v[192:195]
ds_read_b64_tr_b16 a[4:5], v15 offset:32768
v_mfma_f32_16x16x32_bf16 a[128:131], a[32:35], a[92:95], a[128:131]
ds_read_b64_tr_b16 a[6:7], v15 offset:33792
v_mfma_f32_16x16x32_bf16 v[68:71], a[36:39], a[80:83], v[68:71]
v_mfma_f32_16x16x32_bf16 v[132:135], a[36:39], a[84:87], v[132:135]
ds_read_b64_tr_b16 a[8:9], v16 offset:32768
v_mfma_f32_16x16x32_bf16 v[196:199], a[36:39], a[88:91], v[196:199]
ds_read_b64_tr_b16 a[10:11], v16 offset:33792
v_mfma_f32_16x16x32_bf16 a[132:135], a[36:39], a[92:95], a[132:135]
ds_read_b64_tr_b16 a[12:13], v17 offset:32768
v_mfma_f32_16x16x32_bf16 v[72:75], a[40:43], a[80:83], v[72:75]
buffer_load_dwordx4 a[196:199], v5, s[28:31], s74 offen offset:0 sc1
v_mfma_f32_16x16x32_bf16 v[136:139], a[40:43], a[84:87], v[136:139]
v_mfma_f32_16x16x32_bf16 v[200:203], a[40:43], a[88:91], v[200:203]
ds_read_b64_tr_b16 a[14:15], v17 offset:33792
v_mfma_f32_16x16x32_bf16 a[136:139], a[40:43], a[92:95], a[136:139]
ds_read_b64_tr_b16 a[16:17], v18 offset:32768
v_mfma_f32_16x16x32_bf16 v[76:79], a[44:47], a[80:83], v[76:79]
ds_read_b64_tr_b16 a[18:19], v18 offset:33792
v_mfma_f32_16x16x32_bf16 v[140:143], a[44:47], a[84:87], v[140:143]
ds_read_b64_tr_b16 a[20:21], v19 offset:32768
v_mfma_f32_16x16x32_bf16 v[204:207], a[44:47], a[88:91], v[204:207]
v_mfma_f32_16x16x32_bf16 a[140:143], a[44:47], a[92:95], a[140:143]
ds_read_b64_tr_b16 a[22:23], v19 offset:33792
v_mfma_f32_16x16x32_bf16 v[80:83], a[48:51], a[80:83], v[80:83]
buffer_load_dwordx4 a[200:203], v6, s[28:31], s74 offen offset:0 sc1
v_mfma_f32_16x16x32_bf16 v[144:147], a[48:51], a[84:87], v[144:147]
ds_read_b64_tr_b16 a[24:25], v20 offset:32768
v_mfma_f32_16x16x32_bf16 v[208:211], a[48:51], a[88:91], v[208:211]
ds_read_b64_tr_b16 a[26:27], v20 offset:33792
v_mfma_f32_16x16x32_bf16 a[144:147], a[48:51], a[92:95], a[144:147]
v_mfma_f32_16x16x32_bf16 v[84:87], a[52:55], a[80:83], v[84:87]
ds_read_b64_tr_b16 a[28:29], v21 offset:32768
v_mfma_f32_16x16x32_bf16 v[148:151], a[52:55], a[84:87], v[148:151]
ds_read_b64_tr_b16 a[30:31], v21 offset:33792
v_mfma_f32_16x16x32_bf16 v[212:215], a[52:55], a[88:91], v[212:215]
v_mfma_f32_16x16x32_bf16 a[148:151], a[52:55], a[92:95], a[148:151]
v_mfma_f32_16x16x32_bf16 v[88:91], a[56:59], a[80:83], v[88:91]
buffer_load_dwordx4 a[204:207], v7, s[28:31], s74 offen offset:0 sc1
v_mfma_f32_16x16x32_bf16 v[152:155], a[56:59], a[84:87], v[152:155]
v_mfma_f32_16x16x32_bf16 v[216:219], a[56:59], a[88:91], v[216:219]
v_mfma_f32_16x16x32_bf16 a[152:155], a[56:59], a[92:95], a[152:155]
v_mfma_f32_16x16x32_bf16 v[92:95], a[60:63], a[80:83], v[92:95]
v_mfma_f32_16x16x32_bf16 v[156:159], a[60:63], a[84:87], v[156:159]
v_mfma_f32_16x16x32_bf16 v[220:223], a[60:63], a[88:91], v[220:223]
v_mfma_f32_16x16x32_bf16 a[156:159], a[60:63], a[92:95], a[156:159]
s_waitcnt vmcnt(4)
s_barrier
s_cmp_eq_u32 s65, 0
s_cbranch_scc1 M_FASTE
buffer_wbl2 sc1
s_waitcnt vmcnt(0)
M_FASTE:
buffer_store_dword v31, v30, s[28:31], s98 offen sc1
s_waitcnt vmcnt(30) lgkmcnt(0)
v_mfma_f32_16x16x32_bf16 v[64:67], a[0:3], a[96:99], v[64:67]
ds_read_b64_tr_b16 a[32:33], v14 offset:40960
ds_read_b64_tr_b16 a[34:35], v14 offset:41984
v_mfma_f32_16x16x32_bf16 v[128:131], a[0:3], a[100:103], v[128:131]
buffer_load_dwordx4 a[208:211], v4, s[28:31], s74 offen offset:1024 sc1
v_mfma_f32_16x16x32_bf16 v[192:195], a[0:3], a[104:107], v[192:195]
ds_read_b64_tr_b16 a[36:37], v15 offset:40960
v_mfma_f32_16x16x32_bf16 a[128:131], a[0:3], a[108:111], a[128:131]
ds_read_b64_tr_b16 a[38:39], v15 offset:41984
v_mfma_f32_16x16x32_bf16 v[68:71], a[4:7], a[96:99], v[68:71]
v_mfma_f32_16x16x32_bf16 v[132:135], a[4:7], a[100:103], v[132:135]
ds_read_b64_tr_b16 a[40:41], v16 offset:40960
v_mfma_f32_16x16x32_bf16 v[196:199], a[4:7], a[104:107], v[196:199]
ds_read_b64_tr_b16 a[42:43], v16 offset:41984
v_mfma_f32_16x16x32_bf16 a[132:135], a[4:7], a[108:111], a[132:135]
ds_read_b64_tr_b16 a[44:45], v17 offset:40960
v_mfma_f32_16x16x32_bf16 v[72:75], a[8:11], a[96:99], v[72:75]
buffer_load_dwordx4 a[212:215], v5, s[28:31], s74 offen offset:1024 sc1
v_mfma_f32_16x16x32_bf16 v[136:139], a[8:11], a[100:103], v[136:139]
v_mfma_f32_16x16x32_bf16 v[200:203], a[8:11], a[104:107], v[200:203]
ds_read_b64_tr_b16 a[46:47], v17 offset:41984
v_mfma_f32_16x16x32_bf16 a[136:139], a[8:11], a[108:111], a[136:139]
ds_read_b64_tr_b16 a[48:49], v18 offset:40960
v_mfma_f32_16x16x32_bf16 v[76:79], a[12:15], a[96:99], v[76:79]
ds_read_b64_tr_b16 a[50:51], v18 offset:41984
v_mfma_f32_16x16x32_bf16 v[140:143], a[12:15], a[100:103], v[140:143]
ds_read_b64_tr_b16 a[52:53], v19 offset:40960
v_mfma_f32_16x16x32_bf16 v[204:207], a[12:15], a[104:107], v[204:207]
v_mfma_f32_16x16x32_bf16 a[140:143], a[12:15], a[108:111], a[140:143]
ds_read_b64_tr_b16 a[54:55], v19 offset:41984
v_mfma_f32_16x16x32_bf16 v[80:83], a[16:19], a[96:99], v[80:83]
buffer_load_dwordx4 a[216:219], v6, s[28:31], s74 offen offset:1024 sc1
v_mfma_f32_16x16x32_bf16 v[144:147], a[16:19], a[100:103], v[144:147]
ds_read_b64_tr_b16 a[56:57], v20 offset:40960
v_mfma_f32_16x16x32_bf16 v[208:211], a[16:19], a[104:107], v[208:211]
ds_read_b64_tr_b16 a[58:59], v20 offset:41984
v_mfma_f32_16x16x32_bf16 a[144:147], a[16:19], a[108:111], a[144:147]
v_mfma_f32_16x16x32_bf16 v[84:87], a[20:23], a[96:99], v[84:87]
ds_read_b64_tr_b16 a[60:61], v21 offset:40960
v_mfma_f32_16x16x32_bf16 v[148:151], a[20:23], a[100:103], v[148:151]
ds_read_b64_tr_b16 a[62:63], v21 offset:41984
v_mfma_f32_16x16x32_bf16 v[212:215], a[20:23], a[104:107], v[212:215]
v_mfma_f32_16x16x32_bf16 a[148:151], a[20:23], a[108:111], a[148:151]
v_mfma_f32_16x16x32_bf16 v[88:91], a[24:27], a[96:99], v[88:91]
buffer_load_dwordx4 a[220:223], v7, s[28:31], s74 offen offset:1024 sc1
v_mfma_f32_16x16x32_bf16 v[152:155], a[24:27], a[100:103], v[152:155]
v_mfma_f32_16x16x32_bf16 v[216:219], a[24:27], a[104:107], v[216:219]
v_mfma_f32_16x16x32_bf16 a[152:155], a[24:27], a[108:111], a[152:155]
v_mfma_f32_16x16x32_bf16 v[92:95], a[28:31], a[96:99], v[92:95]
v_mfma_f32_16x16x32_bf16 v[156:159], a[28:31], a[100:103], v[156:159]
v_mfma_f32_16x16x32_bf16 v[220:223], a[28:31], a[104:107], v[220:223]
s_mov_b32 s71, s56
v_mfma_f32_16x16x32_bf16 a[156:159], a[28:31], a[108:111], a[156:159]
s_waitcnt vmcnt(26) lgkmcnt(0)
v_mfma_f32_16x16x32_bf16 v[64:67], a[32:35], a[112:115], v[64:67]
ds_read_b64_tr_b16 a[0:1], v14 offset:49152
ds_read_b64_tr_b16 a[2:3], v14 offset:50176
v_mfma_f32_16x16x32_bf16 v[128:131], a[32:35], a[116:119], v[128:131]
buffer_load_dwordx4 a[224:227], v4, s[28:31], s74 offen offset:2048 sc1
s_mov_b32 s20, s88
v_mfma_f32_16x16x32_bf16 v[192:195], a[32:35], a[120:123], v[192:195]
ds_read_b64_tr_b16 a[4:5], v15 offset:49152
v_mfma_f32_16x16x32_bf16 a[128:131], a[32:35], a[124:127], a[128:131]
ds_read_b64_tr_b16 a[6:7], v15 offset:50176
v_mfma_f32_16x16x32_bf16 v[68:71], a[36:39], a[112:115], v[68:71]
s_and_b32 s21, s89, 0xffff
v_mfma_f32_16x16x32_bf16 v[132:135], a[36:39], a[116:119], v[132:135]
ds_read_b64_tr_b16 a[8:9], v16 offset:49152
v_mfma_f32_16x16x32_bf16 v[196:199], a[36:39], a[120:123], v[196:199]
ds_read_b64_tr_b16 a[10:11], v16 offset:50176
v_mfma_f32_16x16x32_bf16 a[132:135], a[36:39], a[124:127], a[132:135]
ds_read_b64_tr_b16 a[12:13], v17 offset:49152
v_mfma_f32_16x16x32_bf16 v[72:75], a[40:43], a[112:115], v[72:75]
buffer_load_dwordx4 a[228:231], v5, s[28:31], s74 offen offset:2048 sc1
v_mfma_f32_16x16x32_bf16 v[136:139], a[40:43], a[116:119], v[136:139]
s_mov_b32 s22, 0x1c0000
v_mfma_f32_16x16x32_bf16 v[200:203], a[40:43], a[120:123], v[200:203]
ds_read_b64_tr_b16 a[14:15], v17 offset:50176
v_mfma_f32_16x16x32_bf16 a[136:139], a[40:43], a[124:127], a[136:139]
ds_read_b64_tr_b16 a[16:17], v18 offset:49152
v_mfma_f32_16x16x32_bf16 v[76:79], a[44:47], a[112:115], v[76:79]
ds_read_b64_tr_b16 a[18:19], v18 offset:50176
v_mfma_f32_16x16x32_bf16 v[140:143], a[44:47], a[116:119], v[140:143]
ds_read_b64_tr_b16 a[20:21], v19 offset:49152
v_mfma_f32_16x16x32_bf16 v[204:207], a[44:47], a[120:123], v[204:207]
s_mov_b32 s23, 0x20000
v_mfma_f32_16x16x32_bf16 a[140:143], a[44:47], a[124:127], a[140:143]
ds_read_b64_tr_b16 a[22:23], v19 offset:50176
v_mfma_f32_16x16x32_bf16 v[80:83], a[48:51], a[112:115], v[80:83]
buffer_load_dwordx4 a[232:235], v6, s[28:31], s74 offen offset:2048 sc1
v_mfma_f32_16x16x32_bf16 v[144:147], a[48:51], a[116:119], v[144:147]
ds_read_b64_tr_b16 a[24:25], v20 offset:49152
v_mfma_f32_16x16x32_bf16 v[208:211], a[48:51], a[120:123], v[208:211]
ds_read_b64_tr_b16 a[26:27], v20 offset:50176
v_mfma_f32_16x16x32_bf16 a[144:147], a[48:51], a[124:127], a[144:147]
s_mov_b32 s24, s90
v_mfma_f32_16x16x32_bf16 v[84:87], a[52:55], a[112:115], v[84:87]
ds_read_b64_tr_b16 a[28:29], v21 offset:49152
v_mfma_f32_16x16x32_bf16 v[148:151], a[52:55], a[116:119], v[148:151]
ds_read_b64_tr_b16 a[30:31], v21 offset:50176
v_mfma_f32_16x16x32_bf16 v[212:215], a[52:55], a[120:123], v[212:215]
s_and_b32 s25, s91, 0xffff
v_mfma_f32_16x16x32_bf16 a[148:151], a[52:55], a[124:127], a[148:151]
s_mov_b32 s26, 0x1c0000
v_mfma_f32_16x16x32_bf16 v[88:91], a[56:59], a[112:115], v[88:91]
buffer_load_dwordx4 a[236:239], v7, s[28:31], s74 offen offset:2048 sc1
v_mfma_f32_16x16x32_bf16 v[152:155], a[56:59], a[116:119], v[152:155]
s_mov_b32 s27, 0x20000
v_mfma_f32_16x16x32_bf16 v[216:219], a[56:59], a[120:123], v[216:219]
s_mov_b32 s32, s92
v_mfma_f32_16x16x32_bf16 a[152:155], a[56:59], a[124:127], a[152:155]
s_and_b32 s33, s93, 0xffff
v_mfma_f32_16x16x32_bf16 v[92:95], a[60:63], a[112:115], v[92:95]
s_mov_b32 s34, 0x1c0000
v_mfma_f32_16x16x32_bf16 v[156:159], a[60:63], a[116:119], v[156:159]
s_mov_b32 s35, 0x20000
v_mfma_f32_16x16x32_bf16 v[220:223], a[60:63], a[120:123], v[220:223]
v_mfma_f32_16x16x32_bf16 a[156:159], a[60:63], a[124:127], a[156:159]
s_waitcnt vmcnt(22) lgkmcnt(0)
v_mfma_f32_16x16x32_bf16 v[64:67], a[0:3], a[160:163], v[64:67]
ds_read_b64_tr_b16 a[32:33], v14 offset:57344
ds_read_b64_tr_b16 a[34:35], v14 offset:58368
v_mfma_f32_16x16x32_bf16 v[128:131], a[0:3], a[164:167], v[128:131]
buffer_load_dwordx4 a[240:243], v4, s[28:31], s74 offen offset:3072 sc1
s_lshl_b32 s46, s43, 2
v_mfma_f32_16x16x32_bf16 v[192:195], a[0:3], a[168:171], v[192:195]
ds_read_b64_tr_b16 a[36:37], v15 offset:57344
v_mfma_f32_16x16x32_bf16 a[128:131], a[0:3], a[172:175], a[128:131]
ds_read_b64_tr_b16 a[38:39], v15 offset:58368
s_add_u32 s46, s46, s3
v_mfma_f32_16x16x32_bf16 v[68:71], a[4:7], a[160:163], v[68:71]
s_mul_i32 s47, s46, 14336
v_mfma_f32_16x16x32_bf16 v[132:135], a[4:7], a[164:167], v[132:135]
ds_read_b64_tr_b16 a[40:41], v16 offset:57344
v_mfma_f32_16x16x32_bf16 v[196:199], a[4:7], a[168:171], v[196:199]
ds_read_b64_tr_b16 a[42:43], v16 offset:58368
v_mfma_f32_16x16x32_bf16 a[132:135], a[4:7], a[172:175], a[132:135]
ds_read_b64_tr_b16 a[44:45], v17 offset:57344
s_mul_i32 s48, s42, 448
v_mfma_f32_16x16x32_bf16 v[72:75], a[8:11], a[160:163], v[72:75]
buffer_load_dwordx4 a[244:247], v5, s[28:31], s74 offen offset:3072 sc1
v_mfma_f32_16x16x32_bf16 v[136:139], a[8:11], a[164:167], v[136:139]
s_andn2_b32 s48, s48, 127
v_mfma_f32_16x16x32_bf16 v[200:203], a[8:11], a[168:171], v[200:203]
ds_read_b64_tr_b16 a[46:47], v17 offset:58368
s_add_u32 s47, s47, s48
v_mfma_f32_16x16x32_bf16 a[136:139], a[8:11], a[172:175], a[136:139]
ds_read_b64_tr_b16 a[48:49], v18 offset:57344
v_mfma_f32_16x16x32_bf16 v[76:79], a[12:15], a[160:163], v[76:79]
ds_read_b64_tr_b16 a[50:51], v18 offset:58368
v_mfma_f32_16x16x32_bf16 v[140:143], a[12:15], a[164:167], v[140:143]
ds_read_b64_tr_b16 a[52:53], v19 offset:57344
v_mfma_f32_16x16x32_bf16 v[204:207], a[12:15], a[168:171], v[204:207]
v_lshrrev_b32 v22, 2, v1
v_mul_u32_u24 v22, 3584, v22
v_mfma_f32_16x16x32_bf16 a[140:143], a[12:15], a[172:175], a[140:143]
ds_read_b64_tr_b16 a[54:55], v19 offset:58368
v_mfma_f32_16x16x32_bf16 v[80:83], a[16:19], a[160:163], v[80:83]
buffer_load_dwordx4 a[248:251], v6, s[28:31], s74 offen offset:3072 sc1
v_mfma_f32_16x16x32_bf16 v[144:147], a[16:19], a[164:167], v[144:147]
ds_read_b64_tr_b16 a[56:57], v20 offset:57344
v_and_b32 v23, 3, v1
v_mfma_f32_16x16x32_bf16 v[208:211], a[16:19], a[168:171], v[208:211]
ds_read_b64_tr_b16 a[58:59], v20 offset:58368
v_mfma_f32_16x16x32_bf16 a[144:147], a[16:19], a[172:175], a[144:147]
v_lshl_add_u32 v22, v23, 7, v22
v_mfma_f32_16x16x32_bf16 v[84:87], a[20:23], a[160:163], v[84:87]
ds_read_b64_tr_b16 a[60:61], v21 offset:57344
v_mfma_f32_16x16x32_bf16 v[148:151], a[20:23], a[164:167], v[148:151]
ds_read_b64_tr_b16 a[62:63], v21 offset:58368
v_add_u32 v22, s47, v22
v_mfma_f32_16x16x32_bf16 v[212:215], a[20:23], a[168:171], v[212:215]
v_cmp_gt_u32 vcc, 16, v1
v_mfma_f32_16x16x32_bf16 a[148:151], a[20:23], a[172:175], a[148:151]
v_mov_b32 v24, 0x40000000
v_mfma_f32_16x16x32_bf16 v[88:91], a[24:27], a[160:163], v[88:91]
buffer_load_dwordx4 a[252:255], v7, s[28:31], s74 offen offset:3072 sc1
s_mul_i32 s47, s46, 1792
v_mfma_f32_16x16x32_bf16 v[152:155], a[24:27], a[164:167], v[152:155]
s_mul_i32 s48, s42, 229376
v_mfma_f32_16x16x32_bf16 v[216:219], a[24:27], a[168:171], v[216:219]
s_add_u32 s47, s47, s48
v_mfma_f32_16x16x32_bf16 a[152:155], a[24:27], a[172:175], a[152:155]
v_cndmask_b32 v25, v24, v22, vcc
v_mfma_f32_16x16x32_bf16 v[92:95], a[28:31], a[160:163], v[92:95]
v_cmp_gt_u32 vcc, 14, v1
v_lshlrev_b32 v23, 7, v1
v_mfma_f32_16x16x32_bf16 v[156:159], a[28:31], a[164:167], v[156:159]
v_add_u32 v23, s47, v23
v_mfma_f32_16x16x32_bf16 v[220:223], a[28:31], a[168:171], v[220:223]
v_cndmask_b32 v26, v24, v23, vcc
v_mfma_f32_16x16x32_bf16 a[156:159], a[28:31], a[172:175], a[156:159]
s_waitcnt vmcnt(40) lgkmcnt(0)
s_barrier
s_waitcnt vmcnt(18) lgkmcnt(0)
v_mfma_f32_16x16x32_bf16 v[64:67], a[32:35], a[176:179], v[64:67]
v_add_u32 v14, 0x18000, v14
v_add_u32 v15, 0x18000, v15
v_mfma_f32_16x16x32_bf16 v[128:131], a[32:35], a[180:183], v[128:131]
v_add_u32 v16, 0x18000, v16
v_add_u32 v17, 0x18000, v17
v_mfma_f32_16x16x32_bf16 v[192:195], a[32:35], a[184:187], v[192:195]
v_add_u32 v18, 0x18000, v18
v_add_u32 v19, 0x18000, v19
v_mfma_f32_16x16x32_bf16 a[128:131], a[32:35], a[188:191], a[128:131]
v_add_u32 v20, 0x18000, v20
v_add_u32 v21, 0x18000, v21
v_mfma_f32_16x16x32_bf16 v[68:71], a[36:39], a[176:179], v[68:71]
v_mfma_f32_16x16x32_bf16 v[132:135], a[36:39], a[180:183], v[132:135]
ds_read_b64_tr_b16 a[0:1], v14 offset:0
ds_read_b64_tr_b16 a[2:3], v14 offset:1024
v_mfma_f32_16x16x32_bf16 v[196:199], a[36:39], a[184:187], v[196:199]
ds_read_b64_tr_b16 a[4:5], v15 offset:0
v_mfma_f32_16x16x32_bf16 a[132:135], a[36:39], a[188:191], a[132:135]
ds_read_b64_tr_b16 a[6:7], v15 offset:1024
v_mfma_f32_16x16x32_bf16 v[72:75], a[40:43], a[176:179], v[72:75]
ds_read_b64_tr_b16 a[8:9], v16 offset:0
v_mfma_f32_16x16x32_bf16 v[136:139], a[40:43], a[180:183], v[136:139]
ds_read_b64_tr_b16 a[10:11], v16 offset:1024
v_mfma_f32_16x16x32_bf16 v[200:203], a[40:43], a[184:187], v[200:203]
ds_read_b64_tr_b16 a[12:13], v17 offset:0
v_mfma_f32_16x16x32_bf16 a[136:139], a[40:43], a[188:191], a[136:139]
v_mfma_f32_16x16x32_bf16 v[76:79], a[44:47], a[176:179], v[76:79]
ds_read_b64_tr_b16 a[14:15], v17 offset:1024
v_mfma_f32_16x16x32_bf16 v[140:143], a[44:47], a[180:183], v[140:143]
ds_read_b64_tr_b16 a[16:17], v18 offset:0
v_mfma_f32_16x16x32_bf16 v[204:207], a[44:47], a[184:187], v[204:207]
ds_read_b64_tr_b16 a[18:19], v18 offset:1024
v_mfma_f32_16x16x32_bf16 a[140:143], a[44:47], a[188:191], a[140:143]
ds_read_b64_tr_b16 a[20:21], v19 offset:0
v_mfma_f32_16x16x32_bf16 v[80:83], a[48:51], a[176:179], v[80:83]
ds_read_b64_tr_b16 a[22:23], v19 offset:1024
v_mfma_f32_16x16x32_bf16 v[144:147], a[48:51], a[180:183], v[144:147]
v_mfma_f32_16x16x32_bf16 v[208:211], a[48:51], a[184:187], v[208:211]
ds_read_b64_tr_b16 a[24:25], v20 offset:0
v_mfma_f32_16x16x32_bf16 a[144:147], a[48:51], a[188:191], a[144:147]
ds_read_b64_tr_b16 a[26:27], v20 offset:1024
v_mfma_f32_16x16x32_bf16 v[84:87], a[52:55], a[176:179], v[84:87]
ds_read_b64_tr_b16 a[28:29], v21 offset:0
v_mfma_f32_16x16x32_bf16 v[148:151], a[52:55], a[180:183], v[148:151]
ds_read_b64_tr_b16 a[30:31], v21 offset:1024
v_mfma_f32_16x16x32_bf16 v[212:215], a[52:55], a[184:187], v[212:215]
v_mfma_f32_16x16x32_bf16 a[148:151], a[52:55], a[188:191], a[148:151]
v_mfma_f32_16x16x32_bf16 v[88:91], a[56:59], a[176:179], v[88:91]
v_mfma_f32_16x16x32_bf16 v[152:155], a[56:59], a[180:183], v[152:155]
v_mfma_f32_16x16x32_bf16 v[216:219], a[56:59], a[184:187], v[216:219]
v_mfma_f32_16x16x32_bf16 a[152:155], a[56:59], a[188:191], a[152:155]
v_mfma_f32_16x16x32_bf16 v[92:95], a[60:63], a[176:179], v[92:95]
v_mfma_f32_16x16x32_bf16 v[156:159], a[60:63], a[180:183], v[156:159]
v_mfma_f32_16x16x32_bf16 v[220:223], a[60:63], a[184:187], v[220:223]
v_mfma_f32_16x16x32_bf16 a[156:159], a[60:63], a[188:191], a[156:159]
s_waitcnt vmcnt(13) lgkmcnt(0)
v_mfma_f32_16x16x32_bf16 v[64:67], a[0:3], a[192:195], v[64:67]
ds_read_b64_tr_b16 a[32:33], v14 offset:8192
ds_read_b64_tr_b16 a[34:35], v14 offset:9216
v_mfma_f32_16x16x32_bf16 v[128:131], a[0:3], a[196:199], v[128:131]
buffer_load_dword v28, v2, s[28:31], s71 offen sc1
s_lshl_b32 s47, s44, 19
v_mfma_f32_16x16x32_bf16 v[192:195], a[0:3], a[200:203], v[192:195]
ds_read_b64_tr_b16 a[36:37], v15 offset:8192
v_mfma_f32_16x16x32_bf16 a[128:131], a[0:3], a[204:207], a[128:131]
s_add_u32 s49, s47, 16777216
v_mfma_f32_16x16x32_bf16 v[68:71], a[4:7], a[192:195], v[68:71]
ds_read_b64_tr_b16 a[38:39], v15 offset:9216
s_mov_b32 s18, 0x80000
v_mfma_f32_16x16x32_bf16 v[132:135], a[4:7], a[196:199], v[132:135]
ds_read_b64_tr_b16 a[40:41], v16 offset:8192
v_mfma_f32_16x16x32_bf16 v[196:199], a[4:7], a[200:203], v[196:199]
s_add_u32 s48, s47, 33554432
v_mfma_f32_16x16x32_bf16 a[132:135], a[4:7], a[204:207], a[132:135]
ds_read_b64_tr_b16 a[42:43], v16 offset:9216
v_mfma_f32_16x16x32_bf16 v[72:75], a[8:11], a[192:195], v[72:75]
ds_read_b64_tr_b16 a[44:45], v17 offset:8192
v_mfma_f32_16x16x32_bf16 v[136:139], a[8:11], a[196:199], v[136:139]
ds_read_b64_tr_b16 a[46:47], v17 offset:9216
s_lshl_b32 s74, s3, 12
v_mfma_f32_16x16x32_bf16 v[200:203], a[8:11], a[200:203], v[200:203]
v_add_u32 v5, s74, v3
v_mfma_f32_16x16x32_bf16 a[136:139], a[8:11], a[204:207], a[136:139]
ds_read_b64_tr_b16 a[48:49], v18 offset:8192
v_mfma_f32_16x16x32_bf16 v[76:79], a[12:15], a[192:195], v[76:79]
ds_read_b64_tr_b16 a[50:51], v18 offset:9216
v_mfma_f32_16x16x32_bf16 v[140:143], a[12:15], a[196:199], v[140:143]
v_add_u32 v4, s49, v5
s_add_u32 s15, s49, s74
v_mfma_f32_16x16x32_bf16 v[204:207], a[12:15], a[200:203], v[204:207]
ds_read_b64_tr_b16 a[52:53], v19 offset:8192
v_mfma_f32_16x16x32_bf16 a[140:143], a[12:15], a[204:207], a[140:143]
ds_read_b64_tr_b16 a[54:55], v19 offset:9216
v_mfma_f32_16x16x32_bf16 v[80:83], a[16:19], a[192:195], v[80:83]
ds_read_b64_tr_b16 a[56:57], v20 offset:8192
v_mfma_f32_16x16x32_bf16 v[144:147], a[16:19], a[196:199], v[144:147]
s_mov_b32 s13, -16384
v_mfma_f32_16x16x32_bf16 v[208:211], a[16:19], a[200:203], v[208:211]
ds_read_b64_tr_b16 a[58:59], v20 offset:9216
s_lshl_b32 s14, s45, 1
v_mfma_f32_16x16x32_bf16 a[144:147], a[16:19], a[204:207], a[144:147]
ds_read_b64_tr_b16 a[60:61], v21 offset:8192
v_mfma_f32_16x16x32_bf16 v[84:87], a[20:23], a[192:195], v[84:87]
s_add_u32 s14, s14, 1
v_mfma_f32_16x16x32_bf16 v[148:151], a[20:23], a[196:199], v[148:151]
ds_read_b64_tr_b16 a[62:63], v21 offset:9216
v_mfma_f32_16x16x32_bf16 v[212:215], a[20:23], a[200:203], v[212:215]
v_lshrrev_b32 v12, 4, v1
v_and_b32 v13, 15, v1
v_mfma_f32_16x16x32_bf16 a[148:151], a[20:23], a[204:207], a[148:151]
v_lshlrev_b32 v12, 2, v12
v_mfma_f32_16x16x32_bf16 v[88:91], a[24:27], a[192:195], v[88:91]
v_sub_u32 v13, v13, v12
v_mfma_f32_16x16x32_bf16 v[152:155], a[24:27], a[196:199], v[152:155]
s_lshl_b32 s47, s3, 4
v_mfma_f32_16x16x32_bf16 v[216:219], a[24:27], a[200:203], v[216:219]
v_add_u32 v7, s47, v13
v_mfma_f32_16x16x32_bf16 a[152:155], a[24:27], a[204:207], a[152:155]
v_mov_b32 v9, 0xff800000
v_mov_b32 v6, v3
v_mfma_f32_16x16x32_bf16 v[92:95], a[28:31], a[192:195], v[92:95]
s_lshl_b32 s47, s44, 12
v_mfma_f32_16x16x32_bf16 v[156:159], a[28:31], a[196:199], v[156:159]
v_add_u32 v11, s47, v3
v_mfma_f32_16x16x32_bf16 v[220:223], a[28:31], a[200:203], v[220:223]
s_add_u32 s16, s28, s48
s_addc_u32 s17, s29, 0
v_mfma_f32_16x16x32_bf16 a[156:159], a[28:31], a[204:207], a[156:159]
s_waitcnt vmcnt(0)
v_cmp_ne_u32 vcc, 0, v28
s_or_b64 vcc, vcc, s[96:97]
s_and_b32 s46, vcc_lo, 0x3
s_cmp_eq_u32 s46, 0x3
s_cbranch_scc0 M_SPINKVE
M_SRETKVE:
s_cmp_eq_u32 s65, 0
s_cbranch_scc1 M_ACQE
buffer_inv sc1
s_waitcnt vmcnt(0)
M_ACQE:
s_barrier
s_waitcnt vmcnt(9) lgkmcnt(0)
v_mfma_f32_16x16x32_bf16 v[64:67], a[32:35], a[208:211], v[64:67]
ds_read_b64_tr_b16 a[0:1], v14 offset:16384
s_add_u32 m0, s74, 0
v_mfma_f32_16x16x32_bf16 v[128:131], a[32:35], a[212:215], v[128:131]
buffer_load_dwordx4 v4, s[28:31], 0 offen offset:0 sc1 lds
s_mul_i32 s58, s75, 131072
v_mfma_f32_16x16x32_bf16 v[192:195], a[32:35], a[216:219], v[192:195]
ds_read_b64_tr_b16 a[2:3], v14 offset:17408
v_mfma_f32_16x16x32_bf16 a[128:131], a[32:35], a[220:223], a[128:131]
ds_read_b64_tr_b16 a[4:5], v15 offset:16384
v_mfma_f32_16x16x32_bf16 v[68:71], a[36:39], a[208:211], v[68:71]
ds_read_b64_tr_b16 a[6:7], v15 offset:17408
v_mfma_f32_16x16x32_bf16 v[132:135], a[36:39], a[212:215], v[132:135]
ds_read_b64_tr_b16 a[8:9], v16 offset:16384
v_mfma_f32_16x16x32_bf16 v[196:199], a[36:39], a[216:219], v[196:199]
s_add_u32 s58, s58, 50331648
s_mul_i32 s59, s76, 131072
v_mfma_f32_16x16x32_bf16 a[132:135], a[36:39], a[220:223], a[132:135]
ds_read_b64_tr_b16 a[10:11], v16 offset:17408
v_mfma_f32_16x16x32_bf16 v[72:75], a[40:43], a[208:211], v[72:75]
buffer_load_dwordx4 v4, s[28:31], 0 offen offset:1024 sc1 lds
v_mfma_f32_16x16x32_bf16 v[136:139], a[40:43], a[212:215], v[136:139]
ds_read_b64_tr_b16 a[12:13], v17 offset:16384
v_mfma_f32_16x16x32_bf16 v[200:203], a[40:43], a[216:219], v[200:203]
ds_read_b64_tr_b16 a[14:15], v17 offset:17408
v_mfma_f32_16x16x32_bf16 a[136:139], a[40:43], a[220:223], a[136:139]
ds_read_b64_tr_b16 a[16:17], v18 offset:16384
v_mfma_f32_16x16x32_bf16 v[76:79], a[44:47], a[208:211], v[76:79]
s_add_u32 s59, s59, 50331648
s_mov_b32 s52, 0x2b800000
v_mfma_f32_16x16x32_bf16 v[140:143], a[44:47], a[212:215], v[140:143]
ds_read_b64_tr_b16 a[18:19], v18 offset:17408
v_mfma_f32_16x16x32_bf16 v[204:207], a[44:47], a[216:219], v[204:207]
ds_read_b64_tr_b16 a[20:21], v19 offset:16384
v_mfma_f32_16x16x32_bf16 a[140:143], a[44:47], a[220:223], a[140:143]
ds_read_b64_tr_b16 a[22:23], v19 offset:17408
v_mfma_f32_16x16x32_bf16 v[80:83], a[48:51], a[208:211], v[80:83]
buffer_load_dwordx4 v4, s[28:31], 0 offen offset:2048 sc1 lds
v_mfma_f32_16x16x32_bf16 v[144:147], a[48:51], a[212:215], v[144:147]
ds_read_b64_tr_b16 a[24:25], v20 offset:16384
v_mfma_f32_16x16x32_bf16 v[208:211], a[48:51], a[216:219], v[208:211]
s_mov_b32 s53, 0x28000000
v_mfma_f32_16x16x32_bf16 a[144:147], a[48:51], a[220:223], a[144:147]
ds_read_b64_tr_b16 a[26:27], v20 offset:17408
s_lshl_b32 s47, s45, 2
v_mfma_f32_16x16x32_bf16 v[84:87], a[52:55], a[208:211], v[84:87]
ds_read_b64_tr_b16 a[28:29], v21 offset:16384
v_mfma_f32_16x16x32_bf16 v[148:151], a[52:55], a[212:215], v[148:151]
ds_read_b64_tr_b16 a[30:31], v21 offset:17408
v_mfma_f32_16x16x32_bf16 v[212:215], a[52:55], a[216:219], v[212:215]
s_sub_u32 s51, s47, 30
v_mfma_f32_16x16x32_bf16 a[148:151], a[52:55], a[220:223], a[148:151]
s_lshl_b32 s51, s51, 14
v_mfma_f32_16x16x32_bf16 v[88:91], a[56:59], a[208:211], v[88:91]
buffer_load_dwordx4 v4, s[28:31], 0 offen offset:3072 sc1 lds
v_mfma_f32_16x16x32_bf16 v[152:155], a[56:59], a[212:215], v[152:155]
s_mov_b32 s50, s74
s_sub_u32 s54, 10, s45
v_mfma_f32_16x16x32_bf16 v[216:219], a[56:59], a[216:219], v[216:219]
v_mov_b32 v12, 0x3e0293ee
v_mfma_f32_16x16x32_bf16 a[152:155], a[56:59], a[220:223], a[152:155]
v_mov_b32 v13, 0x3e0293ee
v_mfma_f32_16x16x32_bf16 v[92:95], a[60:63], a[208:211], v[92:95]
s_mul_i32 s78, s42, 28
v_mfma_f32_16x16x32_bf16 v[156:159], a[60:63], a[212:215], v[156:159]
s_add_u32 s78, s78, s43
v_mfma_f32_16x16x32_bf16 v[220:223], a[60:63], a[216:219], v[220:223]
s_cmp_lt_u32 s43, 28
s_cselect_b32 s78, s78, 0x40000
v_mfma_f32_16x16x32_bf16 a[156:159], a[60:63], a[220:223], a[156:159]
s_waitcnt vmcnt(9) lgkmcnt(0)
v_mfma_f32_16x16x32_bf16 v[64:67], a[0:3], a[224:227], v[64:67]
v_add_u32 v4, 16384, v4
s_add_u32 m0, s74, 32768
v_mfma_f32_16x16x32_bf16 v[128:131], a[0:3], a[228:231], v[128:131]
buffer_load_dwordx4 v4, s[28:31], 0 offen offset:0 sc1 lds
v_mul_u32_u24 v22, 7168, v0
v_mfma_f32_16x16x32_bf16 v[192:195], a[0:3], a[232:235], v[192:195]
ds_read_b64_tr_b16 a[32:33], v14 offset:24576
s_lshl_b32 s79, s78, 4
v_mfma_f32_16x16x32_bf16 a[128:131], a[0:3], a[236:239], a[128:131]
ds_read_b64_tr_b16 a[34:35], v14 offset:25600
v_add_u32 v22, s79, v22
v_mfma_f32_16x16x32_bf16 v[68:71], a[4:7], a[224:227], v[68:71]
ds_read_b64_tr_b16 a[36:37], v15 offset:24576
v_mfma_f32_16x16x32_bf16 v[132:135], a[4:7], a[228:231], v[132:135]
ds_read_b64_tr_b16 a[38:39], v15 offset:25600
s_lshl_b32 s79, s78, 13
v_mfma_f32_16x16x32_bf16 v[196:199], a[4:7], a[232:235], v[196:199]
ds_read_b64_tr_b16 a[40:41], v16 offset:24576
v_mfma_f32_16x16x32_bf16 a[132:135], a[4:7], a[236:239], a[132:135]
ds_read_b64_tr_b16 a[42:43], v16 offset:25600
v_lshlrev_b32 v23, 2, v0
v_mfma_f32_16x16x32_bf16 v[72:75], a[8:11], a[224:227], v[72:75]
buffer_load_dwordx4 v4, s[28:31], 0 offen offset:1024 sc1 lds
v_mfma_f32_16x16x32_bf16 v[136:139], a[8:11], a[228:231], v[136:139]
v_add_u32 v23, s79, v23
v_add_u32 v29, 4096, v23
v_mfma_f32_16x16x32_bf16 v[200:203], a[8:11], a[232:235], v[200:203]
ds_read_b64_tr_b16 a[44:45], v17 offset:24576
v_mfma_f32_16x16x32_bf16 a[136:139], a[8:11], a[236:239], a[136:139]
ds_read_b64_tr_b16 a[46:47], v17 offset:25600
s_lshr_b32 s48, s43, 3
v_mfma_f32_16x16x32_bf16 v[76:79], a[12:15], a[224:227], v[76:79]
ds_read_b64_tr_b16 a[48:49], v18 offset:24576
v_mfma_f32_16x16x32_bf16 v[140:143], a[12:15], a[228:231], v[140:143]
ds_read_b64_tr_b16 a[50:51], v18 offset:25600
s_lshl_b32 s49, s42, 2
v_mfma_f32_16x16x32_bf16 v[204:207], a[12:15], a[232:235], v[204:207]
ds_read_b64_tr_b16 a[52:53], v19 offset:24576
v_mfma_f32_16x16x32_bf16 a[140:143], a[12:15], a[236:239], a[140:143]
ds_read_b64_tr_b16 a[54:55], v19 offset:25600
s_add_u32 s76, s48, s49
v_mfma_f32_16x16x32_bf16 v[80:83], a[16:19], a[224:227], v[80:83]
buffer_load_dwordx4 v4, s[28:31], 0 offen offset:2048 sc1 lds
s_sub_u32 s75, s48, s49
v_mfma_f32_16x16x32_bf16 v[144:147], a[16:19], a[228:231], v[144:147]
s_add_u32 s75, s75, 60
v_mfma_f32_16x16x32_bf16 v[208:211], a[16:19], a[232:235], v[208:211]
ds_read_b64_tr_b16 a[56:57], v20 offset:24576
s_and_b32 s77, s43, 7
v_mfma_f32_16x16x32_bf16 a[144:147], a[16:19], a[236:239], a[144:147]
ds_read_b64_tr_b16 a[58:59], v20 offset:25600
v_mfma_f32_16x16x32_bf16 v[84:87], a[20:23], a[224:227], v[84:87]
ds_read_b64_tr_b16 a[60:61], v21 offset:24576
s_lshl_b32 s46, s3, 15
v_mfma_f32_16x16x32_bf16 v[148:151], a[20:23], a[228:231], v[148:151]
ds_read_b64_tr_b16 a[62:63], v21 offset:25600
v_mfma_f32_16x16x32_bf16 v[212:215], a[20:23], a[232:235], v[212:215]
s_mul_i32 s47, s77, 524288
s_add_u32 s47, s47, s46
v_mfma_f32_16x16x32_bf16 a[148:151], a[20:23], a[236:239], a[148:151]
s_add_u32 s49, s47, 4194304
v_mfma_f32_16x16x32_bf16 v[88:91], a[24:27], a[224:227], v[88:91]
buffer_load_dwordx4 v4, s[28:31], 0 offen offset:3072 sc1 lds
s_sub_u32 s15, s49, s15
v_mfma_f32_16x16x32_bf16 v[152:155], a[24:27], a[228:231], v[152:155]
s_add_u32 s15, s15, 12288
v_mfma_f32_16x16x32_bf16 v[216:219], a[24:27], a[232:235], v[216:219]
s_add_u32 s46, s46, 50331648
s_mul_i32 s47, s75, 262144
v_mfma_f32_16x16x32_bf16 a[152:155], a[24:27], a[236:239], a[152:155]
s_add_u32 s4, s47, s46
v_mfma_f32_16x16x32_bf16 v[92:95], a[28:31], a[224:227], v[92:95]
s_add_u32 s5, s4, 131072
s_mul_i32 s47, s76, 262144
v_mfma_f32_16x16x32_bf16 v[156:159], a[28:31], a[228:231], v[156:159]
s_add_u32 s6, s47, s46
v_mfma_f32_16x16x32_bf16 v[220:223], a[28:31], a[232:235], v[220:223]
s_add_u32 s7, s6, 131072
s_mov_b32 s70, s75
v_mfma_f32_16x16x32_bf16 a[156:159], a[28:31], a[236:239], a[156:159]
s_waitcnt vmcnt(4) lgkmcnt(0)
s_barrier
s_waitcnt vmcnt(9) lgkmcnt(0)
v_mfma_f32_16x16x32_bf16 v[64:67], a[32:35], a[240:243], v[64:67]
v_add_u32 v4, 16384, v4
s_add_u32 m0, s74, 65536
v_add_u32 v14, s49, v3
v_mfma_f32_16x16x32_bf16 v[68:71], a[36:39], a[240:243], v[68:71]
buffer_load_dwordx4 v4, s[28:31], 0 offen offset:0 sc1 lds
ds_read_b128 a[64:67], v6 offset:0
v_add_u32 v15, 131072, v14
v_mfma_f32_16x16x32_bf16 v[72:75], a[40:43], a[240:243], v[72:75]
ds_read_b128 a[68:71], v6 offset:1024
ds_read_b128 a[72:75], v6 offset:2048
v_mfma_f32_16x16x32_bf16 v[76:79], a[44:47], a[240:243], v[76:79]
ds_read_b128 a[76:79], v6 offset:3072
ds_read_b128 a[80:83], v6 offset:4096
v_add_u32 v16, 262144, v14
v_mfma_f32_16x16x32_bf16 v[80:83], a[48:51], a[240:243], v[80:83]
buffer_load_dwordx4 v4, s[28:31], 0 offen offset:1024 sc1 lds
ds_read_b128 a[84:87], v6 offset:5120
v_mfma_f32_16x16x32_bf16 v[84:87], a[52:55], a[240:243], v[84:87]
ds_read_b128 a[88:91], v6 offset:6144
ds_read_b128 a[92:95], v6 offset:7168
v_mfma_f32_16x16x32_bf16 v[88:91], a[56:59], a[240:243], v[88:91]
ds_read_b128 a[96:99], v6 offset:8192
ds_read_b128 a[100:103], v6 offset:9216
v_add_u32 v17, 393216, v14
v_mfma_f32_16x16x32_bf16 v[92:95], a[60:63], a[240:243], v[92:95]
ds_read_b128 a[104:107], v6 offset:10240
ds_read_b128 a[108:111], v6 offset:11264
v_mfma_f32_16x16x32_bf16 v[128:131], a[32:35], a[244:247], v[128:131]
buffer_load_dwordx4 v4, s[28:31], 0 offen offset:2048 sc1 lds
v_add_u32 v18, s4, v3
v_mfma_f32_16x16x32_bf16 v[132:135], a[36:39], a[244:247], v[132:135]
ds_read_b128 a[112:115], v6 offset:12288
ds_read_b128 a[116:119], v6 offset:13312
v_add_u32 v19, s5, v3
v_mfma_f32_16x16x32_bf16 v[136:139], a[40:43], a[244:247], v[136:139]
ds_read_b128 a[120:123], v6 offset:14336
ds_read_b128 a[124:127], v6 offset:15360
v_mfma_f32_16x16x32_bf16 v[140:143], a[44:47], a[244:247], v[140:143]
v_add_u32 v20, s6, v3
v_add_u32 v21, s7, v3
v_mfma_f32_16x16x32_bf16 v[144:147], a[48:51], a[244:247], v[144:147]
buffer_load_dwordx4 v4, s[28:31], 0 offen offset:3072 sc1 lds
v_mfma_f32_16x16x32_bf16 v[148:151], a[52:55], a[244:247], v[148:151]
v_mul_f32 v64, v64, v12
v_mul_f32 v65, v65, v12
v_mfma_f32_16x16x32_bf16 v[152:155], a[56:59], a[244:247], v[152:155]
v_mul_f32 v66, v66, v12
v_mul_f32 v67, v67, v12
v_mfma_f32_16x16x32_bf16 v[156:159], a[60:63], a[244:247], v[156:159]
v_add_u32 v4, 16384, v4
s_add_u32 m0, s74, 98304
v_mfma_f32_16x16x32_bf16 v[192:195], a[32:35], a[248:251], v[192:195]
buffer_load_dwordx4 v4, s[28:31], 0 offen offset:0 sc1 lds
v_mul_f32 v68, v68, v12
v_mfma_f32_16x16x32_bf16 v[196:199], a[36:39], a[248:251], v[196:199]
v_mul_f32 v69, v69, v12
v_mul_f32 v70, v70, v12
v_mfma_f32_16x16x32_bf16 v[200:203], a[40:43], a[248:251], v[200:203]
v_mul_f32 v71, v71, v12
v_cvt_pk_bf16_f32 v64, v64, v65
v_mfma_f32_16x16x32_bf16 v[204:207], a[44:47], a[248:251], v[204:207]
v_cvt_pk_bf16_f32 v65, v66, v67
v_cvt_pk_bf16_f32 v66, v68, v69
v_mfma_f32_16x16x32_bf16 v[208:211], a[48:51], a[248:251], v[208:211]
buffer_load_dwordx4 v4, s[28:31], 0 offen offset:1024 sc1 lds
v_cvt_pk_bf16_f32 v67, v70, v71
v_mfma_f32_16x16x32_bf16 v[212:215], a[52:55], a[248:251], v[212:215]
v_accvgpr_write_b32 a160, v64
v_accvgpr_write_b32 a161, v65
v_mfma_f32_16x16x32_bf16 v[216:219], a[56:59], a[248:251], v[216:219]
v_accvgpr_write_b32 a162, v66
v_accvgpr_write_b32 a163, v67
v_mfma_f32_16x16x32_bf16 v[220:223], a[60:63], a[248:251], v[220:223]
v_mul_f32 v72, v72, v12
v_mul_f32 v73, v73, v12
v_mfma_f32_16x16x32_bf16 a[128:131], a[32:35], a[252:255], a[128:131]
buffer_load_dwordx4 v4, s[28:31], 0 offen offset:2048 sc1 lds
v_mul_f32 v74, v74, v12
v_mfma_f32_16x16x32_bf16 a[132:135], a[36:39], a[252:255], a[132:135]
v_mul_f32 v75, v75, v12
v_mul_f32 v76, v76, v12
v_mfma_f32_16x16x32_bf16 a[136:139], a[40:43], a[252:255], a[136:139]
v_mul_f32 v77, v77, v12
v_mul_f32 v78, v78, v12
v_mfma_f32_16x16x32_bf16 a[140:143], a[44:47], a[252:255], a[140:143]
v_mul_f32 v79, v79, v12
v_cvt_pk_bf16_f32 v72, v72, v73
v_mfma_f32_16x16x32_bf16 a[144:147], a[48:51], a[252:255], a[144:147]
buffer_load_dwordx4 v4, s[28:31], 0 offen offset:3072 sc1 lds
v_cvt_pk_bf16_f32 v73, v74, v75
v_mfma_f32_16x16x32_bf16 a[148:151], a[52:55], a[252:255], a[148:151]
v_cvt_pk_bf16_f32 v74, v76, v77
v_cvt_pk_bf16_f32 v75, v78, v79
v_mfma_f32_16x16x32_bf16 a[152:155], a[56:59], a[252:255], a[152:155]
v_accvgpr_write_b32 a164, v72
v_accvgpr_write_b32 a165, v73
v_mfma_f32_16x16x32_bf16 a[156:159], a[60:63], a[252:255], a[156:159]
v_accvgpr_write_b32 a166, v74
v_accvgpr_write_b32 a167, v75
v_pk_mul_f32 v[80:81], v[80:81], v[12:13]
v_pk_mul_f32 v[82:83], v[82:83], v[12:13]
v_pk_mul_f32 v[84:85], v[84:85], v[12:13]
v_pk_mul_f32 v[86:87], v[86:87], v[12:13]
v_cvt_pk_bf16_f32 v80, v80, v81
v_cvt_pk_bf16_f32 v81, v82, v83
v_cvt_pk_bf16_f32 v82, v84, v85
v_cvt_pk_bf16_f32 v83, v86, v87
v_accvgpr_write_b32 a168, v80
v_accvgpr_write_b32 a169, v81
v_accvgpr_write_b32 a170, v82
v_accvgpr_write_b32 a171, v83
v_pk_mul_f32 v[88:89], v[88:89], v[12:13]
v_pk_mul_f32 v[90:91], v[90:91], v[12:13]
s_add_u32 m0, s74, 114688
v_pk_mul_f32 v[92:93], v[92:93], v[12:13]
v_pk_mul_f32 v[94:95], v[94:95], v[12:13]
v_cvt_pk_bf16_f32 v88, v88, v89
v_cvt_pk_bf16_f32 v89, v90, v91
v_cvt_pk_bf16_f32 v90, v92, v93
v_cvt_pk_bf16_f32 v91, v94, v95
v_accvgpr_write_b32 a172, v88
v_accvgpr_write_b32 a173, v89
v_accvgpr_write_b32 a174, v90
v_accvgpr_write_b32 a175, v91
v_pk_mul_f32 v[128:129], v[128:129], v[12:13]
v_pk_mul_f32 v[130:131], v[130:131], v[12:13]
v_pk_mul_f32 v[132:133], v[132:133], v[12:13]
v_pk_mul_f32 v[134:135], v[134:135], v[12:13]
buffer_load_dwordx4 v5, s[16:19], 0 offen offset:0 sc1 lds
v_cvt_pk_bf16_f32 v128, v128, v129
v_cvt_pk_bf16_f32 v129, v130, v131
v_cvt_pk_bf16_f32 v130, v132, v133
v_cvt_pk_bf16_f32 v131, v134, v135
v_accvgpr_write_b32 a176, v128
v_accvgpr_write_b32 a177, v129
v_accvgpr_write_b32 a178, v130
v_accvgpr_write_b32 a179, v131
v_pk_mul_f32 v[136:137], v[136:137], v[12:13]
v_pk_mul_f32 v[138:139], v[138:139], v[12:13]
v_pk_mul_f32 v[140:141], v[140:141], v[12:13]
v_pk_mul_f32 v[142:143], v[142:143], v[12:13]
v_cvt_pk_bf16_f32 v136, v136, v137
v_cvt_pk_bf16_f32 v137, v138, v139
buffer_load_dwordx4 v5, s[16:19], 0 offen offset:1024 sc1 lds
v_cvt_pk_bf16_f32 v138, v140, v141
v_cvt_pk_bf16_f32 v139, v142, v143
v_accvgpr_write_b32 a180, v136
v_accvgpr_write_b32 a181, v137
v_accvgpr_write_b32 a182, v138
v_accvgpr_write_b32 a183, v139
v_pk_mul_f32 v[144:145], v[144:145], v[12:13]
v_pk_mul_f32 v[146:147], v[146:147], v[12:13]
v_pk_mul_f32 v[148:149], v[148:149], v[12:13]
v_pk_mul_f32 v[150:151], v[150:151], v[12:13]
v_cvt_pk_bf16_f32 v144, v144, v145
v_cvt_pk_bf16_f32 v145, v146, v147
v_cvt_pk_bf16_f32 v146, v148, v149
v_cvt_pk_bf16_f32 v147, v150, v151
buffer_load_dwordx4 v5, s[16:19], 0 offen offset:2048 sc1 lds
v_accvgpr_write_b32 a184, v144
v_accvgpr_write_b32 a185, v145
v_accvgpr_write_b32 a186, v146
v_accvgpr_write_b32 a187, v147
v_pk_mul_f32 v[152:153], v[152:153], v[12:13]
v_pk_mul_f32 v[154:155], v[154:155], v[12:13]
v_pk_mul_f32 v[156:157], v[156:157], v[12:13]
v_pk_mul_f32 v[158:159], v[158:159], v[12:13]
v_cvt_pk_bf16_f32 v152, v152, v153
v_cvt_pk_bf16_f32 v153, v154, v155
v_cvt_pk_bf16_f32 v154, v156, v157
v_cvt_pk_bf16_f32 v155, v158, v159
v_accvgpr_write_b32 a188, v152
v_accvgpr_write_b32 a189, v153
buffer_load_dwordx4 v5, s[16:19], 0 offen offset:3072 sc1 lds
v_accvgpr_write_b32 a190, v154
v_accvgpr_write_b32 a191, v155
v_pk_mul_f32 v[192:193], v[192:193], v[12:13]
v_pk_mul_f32 v[194:195], v[194:195], v[12:13]
v_pk_mul_f32 v[196:197], v[196:197], v[12:13]
v_pk_mul_f32 v[198:199], v[198:199], v[12:13]
v_cvt_pk_bf16_f32 v192, v192, v193
v_cvt_pk_bf16_f32 v193, v194, v195
v_cvt_pk_bf16_f32 v194, v196, v197
v_cvt_pk_bf16_f32 v195, v198, v199
v_accvgpr_write_b32 a192, v192
v_accvgpr_write_b32 a193, v193
v_accvgpr_write_b32 a194, v194
v_accvgpr_write_b32 a195, v195
v_pk_mul_f32 v[200:201], v[200:201], v[12:13]
v_pk_mul_f32 v[202:203], v[202:203], v[12:13]
v_pk_mul_f32 v[204:205], v[204:205], v[12:13]
v_pk_mul_f32 v[206:207], v[206:207], v[12:13]
v_cvt_pk_bf16_f32 v200, v200, v201
v_cvt_pk_bf16_f32 v201, v202, v203
v_cvt_pk_bf16_f32 v202, v204, v205
v_cvt_pk_bf16_f32 v203, v206, v207
v_accvgpr_write_b32 a196, v200
v_accvgpr_write_b32 a197, v201
v_accvgpr_write_b32 a198, v202
v_accvgpr_write_b32 a199, v203
v_pk_mul_f32 v[208:209], v[208:209], v[12:13]
v_pk_mul_f32 v[210:211], v[210:211], v[12:13]
v_pk_mul_f32 v[212:213], v[212:213], v[12:13]
v_pk_mul_f32 v[214:215], v[214:215], v[12:13]
v_cvt_pk_bf16_f32 v208, v208, v209
v_cvt_pk_bf16_f32 v209, v210, v211
v_cvt_pk_bf16_f32 v210, v212, v213
v_cvt_pk_bf16_f32 v211, v214, v215
v_accvgpr_write_b32 a200, v208
v_accvgpr_write_b32 a201, v209
v_accvgpr_write_b32 a202, v210
v_accvgpr_write_b32 a203, v211
v_pk_mul_f32 v[216:217], v[216:217], v[12:13]
v_pk_mul_f32 v[218:219], v[218:219], v[12:13]
v_pk_mul_f32 v[220:221], v[220:221], v[12:13]
v_pk_mul_f32 v[222:223], v[222:223], v[12:13]
v_cvt_pk_bf16_f32 v216, v216, v217
v_cvt_pk_bf16_f32 v217, v218, v219
v_cvt_pk_bf16_f32 v218, v220, v221
v_cvt_pk_bf16_f32 v219, v222, v223
v_accvgpr_write_b32 a204, v216
v_accvgpr_write_b32 a205, v217
v_accvgpr_write_b32 a206, v218
v_accvgpr_write_b32 a207, v219
v_accvgpr_read_b32 v240, a128
v_accvgpr_read_b32 v241, a129
v_accvgpr_read_b32 v242, a130
v_accvgpr_read_b32 v243, a131
v_accvgpr_read_b32 v244, a132
v_accvgpr_read_b32 v245, a133
v_accvgpr_read_b32 v246, a134
v_accvgpr_read_b32 v247, a135
v_pk_mul_f32 v[240:241], v[240:241], v[12:13]
v_pk_mul_f32 v[242:243], v[242:243], v[12:13]
v_pk_mul_f32 v[244:245], v[244:245], v[12:13]
v_pk_mul_f32 v[246:247], v[246:247], v[12:13]
v_cvt_pk_bf16_f32 v240, v240, v241
v_cvt_pk_bf16_f32 v241, v242, v243
v_cvt_pk_bf16_f32 v242, v244, v245
v_cvt_pk_bf16_f32 v243, v246, v247
v_accvgpr_write_b32 a208, v240
v_accvgpr_write_b32 a209, v241
v_accvgpr_write_b32 a210, v242
v_accvgpr_write_b32 a211, v243
v_accvgpr_read_b32 v248, a136
v_accvgpr_read_b32 v249, a137
v_accvgpr_read_b32 v250, a138
v_accvgpr_read_b32 v251, a139
v_accvgpr_read_b32 v252, a140
v_accvgpr_read_b32 v253, a141
v_accvgpr_read_b32 v254, a142
v_accvgpr_read_b32 v255, a143
v_pk_mul_f32 v[248:249], v[248:249], v[12:13]
v_pk_mul_f32 v[250:251], v[250:251], v[12:13]
v_pk_mul_f32 v[252:253], v[252:253], v[12:13]
v_pk_mul_f32 v[254:255], v[254:255], v[12:13]
v_cvt_pk_bf16_f32 v248, v248, v249
v_cvt_pk_bf16_f32 v249, v250, v251
v_cvt_pk_bf16_f32 v250, v252, v253
v_cvt_pk_bf16_f32 v251, v254, v255
v_accvgpr_write_b32 a212, v248
v_accvgpr_write_b32 a213, v249
v_accvgpr_write_b32 a214, v250
v_accvgpr_write_b32 a215, v251
v_accvgpr_read_b32 v240, a144
v_accvgpr_read_b32 v241, a145
v_accvgpr_read_b32 v242, a146
v_accvgpr_read_b32 v243, a147
v_accvgpr_read_b32 v244, a148
v_accvgpr_read_b32 v245, a149
v_accvgpr_read_b32 v246, a150
v_accvgpr_read_b32 v247, a151
v_pk_mul_f32 v[240:241], v[240:241], v[12:13]
v_pk_mul_f32 v[242:243], v[242:243], v[12:13]
v_pk_mul_f32 v[244:245], v[244:245], v[12:13]
v_pk_mul_f32 v[246:247], v[246:247], v[12:13]
v_cvt_pk_bf16_f32 v240, v240, v241
v_cvt_pk_bf16_f32 v241, v242, v243
v_cvt_pk_bf16_f32 v242, v244, v245
v_cvt_pk_bf16_f32 v243, v246, v247
v_accvgpr_write_b32 a216, v240
v_accvgpr_write_b32 a217, v241
v_accvgpr_write_b32 a218, v242
v_accvgpr_write_b32 a219, v243
s_waitcnt vmcnt(12) lgkmcnt(0)
s_barrier
ds_read_b128 a[0:3], v6 offset:32768
ds_read_b128 a[4:7], v6 offset:33792
s_add_u32 m0, s50, 0
v_add_u32 v4, 16384, v4
v_mfma_f32_16x16x32_bf16 v[32:35], a[64:67], a[160:163], 0
ds_read_b128 a[8:11], v6 offset:34816
ds_read_b128 a[12:15], v6 offset:35840
v_mfma_f32_16x16x32_bf16 v[32:35], a[68:71], a[164:167], v[32:35]
buffer_load_dwordx4 v4, s[28:31], 0 offen offset:0 sc1 lds
ds_read_b128 a[16:19], v6 offset:36864
v_mfma_f32_16x16x32_bf16 v[32:35], a[72:75], a[168:171], v[32:35]
ds_read_b128 a[20:23], v6 offset:37888
ds_read_b128 a[24:27], v6 offset:38912
v_mfma_f32_16x16x32_bf16 v[32:35], a[76:79], a[172:175], v[32:35]
ds_read_b128 a[28:31], v6 offset:39936
v_add_u32 v5, 16384, v5
v_mfma_f32_16x16x32_bf16 v[36:39], a[80:83], a[160:163], 0
ds_read_b128 a[32:35], v6 offset:40960
ds_read_b128 a[36:39], v6 offset:41984
v_mfma_f32_16x16x32_bf16 v[36:39], a[84:87], a[164:167], v[36:39]
buffer_load_dwordx4 v4, s[28:31], 0 offen offset:1024 sc1 lds
ds_read_b128 a[40:43], v6 offset:43008
v_mfma_f32_16x16x32_bf16 v[36:39], a[88:91], a[168:171], v[36:39]
ds_read_b128 a[44:47], v6 offset:44032
ds_read_b128 a[48:51], v6 offset:45056
v_mfma_f32_16x16x32_bf16 v[36:39], a[92:95], a[172:175], v[36:39]
ds_read_b128 a[52:55], v6 offset:46080
ds_read_b128 a[56:59], v6 offset:47104
v_mfma_f32_16x16x32_bf16 v[40:43], a[96:99], a[160:163], 0
ds_read_b128 a[60:63], v6 offset:48128
v_mov_b32 v144, 0
v_mfma_f32_16x16x32_bf16 v[40:43], a[100:103], a[164:167], v[40:43]
buffer_load_dwordx4 v4, s[28:31], 0 offen offset:2048 sc1 lds
v_mov_b32 v145, 0
v_mfma_f32_16x16x32_bf16 v[40:43], a[104:107], a[168:171], v[40:43]
v_mov_b32 v146, 0
v_mov_b32 v147, 0
v_mfma_f32_16x16x32_bf16 v[40:43], a[108:111], a[172:175], v[40:43]
v_mov_b32 v148, 0
v_mov_b32 v149, 0
v_mfma_f32_16x16x32_bf16 v[44:47], a[112:115], a[160:163], 0
v_mov_b32 v150, 0
v_mov_b32 v151, 0
v_mfma_f32_16x16x32_bf16 v[44:47], a[116:119], a[164:167], v[44:47]
buffer_load_dwordx4 v4, s[28:31], 0 offen offset:3072 sc1 lds
v_mov_b32 v128, 0
v_mfma_f32_16x16x32_bf16 v[44:47], a[120:123], a[168:171], v[44:47]
s_add_u32 m0, s50, 16384
v_mov_b32 v129, 0
v_mfma_f32_16x16x32_bf16 v[44:47], a[124:127], a[172:175], v[44:47]
v_mov_b32 v130, 0
v_mov_b32 v131, 0
v_mfma_f32_16x16x32_bf16 v[48:51], a[64:67], a[176:179], 0
v_mov_b32 v132, 0
v_mov_b32 v133, 0
v_mfma_f32_16x16x32_bf16 v[48:51], a[68:71], a[180:183], v[48:51]
buffer_load_dwordx4 v5, s[16:19], 0 offen offset:0 sc1 lds
v_mov_b32 v134, 0
v_mfma_f32_16x16x32_bf16 v[48:51], a[72:75], a[184:187], v[48:51]
v_mov_b32 v135, 0
v_mov_b32 v136, 0
v_mfma_f32_16x16x32_bf16 v[48:51], a[76:79], a[188:191], v[48:51]
v_mov_b32 v137, 0
v_mov_b32 v138, 0
v_mfma_f32_16x16x32_bf16 v[52:55], a[80:83], a[176:179], 0
v_mov_b32 v139, 0
v_mov_b32 v140, 0
v_mfma_f32_16x16x32_bf16 v[52:55], a[84:87], a[180:183], v[52:55]
buffer_load_dwordx4 v5, s[16:19], 0 offen offset:1024 sc1 lds
v_mov_b32 v141, 0
v_mfma_f32_16x16x32_bf16 v[52:55], a[88:91], a[184:187], v[52:55]
v_mov_b32 v142, 0
v_mov_b32 v143, 0
v_mfma_f32_16x16x32_bf16 v[52:55], a[92:95], a[188:191], v[52:55]
v_and_b32 v152, 3, v1
v_cmp_eq_u32 vcc, 0, v152
v_mfma_f32_16x16x32_bf16 v[56:59], a[96:99], a[176:179], 0
v_mov_b32 v153, 0x3f803f80
s_nop 0
v_mfma_f32_16x16x32_bf16 v[56:59], a[100:103], a[180:183], v[56:59]
buffer_load_dwordx4 v5, s[16:19], 0 offen offset:2048 sc1 lds
v_cndmask_b32 v152, 0, v153, vcc
v_mfma_f32_16x16x32_bf16 v[56:59], a[104:107], a[184:187], v[56:59]
v_mov_b32 v153, v152
v_mov_b32 v154, v152
v_mfma_f32_16x16x32_bf16 v[56:59], a[108:111], a[188:191], v[56:59]
v_mov_b32 v155, v152
v_accvgpr_read_b32 v248, a152
v_mfma_f32_16x16x32_bf16 v[60:63], a[112:115], a[176:179], 0
v_accvgpr_read_b32 v249, a153
v_accvgpr_read_b32 v250, a154
v_mfma_f32_16x16x32_bf16 v[60:63], a[116:119], a[180:183], v[60:63]
buffer_load_dwordx4 v5, s[16:19], 0 offen offset:3072 sc1 lds
v_accvgpr_read_b32 v251, a155
v_mfma_f32_16x16x32_bf16 v[60:63], a[120:123], a[184:187], v[60:63]
v_accvgpr_read_b32 v252, a156
v_accvgpr_read_b32 v253, a157
v_mfma_f32_16x16x32_bf16 v[60:63], a[124:127], a[188:191], v[60:63]
v_accvgpr_read_b32 v254, a158
v_accvgpr_read_b32 v255, a159
v_xor_b32 v6, 0x10000, v6
s_branch M_QJ
M_QL:
s_waitcnt vmcnt(28) lgkmcnt(0)
v_mfma_f32_16x16x32_bf16 v[64:67], a[0:3], a[160:163], 0
ds_read_b64_tr_b16 a[32:33], v14 offset:8192
ds_read_b64_tr_b16 a[34:35], v14 offset:9216
v_mfma_f32_16x16x32_bf16 v[68:71], a[4:7], a[160:163], 0
buffer_load_dwordx4 a[240:243], v4, s[28:31], s68 offen offset:1024 sc1
v_mfma_f32_16x16x32_bf16 v[72:75], a[8:11], a[160:163], 0
ds_read_b64_tr_b16 a[36:37], v15 offset:8192
v_accvgpr_read_b32 v24, a128
v_accvgpr_read_b32 v25, a129
v_accvgpr_read_b32 v26, a130
v_mfma_f32_16x16x32_bf16 v[76:79], a[12:15], a[160:163], 0
ds_read_b64_tr_b16 a[38:39], v15 offset:9216
v_accvgpr_read_b32 v27, a131
v_cvt_pk_bf16_f32 v224, v224, v225
v_cvt_pk_bf16_f32 v225, v226, v227
v_mfma_f32_16x16x32_bf16 v[80:83], a[16:19], a[160:163], 0
v_cvt_pk_bf16_f32 v226, v24, v25
v_cvt_pk_bf16_f32 v227, v26, v27
v_accvgpr_read_b32 v24, a132
v_accvgpr_read_b32 v25, a133
v_mfma_f32_16x16x32_bf16 v[84:87], a[20:23], a[160:163], 0
ds_read_b64_tr_b16 a[40:41], v16 offset:8192
v_accvgpr_read_b32 v26, a134
v_accvgpr_read_b32 v27, a135
v_cvt_pk_bf16_f32 v228, v228, v229
v_mfma_f32_16x16x32_bf16 v[88:91], a[24:27], a[160:163], 0
ds_read_b64_tr_b16 a[42:43], v16 offset:9216
v_cvt_pk_bf16_f32 v229, v230, v231
v_cvt_pk_bf16_f32 v230, v24, v25
v_cvt_pk_bf16_f32 v231, v26, v27
v_mfma_f32_16x16x32_bf16 v[92:95], a[28:31], a[160:163], 0
ds_read_b64_tr_b16 a[44:45], v17 offset:8192
v_accvgpr_read_b32 v24, a136
v_accvgpr_read_b32 v25, a137
v_accvgpr_read_b32 v26, a138
v_mfma_f32_16x16x32_bf16 v[128:131], a[0:3], a[164:167], 0
buffer_load_dwordx4 a[244:247], v5, s[28:31], s68 offen offset:1024 sc1
v_accvgpr_read_b32 v27, a139
v_cvt_pk_bf16_f32 v232, v232, v233
v_cvt_pk_bf16_f32 v233, v234, v235
v_mfma_f32_16x16x32_bf16 v[132:135], a[4:7], a[164:167], 0
v_cvt_pk_bf16_f32 v234, v24, v25
v_cvt_pk_bf16_f32 v235, v26, v27
v_accvgpr_read_b32 v24, a140
v_accvgpr_read_b32 v25, a141
v_mfma_f32_16x16x32_bf16 v[136:139], a[8:11], a[164:167], 0
ds_read_b64_tr_b16 a[46:47], v17 offset:9216
v_accvgpr_read_b32 v26, a142
v_accvgpr_read_b32 v27, a143
v_cvt_pk_bf16_f32 v236, v236, v237
v_mfma_f32_16x16x32_bf16 v[140:143], a[12:15], a[164:167], 0
ds_read_b64_tr_b16 a[48:49], v18 offset:8192
v_cvt_pk_bf16_f32 v237, v238, v239
v_cvt_pk_bf16_f32 v238, v24, v25
v_cvt_pk_bf16_f32 v239, v26, v27
v_mfma_f32_16x16x32_bf16 v[144:147], a[16:19], a[164:167], 0
ds_read_b64_tr_b16 a[50:51], v18 offset:9216
v_accvgpr_read_b32 v24, a144
v_accvgpr_read_b32 v25, a145
v_mfma_f32_16x16x32_bf16 v[148:151], a[20:23], a[164:167], 0
ds_read_b64_tr_b16 a[52:53], v19 offset:8192
v_accvgpr_read_b32 v26, a146
v_accvgpr_read_b32 v27, a147
v_cvt_pk_bf16_f32 v240, v240, v241
v_mfma_f32_16x16x32_bf16 v[152:155], a[24:27], a[164:167], 0
v_cvt_pk_bf16_f32 v241, v242, v243
v_cvt_pk_bf16_f32 v242, v24, v25
v_cvt_pk_bf16_f32 v243, v26, v27
v_accvgpr_read_b32 v24, a148
v_mfma_f32_16x16x32_bf16 v[156:159], a[28:31], a[164:167], 0
ds_read_b64_tr_b16 a[54:55], v19 offset:9216
v_accvgpr_read_b32 v25, a149
v_accvgpr_read_b32 v26, a150
v_accvgpr_read_b32 v27, a151
v_mfma_f32_16x16x32_bf16 v[192:195], a[0:3], a[168:171], 0
buffer_load_dwordx4 a[248:251], v6, s[28:31], s68 offen offset:1024 sc1
v_cvt_pk_bf16_f32 v244, v244, v245
v_cvt_pk_bf16_f32 v245, v246, v247
v_cvt_pk_bf16_f32 v246, v24, v25
v_mfma_f32_16x16x32_bf16 v[196:199], a[4:7], a[168:171], 0
ds_read_b64_tr_b16 a[56:57], v20 offset:8192
v_cvt_pk_bf16_f32 v247, v26, v27
v_accvgpr_read_b32 v24, a152
v_mfma_f32_16x16x32_bf16 v[200:203], a[8:11], a[168:171], 0
ds_read_b64_tr_b16 a[58:59], v20 offset:9216
v_accvgpr_read_b32 v25, a153
v_accvgpr_read_b32 v26, a154
v_accvgpr_read_b32 v27, a155
v_mfma_f32_16x16x32_bf16 v[204:207], a[12:15], a[168:171], 0
v_cvt_pk_bf16_f32 v248, v248, v249
v_cvt_pk_bf16_f32 v249, v250, v251
v_cvt_pk_bf16_f32 v250, v24, v25
v_cvt_pk_bf16_f32 v251, v26, v27
v_mfma_f32_16x16x32_bf16 v[208:211], a[16:19], a[168:171], 0
ds_read_b64_tr_b16 a[60:61], v21 offset:8192
v_accvgpr_read_b32 v24, a156
v_accvgpr_read_b32 v25, a157
v_accvgpr_read_b32 v26, a158
v_mfma_f32_16x16x32_bf16 v[212:215], a[20:23], a[168:171], 0
ds_read_b64_tr_b16 a[62:63], v21 offset:9216
v_accvgpr_read_b32 v27, a159
v_cvt_pk_bf16_f32 v252, v252, v253
v_cvt_pk_bf16_f32 v253, v254, v255
v_mfma_f32_16x16x32_bf16 v[216:219], a[24:27], a[168:171], 0
v_cvt_pk_bf16_f32 v254, v24, v25
v_cvt_pk_bf16_f32 v255, v26, v27
v_mfma_f32_16x16x32_bf16 v[220:223], a[28:31], a[168:171], 0
v_mfma_f32_16x16x32_bf16 a[128:131], a[0:3], a[172:175], 0
buffer_load_dwordx4 a[252:255], v7, s[28:31], s68 offen offset:1024 sc1
v_mfma_f32_16x16x32_bf16 a[132:135], a[4:7], a[172:175], 0
v_mfma_f32_16x16x32_bf16 a[136:139], a[8:11], a[172:175], 0
v_mfma_f32_16x16x32_bf16 a[140:143], a[12:15], a[172:175], 0
v_mfma_f32_16x16x32_bf16 a[144:147], a[16:19], a[172:175], 0
v_mfma_f32_16x16x32_bf16 a[148:151], a[20:23], a[172:175], 0
v_mfma_f32_16x16x32_bf16 a[152:155], a[24:27], a[172:175], 0
v_mfma_f32_16x16x32_bf16 a[156:159], a[28:31], a[172:175], 0
s_waitcnt vmcnt(28) lgkmcnt(0)
v_mfma_f32_16x16x32_bf16 v[64:67], a[32:35], a[176:179], v[64:67]
ds_read_b64_tr_b16 a[0:1], v14 offset:16384
ds_read_b64_tr_b16 a[2:3], v14 offset:17408
v_mfma_f32_16x16x32_bf16 v[128:131], a[32:35], a[180:183], v[128:131]
buffer_load_dwordx4 a[64:67], v4, s[28:31], s68 offen offset:2048 sc1
v_mfma_f32_16x16x32_bf16 v[192:195], a[32:35], a[184:187], v[192:195]
ds_read_b64_tr_b16 a[4:5], v15 offset:16384
v_mfma_f32_16x16x32_bf16 a[128:131], a[32:35], a[188:191], a[128:131]
ds_read_b64_tr_b16 a[6:7], v15 offset:17408
v_mfma_f32_16x16x32_bf16 v[68:71], a[36:39], a[176:179], v[68:71]
v_mfma_f32_16x16x32_bf16 v[132:135], a[36:39], a[180:183], v[132:135]
ds_read_b64_tr_b16 a[8:9], v16 offset:16384
v_mfma_f32_16x16x32_bf16 v[196:199], a[36:39], a[184:187], v[196:199]
ds_read_b64_tr_b16 a[10:11], v16 offset:17408
v_mfma_f32_16x16x32_bf16 a[132:135], a[36:39], a[188:191], a[132:135]
ds_read_b64_tr_b16 a[12:13], v17 offset:16384
v_mfma_f32_16x16x32_bf16 v[72:75], a[40:43], a[176:179], v[72:75]
buffer_load_dwordx4 a[68:71], v5, s[28:31], s68 offen offset:2048 sc1
v_mfma_f32_16x16x32_bf16 v[136:139], a[40:43], a[180:183], v[136:139]
v_mfma_f32_16x16x32_bf16 v[200:203], a[40:43], a[184:187], v[200:203]
ds_read_b64_tr_b16 a[14:15], v17 offset:17408
v_mfma_f32_16x16x32_bf16 a[136:139], a[40:43], a[188:191], a[136:139]
ds_read_b64_tr_b16 a[16:17], v18 offset:16384
v_mfma_f32_16x16x32_bf16 v[76:79], a[44:47], a[176:179], v[76:79]
ds_read_b64_tr_b16 a[18:19], v18 offset:17408
v_mfma_f32_16x16x32_bf16 v[140:143], a[44:47], a[180:183], v[140:143]
ds_read_b64_tr_b16 a[20:21], v19 offset:16384
v_mfma_f32_16x16x32_bf16 v[204:207], a[44:47], a[184:187], v[204:207]
v_mfma_f32_16x16x32_bf16 a[140:143], a[44:47], a[188:191], a[140:143]
ds_read_b64_tr_b16 a[22:23], v19 offset:17408
v_mfma_f32_16x16x32_bf16 v[80:83], a[48:51], a[176:179], v[80:83]
buffer_load_dwordx4 a[72:75], v6, s[28:31], s68 offen offset:2048 sc1
v_mfma_f32_16x16x32_bf16 v[144:147], a[48:51], a[180:183], v[144:147]
ds_read_b64_tr_b16 a[24:25], v20 offset:16384
v_mfma_f32_16x16x32_bf16 v[208:211], a[48:51], a[184:187], v[208:211]
ds_read_b64_tr_b16 a[26:27], v20 offset:17408
v_mfma_f32_16x16x32_bf16 a[144:147], a[48:51], a[188:191], a[144:147]
v_mfma_f32_16x16x32_bf16 v[84:87], a[52:55], a[176:179], v[84:87]
ds_read_b64_tr_b16 a[28:29], v21 offset:16384
v_mfma_f32_16x16x32_bf16 v[148:151], a[52:55], a[180:183], v[148:151]
ds_read_b64_tr_b16 a[30:31], v21 offset:17408
v_mfma_f32_16x16x32_bf16 v[212:215], a[52:55], a[184:187], v[212:215]
v_mfma_f32_16x16x32_bf16 a[148:151], a[52:55], a[188:191], a[148:151]
v_mfma_f32_16x16x32_bf16 v[88:91], a[56:59], a[176:179], v[88:91]
buffer_load_dwordx4 a[76:79], v7, s[28:31], s68 offen offset:2048 sc1
v_mfma_f32_16x16x32_bf16 v[152:155], a[56:59], a[180:183], v[152:155]
v_mfma_f32_16x16x32_bf16 v[216:219], a[56:59], a[184:187], v[216:219]
v_mfma_f32_16x16x32_bf16 a[152:155], a[56:59], a[188:191], a[152:155]
v_mfma_f32_16x16x32_bf16 v[92:95], a[60:63], a[176:179], v[92:95]
s_and_b32 s78, s78, s79
s_or_b32 s78, s78, s96
v_mfma_f32_16x16x32_bf16 v[156:159], a[60:63], a[180:183], v[156:159]
v_mfma_f32_16x16x32_bf16 v[220:223], a[60:63], a[184:187], v[220:223]
s_and_b32 s78, s78, s77
s_xor_b32 s65, s78, s77
v_mfma_f32_16x16x32_bf16 a[156:159], a[60:63], a[188:191], a[156:159]
s_waitcnt vmcnt(28) lgkmcnt(0)
v_mfma_f32_16x16x32_bf16 v[64:67], a[0:3], a[192:195], v[64:67]
ds_read_b64_tr_b16 a[32:33], v14 offset:24576
ds_read_b64_tr_b16 a[34:35], v14 offset:25600
v_mfma_f32_16x16x32_bf16 v[128:131], a[0:3], a[196:199], v[128:131]
buffer_load_dwordx4 a[80:83], v4, s[28:31], s68 offen offset:3072 sc1
v_mfma_f32_16x16x32_bf16 v[192:195], a[0:3], a[200:203], v[192:195]
ds_read_b64_tr_b16 a[36:37], v15 offset:24576
v_mfma_f32_16x16x32_bf16 a[128:131], a[0:3], a[204:207], a[128:131]
ds_read_b64_tr_b16 a[38:39], v15 offset:25600
v_mfma_f32_16x16x32_bf16 v[68:71], a[4:7], a[192:195], v[68:71]
ds_read_b64_tr_b16 a[40:41], v16 offset:24576
v_mfma_f32_16x16x32_bf16 v[132:135], a[4:7], a[196:199], v[132:135]
s_add_u32 s62, s62, s63
v_mfma_f32_16x16x32_bf16 v[196:199], a[4:7], a[200:203], v[196:199]
buffer_store_dwordx4 v[48:51], v3, s[28:31], s62 offen
v_mfma_f32_16x16x32_bf16 a[132:135], a[4:7], a[204:207], a[132:135]
ds_read_b64_tr_b16 a[42:43], v16 offset:25600
v_mfma_f32_16x16x32_bf16 v[72:75], a[8:11], a[192:195], v[72:75]
ds_read_b64_tr_b16 a[44:45], v17 offset:24576
v_mfma_f32_16x16x32_bf16 v[136:139], a[8:11], a[196:199], v[136:139]
ds_read_b64_tr_b16 a[46:47], v17 offset:25600
v_mfma_f32_16x16x32_bf16 v[200:203], a[8:11], a[200:203], v[200:203]
ds_read_b64_tr_b16 a[48:49], v18 offset:24576
v_mfma_f32_16x16x32_bf16 a[136:139], a[8:11], a[204:207], a[136:139]
buffer_load_dwordx4 a[84:87], v5, s[28:31], s68 offen offset:3072 sc1
v_mfma_f32_16x16x32_bf16 v[76:79], a[12:15], a[192:195], v[76:79]
ds_read_b64_tr_b16 a[50:51], v18 offset:25600
v_mfma_f32_16x16x32_bf16 v[140:143], a[12:15], a[196:199], v[140:143]
ds_read_b64_tr_b16 a[52:53], v19 offset:24576
v_mfma_f32_16x16x32_bf16 v[204:207], a[12:15], a[200:203], v[204:207]
ds_read_b64_tr_b16 a[54:55], v19 offset:25600
v_mfma_f32_16x16x32_bf16 a[140:143], a[12:15], a[204:207], a[140:143]
ds_read_b64_tr_b16 a[56:57], v20 offset:24576
v_mfma_f32_16x16x32_bf16 v[80:83], a[16:19], a[192:195], v[80:83]
buffer_load_dwordx4 a[88:91], v6, s[28:31], s68 offen offset:3072 sc1
v_mfma_f32_16x16x32_bf16 v[144:147], a[16:19], a[196:199], v[144:147]
ds_read_b64_tr_b16 a[58:59], v20 offset:25600
v_mfma_f32_16x16x32_bf16 v[208:211], a[16:19], a[200:203], v[208:211]
ds_read_b64_tr_b16 a[60:61], v21 offset:24576
v_mfma_f32_16x16x32_bf16 a[144:147], a[16:19], a[204:207], a[144:147]
ds_read_b64_tr_b16 a[62:63], v21 offset:25600
v_mfma_f32_16x16x32_bf16 v[84:87], a[20:23], a[192:195], v[84:87]
s_add_u32 s62, s62, s63
v_mfma_f32_16x16x32_bf16 v[148:151], a[20:23], a[196:199], v[148:151]
buffer_store_dwordx4 v[52:55], v3, s[28:31], s62 offen
v_mfma_f32_16x16x32_bf16 v[212:215], a[20:23], a[200:203], v[212:215]
v_mfma_f32_16x16x32_bf16 a[148:151], a[20:23], a[204:207], a[148:151]
v_mfma_f32_16x16x32_bf16 v[88:91], a[24:27], a[192:195], v[88:91]
v_mfma_f32_16x16x32_bf16 v[152:155], a[24:27], a[196:199], v[152:155]
v_mfma_f32_16x16x32_bf16 v[216:219], a[24:27], a[200:203], v[216:219]
buffer_load_dwordx4 a[92:95], v7, s[28:31], s68 offen offset:3072 sc1
v_mfma_f32_16x16x32_bf16 a[152:155], a[24:27], a[204:207], a[152:155]
v_mfma_f32_16x16x32_bf16 v[92:95], a[28:31], a[192:195], v[92:95]
v_mfma_f32_16x16x32_bf16 v[156:159], a[28:31], a[196:199], v[156:159]
v_mfma_f32_16x16x32_bf16 v[220:223], a[28:31], a[200:203], v[220:223]
v_mfma_f32_16x16x32_bf16 a[156:159], a[28:31], a[204:207], a[156:159]
s_waitcnt vmcnt(40) lgkmcnt(0)
s_barrier
s_waitcnt vmcnt(30) lgkmcnt(0)
v_mfma_f32_16x16x32_bf16 v[64:67], a[32:35], a[208:211], v[64:67]
v_add_u32 v14, 0xfffe0000, v14
v_add_u32 v15, 0xfffe0000, v15
v_mfma_f32_16x16x32_bf16 v[128:131], a[32:35], a[212:215], v[128:131]
buffer_load_dwordx4 a[96:99], v4, s[28:31], s69 offen offset:0 sc1
v_add_u32 v16, 0xfffe0000, v16
v_mfma_f32_16x16x32_bf16 v[192:195], a[32:35], a[216:219], v[192:195]
v_add_u32 v17, 0xfffe0000, v17
v_add_u32 v18, 0xfffe0000, v18
v_mfma_f32_16x16x32_bf16 a[128:131], a[32:35], a[220:223], a[128:131]
v_add_u32 v19, 0xfffe0000, v19
v_add_u32 v20, 0xfffe0000, v20
v_mfma_f32_16x16x32_bf16 v[68:71], a[36:39], a[208:211], v[68:71]
v_add_u32 v21, 0xfffe0000, v21
v_mfma_f32_16x16x32_bf16 v[132:135], a[36:39], a[212:215], v[132:135]
ds_read_b64_tr_b16 a[0:1], v14 offset:0
s_add_u32 s62, s62, s63
v_mfma_f32_16x16x32_bf16 v[196:199], a[36:39], a[216:219], v[196:199]
buffer_store_dwordx4 v[56:59], v3, s[28:31], s62 offen
ds_read_b64_tr_b16 a[2:3], v14 offset:1024
v_mfma_f32_16x16x32_bf16 a[132:135], a[36:39], a[220:223], a[132:135]
ds_read_b64_tr_b16 a[4:5], v15 offset:0
v_mfma_f32_16x16x32_bf16 v[72:75], a[40:43], a[208:211], v[72:75]
ds_read_b64_tr_b16 a[6:7], v15 offset:1024
v_mfma_f32_16x16x32_bf16 v[136:139], a[40:43], a[212:215], v[136:139]
ds_read_b64_tr_b16 a[8:9], v16 offset:0
v_mfma_f32_16x16x32_bf16 v[200:203], a[40:43], a[216:219], v[200:203]
ds_read_b64_tr_b16 a[10:11], v16 offset:1024
v_mfma_f32_16x16x32_bf16 a[136:139], a[40:43], a[220:223], a[136:139]
buffer_load_dwordx4 a[100:103], v5, s[28:31], s69 offen offset:0 sc1
ds_read_b64_tr_b16 a[12:13], v17 offset:0
v_mfma_f32_16x16x32_bf16 v[76:79], a[44:47], a[208:211], v[76:79]
ds_read_b64_tr_b16 a[14:15], v17 offset:1024
v_mfma_f32_16x16x32_bf16 v[140:143], a[44:47], a[212:215], v[140:143]
ds_read_b64_tr_b16 a[16:17], v18 offset:0
v_mfma_f32_16x16x32_bf16 v[204:207], a[44:47], a[216:219], v[204:207]
ds_read_b64_tr_b16 a[18:19], v18 offset:1024
v_mfma_f32_16x16x32_bf16 a[140:143], a[44:47], a[220:223], a[140:143]
ds_read_b64_tr_b16 a[20:21], v19 offset:0
v_mfma_f32_16x16x32_bf16 v[80:83], a[48:51], a[208:211], v[80:83]
buffer_load_dwordx4 a[104:107], v6, s[28:31], s69 offen offset:0 sc1
v_mfma_f32_16x16x32_bf16 v[144:147], a[48:51], a[212:215], v[144:147]
ds_read_b64_tr_b16 a[22:23], v19 offset:1024
ds_read_b64_tr_b16 a[24:25], v20 offset:0
v_mfma_f32_16x16x32_bf16 v[208:211], a[48:51], a[216:219], v[208:211]
ds_read_b64_tr_b16 a[26:27], v20 offset:1024
v_mfma_f32_16x16x32_bf16 a[144:147], a[48:51], a[220:223], a[144:147]
ds_read_b64_tr_b16 a[28:29], v21 offset:0
v_mfma_f32_16x16x32_bf16 v[84:87], a[52:55], a[208:211], v[84:87]
s_add_u32 s62, s62, s63
v_mfma_f32_16x16x32_bf16 v[148:151], a[52:55], a[212:215], v[148:151]
buffer_store_dwordx4 v[60:63], v3, s[28:31], s62 offen
v_mfma_f32_16x16x32_bf16 v[212:215], a[52:55], a[216:219], v[212:215]
ds_read_b64_tr_b16 a[30:31], v21 offset:1024
v_mfma_f32_16x16x32_bf16 a[148:151], a[52:55], a[220:223], a[148:151]
v_mfma_f32_16x16x32_bf16 v[88:91], a[56:59], a[208:211], v[88:91]
v_mfma_f32_16x16x32_bf16 v[152:155], a[56:59], a[212:215], v[152:155]
v_mfma_f32_16x16x32_bf16 v[216:219], a[56:59], a[216:219], v[216:219]
buffer_load_dwordx4 a[108:111], v7, s[28:31], s69 offen offset:0 sc1
v_mfma_f32_16x16x32_bf16 a[152:155], a[56:59], a[220:223], a[152:155]
v_mfma_f32_16x16x32_bf16 v[92:95], a[60:63], a[208:211], v[92:95]
v_mfma_f32_16x16x32_bf16 v[156:159], a[60:63], a[212:215], v[156:159]
v_mfma_f32_16x16x32_bf16 v[220:223], a[60:63], a[216:219], v[220:223]
v_mfma_f32_16x16x32_bf16 a[156:159], a[60:63], a[220:223], a[156:159]
s_waitcnt vmcnt(24) lgkmcnt(0)
v_mfma_f32_16x16x32_bf16 v[64:67], a[0:3], a[224:227], v[64:67]
ds_read_b64_tr_b16 a[32:33], v14 offset:8192
ds_read_b64_tr_b16 a[34:35], v14 offset:9216
v_mfma_f32_16x16x32_bf16 v[128:131], a[0:3], a[228:231], v[128:131]
buffer_load_dwordx4 a[112:115], v4, s[28:31], s69 offen offset:1024 sc1
v_mfma_f32_16x16x32_bf16 v[192:195], a[0:3], a[232:235], v[192:195]
ds_read_b64_tr_b16 a[36:37], v15 offset:8192
v_mfma_f32_16x16x32_bf16 a[128:131], a[0:3], a[236:239], a[128:131]
ds_read_b64_tr_b16 a[38:39], v15 offset:9216
v_mfma_f32_16x16x32_bf16 v[68:71], a[4:7], a[224:227], v[68:71]
ds_read_b64_tr_b16 a[40:41], v16 offset:8192
v_mfma_f32_16x16x32_bf16 v[132:135], a[4:7], a[228:231], v[132:135]
s_add_u32 s62, s62, s64
v_mfma_f32_16x16x32_bf16 v[196:199], a[4:7], a[232:235], v[196:199]
buffer_store_dwordx4 v[96:99], v3, s[28:31], s62 offen
v_mfma_f32_16x16x32_bf16 a[132:135], a[4:7], a[236:239], a[132:135]
ds_read_b64_tr_b16 a[42:43], v16 offset:9216
v_mfma_f32_16x16x32_bf16 v[72:75], a[8:11], a[224:227], v[72:75]
ds_read_b64_tr_b16 a[44:45], v17 offset:8192
v_mfma_f32_16x16x32_bf16 v[136:139], a[8:11], a[228:231], v[136:139]
ds_read_b64_tr_b16 a[46:47], v17 offset:9216
v_mfma_f32_16x16x32_bf16 v[200:203], a[8:11], a[232:235], v[200:203]
ds_read_b64_tr_b16 a[48:49], v18 offset:8192
v_mfma_f32_16x16x32_bf16 a[136:139], a[8:11], a[236:239], a[136:139]
buffer_load_dwordx4 a[116:119], v5, s[28:31], s69 offen offset:1024 sc1
v_mfma_f32_16x16x32_bf16 v[76:79], a[12:15], a[224:227], v[76:79]
ds_read_b64_tr_b16 a[50:51], v18 offset:9216
v_mfma_f32_16x16x32_bf16 v[140:143], a[12:15], a[228:231], v[140:143]
ds_read_b64_tr_b16 a[52:53], v19 offset:8192
v_mfma_f32_16x16x32_bf16 v[204:207], a[12:15], a[232:235], v[204:207]
ds_read_b64_tr_b16 a[54:55], v19 offset:9216
v_mfma_f32_16x16x32_bf16 a[140:143], a[12:15], a[236:239], a[140:143]
ds_read_b64_tr_b16 a[56:57], v20 offset:8192
v_mfma_f32_16x16x32_bf16 v[80:83], a[16:19], a[224:227], v[80:83]
buffer_load_dwordx4 a[120:123], v6, s[28:31], s69 offen offset:1024 sc1
v_mfma_f32_16x16x32_bf16 v[144:147], a[16:19], a[228:231], v[144:147]
ds_read_b64_tr_b16 a[58:59], v20 offset:9216
v_mfma_f32_16x16x32_bf16 v[208:211], a[16:19], a[232:235], v[208:211]
ds_read_b64_tr_b16 a[60:61], v21 offset:8192
v_mfma_f32_16x16x32_bf16 a[144:147], a[16:19], a[236:239], a[144:147]
ds_read_b64_tr_b16 a[62:63], v21 offset:9216
v_mfma_f32_16x16x32_bf16 v[84:87], a[20:23], a[224:227], v[84:87]
s_add_u32 s62, s62, s63
v_mfma_f32_16x16x32_bf16 v[148:151], a[20:23], a[228:231], v[148:151]
buffer_store_dwordx4 v[100:103], v3, s[28:31], s62 offen
v_mfma_f32_16x16x32_bf16 v[212:215], a[20:23], a[232:235], v[212:215]
v_mfma_f32_16x16x32_bf16 a[148:151], a[20:23], a[236:239], a[148:151]
v_mfma_f32_16x16x32_bf16 v[88:91], a[24:27], a[224:227], v[88:91]
v_mfma_f32_16x16x32_bf16 v[152:155], a[24:27], a[228:231], v[152:155]
v_mfma_f32_16x16x32_bf16 v[216:219], a[24:27], a[232:235], v[216:219]
buffer_load_dwordx4 a[124:127], v7, s[28:31], s69 offen offset:1024 sc1
v_mfma_f32_16x16x32_bf16 a[152:155], a[24:27], a[236:239], a[152:155]
v_mfma_f32_16x16x32_bf16 v[92:95], a[28:31], a[224:227], v[92:95]
v_mfma_f32_16x16x32_bf16 v[156:159], a[28:31], a[228:231], v[156:159]
v_mfma_f32_16x16x32_bf16 v[220:223], a[28:31], a[232:235], v[220:223]
v_mfma_f32_16x16x32_bf16 a[156:159], a[28:31], a[236:239], a[156:159]
s_waitcnt vmcnt(22) lgkmcnt(0)
v_mfma_f32_16x16x32_bf16 v[64:67], a[32:35], a[240:243], v[64:67]
ds_read_b64_tr_b16 a[0:1], v14 offset:16384
ds_read_b64_tr_b16 a[2:3], v14 offset:17408
v_mfma_f32_16x16x32_bf16 v[128:131], a[32:35], a[244:247], v[128:131]
buffer_load_dwordx4 a[160:163], v4, s[28:31], s69 offen offset:2048 sc1
v_mfma_f32_16x16x32_bf16 v[192:195], a[32:35], a[248:251], v[192:195]
ds_read_b64_tr_b16 a[4:5], v15 offset:16384
v_mfma_f32_16x16x32_bf16 a[128:131], a[32:35], a[252:255], a[128:131]
ds_read_b64_tr_b16 a[6:7], v15 offset:17408
v_mfma_f32_16x16x32_bf16 v[68:71], a[36:39], a[240:243], v[68:71]
ds_read_b64_tr_b16 a[8:9], v16 offset:16384
v_mfma_f32_16x16x32_bf16 v[132:135], a[36:39], a[244:247], v[132:135]
s_add_u32 s62, s62, s63
v_mfma_f32_16x16x32_bf16 v[196:199], a[36:39], a[248:251], v[196:199]
buffer_store_dwordx4 v[104:107], v3, s[28:31], s62 offen
v_mfma_f32_16x16x32_bf16 a[132:135], a[36:39], a[252:255], a[132:135]
ds_read_b64_tr_b16 a[10:11], v16 offset:17408
v_mfma_f32_16x16x32_bf16 v[72:75], a[40:43], a[240:243], v[72:75]
ds_read_b64_tr_b16 a[12:13], v17 offset:16384
v_mfma_f32_16x16x32_bf16 v[136:139], a[40:43], a[244:247], v[136:139]
ds_read_b64_tr_b16 a[14:15], v17 offset:17408
v_mfma_f32_16x16x32_bf16 v[200:203], a[40:43], a[248:251], v[200:203]
ds_read_b64_tr_b16 a[16:17], v18 offset:16384
v_mfma_f32_16x16x32_bf16 a[136:139], a[40:43], a[252:255], a[136:139]
buffer_load_dwordx4 a[164:167], v5, s[28:31], s69 offen offset:2048 sc1
v_mfma_f32_16x16x32_bf16 v[76:79], a[44:47], a[240:243], v[76:79]
ds_read_b64_tr_b16 a[18:19], v18 offset:17408
v_mfma_f32_16x16x32_bf16 v[140:143], a[44:47], a[244:247], v[140:143]
ds_read_b64_tr_b16 a[20:21], v19 offset:16384
v_mfma_f32_16x16x32_bf16 v[204:207], a[44:47], a[248:251], v[204:207]
ds_read_b64_tr_b16 a[22:23], v19 offset:17408
v_mfma_f32_16x16x32_bf16 a[140:143], a[44:47], a[252:255], a[140:143]
ds_read_b64_tr_b16 a[24:25], v20 offset:16384
v_mfma_f32_16x16x32_bf16 v[80:83], a[48:51], a[240:243], v[80:83]
buffer_load_dwordx4 a[168:171], v6, s[28:31], s69 offen offset:2048 sc1
v_mfma_f32_16x16x32_bf16 v[144:147], a[48:51], a[244:247], v[144:147]
ds_read_b64_tr_b16 a[26:27], v20 offset:17408
v_mfma_f32_16x16x32_bf16 v[208:211], a[48:51], a[248:251], v[208:211]
ds_read_b64_tr_b16 a[28:29], v21 offset:16384
v_mfma_f32_16x16x32_bf16 a[144:147], a[48:51], a[252:255], a[144:147]
ds_read_b64_tr_b16 a[30:31], v21 offset:17408
v_mfma_f32_16x16x32_bf16 v[84:87], a[52:55], a[240:243], v[84:87]
s_add_u32 s62, s62, s63
v_mfma_f32_16x16x32_bf16 v[148:151], a[52:55], a[244:247], v[148:151]
buffer_store_dwordx4 v[108:111], v3, s[28:31], s62 offen
v_mfma_f32_16x16x32_bf16 v[212:215], a[52:55], a[248:251], v[212:215]
v_mfma_f32_16x16x32_bf16 a[148:151], a[52:55], a[252:255], a[148:151]
v_mfma_f32_16x16x32_bf16 v[88:91], a[56:59], a[240:243], v[88:91]
v_mfma_f32_16x16x32_bf16 v[152:155], a[56:59], a[244:247], v[152:155]
v_mfma_f32_16x16x32_bf16 v[216:219], a[56:59], a[248:251], v[216:219]
buffer_load_dwordx4 a[172:175], v7, s[28:31], s69 offen offset:2048 sc1
v_mfma_f32_16x16x32_bf16 a[152:155], a[56:59], a[252:255], a[152:155]
v_mfma_f32_16x16x32_bf16 v[92:95], a[60:63], a[240:243], v[92:95]
v_mfma_f32_16x16x32_bf16 v[156:159], a[60:63], a[244:247], v[156:159]
v_mfma_f32_16x16x32_bf16 v[220:223], a[60:63], a[248:251], v[220:223]
v_mfma_f32_16x16x32_bf16 a[156:159], a[60:63], a[252:255], a[156:159]
s_waitcnt vmcnt(24) lgkmcnt(0)
v_mfma_f32_16x16x32_bf16 v[64:67], a[0:3], a[64:67], v[64:67]
ds_read_b64_tr_b16 a[32:33], v14 offset:24576
ds_read_b64_tr_b16 a[34:35], v14 offset:25600
v_mfma_f32_16x16x32_bf16 v[128:131], a[0:3], a[68:71], v[128:131]
buffer_load_dwordx4 a[176:179], v4, s[28:31], s69 offen offset:3072 sc1
v_mfma_f32_16x16x32_bf16 v[192:195], a[0:3], a[72:75], v[192:195]
ds_read_b64_tr_b16 a[36:37], v15 offset:24576
v_mfma_f32_16x16x32_bf16 a[128:131], a[0:3], a[76:79], a[128:131]
ds_read_b64_tr_b16 a[38:39], v15 offset:25600
v_mfma_f32_16x16x32_bf16 v[68:71], a[4:7], a[64:67], v[68:71]
ds_read_b64_tr_b16 a[40:41], v16 offset:24576
v_mfma_f32_16x16x32_bf16 v[132:135], a[4:7], a[68:71], v[132:135]
s_add_u32 s62, s62, s63
v_mfma_f32_16x16x32_bf16 v[196:199], a[4:7], a[72:75], v[196:199]
buffer_store_dwordx4 v[112:115], v3, s[28:31], s62 offen
v_mfma_f32_16x16x32_bf16 a[132:135], a[4:7], a[76:79], a[132:135]
ds_read_b64_tr_b16 a[42:43], v16 offset:25600
v_mfma_f32_16x16x32_bf16 v[72:75], a[8:11], a[64:67], v[72:75]
ds_read_b64_tr_b16 a[44:45], v17 offset:24576
v_mfma_f32_16x16x32_bf16 v[136:139], a[8:11], a[68:71], v[136:139]
ds_read_b64_tr_b16 a[46:47], v17 offset:25600
v_mfma_f32_16x16x32_bf16 v[200:203], a[8:11], a[72:75], v[200:203]
ds_read_b64_tr_b16 a[48:49], v18 offset:24576
v_mfma_f32_16x16x32_bf16 a[136:139], a[8:11], a[76:79], a[136:139]
buffer_load_dwordx4 a[180:183], v5, s[28:31], s69 offen offset:3072 sc1
v_mfma_f32_16x16x32_bf16 v[76:79], a[12:15], a[64:67], v[76:79]
ds_read_b64_tr_b16 a[50:51], v18 offset:25600
v_mfma_f32_16x16x32_bf16 v[140:143], a[12:15], a[68:71], v[140:143]
ds_read_b64_tr_b16 a[52:53], v19 offset:24576
v_mfma_f32_16x16x32_bf16 v[204:207], a[12:15], a[72:75], v[204:207]
ds_read_b64_tr_b16 a[54:55], v19 offset:25600
v_mfma_f32_16x16x32_bf16 a[140:143], a[12:15], a[76:79], a[140:143]
ds_read_b64_tr_b16 a[56:57], v20 offset:24576
v_mfma_f32_16x16x32_bf16 v[80:83], a[16:19], a[64:67], v[80:83]
buffer_load_dwordx4 a[184:187], v6, s[28:31], s69 offen offset:3072 sc1
v_mfma_f32_16x16x32_bf16 v[144:147], a[16:19], a[68:71], v[144:147]
ds_read_b64_tr_b16 a[58:59], v20 offset:25600
v_mfma_f32_16x16x32_bf16 v[208:211], a[16:19], a[72:75], v[208:211]
ds_read_b64_tr_b16 a[60:61], v21 offset:24576
v_mfma_f32_16x16x32_bf16 a[144:147], a[16:19], a[76:79], a[144:147]
ds_read_b64_tr_b16 a[62:63], v21 offset:25600
v_mfma_f32_16x16x32_bf16 v[84:87], a[20:23], a[64:67], v[84:87]
s_add_u32 s62, s62, s63
v_mfma_f32_16x16x32_bf16 v[148:151], a[20:23], a[68:71], v[148:151]
buffer_store_dwordx4 v[116:119], v3, s[28:31], s62 offen
v_mfma_f32_16x16x32_bf16 v[212:215], a[20:23], a[72:75], v[212:215]
v_mfma_f32_16x16x32_bf16 a[148:151], a[20:23], a[76:79], a[148:151]
v_mfma_f32_16x16x32_bf16 v[88:91], a[24:27], a[64:67], v[88:91]
v_mfma_f32_16x16x32_bf16 v[152:155], a[24:27], a[68:71], v[152:155]
v_mfma_f32_16x16x32_bf16 v[216:219], a[24:27], a[72:75], v[216:219]
buffer_load_dwordx4 a[188:191], v7, s[28:31], s69 offen offset:3072 sc1
v_mfma_f32_16x16x32_bf16 a[152:155], a[24:27], a[76:79], a[152:155]
v_mfma_f32_16x16x32_bf16 v[92:95], a[28:31], a[64:67], v[92:95]
v_mfma_f32_16x16x32_bf16 v[156:159], a[28:31], a[68:71], v[156:159]
v_mfma_f32_16x16x32_bf16 v[220:223], a[28:31], a[72:75], v[220:223]
v_mfma_f32_16x16x32_bf16 a[156:159], a[28:31], a[76:79], a[156:159]
s_waitcnt vmcnt(40) lgkmcnt(0)
s_barrier
s_waitcnt vmcnt(24) lgkmcnt(0)
v_mfma_f32_16x16x32_bf16 v[64:67], a[32:35], a[80:83], v[64:67]
ds_read_b64_tr_b16 a[0:1], v14 offset:32768
ds_read_b64_tr_b16 a[2:3], v14 offset:33792
v_mfma_f32_16x16x32_bf16 v[128:131], a[32:35], a[84:87], v[128:131]
buffer_load_dwordx4 a[192:195], v4, s[28:31], s74 offen offset:0 sc1
v_mfma_f32_16x16x32_bf16 v[192:195], a[32:35], a[88:91], v[192:195]
ds_read_b64_tr_b16 a[4:5], v15 offset:32768
v_mfma_f32_16x16x32_bf16 a[128:131], a[32:35], a[92:95], a[128:131]
ds_read_b64_tr_b16 a[6:7], v15 offset:33792
v_mfma_f32_16x16x32_bf16 v[68:71], a[36:39], a[80:83], v[68:71]
ds_read_b64_tr_b16 a[8:9], v16 offset:32768
v_mfma_f32_16x16x32_bf16 v[132:135], a[36:39], a[84:87], v[132:135]
s_add_u32 s62, s62, s63
v_mfma_f32_16x16x32_bf16 v[196:199], a[36:39], a[88:91], v[196:199]
buffer_store_dwordx4 v[120:123], v3, s[28:31], s62 offen
v_mfma_f32_16x16x32_bf16 a[132:135], a[36:39], a[92:95], a[132:135]
ds_read_b64_tr_b16 a[10:11], v16 offset:33792
v_mfma_f32_16x16x32_bf16 v[72:75], a[40:43], a[80:83], v[72:75]
ds_read_b64_tr_b16 a[12:13], v17 offset:32768
v_mfma_f32_16x16x32_bf16 v[136:139], a[40:43], a[84:87], v[136:139]
ds_read_b64_tr_b16 a[14:15], v17 offset:33792
v_mfma_f32_16x16x32_bf16 v[200:203], a[40:43], a[88:91], v[200:203]
ds_read_b64_tr_b16 a[16:17], v18 offset:32768
v_mfma_f32_16x16x32_bf16 a[136:139], a[40:43], a[92:95], a[136:139]
buffer_load_dwordx4 a[196:199], v5, s[28:31], s74 offen offset:0 sc1
v_mfma_f32_16x16x32_bf16 v[76:79], a[44:47], a[80:83], v[76:79]
ds_read_b64_tr_b16 a[18:19], v18 offset:33792
v_mfma_f32_16x16x32_bf16 v[140:143], a[44:47], a[84:87], v[140:143]
ds_read_b64_tr_b16 a[20:21], v19 offset:32768
v_mfma_f32_16x16x32_bf16 v[204:207], a[44:47], a[88:91], v[204:207]
ds_read_b64_tr_b16 a[22:23], v19 offset:33792
v_mfma_f32_16x16x32_bf16 a[140:143], a[44:47], a[92:95], a[140:143]
ds_read_b64_tr_b16 a[24:25], v20 offset:32768
v_mfma_f32_16x16x32_bf16 v[80:83], a[48:51], a[80:83], v[80:83]
buffer_load_dwordx4 a[200:203], v6, s[28:31], s74 offen offset:0 sc1
v_mfma_f32_16x16x32_bf16 v[144:147], a[48:51], a[84:87], v[144:147]
ds_read_b64_tr_b16 a[26:27], v20 offset:33792
v_mfma_f32_16x16x32_bf16 v[208:211], a[48:51], a[88:91], v[208:211]
ds_read_b64_tr_b16 a[28:29], v21 offset:32768
v_mfma_f32_16x16x32_bf16 a[144:147], a[48:51], a[92:95], a[144:147]
ds_read_b64_tr_b16 a[30:31], v21 offset:33792
v_mfma_f32_16x16x32_bf16 v[84:87], a[52:55], a[80:83], v[84:87]
s_add_u32 s62, s62, s63
v_mfma_f32_16x16x32_bf16 v[148:151], a[52:55], a[84:87], v[148:151]
buffer_store_dwordx4 v[124:127], v3, s[28:31], s62 offen
v_mfma_f32_16x16x32_bf16 v[212:215], a[52:55], a[88:91], v[212:215]
v_mfma_f32_16x16x32_bf16 a[148:151], a[52:55], a[92:95], a[148:151]
v_mfma_f32_16x16x32_bf16 v[88:91], a[56:59], a[80:83], v[88:91]
v_mfma_f32_16x16x32_bf16 v[152:155], a[56:59], a[84:87], v[152:155]
v_mfma_f32_16x16x32_bf16 v[216:219], a[56:59], a[88:91], v[216:219]
buffer_load_dwordx4 a[204:207], v7, s[28:31], s74 offen offset:0 sc1
v_mfma_f32_16x16x32_bf16 a[152:155], a[56:59], a[92:95], a[152:155]
v_mfma_f32_16x16x32_bf16 v[92:95], a[60:63], a[80:83], v[92:95]
v_mfma_f32_16x16x32_bf16 v[156:159], a[60:63], a[84:87], v[156:159]
v_mfma_f32_16x16x32_bf16 v[220:223], a[60:63], a[88:91], v[220:223]
v_mfma_f32_16x16x32_bf16 a[156:159], a[60:63], a[92:95], a[156:159]
s_waitcnt vmcnt(24) lgkmcnt(0)
v_mfma_f32_16x16x32_bf16 v[64:67], a[0:3], a[96:99], v[64:67]
ds_read_b64_tr_b16 a[32:33], v14 offset:40960
ds_read_b64_tr_b16 a[34:35], v14 offset:41984
v_mfma_f32_16x16x32_bf16 v[128:131], a[0:3], a[100:103], v[128:131]
buffer_load_dwordx4 a[208:211], v4, s[28:31], s74 offen offset:1024 sc1
ds_read_b64_tr_b16 a[36:37], v15 offset:40960
v_mfma_f32_16x16x32_bf16 v[192:195], a[0:3], a[104:107], v[192:195]
ds_read_b64_tr_b16 a[38:39], v15 offset:41984
v_mfma_f32_16x16x32_bf16 a[128:131], a[0:3], a[108:111], a[128:131]
ds_read_b64_tr_b16 a[40:41], v16 offset:40960
v_mfma_f32_16x16x32_bf16 v[68:71], a[4:7], a[96:99], v[68:71]
s_add_u32 s62, s62, s64
v_mfma_f32_16x16x32_bf16 v[132:135], a[4:7], a[100:103], v[132:135]
buffer_store_dwordx4 v[160:163], v3, s[28:31], s62 offen
v_mfma_f32_16x16x32_bf16 v[196:199], a[4:7], a[104:107], v[196:199]
ds_read_b64_tr_b16 a[42:43], v16 offset:41984
v_mfma_f32_16x16x32_bf16 a[132:135], a[4:7], a[108:111], a[132:135]
ds_read_b64_tr_b16 a[44:45], v17 offset:40960
v_mfma_f32_16x16x32_bf16 v[72:75], a[8:11], a[96:99], v[72:75]
ds_read_b64_tr_b16 a[46:47], v17 offset:41984
v_mfma_f32_16x16x32_bf16 v[136:139], a[8:11], a[100:103], v[136:139]
buffer_load_dwordx4 a[212:215], v5, s[28:31], s74 offen offset:1024 sc1
v_mfma_f32_16x16x32_bf16 v[200:203], a[8:11], a[104:107], v[200:203]
ds_read_b64_tr_b16 a[48:49], v18 offset:40960
v_mfma_f32_16x16x32_bf16 a[136:139], a[8:11], a[108:111], a[136:139]
ds_read_b64_tr_b16 a[50:51], v18 offset:41984
v_mfma_f32_16x16x32_bf16 v[76:79], a[12:15], a[96:99], v[76:79]
ds_read_b64_tr_b16 a[52:53], v19 offset:40960
v_mfma_f32_16x16x32_bf16 v[140:143], a[12:15], a[100:103], v[140:143]
s_add_u32 s62, s62, s63
v_mfma_f32_16x16x32_bf16 v[204:207], a[12:15], a[104:107], v[204:207]
buffer_store_dwordx4 v[164:167], v3, s[28:31], s62 offen
v_mfma_f32_16x16x32_bf16 a[140:143], a[12:15], a[108:111], a[140:143]
ds_read_b64_tr_b16 a[54:55], v19 offset:41984
v_mfma_f32_16x16x32_bf16 v[80:83], a[16:19], a[96:99], v[80:83]
ds_read_b64_tr_b16 a[56:57], v20 offset:40960
v_mfma_f32_16x16x32_bf16 v[144:147], a[16:19], a[100:103], v[144:147]
ds_read_b64_tr_b16 a[58:59], v20 offset:41984
v_mfma_f32_16x16x32_bf16 v[208:211], a[16:19], a[104:107], v[208:211]
buffer_load_dwordx4 a[216:219], v6, s[28:31], s74 offen offset:1024 sc1
v_mfma_f32_16x16x32_bf16 a[144:147], a[16:19], a[108:111], a[144:147]
ds_read_b64_tr_b16 a[60:61], v21 offset:40960
v_mfma_f32_16x16x32_bf16 v[84:87], a[20:23], a[96:99], v[84:87]
ds_read_b64_tr_b16 a[62:63], v21 offset:41984
v_mfma_f32_16x16x32_bf16 v[148:151], a[20:23], a[100:103], v[148:151]
v_mfma_f32_16x16x32_bf16 v[212:215], a[20:23], a[104:107], v[212:215]
s_add_u32 s62, s62, s63
v_mfma_f32_16x16x32_bf16 a[148:151], a[20:23], a[108:111], a[148:151]
buffer_store_dwordx4 v[168:171], v3, s[28:31], s62 offen
v_mfma_f32_16x16x32_bf16 v[88:91], a[24:27], a[96:99], v[88:91]
v_mfma_f32_16x16x32_bf16 v[152:155], a[24:27], a[100:103], v[152:155]
v_mfma_f32_16x16x32_bf16 v[216:219], a[24:27], a[104:107], v[216:219]
v_mfma_f32_16x16x32_bf16 a[152:155], a[24:27], a[108:111], a[152:155]
buffer_load_dwordx4 a[220:223], v7, s[28:31], s74 offen offset:1024 sc1
v_mfma_f32_16x16x32_bf16 v[92:95], a[28:31], a[96:99], v[92:95]
v_mfma_f32_16x16x32_bf16 v[156:159], a[28:31], a[100:103], v[156:159]
v_mfma_f32_16x16x32_bf16 v[220:223], a[28:31], a[104:107], v[220:223]
s_mov_b32 s71, s56
v_mfma_f32_16x16x32_bf16 a[156:159], a[28:31], a[108:111], a[156:159]
s_waitcnt vmcnt(25) lgkmcnt(0)
v_mfma_f32_16x16x32_bf16 v[64:67], a[32:35], a[112:115], v[64:67]
ds_read_b64_tr_b16 a[0:1], v14 offset:49152
ds_read_b64_tr_b16 a[2:3], v14 offset:50176
v_mfma_f32_16x16x32_bf16 v[128:131], a[32:35], a[116:119], v[128:131]
buffer_load_dwordx4 a[224:227], v4, s[28:31], s74 offen offset:2048 sc1
s_mov_b32 s20, s88
v_mfma_f32_16x16x32_bf16 v[192:195], a[32:35], a[120:123], v[192:195]
ds_read_b64_tr_b16 a[4:5], v15 offset:49152
v_mfma_f32_16x16x32_bf16 a[128:131], a[32:35], a[124:127], a[128:131]
ds_read_b64_tr_b16 a[6:7], v15 offset:50176
v_mfma_f32_16x16x32_bf16 v[68:71], a[36:39], a[112:115], v[68:71]
ds_read_b64_tr_b16 a[8:9], v16 offset:49152
v_mfma_f32_16x16x32_bf16 v[132:135], a[36:39], a[116:119], v[132:135]
s_add_u32 s62, s62, s63
v_mfma_f32_16x16x32_bf16 v[196:199], a[36:39], a[120:123], v[196:199]
buffer_store_dwordx4 v[172:175], v3, s[28:31], s62 offen
v_mfma_f32_16x16x32_bf16 a[132:135], a[36:39], a[124:127], a[132:135]
ds_read_b64_tr_b16 a[10:11], v16 offset:50176
s_and_b32 s21, s89, 0xffff
v_mfma_f32_16x16x32_bf16 v[72:75], a[40:43], a[112:115], v[72:75]
ds_read_b64_tr_b16 a[12:13], v17 offset:49152
v_mfma_f32_16x16x32_bf16 v[136:139], a[40:43], a[116:119], v[136:139]
ds_read_b64_tr_b16 a[14:15], v17 offset:50176
v_mfma_f32_16x16x32_bf16 v[200:203], a[40:43], a[120:123], v[200:203]
ds_read_b64_tr_b16 a[16:17], v18 offset:49152
v_mfma_f32_16x16x32_bf16 a[136:139], a[40:43], a[124:127], a[136:139]
buffer_load_dwordx4 a[228:231], v5, s[28:31], s74 offen offset:2048 sc1
v_mfma_f32_16x16x32_bf16 v[76:79], a[44:47], a[112:115], v[76:79]
ds_read_b64_tr_b16 a[18:19], v18 offset:50176
v_mfma_f32_16x16x32_bf16 v[140:143], a[44:47], a[116:119], v[140:143]
ds_read_b64_tr_b16 a[20:21], v19 offset:49152
v_mfma_f32_16x16x32_bf16 v[204:207], a[44:47], a[120:123], v[204:207]
ds_read_b64_tr_b16 a[22:23], v19 offset:50176
v_mfma_f32_16x16x32_bf16 a[140:143], a[44:47], a[124:127], a[140:143]
ds_read_b64_tr_b16 a[24:25], v20 offset:49152
s_mov_b32 s22, 0x1c0000
v_mfma_f32_16x16x32_bf16 v[80:83], a[48:51], a[112:115], v[80:83]
buffer_load_dwordx4 a[232:235], v6, s[28:31], s74 offen offset:2048 sc1
v_mfma_f32_16x16x32_bf16 v[144:147], a[48:51], a[116:119], v[144:147]
ds_read_b64_tr_b16 a[26:27], v20 offset:50176
v_mfma_f32_16x16x32_bf16 v[208:211], a[48:51], a[120:123], v[208:211]
ds_read_b64_tr_b16 a[28:29], v21 offset:49152
v_mfma_f32_16x16x32_bf16 a[144:147], a[48:51], a[124:127], a[144:147]
ds_read_b64_tr_b16 a[30:31], v21 offset:50176
v_mfma_f32_16x16x32_bf16 v[84:87], a[52:55], a[112:115], v[84:87]
s_add_u32 s62, s62, s63
v_mfma_f32_16x16x32_bf16 v[148:151], a[52:55], a[116:119], v[148:151]
buffer_store_dwordx4 v[176:179], v3, s[28:31], s62 offen
v_mfma_f32_16x16x32_bf16 v[212:215], a[52:55], a[120:123], v[212:215]
s_mov_b32 s23, 0x20000
v_mfma_f32_16x16x32_bf16 a[148:151], a[52:55], a[124:127], a[148:151]
s_mov_b32 s24, s90
s_and_b32 s25, s91, 0xffff
v_mfma_f32_16x16x32_bf16 v[88:91], a[56:59], a[112:115], v[88:91]
s_mov_b32 s26, 0x1c0000
v_mfma_f32_16x16x32_bf16 v[152:155], a[56:59], a[116:119], v[152:155]
s_mov_b32 s27, 0x20000
v_mfma_f32_16x16x32_bf16 v[216:219], a[56:59], a[120:123], v[216:219]
buffer_load_dwordx4 a[236:239], v7, s[28:31], s74 offen offset:2048 sc1
v_mfma_f32_16x16x32_bf16 a[152:155], a[56:59], a[124:127], a[152:155]
s_mov_b32 s32, s92
v_mfma_f32_16x16x32_bf16 v[92:95], a[60:63], a[112:115], v[92:95]
s_and_b32 s33, s93, 0xffff
v_mfma_f32_16x16x32_bf16 v[156:159], a[60:63], a[116:119], v[156:159]
s_mov_b32 s34, 0x1c0000
v_mfma_f32_16x16x32_bf16 v[220:223], a[60:63], a[120:123], v[220:223]
s_mov_b32 s35, 0x20000
v_mfma_f32_16x16x32_bf16 a[156:159], a[60:63], a[124:127], a[156:159]
s_waitcnt vmcnt(25) lgkmcnt(0)
v_mfma_f32_16x16x32_bf16 v[64:67], a[0:3], a[160:163], v[64:67]
ds_read_b64_tr_b16 a[32:33], v14 offset:57344
ds_read_b64_tr_b16 a[34:35], v14 offset:58368
v_mfma_f32_16x16x32_bf16 v[128:131], a[0:3], a[164:167], v[128:131]
buffer_load_dwordx4 a[240:243], v4, s[28:31], s74 offen offset:3072 sc1
s_lshl_b32 s46, s43, 2
v_mfma_f32_16x16x32_bf16 v[192:195], a[0:3], a[168:171], v[192:195]
ds_read_b64_tr_b16 a[36:37], v15 offset:57344
s_add_u32 s46, s46, s3
v_mfma_f32_16x16x32_bf16 a[128:131], a[0:3], a[172:175], a[128:131]
ds_read_b64_tr_b16 a[38:39], v15 offset:58368
v_mfma_f32_16x16x32_bf16 v[68:71], a[4:7], a[160:163], v[68:71]
ds_read_b64_tr_b16 a[40:41], v16 offset:57344
s_mul_i32 s47, s46, 14336
v_mfma_f32_16x16x32_bf16 v[132:135], a[4:7], a[164:167], v[132:135]
s_add_u32 s62, s62, s63
v_mfma_f32_16x16x32_bf16 v[196:199], a[4:7], a[168:171], v[196:199]
buffer_store_dwordx4 v[180:183], v3, s[28:31], s62 offen
v_mfma_f32_16x16x32_bf16 a[132:135], a[4:7], a[172:175], a[132:135]
ds_read_b64_tr_b16 a[42:43], v16 offset:58368
s_mul_i32 s48, s42, 448
v_mfma_f32_16x16x32_bf16 v[72:75], a[8:11], a[160:163], v[72:75]
ds_read_b64_tr_b16 a[44:45], v17 offset:57344
v_mfma_f32_16x16x32_bf16 v[136:139], a[8:11], a[164:167], v[136:139]
ds_read_b64_tr_b16 a[46:47], v17 offset:58368
s_andn2_b32 s48, s48, 127
v_mfma_f32_16x16x32_bf16 v[200:203], a[8:11], a[168:171], v[200:203]
ds_read_b64_tr_b16 a[48:49], v18 offset:57344
v_mfma_f32_16x16x32_bf16 a[136:139], a[8:11], a[172:175], a[136:139]
buffer_load_dwordx4 a[244:247], v5, s[28:31], s74 offen offset:3072 sc1
v_mfma_f32_16x16x32_bf16 v[76:79], a[12:15], a[160:163], v[76:79]
ds_read_b64_tr_b16 a[50:51], v18 offset:58368
s_add_u32 s47, s47, s48
v_mfma_f32_16x16x32_bf16 v[140:143], a[12:15], a[164:167], v[140:143]
ds_read_b64_tr_b16 a[52:53], v19 offset:57344
v_mfma_f32_16x16x32_bf16 v[204:207], a[12:15], a[168:171], v[204:207]
ds_read_b64_tr_b16 a[54:55], v19 offset:58368
v_lshrrev_b32 v22, 2, v1
v_mfma_f32_16x16x32_bf16 a[140:143], a[12:15], a[172:175], a[140:143]
ds_read_b64_tr_b16 a[56:57], v20 offset:57344
v_mfma_f32_16x16x32_bf16 v[80:83], a[16:19], a[160:163], v[80:83]
buffer_load_dwordx4 a[248:251], v6, s[28:31], s74 offen offset:3072 sc1
v_mfma_f32_16x16x32_bf16 v[144:147], a[16:19], a[164:167], v[144:147]
ds_read_b64_tr_b16 a[58:59], v20 offset:58368
v_mul_u32_u24 v22, 3584, v22
v_mfma_f32_16x16x32_bf16 v[208:211], a[16:19], a[168:171], v[208:211]
ds_read_b64_tr_b16 a[60:61], v21 offset:57344
v_mfma_f32_16x16x32_bf16 a[144:147], a[16:19], a[172:175], a[144:147]
ds_read_b64_tr_b16 a[62:63], v21 offset:58368
v_and_b32 v23, 3, v1
v_mfma_f32_16x16x32_bf16 v[84:87], a[20:23], a[160:163], v[84:87]
s_add_u32 s62, s62, s63
v_mfma_f32_16x16x32_bf16 v[148:151], a[20:23], a[164:167], v[148:151]
buffer_store_dwordx4 v[184:187], v3, s[28:31], s62 offen
v_mfma_f32_16x16x32_bf16 v[212:215], a[20:23], a[168:171], v[212:215]
v_lshl_add_u32 v22, v23, 7, v22
v_add_u32 v22, s47, v22
v_mfma_f32_16x16x32_bf16 a[148:151], a[20:23], a[172:175], a[148:151]
v_cmp_gt_u32 vcc, 16, v1
v_mfma_f32_16x16x32_bf16 v[88:91], a[24:27], a[160:163], v[88:91]
v_mov_b32 v24, 0x40000000
s_mul_i32 s47, s46, 1792
v_mfma_f32_16x16x32_bf16 v[152:155], a[24:27], a[164:167], v[152:155]
s_mul_i32 s48, s42, 229376
v_mfma_f32_16x16x32_bf16 v[216:219], a[24:27], a[168:171], v[216:219]
buffer_load_dwordx4 a[252:255], v7, s[28:31], s74 offen offset:3072 sc1
v_mfma_f32_16x16x32_bf16 a[152:155], a[24:27], a[172:175], a[152:155]
s_add_u32 s47, s47, s48
v_cndmask_b32 v25, v24, v22, vcc
v_mfma_f32_16x16x32_bf16 v[92:95], a[28:31], a[160:163], v[92:95]
v_cmp_gt_u32 vcc, 14, v1
v_mfma_f32_16x16x32_bf16 v[156:159], a[28:31], a[164:167], v[156:159]
v_lshlrev_b32 v23, 7, v1
v_add_u32 v23, s47, v23
v_mfma_f32_16x16x32_bf16 v[220:223], a[28:31], a[168:171], v[220:223]
v_cndmask_b32 v26, v24, v23, vcc
v_mfma_f32_16x16x32_bf16 a[156:159], a[28:31], a[172:175], a[156:159]
s_waitcnt vmcnt(40) lgkmcnt(0)
s_barrier
s_waitcnt vmcnt(25) lgkmcnt(0)
v_mfma_f32_16x16x32_bf16 v[64:67], a[32:35], a[176:179], v[64:67]
s_add_u32 s62, s62, s63
v_add_u32 v14, 0x18000, v14
v_mfma_f32_16x16x32_bf16 v[128:131], a[32:35], a[180:183], v[128:131]
buffer_store_dwordx4 v[188:191], v3, s[28:31], s62 offen
v_add_u32 v15, 0x18000, v15
v_mfma_f32_16x16x32_bf16 v[192:195], a[32:35], a[184:187], v[192:195]
v_add_u32 v16, 0x18000, v16
v_add_u32 v17, 0x18000, v17
v_mfma_f32_16x16x32_bf16 a[128:131], a[32:35], a[188:191], a[128:131]
v_add_u32 v18, 0x18000, v18
v_add_u32 v19, 0x18000, v19
v_mfma_f32_16x16x32_bf16 v[68:71], a[36:39], a[176:179], v[68:71]
v_add_u32 v20, 0x18000, v20
v_add_u32 v21, 0x18000, v21
v_mfma_f32_16x16x32_bf16 v[132:135], a[36:39], a[180:183], v[132:135]
ds_read_b64_tr_b16 a[0:1], v14 offset:0
ds_read_b64_tr_b16 a[2:3], v14 offset:1024
v_mfma_f32_16x16x32_bf16 v[196:199], a[36:39], a[184:187], v[196:199]
ds_read_b64_tr_b16 a[4:5], v15 offset:0
v_mfma_f32_16x16x32_bf16 a[132:135], a[36:39], a[188:191], a[132:135]
ds_read_b64_tr_b16 a[6:7], v15 offset:1024
v_mfma_f32_16x16x32_bf16 v[72:75], a[40:43], a[176:179], v[72:75]
ds_read_b64_tr_b16 a[8:9], v16 offset:0
v_mfma_f32_16x16x32_bf16 v[136:139], a[40:43], a[180:183], v[136:139]
ds_read_b64_tr_b16 a[10:11], v16 offset:1024
v_mfma_f32_16x16x32_bf16 v[200:203], a[40:43], a[184:187], v[200:203]
ds_read_b64_tr_b16 a[12:13], v17 offset:0
v_mfma_f32_16x16x32_bf16 a[136:139], a[40:43], a[188:191], a[136:139]
ds_read_b64_tr_b16 a[14:15], v17 offset:1024
v_mfma_f32_16x16x32_bf16 v[76:79], a[44:47], a[176:179], v[76:79]
ds_read_b64_tr_b16 a[16:17], v18 offset:0
v_mfma_f32_16x16x32_bf16 v[140:143], a[44:47], a[180:183], v[140:143]
ds_read_b64_tr_b16 a[18:19], v18 offset:1024
v_mfma_f32_16x16x32_bf16 v[204:207], a[44:47], a[184:187], v[204:207]
ds_read_b64_tr_b16 a[20:21], v19 offset:0
v_mfma_f32_16x16x32_bf16 a[140:143], a[44:47], a[188:191], a[140:143]
s_add_u32 s62, s62, s64
v_mfma_f32_16x16x32_bf16 v[80:83], a[48:51], a[176:179], v[80:83]
buffer_store_dwordx4 v[224:227], v3, s[28:31], s62 offen
v_mfma_f32_16x16x32_bf16 v[144:147], a[48:51], a[180:183], v[144:147]
ds_read_b64_tr_b16 a[22:23], v19 offset:1024
v_mfma_f32_16x16x32_bf16 v[208:211], a[48:51], a[184:187], v[208:211]
ds_read_b64_tr_b16 a[24:25], v20 offset:0
v_mfma_f32_16x16x32_bf16 a[144:147], a[48:51], a[188:191], a[144:147]
ds_read_b64_tr_b16 a[26:27], v20 offset:1024
v_mfma_f32_16x16x32_bf16 v[84:87], a[52:55], a[176:179], v[84:87]
ds_read_b64_tr_b16 a[28:29], v21 offset:0
v_mfma_f32_16x16x32_bf16 v[148:151], a[52:55], a[180:183], v[148:151]
ds_read_b64_tr_b16 a[30:31], v21 offset:1024
v_mfma_f32_16x16x32_bf16 v[212:215], a[52:55], a[184:187], v[212:215]
v_mfma_f32_16x16x32_bf16 a[148:151], a[52:55], a[188:191], a[148:151]
v_mfma_f32_16x16x32_bf16 v[88:91], a[56:59], a[176:179], v[88:91]
v_mfma_f32_16x16x32_bf16 v[152:155], a[56:59], a[180:183], v[152:155]
v_mfma_f32_16x16x32_bf16 v[216:219], a[56:59], a[184:187], v[216:219]
v_mfma_f32_16x16x32_bf16 a[152:155], a[56:59], a[188:191], a[152:155]
v_mfma_f32_16x16x32_bf16 v[92:95], a[60:63], a[176:179], v[92:95]
v_mfma_f32_16x16x32_bf16 v[156:159], a[60:63], a[180:183], v[156:159]
v_mfma_f32_16x16x32_bf16 v[220:223], a[60:63], a[184:187], v[220:223]
v_mfma_f32_16x16x32_bf16 a[156:159], a[60:63], a[188:191], a[156:159]
s_waitcnt vmcnt(21) lgkmcnt(0)
v_mfma_f32_16x16x32_bf16 v[64:67], a[0:3], a[192:195], v[64:67]
ds_read_b64_tr_b16 a[32:33], v14 offset:8192
ds_read_b64_tr_b16 a[34:35], v14 offset:9216
v_mfma_f32_16x16x32_bf16 v[128:131], a[0:3], a[196:199], v[128:131]
buffer_load_dword v28, v2, s[28:31], s71 offen sc1
s_lshl_b32 s47, s44, 19
v_mfma_f32_16x16x32_bf16 v[192:195], a[0:3], a[200:203], v[192:195]
ds_read_b64_tr_b16 a[36:37], v15 offset:8192
s_add_u32 s49, s47, 16777216
v_mfma_f32_16x16x32_bf16 a[128:131], a[0:3], a[204:207], a[128:131]
ds_read_b64_tr_b16 a[38:39], v15 offset:9216
v_mfma_f32_16x16x32_bf16 v[68:71], a[4:7], a[192:195], v[68:71]
ds_read_b64_tr_b16 a[40:41], v16 offset:8192
v_mfma_f32_16x16x32_bf16 v[132:135], a[4:7], a[196:199], v[132:135]
ds_read_b64_tr_b16 a[42:43], v16 offset:9216
s_mov_b32 s18, 0x80000
v_mfma_f32_16x16x32_bf16 v[196:199], a[4:7], a[200:203], v[196:199]
ds_read_b64_tr_b16 a[44:45], v17 offset:8192
v_mfma_f32_16x16x32_bf16 a[132:135], a[4:7], a[204:207], a[132:135]
ds_read_b64_tr_b16 a[46:47], v17 offset:9216
v_mfma_f32_16x16x32_bf16 v[72:75], a[8:11], a[192:195], v[72:75]
s_add_u32 s48, s47, 33554432
s_lshl_b32 s74, s3, 12
v_mfma_f32_16x16x32_bf16 v[136:139], a[8:11], a[196:199], v[136:139]
ds_read_b64_tr_b16 a[48:49], v18 offset:8192
v_mfma_f32_16x16x32_bf16 v[200:203], a[8:11], a[200:203], v[200:203]
s_add_u32 s62, s62, s63
v_mfma_f32_16x16x32_bf16 a[136:139], a[8:11], a[204:207], a[136:139]
buffer_store_dwordx4 v[228:231], v3, s[28:31], s62 offen
v_add_u32 v5, s74, v3
v_mfma_f32_16x16x32_bf16 v[76:79], a[12:15], a[192:195], v[76:79]
ds_read_b64_tr_b16 a[50:51], v18 offset:9216
v_mfma_f32_16x16x32_bf16 v[140:143], a[12:15], a[196:199], v[140:143]
ds_read_b64_tr_b16 a[52:53], v19 offset:8192
v_mfma_f32_16x16x32_bf16 v[204:207], a[12:15], a[200:203], v[204:207]
ds_read_b64_tr_b16 a[54:55], v19 offset:9216
v_add_u32 v4, s49, v5
v_mfma_f32_16x16x32_bf16 a[140:143], a[12:15], a[204:207], a[140:143]
ds_read_b64_tr_b16 a[56:57], v20 offset:8192
v_mfma_f32_16x16x32_bf16 v[80:83], a[16:19], a[192:195], v[80:83]
s_add_u32 s15, s49, s74
v_mfma_f32_16x16x32_bf16 v[144:147], a[16:19], a[196:199], v[144:147]
ds_read_b64_tr_b16 a[58:59], v20 offset:9216
s_mov_b32 s13, -16384
v_mfma_f32_16x16x32_bf16 v[208:211], a[16:19], a[200:203], v[208:211]
ds_read_b64_tr_b16 a[60:61], v21 offset:8192
v_mfma_f32_16x16x32_bf16 a[144:147], a[16:19], a[204:207], a[144:147]
ds_read_b64_tr_b16 a[62:63], v21 offset:9216
v_mfma_f32_16x16x32_bf16 v[84:87], a[20:23], a[192:195], v[84:87]
s_add_u32 s62, s62, s63
s_lshl_b32 s14, s45, 1
v_mfma_f32_16x16x32_bf16 v[148:151], a[20:23], a[196:199], v[148:151]
buffer_store_dwordx4 v[232:235], v3, s[28:31], s62 offen
v_mfma_f32_16x16x32_bf16 v[212:215], a[20:23], a[200:203], v[212:215]
s_add_u32 s14, s14, 1
v_mfma_f32_16x16x32_bf16 a[148:151], a[20:23], a[204:207], a[148:151]
v_lshrrev_b32 v12, 4, v1
v_and_b32 v13, 15, v1
v_mfma_f32_16x16x32_bf16 v[88:91], a[24:27], a[192:195], v[88:91]
v_lshlrev_b32 v12, 2, v12
v_mfma_f32_16x16x32_bf16 v[152:155], a[24:27], a[196:199], v[152:155]
v_sub_u32 v13, v13, v12
v_mfma_f32_16x16x32_bf16 v[216:219], a[24:27], a[200:203], v[216:219]
s_lshl_b32 s47, s3, 4
v_add_u32 v7, s47, v13
v_mfma_f32_16x16x32_bf16 a[152:155], a[24:27], a[204:207], a[152:155]
v_mov_b32 v9, 0xff800000
v_mfma_f32_16x16x32_bf16 v[92:95], a[28:31], a[192:195], v[92:95]
v_mov_b32 v6, v3
v_mfma_f32_16x16x32_bf16 v[156:159], a[28:31], a[196:199], v[156:159]
s_lshl_b32 s47, s44, 12
v_add_u32 v11, s47, v3
v_mfma_f32_16x16x32_bf16 v[220:223], a[28:31], a[200:203], v[220:223]
s_add_u32 s16, s28, s48
s_addc_u32 s17, s29, 0
v_mfma_f32_16x16x32_bf16 a[156:159], a[28:31], a[204:207], a[156:159]
s_waitcnt vmcnt(2)
v_cmp_ne_u32 vcc, 0, v28
s_or_b64 vcc, vcc, s[96:97]
s_and_b32 s46, vcc_lo, 0x3
s_cmp_eq_u32 s46, 0x3
s_cbranch_scc0 M_SPINKVL
M_SRETKVL:
s_cmp_eq_u32 s65, 0
s_cbranch_scc1 M_ACQL
buffer_inv sc1
s_waitcnt vmcnt(0)
M_ACQL:
s_barrier
s_waitcnt vmcnt(17) lgkmcnt(0)
v_mfma_f32_16x16x32_bf16 v[64:67], a[32:35], a[208:211], v[64:67]
ds_read_b64_tr_b16 a[0:1], v14 offset:16384
s_add_u32 m0, s74, 0
v_mfma_f32_16x16x32_bf16 v[128:131], a[32:35], a[212:215], v[128:131]
buffer_load_dwordx4 v4, s[28:31], 0 offen offset:0 sc1 lds
ds_read_b64_tr_b16 a[2:3], v14 offset:17408
v_mfma_f32_16x16x32_bf16 v[192:195], a[32:35], a[216:219], v[192:195]
ds_read_b64_tr_b16 a[4:5], v15 offset:16384
v_mfma_f32_16x16x32_bf16 a[128:131], a[32:35], a[220:223], a[128:131]
ds_read_b64_tr_b16 a[6:7], v15 offset:17408
s_mul_i32 s58, s75, 131072
v_mfma_f32_16x16x32_bf16 v[68:71], a[36:39], a[208:211], v[68:71]
ds_read_b64_tr_b16 a[8:9], v16 offset:16384
v_mfma_f32_16x16x32_bf16 v[132:135], a[36:39], a[212:215], v[132:135]
s_add_u32 s62, s62, s63
v_mfma_f32_16x16x32_bf16 v[196:199], a[36:39], a[216:219], v[196:199]
buffer_store_dwordx4 v[236:239], v3, s[28:31], s62 offen
v_mfma_f32_16x16x32_bf16 a[132:135], a[36:39], a[220:223], a[132:135]
ds_read_b64_tr_b16 a[10:11], v16 offset:17408
s_add_u32 s58, s58, 50331648
v_mfma_f32_16x16x32_bf16 v[72:75], a[40:43], a[208:211], v[72:75]
ds_read_b64_tr_b16 a[12:13], v17 offset:16384
v_mfma_f32_16x16x32_bf16 v[136:139], a[40:43], a[212:215], v[136:139]
ds_read_b64_tr_b16 a[14:15], v17 offset:17408
v_mfma_f32_16x16x32_bf16 v[200:203], a[40:43], a[216:219], v[200:203]
ds_read_b64_tr_b16 a[16:17], v18 offset:16384
s_mul_i32 s59, s76, 131072
v_mfma_f32_16x16x32_bf16 a[136:139], a[40:43], a[220:223], a[136:139]
buffer_load_dwordx4 v4, s[28:31], 0 offen offset:1024 sc1 lds
v_mfma_f32_16x16x32_bf16 v[76:79], a[44:47], a[208:211], v[76:79]
ds_read_b64_tr_b16 a[18:19], v18 offset:17408
v_mfma_f32_16x16x32_bf16 v[140:143], a[44:47], a[212:215], v[140:143]
ds_read_b64_tr_b16 a[20:21], v19 offset:16384
v_mfma_f32_16x16x32_bf16 v[204:207], a[44:47], a[216:219], v[204:207]
ds_read_b64_tr_b16 a[22:23], v19 offset:17408
s_add_u32 s59, s59, 50331648
v_mfma_f32_16x16x32_bf16 a[140:143], a[44:47], a[220:223], a[140:143]
ds_read_b64_tr_b16 a[24:25], v20 offset:16384
v_mfma_f32_16x16x32_bf16 v[80:83], a[48:51], a[208:211], v[80:83]
buffer_load_dwordx4 v4, s[28:31], 0 offen offset:2048 sc1 lds
v_mfma_f32_16x16x32_bf16 v[144:147], a[48:51], a[212:215], v[144:147]
ds_read_b64_tr_b16 a[26:27], v20 offset:17408
s_mov_b32 s52, 0x2b800000
v_mfma_f32_16x16x32_bf16 v[208:211], a[48:51], a[216:219], v[208:211]
ds_read_b64_tr_b16 a[28:29], v21 offset:16384
v_mfma_f32_16x16x32_bf16 a[144:147], a[48:51], a[220:223], a[144:147]
ds_read_b64_tr_b16 a[30:31], v21 offset:17408
v_mfma_f32_16x16x32_bf16 v[84:87], a[52:55], a[208:211], v[84:87]
s_add_u32 s62, s62, s63
v_mfma_f32_16x16x32_bf16 v[148:151], a[52:55], a[212:215], v[148:151]
buffer_store_dwordx4 v[240:243], v3, s[28:31], s62 offen
s_mov_b32 s53, 0x28000000
v_mfma_f32_16x16x32_bf16 v[212:215], a[52:55], a[216:219], v[212:215]
s_lshl_b32 s47, s45, 2
v_mfma_f32_16x16x32_bf16 a[148:151], a[52:55], a[220:223], a[148:151]
s_sub_u32 s51, s47, 30
v_mfma_f32_16x16x32_bf16 v[88:91], a[56:59], a[208:211], v[88:91]
s_lshl_b32 s51, s51, 14
s_mov_b32 s50, s74
v_mfma_f32_16x16x32_bf16 v[152:155], a[56:59], a[212:215], v[152:155]
s_sub_u32 s54, 10, s45
v_mfma_f32_16x16x32_bf16 v[216:219], a[56:59], a[216:219], v[216:219]
buffer_load_dwordx4 v4, s[28:31], 0 offen offset:3072 sc1 lds
v_mfma_f32_16x16x32_bf16 a[152:155], a[56:59], a[220:223], a[152:155]
v_mov_b32 v12, 0x3e0293ee
v_mfma_f32_16x16x32_bf16 v[92:95], a[60:63], a[208:211], v[92:95]
v_mov_b32 v13, 0x3e0293ee
s_mul_i32 s78, s42, 28
v_mfma_f32_16x16x32_bf16 v[156:159], a[60:63], a[212:215], v[156:159]
s_add_u32 s78, s78, s43
v_mfma_f32_16x16x32_bf16 v[220:223], a[60:63], a[216:219], v[220:223]
s_cmp_lt_u32 s43, 28
s_cselect_b32 s78, s78, 0x40000
v_mfma_f32_16x16x32_bf16 a[156:159], a[60:63], a[220:223], a[156:159]
s_waitcnt vmcnt(17) lgkmcnt(0)
v_mfma_f32_16x16x32_bf16 v[64:67], a[0:3], a[224:227], v[64:67]
v_add_u32 v4, 16384, v4
s_add_u32 m0, s74, 32768
v_mfma_f32_16x16x32_bf16 v[128:131], a[0:3], a[228:231], v[128:131]
buffer_load_dwordx4 v4, s[28:31], 0 offen offset:0 sc1 lds
ds_read_b64_tr_b16 a[32:33], v14 offset:24576
v_mfma_f32_16x16x32_bf16 v[192:195], a[0:3], a[232:235], v[192:195]
ds_read_b64_tr_b16 a[34:35], v14 offset:25600
v_mul_u32_u24 v22, 7168, v0
v_mfma_f32_16x16x32_bf16 a[128:131], a[0:3], a[236:239], a[128:131]
ds_read_b64_tr_b16 a[36:37], v15 offset:24576
s_lshl_b32 s79, s78, 4
v_mfma_f32_16x16x32_bf16 v[68:71], a[4:7], a[224:227], v[68:71]
s_add_u32 s62, s62, s63
v_add_u32 v22, s79, v22
v_mfma_f32_16x16x32_bf16 v[132:135], a[4:7], a[228:231], v[132:135]
buffer_store_dwordx4 v[244:247], v3, s[28:31], s62 offen
s_lshl_b32 s79, s78, 13
v_mfma_f32_16x16x32_bf16 v[196:199], a[4:7], a[232:235], v[196:199]
ds_read_b64_tr_b16 a[38:39], v15 offset:25600
v_lshlrev_b32 v23, 2, v0
v_mfma_f32_16x16x32_bf16 a[132:135], a[4:7], a[236:239], a[132:135]
ds_read_b64_tr_b16 a[40:41], v16 offset:24576
ds_read_b64_tr_b16 a[42:43], v16 offset:25600
v_mfma_f32_16x16x32_bf16 v[72:75], a[8:11], a[224:227], v[72:75]
ds_read_b64_tr_b16 a[44:45], v17 offset:24576
v_mfma_f32_16x16x32_bf16 v[136:139], a[8:11], a[228:231], v[136:139]
buffer_load_dwordx4 v4, s[28:31], 0 offen offset:1024 sc1 lds
v_add_u32 v23, s79, v23
v_mfma_f32_16x16x32_bf16 v[200:203], a[8:11], a[232:235], v[200:203]
ds_read_b64_tr_b16 a[46:47], v17 offset:25600
v_mfma_f32_16x16x32_bf16 a[136:139], a[8:11], a[236:239], a[136:139]
ds_read_b64_tr_b16 a[48:49], v18 offset:24576
v_add_u32 v29, 4096, v23
v_mfma_f32_16x16x32_bf16 v[76:79], a[12:15], a[224:227], v[76:79]
ds_read_b64_tr_b16 a[50:51], v18 offset:25600
s_lshr_b32 s48, s43, 3
v_mfma_f32_16x16x32_bf16 v[140:143], a[12:15], a[228:231], v[140:143]
s_add_u32 s62, s62, s63
s_lshl_b32 s49, s42, 2
v_mfma_f32_16x16x32_bf16 v[204:207], a[12:15], a[232:235], v[204:207]
buffer_store_dwordx4 v[248:251], v3, s[28:31], s62 offen
v_mfma_f32_16x16x32_bf16 a[140:143], a[12:15], a[236:239], a[140:143]
ds_read_b64_tr_b16 a[52:53], v19 offset:24576
ds_read_b64_tr_b16 a[54:55], v19 offset:25600
v_mfma_f32_16x16x32_bf16 v[80:83], a[16:19], a[224:227], v[80:83]
ds_read_b64_tr_b16 a[56:57], v20 offset:24576
s_add_u32 s76, s48, s49
v_mfma_f32_16x16x32_bf16 v[144:147], a[16:19], a[228:231], v[144:147]
ds_read_b64_tr_b16 a[58:59], v20 offset:25600
v_mfma_f32_16x16x32_bf16 v[208:211], a[16:19], a[232:235], v[208:211]
buffer_load_dwordx4 v4, s[28:31], 0 offen offset:2048 sc1 lds
s_sub_u32 s75, s48, s49
v_mfma_f32_16x16x32_bf16 a[144:147], a[16:19], a[236:239], a[144:147]
ds_read_b64_tr_b16 a[60:61], v21 offset:24576
s_add_u32 s75, s75, 60
v_mfma_f32_16x16x32_bf16 v[84:87], a[20:23], a[224:227], v[84:87]
ds_read_b64_tr_b16 a[62:63], v21 offset:25600
s_and_b32 s77, s43, 7
v_mfma_f32_16x16x32_bf16 v[148:151], a[20:23], a[228:231], v[148:151]
s_lshl_b32 s46, s3, 15
v_mfma_f32_16x16x32_bf16 v[212:215], a[20:23], a[232:235], v[212:215]
s_add_u32 s62, s62, s63
s_mul_i32 s47, s77, 524288
v_mfma_f32_16x16x32_bf16 a[148:151], a[20:23], a[236:239], a[148:151]
buffer_store_dwordx4 v[252:255], v3, s[28:31], s62 offen
s_add_u32 s47, s47, s46
v_mfma_f32_16x16x32_bf16 v[88:91], a[24:27], a[224:227], v[88:91]
s_add_u32 s49, s47, 4194304
v_mfma_f32_16x16x32_bf16 v[152:155], a[24:27], a[228:231], v[152:155]
s_sub_u32 s15, s49, s15
s_add_u32 s15, s15, 12288
v_mfma_f32_16x16x32_bf16 v[216:219], a[24:27], a[232:235], v[216:219]
s_add_u32 s46, s46, 50331648
s_mul_i32 s47, s75, 262144
v_mfma_f32_16x16x32_bf16 a[152:155], a[24:27], a[236:239], a[152:155]
buffer_load_dwordx4 v4, s[28:31], 0 offen offset:3072 sc1 lds
s_add_u32 s4, s47, s46
v_mfma_f32_16x16x32_bf16 v[92:95], a[28:31], a[224:227], v[92:95]
s_add_u32 s5, s4, 131072
v_mfma_f32_16x16x32_bf16 v[156:159], a[28:31], a[228:231], v[156:159]
s_mul_i32 s47, s76, 262144
s_add_u32 s6, s47, s46
v_mfma_f32_16x16x32_bf16 v[220:223], a[28:31], a[232:235], v[220:223]
s_add_u32 s7, s6, 131072
s_mov_b32 s70, s75
v_mfma_f32_16x16x32_bf16 a[156:159], a[28:31], a[236:239], a[156:159]
s_waitcnt vmcnt(7) lgkmcnt(0)
s_barrier
s_waitcnt vmcnt(18) lgkmcnt(0)
v_mfma_f32_16x16x32_bf16 v[64:67], a[32:35], a[240:243], v[64:67]
v_add_u32 v4, 16384, v4
s_add_u32 m0, s74, 65536
v_add_u32 v14, s49, v3
v_mfma_f32_16x16x32_bf16 v[68:71], a[36:39], a[240:243], v[68:71]
buffer_load_dwordx4 v4, s[28:31], 0 offen offset:0 sc1 lds
ds_read_b128 a[64:67], v6 offset:0
v_add_u32 v15, 131072, v14
v_mfma_f32_16x16x32_bf16 v[72:75], a[40:43], a[240:243], v[72:75]
ds_read_b128 a[68:71], v6 offset:1024
ds_read_b128 a[72:75], v6 offset:2048
v_mfma_f32_16x16x32_bf16 v[76:79], a[44:47], a[240:243], v[76:79]
ds_read_b128 a[76:79], v6 offset:3072
ds_read_b128 a[80:83], v6 offset:4096
v_add_u32 v16, 262144, v14
v_mfma_f32_16x16x32_bf16 v[80:83], a[48:51], a[240:243], v[80:83]
buffer_load_dwordx4 v4, s[28:31], 0 offen offset:1024 sc1 lds
ds_read_b128 a[84:87], v6 offset:5120
v_mfma_f32_16x16x32_bf16 v[84:87], a[52:55], a[240:243], v[84:87]
ds_read_b128 a[88:91], v6 offset:6144
ds_read_b128 a[92:95], v6 offset:7168
v_mfma_f32_16x16x32_bf16 v[88:91], a[56:59], a[240:243], v[88:91]
ds_read_b128 a[96:99], v6 offset:8192
ds_read_b128 a[100:103], v6 offset:9216
v_add_u32 v17, 393216, v14
v_mfma_f32_16x16x32_bf16 v[92:95], a[60:63], a[240:243], v[92:95]
ds_read_b128 a[104:107], v6 offset:10240
ds_read_b128 a[108:111], v6 offset:11264
v_mfma_f32_16x16x32_bf16 v[128:131], a[32:35], a[244:247], v[128:131]
buffer_load_dwordx4 v4, s[28:31], 0 offen offset:2048 sc1 lds
v_add_u32 v18, s4, v3
v_mfma_f32_16x16x32_bf16 v[132:135], a[36:39], a[244:247], v[132:135]
ds_read_b128 a[112:115], v6 offset:12288
ds_read_b128 a[116:119], v6 offset:13312
v_add_u32 v19, s5, v3
v_mfma_f32_16x16x32_bf16 v[136:139], a[40:43], a[244:247], v[136:139]
ds_read_b128 a[120:123], v6 offset:14336
ds_read_b128 a[124:127], v6 offset:15360
v_mfma_f32_16x16x32_bf16 v[140:143], a[44:47], a[244:247], v[140:143]
v_add_u32 v20, s6, v3
v_add_u32 v21, s7, v3
v_mfma_f32_16x16x32_bf16 v[144:147], a[48:51], a[244:247], v[144:147]
buffer_load_dwordx4 v4, s[28:31], 0 offen offset:3072 sc1 lds
v_mfma_f32_16x16x32_bf16 v[148:151], a[52:55], a[244:247], v[148:151]
v_mul_f32 v64, v64, v12
v_mul_f32 v65, v65, v12
v_mfma_f32_16x16x32_bf16 v[152:155], a[56:59], a[244:247], v[152:155]
v_mul_f32 v66, v66, v12
v_mul_f32 v67, v67, v12
v_mfma_f32_16x16x32_bf16 v[156:159], a[60:63], a[244:247], v[156:159]
v_add_u32 v4, 16384, v4
s_add_u32 m0, s74, 98304
v_mfma_f32_16x16x32_bf16 v[192:195], a[32:35], a[248:251], v[192:195]
buffer_load_dwordx4 v4, s[28:31], 0 offen offset:0 sc1 lds
v_mul_f32 v68, v68, v12
v_mfma_f32_16x16x32_bf16 v[196:199], a[36:39], a[248:251], v[196:199]
v_mul_f32 v69, v69, v12
v_mul_f32 v70, v70, v12
v_mfma_f32_16x16x32_bf16 v[200:203], a[40:43], a[248:251], v[200:203]
v_mul_f32 v71, v71, v12
v_cvt_pk_bf16_f32 v64, v64, v65
v_mfma_f32_16x16x32_bf16 v[204:207], a[44:47], a[248:251], v[204:207]
v_cvt_pk_bf16_f32 v65, v66, v67
v_cvt_pk_bf16_f32 v66, v68, v69
v_mfma_f32_16x16x32_bf16 v[208:211], a[48:51], a[248:251], v[208:211]
buffer_load_dwordx4 v4, s[28:31], 0 offen offset:1024 sc1 lds
v_cvt_pk_bf16_f32 v67, v70, v71
v_mfma_f32_16x16x32_bf16 v[212:215], a[52:55], a[248:251], v[212:215]
v_accvgpr_write_b32 a160, v64
v_accvgpr_write_b32 a161, v65
v_mfma_f32_16x16x32_bf16 v[216:219], a[56:59], a[248:251], v[216:219]
v_accvgpr_write_b32 a162, v66
v_accvgpr_write_b32 a163, v67
v_mfma_f32_16x16x32_bf16 v[220:223], a[60:63], a[248:251], v[220:223]
v_mul_f32 v72, v72, v12
v_mul_f32 v73, v73, v12
v_mfma_f32_16x16x32_bf16 a[128:131], a[32:35], a[252:255], a[128:131]
buffer_load_dwordx4 v4, s[28:31], 0 offen offset:2048 sc1 lds
v_mul_f32 v74, v74, v12
v_mfma_f32_16x16x32_bf16 a[132:135], a[36:39], a[252:255], a[132:135]
v_mul_f32 v75, v75, v12
v_mul_f32 v76, v76, v12
v_mfma_f32_16x16x32_bf16 a[136:139], a[40:43], a[252:255], a[136:139]
v_mul_f32 v77, v77, v12
v_mul_f32 v78, v78, v12
v_mfma_f32_16x16x32_bf16 a[140:143], a[44:47], a[252:255], a[140:143]
v_mul_f32 v79, v79, v12
v_cvt_pk_bf16_f32 v72, v72, v73
v_mfma_f32_16x16x32_bf16 a[144:147], a[48:51], a[252:255], a[144:147]
buffer_load_dwordx4 v4, s[28:31], 0 offen offset:3072 sc1 lds
v_cvt_pk_bf16_f32 v73, v74, v75
v_mfma_f32_16x16x32_bf16 a[148:151], a[52:55], a[252:255], a[148:151]
v_cvt_pk_bf16_f32 v74, v76, v77
v_cvt_pk_bf16_f32 v75, v78, v79
v_mfma_f32_16x16x32_bf16 a[152:155], a[56:59], a[252:255], a[152:155]
v_accvgpr_write_b32 a164, v72
v_accvgpr_write_b32 a165, v73
v_mfma_f32_16x16x32_bf16 a[156:159], a[60:63], a[252:255], a[156:159]
v_accvgpr_write_b32 a166, v74
v_accvgpr_write_b32 a167, v75
v_pk_mul_f32 v[80:81], v[80:81], v[12:13]
v_pk_mul_f32 v[82:83], v[82:83], v[12:13]
v_pk_mul_f32 v[84:85], v[84:85], v[12:13]
v_pk_mul_f32 v[86:87], v[86:87], v[12:13]
v_cvt_pk_bf16_f32 v80, v80, v81
v_cvt_pk_bf16_f32 v81, v82, v83
v_cvt_pk_bf16_f32 v82, v84, v85
v_cvt_pk_bf16_f32 v83, v86, v87
v_accvgpr_write_b32 a168, v80
v_accvgpr_write_b32 a169, v81
v_accvgpr_write_b32 a170, v82
v_accvgpr_write_b32 a171, v83
v_pk_mul_f32 v[88:89], v[88:89], v[12:13]
v_pk_mul_f32 v[90:91], v[90:91], v[12:13]
s_add_u32 m0, s74, 114688
v_pk_mul_f32 v[92:93], v[92:93], v[12:13]
v_pk_mul_f32 v[94:95], v[94:95], v[12:13]
v_cvt_pk_bf16_f32 v88, v88, v89
v_cvt_pk_bf16_f32 v89, v90, v91
v_cvt_pk_bf16_f32 v90, v92, v93
v_cvt_pk_bf16_f32 v91, v94, v95
v_accvgpr_write_b32 a172, v88
v_accvgpr_write_b32 a173, v89
v_accvgpr_write_b32 a174, v90
v_accvgpr_write_b32 a175, v91
v_pk_mul_f32 v[128:129], v[128:129], v[12:13]
v_pk_mul_f32 v[130:131], v[130:131], v[12:13]
v_pk_mul_f32 v[132:133], v[132:133], v[12:13]
v_pk_mul_f32 v[134:135], v[134:135], v[12:13]
buffer_load_dwordx4 v5, s[16:19], 0 offen offset:0 sc1 lds
v_cvt_pk_bf16_f32 v128, v128, v129
v_cvt_pk_bf16_f32 v129, v130, v131
v_cvt_pk_bf16_f32 v130, v132, v133
v_cvt_pk_bf16_f32 v131, v134, v135
v_accvgpr_write_b32 a176, v128
v_accvgpr_write_b32 a177, v129
v_accvgpr_write_b32 a178, v130
v_accvgpr_write_b32 a179, v131
v_pk_mul_f32 v[136:137], v[136:137], v[12:13]
v_pk_mul_f32 v[138:139], v[138:139], v[12:13]
v_pk_mul_f32 v[140:141], v[140:141], v[12:13]
v_pk_mul_f32 v[142:143], v[142:143], v[12:13]
v_cvt_pk_bf16_f32 v136, v136, v137
v_cvt_pk_bf16_f32 v137, v138, v139
buffer_load_dwordx4 v5, s[16:19], 0 offen offset:1024 sc1 lds
v_cvt_pk_bf16_f32 v138, v140, v141
v_cvt_pk_bf16_f32 v139, v142, v143
v_accvgpr_write_b32 a180, v136
v_accvgpr_write_b32 a181, v137
v_accvgpr_write_b32 a182, v138
v_accvgpr_write_b32 a183, v139
v_pk_mul_f32 v[144:145], v[144:145], v[12:13]
v_pk_mul_f32 v[146:147], v[146:147], v[12:13]
v_pk_mul_f32 v[148:149], v[148:149], v[12:13]
v_pk_mul_f32 v[150:151], v[150:151], v[12:13]
v_cvt_pk_bf16_f32 v144, v144, v145
v_cvt_pk_bf16_f32 v145, v146, v147
v_cvt_pk_bf16_f32 v146, v148, v149
v_cvt_pk_bf16_f32 v147, v150, v151
buffer_load_dwordx4 v5, s[16:19], 0 offen offset:2048 sc1 lds
v_accvgpr_write_b32 a184, v144
v_accvgpr_write_b32 a185, v145
v_accvgpr_write_b32 a186, v146
v_accvgpr_write_b32 a187, v147
v_pk_mul_f32 v[152:153], v[152:153], v[12:13]
v_pk_mul_f32 v[154:155], v[154:155], v[12:13]
v_pk_mul_f32 v[156:157], v[156:157], v[12:13]
v_pk_mul_f32 v[158:159], v[158:159], v[12:13]
v_cvt_pk_bf16_f32 v152, v152, v153
v_cvt_pk_bf16_f32 v153, v154, v155
v_cvt_pk_bf16_f32 v154, v156, v157
v_cvt_pk_bf16_f32 v155, v158, v159
v_accvgpr_write_b32 a188, v152
v_accvgpr_write_b32 a189, v153
buffer_load_dwordx4 v5, s[16:19], 0 offen offset:3072 sc1 lds
v_accvgpr_write_b32 a190, v154
v_accvgpr_write_b32 a191, v155
v_pk_mul_f32 v[192:193], v[192:193], v[12:13]
v_pk_mul_f32 v[194:195], v[194:195], v[12:13]
v_pk_mul_f32 v[196:197], v[196:197], v[12:13]
v_pk_mul_f32 v[198:199], v[198:199], v[12:13]
v_cvt_pk_bf16_f32 v192, v192, v193
v_cvt_pk_bf16_f32 v193, v194, v195
v_cvt_pk_bf16_f32 v194, v196, v197
v_cvt_pk_bf16_f32 v195, v198, v199
v_accvgpr_write_b32 a192, v192
v_accvgpr_write_b32 a193, v193
v_accvgpr_write_b32 a194, v194
v_accvgpr_write_b32 a195, v195
v_pk_mul_f32 v[200:201], v[200:201], v[12:13]
v_pk_mul_f32 v[202:203], v[202:203], v[12:13]
v_pk_mul_f32 v[204:205], v[204:205], v[12:13]
v_pk_mul_f32 v[206:207], v[206:207], v[12:13]
v_cvt_pk_bf16_f32 v200, v200, v201
v_cvt_pk_bf16_f32 v201, v202, v203
v_cvt_pk_bf16_f32 v202, v204, v205
v_cvt_pk_bf16_f32 v203, v206, v207
v_accvgpr_write_b32 a196, v200
v_accvgpr_write_b32 a197, v201
v_accvgpr_write_b32 a198, v202
v_accvgpr_write_b32 a199, v203
v_pk_mul_f32 v[208:209], v[208:209], v[12:13]
v_pk_mul_f32 v[210:211], v[210:211], v[12:13]
v_pk_mul_f32 v[212:213], v[212:213], v[12:13]
v_pk_mul_f32 v[214:215], v[214:215], v[12:13]
v_cvt_pk_bf16_f32 v208, v208, v209
v_cvt_pk_bf16_f32 v209, v210, v211
v_cvt_pk_bf16_f32 v210, v212, v213
v_cvt_pk_bf16_f32 v211, v214, v215
v_accvgpr_write_b32 a200, v208
v_accvgpr_write_b32 a201, v209
v_accvgpr_write_b32 a202, v210
v_accvgpr_write_b32 a203, v211
v_pk_mul_f32 v[216:217], v[216:217], v[12:13]
v_pk_mul_f32 v[218:219], v[218:219], v[12:13]
v_pk_mul_f32 v[220:221], v[220:221], v[12:13]
v_pk_mul_f32 v[222:223], v[222:223], v[12:13]
v_cvt_pk_bf16_f32 v216, v216, v217
v_cvt_pk_bf16_f32 v217, v218, v219
v_cvt_pk_bf16_f32 v218, v220, v221
v_cvt_pk_bf16_f32 v219, v222, v223
v_accvgpr_write_b32 a204, v216
v_accvgpr_write_b32 a205, v217
v_accvgpr_write_b32 a206, v218
v_accvgpr_write_b32 a207, v219
v_accvgpr_read_b32 v240, a128
v_accvgpr_read_b32 v241, a129
v_accvgpr_read_b32 v242, a130
v_accvgpr_read_b32 v243, a131
v_accvgpr_read_b32 v244, a132
v_accvgpr_read_b32 v245, a133
v_accvgpr_read_b32 v246, a134
v_accvgpr_read_b32 v247, a135
v_pk_mul_f32 v[240:241], v[240:241], v[12:13]
v_pk_mul_f32 v[242:243], v[242:243], v[12:13]
v_pk_mul_f32 v[244:245], v[244:245], v[12:13]
v_pk_mul_f32 v[246:247], v[246:247], v[12:13]
v_cvt_pk_bf16_f32 v240, v240, v241
v_cvt_pk_bf16_f32 v241, v242, v243
v_cvt_pk_bf16_f32 v242, v244, v245
v_cvt_pk_bf16_f32 v243, v246, v247
v_accvgpr_write_b32 a208, v240
v_accvgpr_write_b32 a209, v241
v_accvgpr_write_b32 a210, v242
v_accvgpr_write_b32 a211, v243
v_accvgpr_read_b32 v248, a136
v_accvgpr_read_b32 v249, a137
v_accvgpr_read_b32 v250, a138
v_accvgpr_read_b32 v251, a139
v_accvgpr_read_b32 v252, a140
v_accvgpr_read_b32 v253, a141
v_accvgpr_read_b32 v254, a142
v_accvgpr_read_b32 v255, a143
v_pk_mul_f32 v[248:249], v[248:249], v[12:13]
v_pk_mul_f32 v[250:251], v[250:251], v[12:13]
v_pk_mul_f32 v[252:253], v[252:253], v[12:13]
v_pk_mul_f32 v[254:255], v[254:255], v[12:13]
v_cvt_pk_bf16_f32 v248, v248, v249
v_cvt_pk_bf16_f32 v249, v250, v251
v_cvt_pk_bf16_f32 v250, v252, v253
v_cvt_pk_bf16_f32 v251, v254, v255
v_accvgpr_write_b32 a212, v248
v_accvgpr_write_b32 a213, v249
v_accvgpr_write_b32 a214, v250
v_accvgpr_write_b32 a215, v251
v_accvgpr_read_b32 v240, a144
v_accvgpr_read_b32 v241, a145
v_accvgpr_read_b32 v242, a146
v_accvgpr_read_b32 v243, a147
v_accvgpr_read_b32 v244, a148
v_accvgpr_read_b32 v245, a149
v_accvgpr_read_b32 v246, a150
v_accvgpr_read_b32 v247, a151
v_pk_mul_f32 v[240:241], v[240:241], v[12:13]
v_pk_mul_f32 v[242:243], v[242:243], v[12:13]
v_pk_mul_f32 v[244:245], v[244:245], v[12:13]
v_pk_mul_f32 v[246:247], v[246:247], v[12:13]
v_cvt_pk_bf16_f32 v240, v240, v241
v_cvt_pk_bf16_f32 v241, v242, v243
v_cvt_pk_bf16_f32 v242, v244, v245
v_cvt_pk_bf16_f32 v243, v246, v247
v_accvgpr_write_b32 a216, v240
v_accvgpr_write_b32 a217, v241
v_accvgpr_write_b32 a218, v242
v_accvgpr_write_b32 a219, v243
s_waitcnt vmcnt(12) lgkmcnt(0)
s_barrier
s_cmp_eq_u32 s65, 0
s_cbranch_scc1 M_FASTL
buffer_wbl2 sc1
s_waitcnt vmcnt(0)
M_FASTL:
buffer_store_dword v31, v30, s[28:31], s98 offen sc1
ds_read_b128 a[0:3], v6 offset:32768
ds_read_b128 a[4:7], v6 offset:33792
s_add_u32 m0, s50, 0
v_add_u32 v4, 16384, v4
v_mfma_f32_16x16x32_bf16 v[32:35], a[64:67], a[160:163], 0
ds_read_b128 a[8:11], v6 offset:34816
ds_read_b128 a[12:15], v6 offset:35840
v_mfma_f32_16x16x32_bf16 v[32:35], a[68:71], a[164:167], v[32:35]
buffer_load_dwordx4 v4, s[28:31], 0 offen offset:0 sc1 lds
ds_read_b128 a[16:19], v6 offset:36864
v_mfma_f32_16x16x32_bf16 v[32:35], a[72:75], a[168:171], v[32:35]
ds_read_b128 a[20:23], v6 offset:37888
ds_read_b128 a[24:27], v6 offset:38912
v_mfma_f32_16x16x32_bf16 v[32:35], a[76:79], a[172:175], v[32:35]
ds_read_b128 a[28:31], v6 offset:39936
v_add_u32 v5, 16384, v5
v_mfma_f32_16x16x32_bf16 v[36:39], a[80:83], a[160:163], 0
ds_read_b128 a[32:35], v6 offset:40960
ds_read_b128 a[36:39], v6 offset:41984
v_mfma_f32_16x16x32_bf16 v[36:39], a[84:87], a[164:167], v[36:39]
buffer_load_dwordx4 v4, s[28:31], 0 offen offset:1024 sc1 lds
ds_read_b128 a[40:43], v6 offset:43008
v_mfma_f32_16x16x32_bf16 v[36:39], a[88:91], a[168:171], v[36:39]
ds_read_b128 a[44:47], v6 offset:44032
ds_read_b128 a[48:51], v6 offset:45056
v_mfma_f32_16x16x32_bf16 v[36:39], a[92:95], a[172:175], v[36:39]
ds_read_b128 a[52:55], v6 offset:46080
ds_read_b128 a[56:59], v6 offset:47104
v_mfma_f32_16x16x32_bf16 v[40:43], a[96:99], a[160:163], 0
ds_read_b128 a[60:63], v6 offset:48128
v_mov_b32 v144, 0
v_mfma_f32_16x16x32_bf16 v[40:43], a[100:103], a[164:167], v[40:43]
buffer_load_dwordx4 v4, s[28:31], 0 offen offset:2048 sc1 lds
v_mov_b32 v145, 0
v_mfma_f32_16x16x32_bf16 v[40:43], a[104:107], a[168:171], v[40:43]
v_mov_b32 v146, 0
v_mov_b32 v147, 0
v_mfma_f32_16x16x32_bf16 v[40:43], a[108:111], a[172:175], v[40:43]
v_mov_b32 v148, 0
v_mov_b32 v149, 0
v_mfma_f32_16x16x32_bf16 v[44:47], a[112:115], a[160:163], 0
v_mov_b32 v150, 0
v_mov_b32 v151, 0
v_mfma_f32_16x16x32_bf16 v[44:47], a[116:119], a[164:167], v[44:47]
buffer_load_dwordx4 v4, s[28:31], 0 offen offset:3072 sc1 lds
v_mov_b32 v128, 0
v_mfma_f32_16x16x32_bf16 v[44:47], a[120:123], a[168:171], v[44:47]
s_add_u32 m0, s50, 16384
v_mov_b32 v129, 0
v_mfma_f32_16x16x32_bf16 v[44:47], a[124:127], a[172:175], v[44:47]
v_mov_b32 v130, 0
v_mov_b32 v131, 0
v_mfma_f32_16x16x32_bf16 v[48:51], a[64:67], a[176:179], 0
v_mov_b32 v132, 0
v_mov_b32 v133, 0
v_mfma_f32_16x16x32_bf16 v[48:51], a[68:71], a[180:183], v[48:51]
buffer_load_dwordx4 v5, s[16:19], 0 offen offset:0 sc1 lds
v_mov_b32 v134, 0
v_mfma_f32_16x16x32_bf16 v[48:51], a[72:75], a[184:187], v[48:51]
v_mov_b32 v135, 0
v_mov_b32 v136, 0
v_mfma_f32_16x16x32_bf16 v[48:51], a[76:79], a[188:191], v[48:51]
v_mov_b32 v137, 0
v_mov_b32 v138, 0
v_mfma_f32_16x16x32_bf16 v[52:55], a[80:83], a[176:179], 0
v_mov_b32 v139, 0
v_mov_b32 v140, 0
v_mfma_f32_16x16x32_bf16 v[52:55], a[84:87], a[180:183], v[52:55]
buffer_load_dwordx4 v5, s[16:19], 0 offen offset:1024 sc1 lds
v_mov_b32 v141, 0
v_mfma_f32_16x16x32_bf16 v[52:55], a[88:91], a[184:187], v[52:55]
v_mov_b32 v142, 0
v_mov_b32 v143, 0
v_mfma_f32_16x16x32_bf16 v[52:55], a[92:95], a[188:191], v[52:55]
v_and_b32 v152, 3, v1
v_cmp_eq_u32 vcc, 0, v152
v_mfma_f32_16x16x32_bf16 v[56:59], a[96:99], a[176:179], 0
v_mov_b32 v153, 0x3f803f80
s_nop 0
v_mfma_f32_16x16x32_bf16 v[56:59], a[100:103], a[180:183], v[56:59]
buffer_load_dwordx4 v5, s[16:19], 0 offen offset:2048 sc1 lds
v_cndmask_b32 v152, 0, v153, vcc
v_mfma_f32_16x16x32_bf16 v[56:59], a[104:107], a[184:187], v[56:59]
v_mov_b32 v153, v152
v_mov_b32 v154, v152
v_mfma_f32_16x16x32_bf16 v[56:59], a[108:111], a[188:191], v[56:59]
v_mov_b32 v155, v152
v_accvgpr_read_b32 v248, a152
v_mfma_f32_16x16x32_bf16 v[60:63], a[112:115], a[176:179], 0
v_accvgpr_read_b32 v249, a153
v_accvgpr_read_b32 v250, a154
v_mfma_f32_16x16x32_bf16 v[60:63], a[116:119], a[180:183], v[60:63]
buffer_load_dwordx4 v5, s[16:19], 0 offen offset:3072 sc1 lds
v_accvgpr_read_b32 v251, a155
v_mfma_f32_16x16x32_bf16 v[60:63], a[120:123], a[184:187], v[60:63]
v_accvgpr_read_b32 v252, a156
v_accvgpr_read_b32 v253, a157
v_mfma_f32_16x16x32_bf16 v[60:63], a[124:127], a[188:191], v[60:63]
v_accvgpr_read_b32 v254, a158
v_accvgpr_read_b32 v255, a159
v_xor_b32 v6, 0x10000, v6
M_QJ:
s_waitcnt vmcnt(16) lgkmcnt(0)
s_barrier
v_exp_f32 v156, v32
s_add_u32 m0, s50, 32768
v_add_u32 v4, 16384, v4
v_mfma_f32_16x16x32_bf16 v[64:67], a[0:3], a[160:163], v[144:147]
v_exp_f32 v157, v33
v_mfma_f32_16x16x32_bf16 v[64:67], a[4:7], a[164:167], v[64:67]
buffer_load_dwordx4 v4, s[28:31], 0 offen offset:0 sc1 lds
v_cvt_pk_bf16_f32 v96, v156, v157
v_mfma_f32_16x16x32_bf16 v[64:67], a[8:11], a[168:171], v[64:67]
v_exp_f32 v158, v34
v_mfma_f32_16x16x32_bf16 v[64:67], a[12:15], a[172:175], v[64:67]
v_add_u32 v5, 16384, v5
v_mul_f32 v248, v248, v12
v_mfma_f32_16x16x32_bf16 v[68:71], a[16:19], a[160:163], v[144:147]
v_exp_f32 v159, v35
v_mfma_f32_16x16x32_bf16 v[68:71], a[20:23], a[164:167], v[68:71]
v_cvt_pk_bf16_f32 v97, v158, v159
v_mul_f32 v249, v249, v12
v_mfma_f32_16x16x32_bf16 v[68:71], a[24:27], a[168:171], v[68:71]
v_exp_f32 v160, v36
v_mfma_f32_16x16x32_bf16 v[68:71], a[28:31], a[172:175], v[68:71]
v_mul_f32 v250, v250, v12
v_mul_f32 v251, v251, v12
v_mfma_f32_16x16x32_bf16 v[72:75], a[32:35], a[160:163], v[144:147]
v_exp_f32 v161, v37
v_mfma_f32_16x16x32_bf16 v[72:75], a[36:39], a[164:167], v[72:75]
buffer_load_dwordx4 v4, s[28:31], 0 offen offset:1024 sc1 lds
v_cvt_pk_bf16_f32 v98, v160, v161
v_mfma_f32_16x16x32_bf16 v[72:75], a[40:43], a[168:171], v[72:75]
v_mul_f32 v252, v252, v12
v_mul_f32 v253, v253, v12
v_mfma_f32_16x16x32_bf16 v[72:75], a[44:47], a[172:175], v[72:75]
v_mul_f32 v254, v254, v12
v_mul_f32 v255, v255, v12
v_mfma_f32_16x16x32_bf16 v[76:79], a[48:51], a[160:163], v[144:147]
v_exp_f32 v162, v38
v_mfma_f32_16x16x32_bf16 v[76:79], a[52:55], a[164:167], v[76:79]
v_cvt_pk_bf16_f32 v248, v248, v249
v_cvt_pk_bf16_f32 v249, v250, v251
v_mfma_f32_16x16x32_bf16 v[76:79], a[56:59], a[168:171], v[76:79]
v_exp_f32 v163, v39
v_mfma_f32_16x16x32_bf16 v[76:79], a[60:63], a[172:175], v[76:79]
v_cvt_pk_bf16_f32 v99, v162, v163
v_cvt_pk_bf16_f32 v250, v252, v253
v_mfma_f32_16x16x32_bf16 v[80:83], a[0:3], a[176:179], v[148:151]
v_exp_f32 v156, v40
v_mfma_f32_16x16x32_bf16 v[80:83], a[4:7], a[180:183], v[80:83]
buffer_load_dwordx4 v4, s[28:31], 0 offen offset:2048 sc1 lds
v_mfma_f32_16x16x32_bf16 v[80:83], a[8:11], a[184:187], v[80:83]
v_exp_f32 v157, v41
v_mfma_f32_16x16x32_bf16 v[80:83], a[12:15], a[188:191], v[80:83]
v_cvt_pk_bf16_f32 v100, v156, v157
v_cvt_pk_bf16_f32 v251, v254, v255
v_mfma_f32_16x16x32_bf16 v[84:87], a[16:19], a[176:179], v[148:151]
v_exp_f32 v158, v42
v_mfma_f32_16x16x32_bf16 v[84:87], a[20:23], a[180:183], v[84:87]
v_accvgpr_write_b32 a220, v248
v_accvgpr_write_b32 a221, v249
v_mfma_f32_16x16x32_bf16 v[84:87], a[24:27], a[184:187], v[84:87]
v_exp_f32 v159, v43
v_mfma_f32_16x16x32_bf16 v[84:87], a[28:31], a[188:191], v[84:87]
v_cvt_pk_bf16_f32 v101, v158, v159
v_accvgpr_write_b32 a222, v250
v_mfma_f32_16x16x32_bf16 v[88:91], a[32:35], a[176:179], v[148:151]
v_exp_f32 v160, v44
v_mfma_f32_16x16x32_bf16 v[88:91], a[36:39], a[180:183], v[88:91]
buffer_load_dwordx4 v4, s[28:31], 0 offen offset:3072 sc1 lds
v_mfma_f32_16x16x32_bf16 v[88:91], a[40:43], a[184:187], v[88:91]
v_exp_f32 v161, v45
v_mfma_f32_16x16x32_bf16 v[88:91], a[44:47], a[188:191], v[88:91]
s_add_u32 m0, s50, 49152
v_cvt_pk_bf16_f32 v102, v160, v161
v_mfma_f32_16x16x32_bf16 v[92:95], a[48:51], a[176:179], v[148:151]
v_exp_f32 v162, v46
v_mfma_f32_16x16x32_bf16 v[92:95], a[52:55], a[180:183], v[92:95]
v_accvgpr_write_b32 a223, v251
v_mfma_f32_16x16x32_bf16 v[92:95], a[56:59], a[184:187], v[92:95]
v_exp_f32 v163, v47
v_mfma_f32_16x16x32_bf16 v[92:95], a[60:63], a[188:191], v[92:95]
v_cvt_pk_bf16_f32 v103, v162, v163
v_exp_f32 v156, v48
ds_read_b128 a[0:3], v6 offset:0
ds_read_b128 a[4:7], v6 offset:1024
v_exp_f32 v157, v49
buffer_load_dwordx4 v5, s[16:19], 0 offen offset:0 sc1 lds
ds_read_b128 a[8:11], v6 offset:2048
v_exp_f32 v158, v50
ds_read_b128 a[12:15], v6 offset:3072
ds_read_b128 a[16:19], v6 offset:4096
v_exp_f32 v159, v51
ds_read_b128 a[20:23], v6 offset:5120
v_cvt_pk_bf16_f32 v104, v156, v157
v_exp_f32 v160, v52
ds_read_b128 a[24:27], v6 offset:6144
ds_read_b128 a[28:31], v6 offset:7168
v_exp_f32 v161, v53
buffer_load_dwordx4 v5, s[16:19], 0 offen offset:1024 sc1 lds
v_cvt_pk_bf16_f32 v105, v158, v159
v_exp_f32 v162, v54
ds_read_b128 a[32:35], v6 offset:8192
ds_read_b128 a[36:39], v6 offset:9216
v_exp_f32 v163, v55
ds_read_b128 a[40:43], v6 offset:10240
v_cvt_pk_bf16_f32 v106, v160, v161
v_mfma_f32_16x16x32_bf16 v[128:131], v[152:155], v[96:99], v[136:139]
v_exp_f32 v156, v56
v_mfma_f32_16x16x32_bf16 v[128:131], v[152:155], v[100:103], v[128:131]
ds_read_b128 a[44:47], v6 offset:11264
ds_read_b128 a[48:51], v6 offset:12288
v_exp_f32 v157, v57
buffer_load_dwordx4 v5, s[16:19], 0 offen offset:2048 sc1 lds
v_cvt_pk_bf16_f32 v107, v162, v163
v_exp_f32 v158, v58
ds_read_b128 a[52:55], v6 offset:13312
ds_read_b128 a[56:59], v6 offset:14336
v_exp_f32 v159, v59
v_subrev_u32 v10, s52, v128
v_cvt_pk_bf16_f32 v108, v156, v157
v_exp_f32 v160, v60
ds_read_b128 a[60:63], v6 offset:15360
v_cmp_lt_u32 vcc, s53, v10
v_exp_f32 v161, v61
buffer_load_dwordx4 v5, s[16:19], 0 offen offset:3072 sc1 lds
s_xor_b32 s50, s50, 0x10000
s_cbranch_vccnz K2_TR0
K2_RT0:
v_cvt_pk_bf16_f32 v109, v158, v159
v_cvt_pk_bf16_f32 v110, v160, v161
v_exp_f32 v162, v62
v_exp_f32 v163, v63
s_nop 0
v_cvt_pk_bf16_f32 v111, v162, v163
s_waitcnt vmcnt(16) lgkmcnt(0)
s_barrier
v_mfma_f32_16x16x32_bf16 v[132:135], v[152:155], v[104:107], v[140:143]
v_exp_f32 v156, v64
v_mfma_f32_16x16x32_bf16 v[132:135], v[152:155], v[108:111], v[132:135]
s_add_u32 m0, s50, 0
v_add_u32 v4, 16384, v4
v_mfma_f32_16x16x32_bf16 v[32:35], a[0:3], a[160:163], v[144:147]
v_exp_f32 v157, v65
v_mfma_f32_16x16x32_bf16 v[32:35], a[4:7], a[164:167], v[32:35]
buffer_load_dwordx4 v4, s[28:31], 0 offen offset:0 sc1 lds
ds_read_b128 a[64:67], v6 offset:49152
v_mfma_f32_16x16x32_bf16 v[32:35], a[8:11], a[168:171], v[32:35]
v_exp_f32 v158, v66
v_mfma_f32_16x16x32_bf16 v[32:35], a[12:15], a[172:175], v[32:35]
ds_read_b128 a[68:71], v6 offset:50176
ds_read_b128 a[72:75], v6 offset:51200
v_mfma_f32_16x16x32_bf16 v[36:39], a[16:19], a[160:163], v[144:147]
v_exp_f32 v159, v67
v_mfma_f32_16x16x32_bf16 v[36:39], a[20:23], a[164:167], v[36:39]
ds_read_b128 a[76:79], v6 offset:52224
v_subrev_u32 v10, s52, v132
v_mfma_f32_16x16x32_bf16 v[36:39], a[24:27], a[168:171], v[36:39]
v_exp_f32 v160, v68
v_mfma_f32_16x16x32_bf16 v[36:39], a[28:31], a[172:175], v[36:39]
ds_read_b128 a[80:83], v6 offset:53248
v_cmp_lt_u32 vcc, s53, v10
v_mfma_f32_16x16x32_bf16 v[40:43], a[32:35], a[160:163], v[144:147]
v_exp_f32 v161, v69
v_mfma_f32_16x16x32_bf16 v[40:43], a[36:39], a[164:167], v[40:43]
buffer_load_dwordx4 v4, s[28:31], 0 offen offset:1024 sc1 lds
v_cvt_pk_bf16_f32 v112, v156, v157
v_mfma_f32_16x16x32_bf16 v[40:43], a[40:43], a[168:171], v[40:43]
s_cbranch_vccnz K2_TR1
K2_RT1:
v_mfma_f32_16x16x32_bf16 v[40:43], a[44:47], a[172:175], v[40:43]
ds_read_b128 a[84:87], v6 offset:54272
ds_read_b128 a[88:91], v6 offset:55296
v_mfma_f32_16x16x32_bf16 v[44:47], a[48:51], a[160:163], v[144:147]
v_exp_f32 v162, v70
v_mfma_f32_16x16x32_bf16 v[44:47], a[52:55], a[164:167], v[44:47]
ds_read_b128 a[92:95], v6 offset:56320
v_cvt_pk_bf16_f32 v113, v158, v159
v_mfma_f32_16x16x32_bf16 v[44:47], a[56:59], a[168:171], v[44:47]
v_exp_f32 v163, v71
v_mfma_f32_16x16x32_bf16 v[44:47], a[60:63], a[172:175], v[44:47]
ds_read_b128 a[96:99], v6 offset:57344
ds_read_b128 a[100:103], v6 offset:58368
v_mfma_f32_16x16x32_bf16 v[48:51], a[0:3], a[176:179], v[148:151]
v_exp_f32 v156, v72
v_mfma_f32_16x16x32_bf16 v[48:51], a[4:7], a[180:183], v[48:51]
buffer_load_dwordx4 v4, s[28:31], 0 offen offset:2048 sc1 lds
v_cvt_pk_bf16_f32 v114, v160, v161
v_mfma_f32_16x16x32_bf16 v[48:51], a[8:11], a[184:187], v[48:51]
v_exp_f32 v157, v73
v_mfma_f32_16x16x32_bf16 v[48:51], a[12:15], a[188:191], v[48:51]
ds_read_b128 a[104:107], v6 offset:59392
ds_read_b128 a[108:111], v6 offset:60416
v_mfma_f32_16x16x32_bf16 v[52:55], a[16:19], a[176:179], v[148:151]
v_exp_f32 v158, v74
v_mfma_f32_16x16x32_bf16 v[52:55], a[20:23], a[180:183], v[52:55]
ds_read_b128 a[112:115], v6 offset:61440
ds_read_b128 a[116:119], v6 offset:62464
v_mfma_f32_16x16x32_bf16 v[52:55], a[24:27], a[184:187], v[52:55]
v_exp_f32 v159, v75
v_mfma_f32_16x16x32_bf16 v[52:55], a[28:31], a[188:191], v[52:55]
ds_read_b128 a[120:123], v6 offset:63488
v_cvt_pk_bf16_f32 v115, v162, v163
v_mfma_f32_16x16x32_bf16 v[56:59], a[32:35], a[176:179], v[148:151]
v_exp_f32 v160, v76
v_mfma_f32_16x16x32_bf16 v[56:59], a[36:39], a[180:183], v[56:59]
buffer_load_dwordx4 v4, s[28:31], 0 offen offset:3072 sc1 lds
ds_read_b128 a[124:127], v6 offset:64512
v_mfma_f32_16x16x32_bf16 v[56:59], a[40:43], a[184:187], v[56:59]
v_exp_f32 v161, v77
v_mfma_f32_16x16x32_bf16 v[56:59], a[44:47], a[188:191], v[56:59]
v_cvt_pk_bf16_f32 v116, v156, v157
v_cvt_pk_bf16_f32 v117, v158, v159
v_mfma_f32_16x16x32_bf16 v[60:63], a[48:51], a[176:179], v[148:151]
v_exp_f32 v162, v78
v_mfma_f32_16x16x32_bf16 v[60:63], a[52:55], a[180:183], v[60:63]
s_add_u32 m0, s50, 16384
v_add_u32 v5, 16384, v5
v_mfma_f32_16x16x32_bf16 v[60:63], a[56:59], a[184:187], v[60:63]
v_exp_f32 v163, v79
v_mfma_f32_16x16x32_bf16 v[60:63], a[60:63], a[188:191], v[60:63]
s_waitcnt lgkmcnt(0)
v_cvt_pk_bf16_f32 v118, v160, v161
v_mfma_f32_16x16x32_bf16 v[176:179], a[64:67], v[96:99], 0
v_exp_f32 v156, v80
v_mfma_f32_16x16x32_bf16 v[176:179], a[96:99], v[100:103], v[176:179]
ds_read_b128 a[0:3], v6 offset:32768
ds_read_b128 a[4:7], v6 offset:33792
v_mfma_f32_16x16x32_bf16 v[180:183], a[68:71], v[96:99], 0
v_exp_f32 v157, v81
v_mfma_f32_16x16x32_bf16 v[180:183], a[100:103], v[100:103], v[180:183]
buffer_load_dwordx4 v5, s[16:19], 0 offen offset:0 sc1 lds
ds_read_b128 a[8:11], v6 offset:34816
v_mfma_f32_16x16x32_bf16 v[184:187], a[72:75], v[96:99], 0
v_exp_f32 v158, v82
v_mfma_f32_16x16x32_bf16 v[184:187], a[104:107], v[100:103], v[184:187]
ds_read_b128 a[12:15], v6 offset:35840
v_cvt_pk_bf16_f32 v119, v162, v163
v_mfma_f32_16x16x32_bf16 v[188:191], a[76:79], v[96:99], 0
v_exp_f32 v159, v83
v_mfma_f32_16x16x32_bf16 v[188:191], a[108:111], v[100:103], v[188:191]
ds_read_b128 a[16:19], v6 offset:36864
v_cvt_pk_bf16_f32 v120, v156, v157
v_mfma_f32_16x16x32_bf16 v[192:195], a[80:83], v[96:99], 0
v_exp_f32 v160, v84
v_mfma_f32_16x16x32_bf16 v[192:195], a[112:115], v[100:103], v[192:195]
ds_read_b128 a[20:23], v6 offset:37888
ds_read_b128 a[24:27], v6 offset:38912
v_mfma_f32_16x16x32_bf16 v[196:199], a[84:87], v[96:99], 0
v_exp_f32 v161, v85
v_mfma_f32_16x16x32_bf16 v[196:199], a[116:119], v[100:103], v[196:199]
buffer_load_dwordx4 v5, s[16:19], 0 offen offset:1024 sc1 lds
ds_read_b128 a[28:31], v6 offset:39936
v_mfma_f32_16x16x32_bf16 v[200:203], a[88:91], v[96:99], 0
v_exp_f32 v162, v86
v_mfma_f32_16x16x32_bf16 v[200:203], a[120:123], v[100:103], v[200:203]
ds_read_b128 a[32:35], v6 offset:40960
v_cvt_pk_bf16_f32 v121, v158, v159
v_mfma_f32_16x16x32_bf16 v[204:207], a[92:95], v[96:99], 0
v_exp_f32 v163, v87
v_mfma_f32_16x16x32_bf16 v[204:207], a[124:127], v[100:103], v[204:207]
ds_read_b128 a[36:39], v6 offset:41984
v_cvt_pk_bf16_f32 v122, v160, v161
v_mfma_f32_16x16x32_bf16 v[136:139], v[152:155], v[112:115], v[128:131]
v_exp_f32 v156, v88
v_mfma_f32_16x16x32_bf16 v[136:139], v[152:155], v[116:119], v[136:139]
ds_read_b128 a[40:43], v6 offset:43008
ds_read_b128 a[44:47], v6 offset:44032
v_mfma_f32_16x16x32_bf16 v[208:211], a[64:67], v[104:107], 0
v_exp_f32 v157, v89
v_mfma_f32_16x16x32_bf16 v[208:211], a[96:99], v[108:111], v[208:211]
buffer_load_dwordx4 v5, s[16:19], 0 offen offset:2048 sc1 lds
ds_read_b128 a[48:51], v6 offset:45056
v_mfma_f32_16x16x32_bf16 v[212:215], a[68:71], v[104:107], 0
v_exp_f32 v158, v90
v_mfma_f32_16x16x32_bf16 v[212:215], a[100:103], v[108:111], v[212:215]
ds_read_b128 a[52:55], v6 offset:46080
v_cvt_pk_bf16_f32 v123, v162, v163
v_mfma_f32_16x16x32_bf16 v[216:219], a[72:75], v[104:107], 0
v_exp_f32 v159, v91
v_mfma_f32_16x16x32_bf16 v[216:219], a[104:107], v[108:111], v[216:219]
ds_read_b128 a[56:59], v6 offset:47104
v_subrev_u32 v10, s52, v136
v_mfma_f32_16x16x32_bf16 v[220:223], a[76:79], v[104:107], 0
v_exp_f32 v160, v92
v_mfma_f32_16x16x32_bf16 v[220:223], a[108:111], v[108:111], v[220:223]
v_cmp_lt_u32 vcc, s53, v10
v_cvt_pk_bf16_f32 v124, v156, v157
v_mfma_f32_16x16x32_bf16 v[224:227], a[80:83], v[104:107], 0
v_exp_f32 v161, v93
v_mfma_f32_16x16x32_bf16 v[224:227], a[112:115], v[108:111], v[224:227]
buffer_load_dwordx4 v5, s[16:19], 0 offen offset:3072 sc1 lds
ds_read_b128 a[60:63], v6 offset:48128
v_mfma_f32_16x16x32_bf16 v[228:231], a[84:87], v[104:107], 0
s_cbranch_vccnz K2_TR2
K2_RT2:
v_mfma_f32_16x16x32_bf16 v[228:231], a[116:119], v[108:111], v[228:231]
v_cvt_pk_bf16_f32 v125, v158, v159
v_cvt_pk_bf16_f32 v126, v160, v161
v_mfma_f32_16x16x32_bf16 v[232:235], a[88:91], v[104:107], 0
v_exp_f32 v162, v94
v_mfma_f32_16x16x32_bf16 v[232:235], a[120:123], v[108:111], v[232:235]
v_xor_b32 v6, 0x10000, v6
v_mfma_f32_16x16x32_bf16 v[236:239], a[92:95], v[104:107], 0
v_exp_f32 v163, v95
v_mfma_f32_16x16x32_bf16 v[236:239], a[124:127], v[108:111], v[236:239]
v_cvt_pk_bf16_f32 v127, v162, v163
s_waitcnt vmcnt(16) lgkmcnt(0)
s_barrier
v_mfma_f32_16x16x32_bf16 v[140:143], v[152:155], v[120:123], v[132:135]
v_exp_f32 v156, v32
v_mfma_f32_16x16x32_bf16 v[140:143], v[152:155], v[124:127], v[140:143]
buffer_load_dword v28, v2, s[28:31], s71 offen sc1
s_add_u32 m0, s50, 32768
v_add_u32 v4, 16384, v4
v_mfma_f32_16x16x32_bf16 v[64:67], a[0:3], a[160:163], v[144:147]
v_exp_f32 v157, v33
v_mfma_f32_16x16x32_bf16 v[64:67], a[4:7], a[164:167], v[64:67]
buffer_load_dwordx4 v4, s[28:31], 0 offen offset:0 sc1 lds
ds_read_b128 a[64:67], v6 offset:16384
v_mfma_f32_16x16x32_bf16 v[64:67], a[8:11], a[168:171], v[64:67]
v_exp_f32 v158, v34
v_mfma_f32_16x16x32_bf16 v[64:67], a[12:15], a[172:175], v[64:67]
ds_read_b128 a[68:71], v6 offset:17408
ds_read_b128 a[72:75], v6 offset:18432
v_mfma_f32_16x16x32_bf16 v[68:71], a[16:19], a[160:163], v[144:147]
v_exp_f32 v159, v35
v_mfma_f32_16x16x32_bf16 v[68:71], a[20:23], a[164:167], v[68:71]
ds_read_b128 a[76:79], v6 offset:19456
v_subrev_u32 v10, s52, v140
v_mfma_f32_16x16x32_bf16 v[68:71], a[24:27], a[168:171], v[68:71]
v_exp_f32 v160, v36
v_mfma_f32_16x16x32_bf16 v[68:71], a[28:31], a[172:175], v[68:71]
ds_read_b128 a[80:83], v6 offset:20480
v_cmp_lt_u32 vcc, s53, v10
v_mfma_f32_16x16x32_bf16 v[72:75], a[32:35], a[160:163], v[144:147]
v_exp_f32 v161, v37
v_mfma_f32_16x16x32_bf16 v[72:75], a[36:39], a[164:167], v[72:75]
buffer_load_dwordx4 v4, s[28:31], 0 offen offset:1024 sc1 lds
v_cvt_pk_bf16_f32 v96, v156, v157
v_mfma_f32_16x16x32_bf16 v[72:75], a[40:43], a[168:171], v[72:75]
s_cbranch_vccnz K2_TR3
K2_RT3:
v_mfma_f32_16x16x32_bf16 v[72:75], a[44:47], a[172:175], v[72:75]
ds_read_b128 a[84:87], v6 offset:21504
ds_read_b128 a[88:91], v6 offset:22528
v_mfma_f32_16x16x32_bf16 v[76:79], a[48:51], a[160:163], v[144:147]
v_exp_f32 v162, v38
v_mfma_f32_16x16x32_bf16 v[76:79], a[52:55], a[164:167], v[76:79]
ds_read_b128 a[92:95], v6 offset:23552
v_cvt_pk_bf16_f32 v97, v158, v159
v_mfma_f32_16x16x32_bf16 v[76:79], a[56:59], a[168:171], v[76:79]
v_exp_f32 v163, v39
v_mfma_f32_16x16x32_bf16 v[76:79], a[60:63], a[172:175], v[76:79]
ds_read_b128 a[96:99], v6 offset:24576
ds_read_b128 a[100:103], v6 offset:25600
v_mfma_f32_16x16x32_bf16 v[80:83], a[0:3], a[176:179], v[148:151]
v_exp_f32 v156, v40
v_mfma_f32_16x16x32_bf16 v[80:83], a[4:7], a[180:183], v[80:83]
buffer_load_dwordx4 v4, s[28:31], 0 offen offset:2048 sc1 lds
v_cvt_pk_bf16_f32 v98, v160, v161
v_mfma_f32_16x16x32_bf16 v[80:83], a[8:11], a[184:187], v[80:83]
v_exp_f32 v157, v41
v_mfma_f32_16x16x32_bf16 v[80:83], a[12:15], a[188:191], v[80:83]
ds_read_b128 a[104:107], v6 offset:26624
ds_read_b128 a[108:111], v6 offset:27648
v_mfma_f32_16x16x32_bf16 v[84:87], a[16:19], a[176:179], v[148:151]
v_exp_f32 v158, v42
v_mfma_f32_16x16x32_bf16 v[84:87], a[20:23], a[180:183], v[84:87]
ds_read_b128 a[112:115], v6 offset:28672
ds_read_b128 a[116:119], v6 offset:29696
v_mfma_f32_16x16x32_bf16 v[84:87], a[24:27], a[184:187], v[84:87]
v_exp_f32 v159, v43
v_mfma_f32_16x16x32_bf16 v[84:87], a[28:31], a[188:191], v[84:87]
ds_read_b128 a[120:123], v6 offset:30720
v_cvt_pk_bf16_f32 v99, v162, v163
v_mfma_f32_16x16x32_bf16 v[88:91], a[32:35], a[176:179], v[148:151]
v_exp_f32 v160, v44
v_mfma_f32_16x16x32_bf16 v[88:91], a[36:39], a[180:183], v[88:91]
buffer_load_dwordx4 v4, s[28:31], 0 offen offset:3072 sc1 lds
ds_read_b128 a[124:127], v6 offset:31744
v_mfma_f32_16x16x32_bf16 v[88:91], a[40:43], a[184:187], v[88:91]
v_exp_f32 v161, v45
v_mfma_f32_16x16x32_bf16 v[88:91], a[44:47], a[188:191], v[88:91]
v_cvt_pk_bf16_f32 v100, v156, v157
v_cvt_pk_bf16_f32 v101, v158, v159
v_mfma_f32_16x16x32_bf16 v[92:95], a[48:51], a[176:179], v[148:151]
v_exp_f32 v162, v46
v_mfma_f32_16x16x32_bf16 v[92:95], a[52:55], a[180:183], v[92:95]
s_add_u32 m0, s50, 49152
v_add_u32 v5, 16384, v5
v_mfma_f32_16x16x32_bf16 v[92:95], a[56:59], a[184:187], v[92:95]
v_exp_f32 v163, v47
v_mfma_f32_16x16x32_bf16 v[92:95], a[60:63], a[188:191], v[92:95]
s_waitcnt lgkmcnt(0)
v_cvt_pk_bf16_f32 v102, v160, v161
v_mfma_f32_16x16x32_bf16 v[176:179], a[64:67], v[112:115], v[176:179]
v_exp_f32 v156, v48
v_mfma_f32_16x16x32_bf16 v[176:179], a[96:99], v[116:119], v[176:179]
ds_read_b128 a[0:3], v6 offset:0
ds_read_b128 a[4:7], v6 offset:1024
v_mfma_f32_16x16x32_bf16 v[180:183], a[68:71], v[112:115], v[180:183]
v_exp_f32 v157, v49
v_mfma_f32_16x16x32_bf16 v[180:183], a[100:103], v[116:119], v[180:183]
buffer_load_dwordx4 v5, s[16:19], 0 offen offset:0 sc1 lds
ds_read_b128 a[8:11], v6 offset:2048
v_mfma_f32_16x16x32_bf16 v[184:187], a[72:75], v[112:115], v[184:187]
v_exp_f32 v158, v50
v_mfma_f32_16x16x32_bf16 v[184:187], a[104:107], v[116:119], v[184:187]
ds_read_b128 a[12:15], v6 offset:3072
v_cvt_pk_bf16_f32 v103, v162, v163
v_mfma_f32_16x16x32_bf16 v[188:191], a[76:79], v[112:115], v[188:191]
v_exp_f32 v159, v51
v_mfma_f32_16x16x32_bf16 v[188:191], a[108:111], v[116:119], v[188:191]
ds_read_b128 a[16:19], v6 offset:4096
v_cvt_pk_bf16_f32 v104, v156, v157
v_mfma_f32_16x16x32_bf16 v[192:195], a[80:83], v[112:115], v[192:195]
v_exp_f32 v160, v52
v_mfma_f32_16x16x32_bf16 v[192:195], a[112:115], v[116:119], v[192:195]
ds_read_b128 a[20:23], v6 offset:5120
ds_read_b128 a[24:27], v6 offset:6144
v_mfma_f32_16x16x32_bf16 v[196:199], a[84:87], v[112:115], v[196:199]
v_exp_f32 v161, v53
v_mfma_f32_16x16x32_bf16 v[196:199], a[116:119], v[116:119], v[196:199]
buffer_load_dwordx4 v5, s[16:19], 0 offen offset:1024 sc1 lds
ds_read_b128 a[28:31], v6 offset:7168
v_mfma_f32_16x16x32_bf16 v[200:203], a[88:91], v[112:115], v[200:203]
v_exp_f32 v162, v54
v_mfma_f32_16x16x32_bf16 v[200:203], a[120:123], v[116:119], v[200:203]
ds_read_b128 a[32:35], v6 offset:8192
v_cvt_pk_bf16_f32 v105, v158, v159
v_mfma_f32_16x16x32_bf16 v[204:207], a[92:95], v[112:115], v[204:207]
v_exp_f32 v163, v55
v_mfma_f32_16x16x32_bf16 v[204:207], a[124:127], v[116:119], v[204:207]
ds_read_b128 a[36:39], v6 offset:9216
v_cvt_pk_bf16_f32 v106, v160, v161
v_mfma_f32_16x16x32_bf16 v[128:131], v[152:155], v[96:99], v[136:139]
v_exp_f32 v156, v56
v_mfma_f32_16x16x32_bf16 v[128:131], v[152:155], v[100:103], v[128:131]
ds_read_b128 a[40:43], v6 offset:10240
ds_read_b128 a[44:47], v6 offset:11264
v_mfma_f32_16x16x32_bf16 v[208:211], a[64:67], v[120:123], v[208:211]
v_exp_f32 v157, v57
v_mfma_f32_16x16x32_bf16 v[208:211], a[96:99], v[124:127], v[208:211]
buffer_load_dwordx4 v5, s[16:19], 0 offen offset:2048 sc1 lds
ds_read_b128 a[48:51], v6 offset:12288
v_mfma_f32_16x16x32_bf16 v[212:215], a[68:71], v[120:123], v[212:215]
v_exp_f32 v158, v58
v_mfma_f32_16x16x32_bf16 v[212:215], a[100:103], v[124:127], v[212:215]
ds_read_b128 a[52:55], v6 offset:13312
v_cvt_pk_bf16_f32 v107, v162, v163
v_mfma_f32_16x16x32_bf16 v[216:219], a[72:75], v[120:123], v[216:219]
v_exp_f32 v159, v59
v_mfma_f32_16x16x32_bf16 v[216:219], a[104:107], v[124:127], v[216:219]
ds_read_b128 a[56:59], v6 offset:14336
v_subrev_u32 v10, s52, v128
v_mfma_f32_16x16x32_bf16 v[220:223], a[76:79], v[120:123], v[220:223]
v_exp_f32 v160, v60
v_mfma_f32_16x16x32_bf16 v[220:223], a[108:111], v[124:127], v[220:223]
v_cmp_lt_u32 vcc, s53, v10
v_cvt_pk_bf16_f32 v108, v156, v157
v_mfma_f32_16x16x32_bf16 v[224:227], a[80:83], v[120:123], v[224:227]
v_exp_f32 v161, v61
v_mfma_f32_16x16x32_bf16 v[224:227], a[112:115], v[124:127], v[224:227]
buffer_load_dwordx4 v5, s[16:19], 0 offen offset:3072 sc1 lds
ds_read_b128 a[60:63], v6 offset:15360
v_mfma_f32_16x16x32_bf16 v[228:231], a[84:87], v[120:123], v[228:231]
s_cbranch_vccnz K2_TR4
K2_RT4:
v_mfma_f32_16x16x32_bf16 v[228:231], a[116:119], v[124:127], v[228:231]
s_xor_b32 s50, s50, 0x10000
v_cvt_pk_bf16_f32 v109, v158, v159
v_mfma_f32_16x16x32_bf16 v[232:235], a[88:91], v[120:123], v[232:235]
v_exp_f32 v162, v62
v_mfma_f32_16x16x32_bf16 v[232:235], a[120:123], v[124:127], v[232:235]
v_cvt_pk_bf16_f32 v110, v160, v161
v_mfma_f32_16x16x32_bf16 v[236:239], a[92:95], v[120:123], v[236:239]
v_exp_f32 v163, v63
v_mfma_f32_16x16x32_bf16 v[236:239], a[124:127], v[124:127], v[236:239]
v_cvt_pk_bf16_f32 v111, v162, v163
s_waitcnt vmcnt(8) lgkmcnt(0)
v_cmp_ne_u32 vcc, 0, v28
s_or_b64 vcc, vcc, s[96:97]
s_and_b32 s46, vcc_lo, 0xff
s_cmp_eq_u32 s46, 0xff
s_cbranch_scc0 M_SPINKVA
M_SRETKVA:
s_cmp_eq_u32 s65, 0
s_cbranch_scc1 M_ACQA
buffer_inv sc1
s_waitcnt vmcnt(0)
M_ACQA:
s_barrier
v_mfma_f32_16x16x32_bf16 v[132:135], v[152:155], v[104:107], v[140:143]
v_exp_f32 v156, v64
v_mfma_f32_16x16x32_bf16 v[132:135], v[152:155], v[108:111], v[132:135]
s_add_u32 m0, s50, 0
v_add_u32 v4, 16384, v4
v_mfma_f32_16x16x32_bf16 v[32:35], a[0:3], a[160:163], v[144:147]
v_exp_f32 v157, v65
v_mfma_f32_16x16x32_bf16 v[32:35], a[4:7], a[164:167], v[32:35]
buffer_load_dwordx4 v4, s[28:31], 0 offen offset:0 sc1 lds
ds_read_b128 a[64:67], v6 offset:49152
v_mfma_f32_16x16x32_bf16 v[32:35], a[8:11], a[168:171], v[32:35]
v_exp_f32 v158, v66
v_mfma_f32_16x16x32_bf16 v[32:35], a[12:15], a[172:175], v[32:35]
ds_read_b128 a[68:71], v6 offset:50176
ds_read_b128 a[72:75], v6 offset:51200
v_mfma_f32_16x16x32_bf16 v[36:39], a[16:19], a[160:163], v[144:147]
v_exp_f32 v159, v67
v_mfma_f32_16x16x32_bf16 v[36:39], a[20:23], a[164:167], v[36:39]
ds_read_b128 a[76:79], v6 offset:52224
v_subrev_u32 v10, s52, v132
v_mfma_f32_16x16x32_bf16 v[36:39], a[24:27], a[168:171], v[36:39]
v_exp_f32 v160, v68
v_mfma_f32_16x16x32_bf16 v[36:39], a[28:31], a[172:175], v[36:39]
ds_read_b128 a[80:83], v6 offset:53248
v_cmp_lt_u32 vcc, s53, v10
v_mfma_f32_16x16x32_bf16 v[40:43], a[32:35], a[160:163], v[144:147]
v_exp_f32 v161, v69
v_mfma_f32_16x16x32_bf16 v[40:43], a[36:39], a[164:167], v[40:43]
buffer_load_dwordx4 v4, s[28:31], 0 offen offset:1024 sc1 lds
v_cvt_pk_bf16_f32 v112, v156, v157
v_mfma_f32_16x16x32_bf16 v[40:43], a[40:43], a[168:171], v[40:43]
s_cbranch_vccnz K2_TR5
K2_RT5:
v_mfma_f32_16x16x32_bf16 v[40:43], a[44:47], a[172:175], v[40:43]
ds_read_b128 a[84:87], v6 offset:54272
ds_read_b128 a[88:91], v6 offset:55296
v_mfma_f32_16x16x32_bf16 v[44:47], a[48:51], a[160:163], v[144:147]
v_exp_f32 v162, v70
v_mfma_f32_16x16x32_bf16 v[44:47], a[52:55], a[164:167], v[44:47]
ds_read_b128 a[92:95], v6 offset:56320
v_cvt_pk_bf16_f32 v113, v158, v159
v_mfma_f32_16x16x32_bf16 v[44:47], a[56:59], a[168:171], v[44:47]
v_exp_f32 v163, v71
v_mfma_f32_16x16x32_bf16 v[44:47], a[60:63], a[172:175], v[44:47]
ds_read_b128 a[96:99], v6 offset:57344
ds_read_b128 a[100:103], v6 offset:58368
v_mfma_f32_16x16x32_bf16 v[48:51], a[0:3], a[176:179], v[148:151]
v_exp_f32 v156, v72
v_mfma_f32_16x16x32_bf16 v[48:51], a[4:7], a[180:183], v[48:51]
buffer_load_dwordx4 v4, s[28:31], 0 offen offset:2048 sc1 lds
v_cvt_pk_bf16_f32 v114, v160, v161
v_mfma_f32_16x16x32_bf16 v[48:51], a[8:11], a[184:187], v[48:51]
v_exp_f32 v157, v73
v_mfma_f32_16x16x32_bf16 v[48:51], a[12:15], a[188:191], v[48:51]
ds_read_b128 a[104:107], v6 offset:59392
ds_read_b128 a[108:111], v6 offset:60416
v_mfma_f32_16x16x32_bf16 v[52:55], a[16:19], a[176:179], v[148:151]
v_exp_f32 v158, v74
v_mfma_f32_16x16x32_bf16 v[52:55], a[20:23], a[180:183], v[52:55]
ds_read_b128 a[112:115], v6 offset:61440
ds_read_b128 a[116:119], v6 offset:62464
v_mfma_f32_16x16x32_bf16 v[52:55], a[24:27], a[184:187], v[52:55]
v_exp_f32 v159, v75
v_mfma_f32_16x16x32_bf16 v[52:55], a[28:31], a[188:191], v[52:55]
ds_read_b128 a[120:123], v6 offset:63488
v_cvt_pk_bf16_f32 v115, v162, v163
v_mfma_f32_16x16x32_bf16 v[56:59], a[32:35], a[176:179], v[148:151]
v_exp_f32 v160, v76
v_mfma_f32_16x16x32_bf16 v[56:59], a[36:39], a[180:183], v[56:59]
buffer_load_dwordx4 v4, s[28:31], 0 offen offset:3072 sc1 lds
ds_read_b128 a[124:127], v6 offset:64512
v_mfma_f32_16x16x32_bf16 v[56:59], a[40:43], a[184:187], v[56:59]
v_exp_f32 v161, v77
v_mfma_f32_16x16x32_bf16 v[56:59], a[44:47], a[188:191], v[56:59]
v_cvt_pk_bf16_f32 v116, v156, v157
v_cvt_pk_bf16_f32 v117, v158, v159
v_mfma_f32_16x16x32_bf16 v[60:63], a[48:51], a[176:179], v[148:151]
v_exp_f32 v162, v78
v_mfma_f32_16x16x32_bf16 v[60:63], a[52:55], a[180:183], v[60:63]
s_add_u32 m0, s50, 16384
v_add_u32 v5, 16384, v5
v_mfma_f32_16x16x32_bf16 v[60:63], a[56:59], a[184:187], v[60:63]
v_exp_f32 v163, v79
v_mfma_f32_16x16x32_bf16 v[60:63], a[60:63], a[188:191], v[60:63]
s_waitcnt lgkmcnt(0)
v_cvt_pk_bf16_f32 v118, v160, v161
v_mfma_f32_16x16x32_bf16 v[176:179], a[64:67], v[96:99], v[176:179]
v_exp_f32 v156, v80
v_mfma_f32_16x16x32_bf16 v[176:179], a[96:99], v[100:103], v[176:179]
ds_read_b128 a[0:3], v6 offset:32768
ds_read_b128 a[4:7], v6 offset:33792
v_mfma_f32_16x16x32_bf16 v[180:183], a[68:71], v[96:99], v[180:183]
v_exp_f32 v157, v81
v_mfma_f32_16x16x32_bf16 v[180:183], a[100:103], v[100:103], v[180:183]
buffer_load_dwordx4 v5, s[16:19], 0 offen offset:0 sc1 lds
ds_read_b128 a[8:11], v6 offset:34816
v_mfma_f32_16x16x32_bf16 v[184:187], a[72:75], v[96:99], v[184:187]
v_exp_f32 v158, v82
v_mfma_f32_16x16x32_bf16 v[184:187], a[104:107], v[100:103], v[184:187]
ds_read_b128 a[12:15], v6 offset:35840
v_cvt_pk_bf16_f32 v119, v162, v163
v_mfma_f32_16x16x32_bf16 v[188:191], a[76:79], v[96:99], v[188:191]
v_exp_f32 v159, v83
v_mfma_f32_16x16x32_bf16 v[188:191], a[108:111], v[100:103], v[188:191]
buffer_load_dword v27, v25, s[20:23], 0 offen
ds_read_b128 a[16:19], v6 offset:36864
v_cvt_pk_bf16_f32 v120, v156, v157
v_mfma_f32_16x16x32_bf16 v[192:195], a[80:83], v[96:99], v[192:195]
v_exp_f32 v160, v84
v_mfma_f32_16x16x32_bf16 v[192:195], a[112:115], v[100:103], v[192:195]
ds_read_b128 a[20:23], v6 offset:37888
ds_read_b128 a[24:27], v6 offset:38912
v_mfma_f32_16x16x32_bf16 v[196:199], a[84:87], v[96:99], v[196:199]
v_exp_f32 v161, v85
v_mfma_f32_16x16x32_bf16 v[196:199], a[116:119], v[100:103], v[196:199]
buffer_load_dwordx4 v5, s[16:19], 0 offen offset:1024 sc1 lds
ds_read_b128 a[28:31], v6 offset:39936
v_mfma_f32_16x16x32_bf16 v[200:203], a[88:91], v[96:99], v[200:203]
v_exp_f32 v162, v86
v_mfma_f32_16x16x32_bf16 v[200:203], a[120:123], v[100:103], v[200:203]
ds_read_b128 a[32:35], v6 offset:40960
v_cvt_pk_bf16_f32 v121, v158, v159
v_mfma_f32_16x16x32_bf16 v[204:207], a[92:95], v[96:99], v[204:207]
v_exp_f32 v163, v87
v_mfma_f32_16x16x32_bf16 v[204:207], a[124:127], v[100:103], v[204:207]
buffer_load_dword v27, v25, s[24:27], 0 offen
ds_read_b128 a[36:39], v6 offset:41984
v_cvt_pk_bf16_f32 v122, v160, v161
v_mfma_f32_16x16x32_bf16 v[136:139], v[152:155], v[112:115], v[128:131]
v_exp_f32 v156, v88
v_mfma_f32_16x16x32_bf16 v[136:139], v[152:155], v[116:119], v[136:139]
ds_read_b128 a[40:43], v6 offset:43008
ds_read_b128 a[44:47], v6 offset:44032
v_mfma_f32_16x16x32_bf16 v[208:211], a[64:67], v[104:107], v[208:211]
v_exp_f32 v157, v89
v_mfma_f32_16x16x32_bf16 v[208:211], a[96:99], v[108:111], v[208:211]
buffer_load_dwordx4 v5, s[16:19], 0 offen offset:2048 sc1 lds
ds_read_b128 a[48:51], v6 offset:45056
v_mfma_f32_16x16x32_bf16 v[212:215], a[68:71], v[104:107], v[212:215]
v_exp_f32 v158, v90
v_mfma_f32_16x16x32_bf16 v[212:215], a[100:103], v[108:111], v[212:215]
ds_read_b128 a[52:55], v6 offset:46080
v_cvt_pk_bf16_f32 v123, v162, v163
v_mfma_f32_16x16x32_bf16 v[216:219], a[72:75], v[104:107], v[216:219]
v_exp_f32 v159, v91
v_mfma_f32_16x16x32_bf16 v[216:219], a[104:107], v[108:111], v[216:219]
buffer_load_dword v27, v26, s[32:35], 0 offen
ds_read_b128 a[56:59], v6 offset:47104
v_subrev_u32 v10, s52, v136
v_mfma_f32_16x16x32_bf16 v[220:223], a[76:79], v[104:107], v[220:223]
v_exp_f32 v160, v92
v_mfma_f32_16x16x32_bf16 v[220:223], a[108:111], v[108:111], v[220:223]
v_cmp_lt_u32 vcc, s53, v10
v_cvt_pk_bf16_f32 v124, v156, v157
v_mfma_f32_16x16x32_bf16 v[224:227], a[80:83], v[104:107], v[224:227]
v_exp_f32 v161, v93
v_mfma_f32_16x16x32_bf16 v[224:227], a[112:115], v[108:111], v[224:227]
buffer_load_dwordx4 v5, s[16:19], 0 offen offset:3072 sc1 lds
ds_read_b128 a[60:63], v6 offset:48128
v_mfma_f32_16x16x32_bf16 v[228:231], a[84:87], v[104:107], v[228:231]
s_cbranch_vccnz K2_TR6
K2_RT6:
v_mfma_f32_16x16x32_bf16 v[228:231], a[116:119], v[108:111], v[228:231]
v_cvt_pk_bf16_f32 v125, v158, v159
v_cvt_pk_bf16_f32 v126, v160, v161
v_mfma_f32_16x16x32_bf16 v[232:235], a[88:91], v[104:107], v[232:235]
v_exp_f32 v162, v94
v_mfma_f32_16x16x32_bf16 v[232:235], a[120:123], v[108:111], v[232:235]
v_xor_b32 v6, 0x10000, v6
v_mfma_f32_16x16x32_bf16 v[236:239], a[92:95], v[104:107], v[236:239]
v_exp_f32 v163, v95
v_mfma_f32_16x16x32_bf16 v[236:239], a[124:127], v[108:111], v[236:239]
v_cvt_pk_bf16_f32 v127, v162, v163
.p2align 6
K2_LOOPB:
s_waitcnt vmcnt(16) lgkmcnt(0)
s_barrier
v_mfma_f32_16x16x32_bf16 v[140:143], v[152:155], v[120:123], v[132:135]
v_exp_f32 v156, v32
v_mfma_f32_16x16x32_bf16 v[140:143], v[152:155], v[124:127], v[140:143]
s_add_u32 m0, s50, 32768
v_add_u32 v4, 16384, v4
v_mfma_f32_16x16x32_bf16 v[64:67], a[0:3], a[160:163], v[144:147]
v_exp_f32 v157, v33
v_mfma_f32_16x16x32_bf16 v[64:67], a[4:7], a[164:167], v[64:67]
buffer_load_dwordx4 v4, s[28:31], 0 offen offset:0 sc1 lds
ds_read_b128 a[64:67], v6 offset:16384
v_mfma_f32_16x16x32_bf16 v[64:67], a[8:11], a[168:171], v[64:67]
v_exp_f32 v158, v34
v_mfma_f32_16x16x32_bf16 v[64:67], a[12:15], a[172:175], v[64:67]
ds_read_b128 a[68:71], v6 offset:17408
ds_read_b128 a[72:75], v6 offset:18432
v_mfma_f32_16x16x32_bf16 v[68:71], a[16:19], a[160:163], v[144:147]
v_exp_f32 v159, v35
v_mfma_f32_16x16x32_bf16 v[68:71], a[20:23], a[164:167], v[68:71]
ds_read_b128 a[76:79], v6 offset:19456
v_subrev_u32 v10, s52, v140
v_mfma_f32_16x16x32_bf16 v[68:71], a[24:27], a[168:171], v[68:71]
v_exp_f32 v160, v36
v_mfma_f32_16x16x32_bf16 v[68:71], a[28:31], a[172:175], v[68:71]
ds_read_b128 a[80:83], v6 offset:20480
v_cmp_lt_u32 vcc, s53, v10
v_mfma_f32_16x16x32_bf16 v[72:75], a[32:35], a[160:163], v[144:147]
v_exp_f32 v161, v37
v_mfma_f32_16x16x32_bf16 v[72:75], a[36:39], a[164:167], v[72:75]
buffer_load_dwordx4 v4, s[28:31], 0 offen offset:1024 sc1 lds
v_cvt_pk_bf16_f32 v96, v156, v157
v_mfma_f32_16x16x32_bf16 v[72:75], a[40:43], a[168:171], v[72:75]
s_cbranch_vccnz K2_TR7
K2_RT7:
v_mfma_f32_16x16x32_bf16 v[72:75], a[44:47], a[172:175], v[72:75]
ds_read_b128 a[84:87], v6 offset:21504
ds_read_b128 a[88:91], v6 offset:22528
v_mfma_f32_16x16x32_bf16 v[76:79], a[48:51], a[160:163], v[144:147]
v_exp_f32 v162, v38
v_mfma_f32_16x16x32_bf16 v[76:79], a[52:55], a[164:167], v[76:79]
ds_read_b128 a[92:95], v6 offset:23552
v_cvt_pk_bf16_f32 v97, v158, v159
v_mfma_f32_16x16x32_bf16 v[76:79], a[56:59], a[168:171], v[76:79]
v_exp_f32 v163, v39
v_mfma_f32_16x16x32_bf16 v[76:79], a[60:63], a[172:175], v[76:79]
ds_read_b128 a[96:99], v6 offset:24576
ds_read_b128 a[100:103], v6 offset:25600
v_mfma_f32_16x16x32_bf16 v[80:83], a[0:3], a[176:179], v[148:151]
v_exp_f32 v156, v40
v_mfma_f32_16x16x32_bf16 v[80:83], a[4:7], a[180:183], v[80:83]
buffer_load_dwordx4 v4, s[28:31], 0 offen offset:2048 sc1 lds
v_cvt_pk_bf16_f32 v98, v160, v161
v_mfma_f32_16x16x32_bf16 v[80:83], a[8:11], a[184:187], v[80:83]
v_exp_f32 v157, v41
v_mfma_f32_16x16x32_bf16 v[80:83], a[12:15], a[188:191], v[80:83]
ds_read_b128 a[104:107], v6 offset:26624
ds_read_b128 a[108:111], v6 offset:27648
v_mfma_f32_16x16x32_bf16 v[84:87], a[16:19], a[176:179], v[148:151]
v_exp_f32 v158, v42
v_mfma_f32_16x16x32_bf16 v[84:87], a[20:23], a[180:183], v[84:87]
ds_read_b128 a[112:115], v6 offset:28672
ds_read_b128 a[116:119], v6 offset:29696
v_mfma_f32_16x16x32_bf16 v[84:87], a[24:27], a[184:187], v[84:87]
v_exp_f32 v159, v43
v_mfma_f32_16x16x32_bf16 v[84:87], a[28:31], a[188:191], v[84:87]
ds_read_b128 a[120:123], v6 offset:30720
v_cvt_pk_bf16_f32 v99, v162, v163
v_mfma_f32_16x16x32_bf16 v[88:91], a[32:35], a[176:179], v[148:151]
v_exp_f32 v160, v44
v_mfma_f32_16x16x32_bf16 v[88:91], a[36:39], a[180:183], v[88:91]
buffer_load_dwordx4 v4, s[28:31], 0 offen offset:3072 sc1 lds
ds_read_b128 a[124:127], v6 offset:31744
v_mfma_f32_16x16x32_bf16 v[88:91], a[40:43], a[184:187], v[88:91]
v_exp_f32 v161, v45
v_mfma_f32_16x16x32_bf16 v[88:91], a[44:47], a[188:191], v[88:91]
v_cvt_pk_bf16_f32 v100, v156, v157
v_cvt_pk_bf16_f32 v101, v158, v159
v_mfma_f32_16x16x32_bf16 v[92:95], a[48:51], a[176:179], v[148:151]
v_exp_f32 v162, v46
v_mfma_f32_16x16x32_bf16 v[92:95], a[52:55], a[180:183], v[92:95]
s_add_u32 m0, s50, 49152
v_add_u32 v5, 16384, v5
v_mfma_f32_16x16x32_bf16 v[92:95], a[56:59], a[184:187], v[92:95]
v_exp_f32 v163, v47
v_mfma_f32_16x16x32_bf16 v[92:95], a[60:63], a[188:191], v[92:95]
s_waitcnt lgkmcnt(0)
v_cvt_pk_bf16_f32 v102, v160, v161
v_mfma_f32_16x16x32_bf16 v[176:179], a[64:67], v[112:115], v[176:179]
v_exp_f32 v156, v48
v_mfma_f32_16x16x32_bf16 v[176:179], a[96:99], v[116:119], v[176:179]
ds_read_b128 a[0:3], v6 offset:0
ds_read_b128 a[4:7], v6 offset:1024
v_mfma_f32_16x16x32_bf16 v[180:183], a[68:71], v[112:115], v[180:183]
v_exp_f32 v157, v49
v_mfma_f32_16x16x32_bf16 v[180:183], a[100:103], v[116:119], v[180:183]
buffer_load_dwordx4 v5, s[16:19], 0 offen offset:0 sc1 lds
ds_read_b128 a[8:11], v6 offset:2048
v_mfma_f32_16x16x32_bf16 v[184:187], a[72:75], v[112:115], v[184:187]
v_exp_f32 v158, v50
v_mfma_f32_16x16x32_bf16 v[184:187], a[104:107], v[116:119], v[184:187]
ds_read_b128 a[12:15], v6 offset:3072
v_cvt_pk_bf16_f32 v103, v162, v163
v_mfma_f32_16x16x32_bf16 v[188:191], a[76:79], v[112:115], v[188:191]
v_exp_f32 v159, v51
v_mfma_f32_16x16x32_bf16 v[188:191], a[108:111], v[116:119], v[188:191]
ds_read_b128 a[16:19], v6 offset:4096
v_cvt_pk_bf16_f32 v104, v156, v157
v_mfma_f32_16x16x32_bf16 v[192:195], a[80:83], v[112:115], v[192:195]
v_exp_f32 v160, v52
v_mfma_f32_16x16x32_bf16 v[192:195], a[112:115], v[116:119], v[192:195]
ds_read_b128 a[20:23], v6 offset:5120
ds_read_b128 a[24:27], v6 offset:6144
v_mfma_f32_16x16x32_bf16 v[196:199], a[84:87], v[112:115], v[196:199]
v_exp_f32 v161, v53
v_mfma_f32_16x16x32_bf16 v[196:199], a[116:119], v[116:119], v[196:199]
buffer_load_dwordx4 v5, s[16:19], 0 offen offset:1024 sc1 lds
ds_read_b128 a[28:31], v6 offset:7168
v_mfma_f32_16x16x32_bf16 v[200:203], a[88:91], v[112:115], v[200:203]
v_exp_f32 v162, v54
v_mfma_f32_16x16x32_bf16 v[200:203], a[120:123], v[116:119], v[200:203]
ds_read_b128 a[32:35], v6 offset:8192
v_cvt_pk_bf16_f32 v105, v158, v159
v_mfma_f32_16x16x32_bf16 v[204:207], a[92:95], v[112:115], v[204:207]
v_exp_f32 v163, v55
v_mfma_f32_16x16x32_bf16 v[204:207], a[124:127], v[116:119], v[204:207]
ds_read_b128 a[36:39], v6 offset:9216
v_cvt_pk_bf16_f32 v106, v160, v161
v_mfma_f32_16x16x32_bf16 v[128:131], v[152:155], v[96:99], v[136:139]
v_exp_f32 v156, v56
v_mfma_f32_16x16x32_bf16 v[128:131], v[152:155], v[100:103], v[128:131]
ds_read_b128 a[40:43], v6 offset:10240
ds_read_b128 a[44:47], v6 offset:11264
v_mfma_f32_16x16x32_bf16 v[208:211], a[64:67], v[120:123], v[208:211]
v_exp_f32 v157, v57
v_mfma_f32_16x16x32_bf16 v[208:211], a[96:99], v[124:127], v[208:211]
buffer_load_dwordx4 v5, s[16:19], 0 offen offset:2048 sc1 lds
ds_read_b128 a[48:51], v6 offset:12288
v_mfma_f32_16x16x32_bf16 v[212:215], a[68:71], v[120:123], v[212:215]
v_exp_f32 v158, v58
v_mfma_f32_16x16x32_bf16 v[212:215], a[100:103], v[124:127], v[212:215]
ds_read_b128 a[52:55], v6 offset:13312
v_cvt_pk_bf16_f32 v107, v162, v163
v_mfma_f32_16x16x32_bf16 v[216:219], a[72:75], v[120:123], v[216:219]
v_exp_f32 v159, v59
v_mfma_f32_16x16x32_bf16 v[216:219], a[104:107], v[124:127], v[216:219]
ds_read_b128 a[56:59], v6 offset:14336
v_subrev_u32 v10, s52, v128
v_mfma_f32_16x16x32_bf16 v[220:223], a[76:79], v[120:123], v[220:223]
v_exp_f32 v160, v60
v_mfma_f32_16x16x32_bf16 v[220:223], a[108:111], v[124:127], v[220:223]
v_cmp_lt_u32 vcc, s53, v10
v_cvt_pk_bf16_f32 v108, v156, v157
v_mfma_f32_16x16x32_bf16 v[224:227], a[80:83], v[120:123], v[224:227]
v_exp_f32 v161, v61
v_mfma_f32_16x16x32_bf16 v[224:227], a[112:115], v[124:127], v[224:227]
buffer_load_dwordx4 v5, s[16:19], 0 offen offset:3072 sc1 lds
ds_read_b128 a[60:63], v6 offset:15360
v_mfma_f32_16x16x32_bf16 v[228:231], a[84:87], v[120:123], v[228:231]
s_cbranch_vccnz K2_TR8
K2_RT8:
v_mfma_f32_16x16x32_bf16 v[228:231], a[116:119], v[124:127], v[228:231]
s_xor_b32 s50, s50, 0x10000
v_cvt_pk_bf16_f32 v109, v158, v159
v_mfma_f32_16x16x32_bf16 v[232:235], a[88:91], v[120:123], v[232:235]
v_exp_f32 v162, v62
v_mfma_f32_16x16x32_bf16 v[232:235], a[120:123], v[124:127], v[232:235]
v_cvt_pk_bf16_f32 v110, v160, v161
v_mfma_f32_16x16x32_bf16 v[236:239], a[92:95], v[120:123], v[236:239]
v_exp_f32 v163, v63
v_mfma_f32_16x16x32_bf16 v[236:239], a[124:127], v[124:127], v[236:239]
v_cvt_pk_bf16_f32 v111, v162, v163
s_waitcnt vmcnt(16) lgkmcnt(0)
s_barrier
v_mfma_f32_16x16x32_bf16 v[132:135], v[152:155], v[104:107], v[140:143]
v_exp_f32 v156, v64
v_mfma_f32_16x16x32_bf16 v[132:135], v[152:155], v[108:111], v[132:135]
s_add_u32 m0, s50, 0
v_add_u32 v4, 16384, v4
v_mfma_f32_16x16x32_bf16 v[32:35], a[0:3], a[160:163], v[144:147]
v_exp_f32 v157, v65
v_mfma_f32_16x16x32_bf16 v[32:35], a[4:7], a[164:167], v[32:35]
buffer_load_dwordx4 v4, s[28:31], 0 offen offset:0 sc1 lds
ds_read_b128 a[64:67], v6 offset:49152
v_mfma_f32_16x16x32_bf16 v[32:35], a[8:11], a[168:171], v[32:35]
v_exp_f32 v158, v66
v_mfma_f32_16x16x32_bf16 v[32:35], a[12:15], a[172:175], v[32:35]
ds_read_b128 a[68:71], v6 offset:50176
ds_read_b128 a[72:75], v6 offset:51200
v_mfma_f32_16x16x32_bf16 v[36:39], a[16:19], a[160:163], v[144:147]
v_exp_f32 v159, v67
v_mfma_f32_16x16x32_bf16 v[36:39], a[20:23], a[164:167], v[36:39]
ds_read_b128 a[76:79], v6 offset:52224
v_subrev_u32 v10, s52, v132
v_mfma_f32_16x16x32_bf16 v[36:39], a[24:27], a[168:171], v[36:39]
v_exp_f32 v160, v68
v_mfma_f32_16x16x32_bf16 v[36:39], a[28:31], a[172:175], v[36:39]
ds_read_b128 a[80:83], v6 offset:53248
v_cmp_lt_u32 vcc, s53, v10
v_mfma_f32_16x16x32_bf16 v[40:43], a[32:35], a[160:163], v[144:147]
v_exp_f32 v161, v69
v_mfma_f32_16x16x32_bf16 v[40:43], a[36:39], a[164:167], v[40:43]
buffer_load_dwordx4 v4, s[28:31], 0 offen offset:1024 sc1 lds
v_cvt_pk_bf16_f32 v112, v156, v157
v_mfma_f32_16x16x32_bf16 v[40:43], a[40:43], a[168:171], v[40:43]
s_cbranch_vccnz K2_TR9
K2_RT9:
v_mfma_f32_16x16x32_bf16 v[40:43], a[44:47], a[172:175], v[40:43]
ds_read_b128 a[84:87], v6 offset:54272
ds_read_b128 a[88:91], v6 offset:55296
v_mfma_f32_16x16x32_bf16 v[44:47], a[48:51], a[160:163], v[144:147]
v_exp_f32 v162, v70
v_mfma_f32_16x16x32_bf16 v[44:47], a[52:55], a[164:167], v[44:47]
ds_read_b128 a[92:95], v6 offset:56320
v_cvt_pk_bf16_f32 v113, v158, v159
v_mfma_f32_16x16x32_bf16 v[44:47], a[56:59], a[168:171], v[44:47]
v_exp_f32 v163, v71
v_mfma_f32_16x16x32_bf16 v[44:47], a[60:63], a[172:175], v[44:47]
ds_read_b128 a[96:99], v6 offset:57344
ds_read_b128 a[100:103], v6 offset:58368
v_mfma_f32_16x16x32_bf16 v[48:51], a[0:3], a[176:179], v[148:151]
v_exp_f32 v156, v72
v_mfma_f32_16x16x32_bf16 v[48:51], a[4:7], a[180:183], v[48:51]
buffer_load_dwordx4 v4, s[28:31], 0 offen offset:2048 sc1 lds
v_cvt_pk_bf16_f32 v114, v160, v161
v_mfma_f32_16x16x32_bf16 v[48:51], a[8:11], a[184:187], v[48:51]
v_exp_f32 v157, v73
v_mfma_f32_16x16x32_bf16 v[48:51], a[12:15], a[188:191], v[48:51]
ds_read_b128 a[104:107], v6 offset:59392
ds_read_b128 a[108:111], v6 offset:60416
v_mfma_f32_16x16x32_bf16 v[52:55], a[16:19], a[176:179], v[148:151]
v_exp_f32 v158, v74
v_mfma_f32_16x16x32_bf16 v[52:55], a[20:23], a[180:183], v[52:55]
ds_read_b128 a[112:115], v6 offset:61440
ds_read_b128 a[116:119], v6 offset:62464
v_mfma_f32_16x16x32_bf16 v[52:55], a[24:27], a[184:187], v[52:55]
v_exp_f32 v159, v75
v_mfma_f32_16x16x32_bf16 v[52:55], a[28:31], a[188:191], v[52:55]
ds_read_b128 a[120:123], v6 offset:63488
v_cvt_pk_bf16_f32 v115, v162, v163
v_mfma_f32_16x16x32_bf16 v[56:59], a[32:35], a[176:179], v[148:151]
v_exp_f32 v160, v76
v_mfma_f32_16x16x32_bf16 v[56:59], a[36:39], a[180:183], v[56:59]
buffer_load_dwordx4 v4, s[28:31], 0 offen offset:3072 sc1 lds
ds_read_b128 a[124:127], v6 offset:64512
v_mfma_f32_16x16x32_bf16 v[56:59], a[40:43], a[184:187], v[56:59]
v_exp_f32 v161, v77
v_mfma_f32_16x16x32_bf16 v[56:59], a[44:47], a[188:191], v[56:59]
v_cvt_pk_bf16_f32 v116, v156, v157
v_cvt_pk_bf16_f32 v117, v158, v159
v_mfma_f32_16x16x32_bf16 v[60:63], a[48:51], a[176:179], v[148:151]
v_exp_f32 v162, v78
v_mfma_f32_16x16x32_bf16 v[60:63], a[52:55], a[180:183], v[60:63]
s_add_u32 m0, s50, 16384
v_add_u32 v5, 16384, v5
v_mfma_f32_16x16x32_bf16 v[60:63], a[56:59], a[184:187], v[60:63]
v_exp_f32 v163, v79
v_mfma_f32_16x16x32_bf16 v[60:63], a[60:63], a[188:191], v[60:63]
s_waitcnt lgkmcnt(0)
v_cvt_pk_bf16_f32 v118, v160, v161
v_mfma_f32_16x16x32_bf16 v[176:179], a[64:67], v[96:99], v[176:179]
v_exp_f32 v156, v80
v_mfma_f32_16x16x32_bf16 v[176:179], a[96:99], v[100:103], v[176:179]
ds_read_b128 a[0:3], v6 offset:32768
ds_read_b128 a[4:7], v6 offset:33792
v_mfma_f32_16x16x32_bf16 v[180:183], a[68:71], v[96:99], v[180:183]
v_exp_f32 v157, v81
v_mfma_f32_16x16x32_bf16 v[180:183], a[100:103], v[100:103], v[180:183]
buffer_load_dwordx4 v5, s[16:19], 0 offen offset:0 sc1 lds
ds_read_b128 a[8:11], v6 offset:34816
v_mfma_f32_16x16x32_bf16 v[184:187], a[72:75], v[96:99], v[184:187]
v_exp_f32 v158, v82
v_mfma_f32_16x16x32_bf16 v[184:187], a[104:107], v[100:103], v[184:187]
ds_read_b128 a[12:15], v6 offset:35840
v_cvt_pk_bf16_f32 v119, v162, v163
v_mfma_f32_16x16x32_bf16 v[188:191], a[76:79], v[96:99], v[188:191]
v_exp_f32 v159, v83
v_mfma_f32_16x16x32_bf16 v[188:191], a[108:111], v[100:103], v[188:191]
ds_read_b128 a[16:19], v6 offset:36864
v_cvt_pk_bf16_f32 v120, v156, v157
v_mfma_f32_16x16x32_bf16 v[192:195], a[80:83], v[96:99], v[192:195]
v_exp_f32 v160, v84
v_mfma_f32_16x16x32_bf16 v[192:195], a[112:115], v[100:103], v[192:195]
ds_read_b128 a[20:23], v6 offset:37888
ds_read_b128 a[24:27], v6 offset:38912
v_mfma_f32_16x16x32_bf16 v[196:199], a[84:87], v[96:99], v[196:199]
v_exp_f32 v161, v85
v_mfma_f32_16x16x32_bf16 v[196:199], a[116:119], v[100:103], v[196:199]
buffer_load_dwordx4 v5, s[16:19], 0 offen offset:1024 sc1 lds
ds_read_b128 a[28:31], v6 offset:39936
v_mfma_f32_16x16x32_bf16 v[200:203], a[88:91], v[96:99], v[200:203]
v_exp_f32 v162, v86
v_mfma_f32_16x16x32_bf16 v[200:203], a[120:123], v[100:103], v[200:203]
ds_read_b128 a[32:35], v6 offset:40960
v_cvt_pk_bf16_f32 v121, v158, v159
v_mfma_f32_16x16x32_bf16 v[204:207], a[92:95], v[96:99], v[204:207]
v_exp_f32 v163, v87
v_mfma_f32_16x16x32_bf16 v[204:207], a[124:127], v[100:103], v[204:207]
ds_read_b128 a[36:39], v6 offset:41984
v_cvt_pk_bf16_f32 v122, v160, v161
v_mfma_f32_16x16x32_bf16 v[136:139], v[152:155], v[112:115], v[128:131]
v_exp_f32 v156, v88
v_mfma_f32_16x16x32_bf16 v[136:139], v[152:155], v[116:119], v[136:139]
ds_read_b128 a[40:43], v6 offset:43008
ds_read_b128 a[44:47], v6 offset:44032
v_mfma_f32_16x16x32_bf16 v[208:211], a[64:67], v[104:107], v[208:211]
v_exp_f32 v157, v89
v_mfma_f32_16x16x32_bf16 v[208:211], a[96:99], v[108:111], v[208:211]
buffer_load_dwordx4 v5, s[16:19], 0 offen offset:2048 sc1 lds
ds_read_b128 a[48:51], v6 offset:45056
v_mfma_f32_16x16x32_bf16 v[212:215], a[68:71], v[104:107], v[212:215]
v_exp_f32 v158, v90
v_mfma_f32_16x16x32_bf16 v[212:215], a[100:103], v[108:111], v[212:215]
ds_read_b128 a[52:55], v6 offset:46080
v_cvt_pk_bf16_f32 v123, v162, v163
v_mfma_f32_16x16x32_bf16 v[216:219], a[72:75], v[104:107], v[216:219]
v_exp_f32 v159, v91
v_mfma_f32_16x16x32_bf16 v[216:219], a[104:107], v[108:111], v[216:219]
ds_read_b128 a[56:59], v6 offset:47104
v_subrev_u32 v10, s52, v136
v_mfma_f32_16x16x32_bf16 v[220:223], a[76:79], v[104:107], v[220:223]
v_exp_f32 v160, v92
v_mfma_f32_16x16x32_bf16 v[220:223], a[108:111], v[108:111], v[220:223]
v_cmp_lt_u32 vcc, s53, v10
v_cvt_pk_bf16_f32 v124, v156, v157
v_mfma_f32_16x16x32_bf16 v[224:227], a[80:83], v[104:107], v[224:227]
v_exp_f32 v161, v93
v_mfma_f32_16x16x32_bf16 v[224:227], a[112:115], v[108:111], v[224:227]
buffer_load_dwordx4 v5, s[16:19], 0 offen offset:3072 sc1 lds
ds_read_b128 a[60:63], v6 offset:48128
v_mfma_f32_16x16x32_bf16 v[228:231], a[84:87], v[104:107], v[228:231]
s_cbranch_vccnz K2_TR10
K2_RT10:
v_mfma_f32_16x16x32_bf16 v[228:231], a[116:119], v[108:111], v[228:231]
v_cvt_pk_bf16_f32 v125, v158, v159
v_cvt_pk_bf16_f32 v126, v160, v161
v_mfma_f32_16x16x32_bf16 v[232:235], a[88:91], v[104:107], v[232:235]
v_exp_f32 v162, v94
v_mfma_f32_16x16x32_bf16 v[232:235], a[120:123], v[108:111], v[232:235]
v_xor_b32 v6, 0x10000, v6
v_mfma_f32_16x16x32_bf16 v[236:239], a[92:95], v[104:107], v[236:239]
v_exp_f32 v163, v95
v_mfma_f32_16x16x32_bf16 v[236:239], a[124:127], v[108:111], v[236:239]
s_add_u32 s54, s54, -1
v_cvt_pk_bf16_f32 v127, v162, v163
s_cbranch_scc1 K2_LOOPB
K2_MID:
s_waitcnt vmcnt(16) lgkmcnt(0)
s_barrier
v_mfma_f32_16x16x32_bf16 v[140:143], v[152:155], v[120:123], v[132:135]
v_exp_f32 v156, v32
v_mfma_f32_16x16x32_bf16 v[140:143], v[152:155], v[124:127], v[140:143]
s_add_u32 m0, s50, 32768
v_add_u32 v4, 16384, v4
v_mfma_f32_16x16x32_bf16 v[64:67], a[0:3], a[160:163], v[144:147]
v_exp_f32 v157, v33
v_mfma_f32_16x16x32_bf16 v[64:67], a[4:7], a[164:167], v[64:67]
buffer_load_dwordx4 v4, s[28:31], 0 offen offset:0 sc1 lds
ds_read_b128 a[64:67], v6 offset:16384
v_mfma_f32_16x16x32_bf16 v[64:67], a[8:11], a[168:171], v[64:67]
v_exp_f32 v158, v34
v_mfma_f32_16x16x32_bf16 v[64:67], a[12:15], a[172:175], v[64:67]
ds_read_b128 a[68:71], v6 offset:17408
ds_read_b128 a[72:75], v6 offset:18432
v_lshlrev_b32 v28, 4, v1
s_lshl_b32 s47, s3, 30
v_or_b32 v28, s47, v28
s_mov_b32 s69, 2752512
s_nop 0
buffer_load_dwordx4 v[24:27], v28, s[28:31], s69 offen sc1
v_mfma_f32_16x16x32_bf16 v[68:71], a[16:19], a[160:163], v[144:147]
v_exp_f32 v159, v35
v_mfma_f32_16x16x32_bf16 v[68:71], a[20:23], a[164:167], v[68:71]
ds_read_b128 a[76:79], v6 offset:19456
v_subrev_u32 v10, s52, v140
v_mfma_f32_16x16x32_bf16 v[68:71], a[24:27], a[168:171], v[68:71]
v_exp_f32 v160, v36
v_mfma_f32_16x16x32_bf16 v[68:71], a[28:31], a[172:175], v[68:71]
ds_read_b128 a[80:83], v6 offset:20480
v_cmp_lt_u32 vcc, s53, v10
v_mfma_f32_16x16x32_bf16 v[72:75], a[32:35], a[160:163], v[144:147]
v_exp_f32 v161, v37
v_mfma_f32_16x16x32_bf16 v[72:75], a[36:39], a[164:167], v[72:75]
buffer_load_dwordx4 v4, s[28:31], 0 offen offset:1024 sc1 lds
v_cvt_pk_bf16_f32 v96, v156, v157
v_mfma_f32_16x16x32_bf16 v[72:75], a[40:43], a[168:171], v[72:75]
s_cbranch_vccnz K2_TR11
K2_RT11:
v_mfma_f32_16x16x32_bf16 v[72:75], a[44:47], a[172:175], v[72:75]
ds_read_b128 a[84:87], v6 offset:21504
ds_read_b128 a[88:91], v6 offset:22528
v_mfma_f32_16x16x32_bf16 v[76:79], a[48:51], a[160:163], v[144:147]
v_exp_f32 v162, v38
v_mfma_f32_16x16x32_bf16 v[76:79], a[52:55], a[164:167], v[76:79]
ds_read_b128 a[92:95], v6 offset:23552
v_cvt_pk_bf16_f32 v97, v158, v159
v_mfma_f32_16x16x32_bf16 v[76:79], a[56:59], a[168:171], v[76:79]
v_exp_f32 v163, v39
v_mfma_f32_16x16x32_bf16 v[76:79], a[60:63], a[172:175], v[76:79]
s_mov_b32 s68, 2097152
s_nop 0
buffer_load_dwordx4 v[240:243], v3, s[28:31], s68 offen offset:0 sc1
ds_read_b128 a[96:99], v6 offset:24576
ds_read_b128 a[100:103], v6 offset:25600
v_mfma_f32_16x16x32_bf16 v[80:83], a[0:3], a[176:179], v[148:151]
v_exp_f32 v156, v40
v_mfma_f32_16x16x32_bf16 v[80:83], a[4:7], a[180:183], v[80:83]
buffer_load_dwordx4 v4, s[28:31], 0 offen offset:2048 sc1 lds
v_cvt_pk_bf16_f32 v98, v160, v161
v_mfma_f32_16x16x32_bf16 v[80:83], a[8:11], a[184:187], v[80:83]
v_exp_f32 v157, v41
v_mfma_f32_16x16x32_bf16 v[80:83], a[12:15], a[188:191], v[80:83]
ds_read_b128 a[104:107], v6 offset:26624
ds_read_b128 a[108:111], v6 offset:27648
v_mfma_f32_16x16x32_bf16 v[84:87], a[16:19], a[176:179], v[148:151]
v_exp_f32 v158, v42
v_mfma_f32_16x16x32_bf16 v[84:87], a[20:23], a[180:183], v[84:87]
ds_read_b128 a[112:115], v6 offset:28672
ds_read_b128 a[116:119], v6 offset:29696
v_mfma_f32_16x16x32_bf16 v[84:87], a[24:27], a[184:187], v[84:87]
v_exp_f32 v159, v43
v_mfma_f32_16x16x32_bf16 v[84:87], a[28:31], a[188:191], v[84:87]
ds_read_b128 a[120:123], v6 offset:30720
v_cvt_pk_bf16_f32 v99, v162, v163
v_mfma_f32_16x16x32_bf16 v[88:91], a[32:35], a[176:179], v[148:151]
v_exp_f32 v160, v44
v_mfma_f32_16x16x32_bf16 v[88:91], a[36:39], a[180:183], v[88:91]
buffer_load_dwordx4 v4, s[28:31], 0 offen offset:3072 sc1 lds
ds_read_b128 a[124:127], v6 offset:31744
v_mfma_f32_16x16x32_bf16 v[88:91], a[40:43], a[184:187], v[88:91]
v_exp_f32 v161, v45
v_mfma_f32_16x16x32_bf16 v[88:91], a[44:47], a[188:191], v[88:91]
buffer_load_dwordx4 v[244:247], v3, s[28:31], s68 offen offset:1024 sc1
v_cvt_pk_bf16_f32 v100, v156, v157
v_cvt_pk_bf16_f32 v101, v158, v159
v_mfma_f32_16x16x32_bf16 v[92:95], a[48:51], a[176:179], v[148:151]
v_exp_f32 v162, v46
v_mfma_f32_16x16x32_bf16 v[92:95], a[52:55], a[180:183], v[92:95]
s_add_u32 m0, s50, 49152
v_add_u32 v5, 16384, v5
v_mfma_f32_16x16x32_bf16 v[92:95], a[56:59], a[184:187], v[92:95]
v_exp_f32 v163, v47
v_mfma_f32_16x16x32_bf16 v[92:95], a[60:63], a[188:191], v[92:95]
s_waitcnt lgkmcnt(0)
v_cvt_pk_bf16_f32 v102, v160, v161
v_mfma_f32_16x16x32_bf16 v[176:179], a[64:67], v[112:115], v[176:179]
v_exp_f32 v156, v48
v_mfma_f32_16x16x32_bf16 v[176:179], a[96:99], v[116:119], v[176:179]
ds_read_b128 a[0:3], v6 offset:0
ds_read_b128 a[4:7], v6 offset:1024
v_mfma_f32_16x16x32_bf16 v[180:183], a[68:71], v[112:115], v[180:183]
v_exp_f32 v157, v49
v_mfma_f32_16x16x32_bf16 v[180:183], a[100:103], v[116:119], v[180:183]
buffer_load_dwordx4 v5, s[16:19], 0 offen offset:0 sc1 lds
ds_read_b128 a[8:11], v6 offset:2048
v_mfma_f32_16x16x32_bf16 v[184:187], a[72:75], v[112:115], v[184:187]
v_exp_f32 v158, v50
v_mfma_f32_16x16x32_bf16 v[184:187], a[104:107], v[116:119], v[184:187]
ds_read_b128 a[12:15], v6 offset:3072
v_cvt_pk_bf16_f32 v103, v162, v163
v_mfma_f32_16x16x32_bf16 v[188:191], a[76:79], v[112:115], v[188:191]
v_exp_f32 v159, v51
v_mfma_f32_16x16x32_bf16 v[188:191], a[108:111], v[116:119], v[188:191]
buffer_load_dwordx4 v[248:251], v3, s[28:31], s68 offen offset:2048 sc1
ds_read_b128 a[16:19], v6 offset:4096
v_cvt_pk_bf16_f32 v104, v156, v157
v_mfma_f32_16x16x32_bf16 v[192:195], a[80:83], v[112:115], v[192:195]
v_exp_f32 v160, v52
v_mfma_f32_16x16x32_bf16 v[192:195], a[112:115], v[116:119], v[192:195]
ds_read_b128 a[20:23], v6 offset:5120
ds_read_b128 a[24:27], v6 offset:6144
v_mfma_f32_16x16x32_bf16 v[196:199], a[84:87], v[112:115], v[196:199]
v_exp_f32 v161, v53
v_mfma_f32_16x16x32_bf16 v[196:199], a[116:119], v[116:119], v[196:199]
buffer_load_dwordx4 v5, s[16:19], 0 offen offset:1024 sc1 lds
ds_read_b128 a[28:31], v6 offset:7168
v_mfma_f32_16x16x32_bf16 v[200:203], a[88:91], v[112:115], v[200:203]
v_exp_f32 v162, v54
v_mfma_f32_16x16x32_bf16 v[200:203], a[120:123], v[116:119], v[200:203]
ds_read_b128 a[32:35], v6 offset:8192
v_cvt_pk_bf16_f32 v105, v158, v159
v_mfma_f32_16x16x32_bf16 v[204:207], a[92:95], v[112:115], v[204:207]
v_exp_f32 v163, v55
v_mfma_f32_16x16x32_bf16 v[204:207], a[124:127], v[116:119], v[204:207]
ds_read_b128 a[36:39], v6 offset:9216
v_cvt_pk_bf16_f32 v106, v160, v161
v_mfma_f32_16x16x32_bf16 v[128:131], v[152:155], v[96:99], v[136:139]
v_exp_f32 v156, v56
v_mfma_f32_16x16x32_bf16 v[128:131], v[152:155], v[100:103], v[128:131]
ds_read_b128 a[40:43], v6 offset:10240
ds_read_b128 a[44:47], v6 offset:11264
v_mfma_f32_16x16x32_bf16 v[208:211], a[64:67], v[120:123], v[208:211]
v_exp_f32 v157, v57
v_mfma_f32_16x16x32_bf16 v[208:211], a[96:99], v[124:127], v[208:211]
buffer_load_dwordx4 v[252:255], v3, s[28:31], s68 offen offset:3072 sc1
buffer_load_dwordx4 v5, s[16:19], 0 offen offset:2048 sc1 lds
ds_read_b128 a[48:51], v6 offset:12288
v_mfma_f32_16x16x32_bf16 v[212:215], a[68:71], v[120:123], v[212:215]
v_exp_f32 v158, v58
v_mfma_f32_16x16x32_bf16 v[212:215], a[100:103], v[124:127], v[212:215]
ds_read_b128 a[52:55], v6 offset:13312
v_cvt_pk_bf16_f32 v107, v162, v163
v_mfma_f32_16x16x32_bf16 v[216:219], a[72:75], v[120:123], v[216:219]
v_exp_f32 v159, v59
v_mfma_f32_16x16x32_bf16 v[216:219], a[104:107], v[124:127], v[216:219]
ds_read_b128 a[56:59], v6 offset:14336
v_subrev_u32 v10, s52, v128
v_mfma_f32_16x16x32_bf16 v[220:223], a[76:79], v[120:123], v[220:223]
v_exp_f32 v160, v60
v_mfma_f32_16x16x32_bf16 v[220:223], a[108:111], v[124:127], v[220:223]
v_cmp_lt_u32 vcc, s53, v10
v_cvt_pk_bf16_f32 v108, v156, v157
v_mfma_f32_16x16x32_bf16 v[224:227], a[80:83], v[120:123], v[224:227]
v_exp_f32 v161, v61
v_mfma_f32_16x16x32_bf16 v[224:227], a[112:115], v[124:127], v[224:227]
buffer_load_dwordx4 v5, s[16:19], 0 offen offset:3072 sc1 lds
ds_read_b128 a[60:63], v6 offset:15360
v_mfma_f32_16x16x32_bf16 v[228:231], a[84:87], v[120:123], v[228:231]
s_cbranch_vccnz K2_TR12
K2_RT12:
v_mfma_f32_16x16x32_bf16 v[228:231], a[116:119], v[124:127], v[228:231]
s_xor_b32 s50, s50, 0x10000
v_cvt_pk_bf16_f32 v109, v158, v159
v_mfma_f32_16x16x32_bf16 v[232:235], a[88:91], v[120:123], v[232:235]
v_exp_f32 v162, v62
v_mfma_f32_16x16x32_bf16 v[232:235], a[120:123], v[124:127], v[232:235]
v_cvt_pk_bf16_f32 v110, v160, v161
v_mfma_f32_16x16x32_bf16 v[236:239], a[92:95], v[120:123], v[236:239]
v_exp_f32 v163, v63
v_mfma_f32_16x16x32_bf16 v[236:239], a[124:127], v[124:127], v[236:239]
v_cvt_pk_bf16_f32 v111, v162, v163
s_waitcnt vmcnt(16) lgkmcnt(0)
s_barrier
v_mfma_f32_16x16x32_bf16 v[132:135], v[152:155], v[104:107], v[140:143]
v_exp_f32 v156, v64
v_mfma_f32_16x16x32_bf16 v[132:135], v[152:155], v[108:111], v[132:135]
s_add_u32 m0, s50, 0
v_add_u32 v4, s51, v4
v_mfma_f32_16x16x32_bf16 v[32:35], a[0:3], a[160:163], v[144:147]
v_exp_f32 v157, v65
v_mfma_f32_16x16x32_bf16 v[32:35], a[4:7], a[164:167], v[32:35]
buffer_load_dwordx4 v4, s[28:31], 0 offen offset:0 sc1 lds
ds_read_b128 a[64:67], v6 offset:49152
v_mfma_f32_16x16x32_bf16 v[32:35], a[8:11], a[168:171], v[32:35]
v_exp_f32 v158, v66
v_mfma_f32_16x16x32_bf16 v[32:35], a[12:15], a[172:175], v[32:35]
buffer_load_dwordx4 a[128:131], v22, s[20:23], 0 offen
ds_read_b128 a[68:71], v6 offset:50176
ds_read_b128 a[72:75], v6 offset:51200
v_mfma_f32_16x16x32_bf16 v[36:39], a[16:19], a[160:163], v[144:147]
v_exp_f32 v159, v67
v_mfma_f32_16x16x32_bf16 v[36:39], a[20:23], a[164:167], v[36:39]
ds_read_b128 a[76:79], v6 offset:52224
v_subrev_u32 v10, s52, v132
v_mfma_f32_16x16x32_bf16 v[36:39], a[24:27], a[168:171], v[36:39]
v_exp_f32 v160, v68
v_mfma_f32_16x16x32_bf16 v[36:39], a[28:31], a[172:175], v[36:39]
ds_read_b128 a[80:83], v6 offset:53248
v_cmp_lt_u32 vcc, s53, v10
v_mfma_f32_16x16x32_bf16 v[40:43], a[32:35], a[160:163], v[144:147]
v_exp_f32 v161, v69
v_mfma_f32_16x16x32_bf16 v[40:43], a[36:39], a[164:167], v[40:43]
buffer_load_dwordx4 v4, s[28:31], 0 offen offset:1024 sc1 lds
v_cvt_pk_bf16_f32 v112, v156, v157
v_mfma_f32_16x16x32_bf16 v[40:43], a[40:43], a[168:171], v[40:43]
s_cbranch_vccnz K2_TR13
K2_RT13:
v_mfma_f32_16x16x32_bf16 v[40:43], a[44:47], a[172:175], v[40:43]
ds_read_b128 a[84:87], v6 offset:54272
ds_read_b128 a[88:91], v6 offset:55296
v_mfma_f32_16x16x32_bf16 v[44:47], a[48:51], a[160:163], v[144:147]
v_exp_f32 v162, v70
v_mfma_f32_16x16x32_bf16 v[44:47], a[52:55], a[164:167], v[44:47]
ds_read_b128 a[92:95], v6 offset:56320
v_cvt_pk_bf16_f32 v113, v158, v159
v_mfma_f32_16x16x32_bf16 v[44:47], a[56:59], a[168:171], v[44:47]
v_exp_f32 v163, v71
v_mfma_f32_16x16x32_bf16 v[44:47], a[60:63], a[172:175], v[44:47]
ds_read_b128 a[96:99], v6 offset:57344
ds_read_b128 a[100:103], v6 offset:58368
v_mfma_f32_16x16x32_bf16 v[48:51], a[0:3], a[176:179], v[148:151]
v_exp_f32 v156, v72
v_mfma_f32_16x16x32_bf16 v[48:51], a[4:7], a[180:183], v[48:51]
buffer_load_dwordx4 v4, s[28:31], 0 offen offset:2048 sc1 lds
v_cvt_pk_bf16_f32 v114, v160, v161
v_mfma_f32_16x16x32_bf16 v[48:51], a[8:11], a[184:187], v[48:51]
v_exp_f32 v157, v73
v_mfma_f32_16x16x32_bf16 v[48:51], a[12:15], a[188:191], v[48:51]
buffer_load_dwordx4 a[132:135], v22, s[20:23], 0 offen offset:3584
ds_read_b128 a[104:107], v6 offset:59392
ds_read_b128 a[108:111], v6 offset:60416
v_mfma_f32_16x16x32_bf16 v[52:55], a[16:19], a[176:179], v[148:151]
v_exp_f32 v158, v74
v_mfma_f32_16x16x32_bf16 v[52:55], a[20:23], a[180:183], v[52:55]
ds_read_b128 a[112:115], v6 offset:61440
ds_read_b128 a[116:119], v6 offset:62464
v_mfma_f32_16x16x32_bf16 v[52:55], a[24:27], a[184:187], v[52:55]
v_exp_f32 v159, v75
v_mfma_f32_16x16x32_bf16 v[52:55], a[28:31], a[188:191], v[52:55]
ds_read_b128 a[120:123], v6 offset:63488
v_cvt_pk_bf16_f32 v115, v162, v163
v_mfma_f32_16x16x32_bf16 v[56:59], a[32:35], a[176:179], v[148:151]
v_exp_f32 v160, v76
v_mfma_f32_16x16x32_bf16 v[56:59], a[36:39], a[180:183], v[56:59]
buffer_load_dwordx4 v4, s[28:31], 0 offen offset:3072 sc1 lds
ds_read_b128 a[124:127], v6 offset:64512
v_mfma_f32_16x16x32_bf16 v[56:59], a[40:43], a[184:187], v[56:59]
v_exp_f32 v161, v77
v_mfma_f32_16x16x32_bf16 v[56:59], a[44:47], a[188:191], v[56:59]
v_cvt_pk_bf16_f32 v116, v156, v157
v_cvt_pk_bf16_f32 v117, v158, v159
v_mfma_f32_16x16x32_bf16 v[60:63], a[48:51], a[176:179], v[148:151]
v_exp_f32 v162, v78
v_mfma_f32_16x16x32_bf16 v[60:63], a[52:55], a[180:183], v[60:63]
s_add_u32 m0, s50, 16384
v_add_u32 v5, 16384, v5
v_mfma_f32_16x16x32_bf16 v[60:63], a[56:59], a[184:187], v[60:63]
v_exp_f32 v163, v79
v_mfma_f32_16x16x32_bf16 v[60:63], a[60:63], a[188:191], v[60:63]
s_waitcnt lgkmcnt(0)
v_cvt_pk_bf16_f32 v118, v160, v161
v_mfma_f32_16x16x32_bf16 v[176:179], a[64:67], v[96:99], v[176:179]
v_exp_f32 v156, v80
v_mfma_f32_16x16x32_bf16 v[176:179], a[96:99], v[100:103], v[176:179]
buffer_load_dwordx4 a[136:139], v22, s[24:27], 0 offen
ds_read_b128 a[0:3], v6 offset:32768
ds_read_b128 a[4:7], v6 offset:33792
v_mfma_f32_16x16x32_bf16 v[180:183], a[68:71], v[96:99], v[180:183]
v_exp_f32 v157, v81
v_mfma_f32_16x16x32_bf16 v[180:183], a[100:103], v[100:103], v[180:183]
buffer_load_dwordx4 v5, s[16:19], 0 offen offset:0 sc1 lds
ds_read_b128 a[8:11], v6 offset:34816
v_mfma_f32_16x16x32_bf16 v[184:187], a[72:75], v[96:99], v[184:187]
v_exp_f32 v158, v82
v_mfma_f32_16x16x32_bf16 v[184:187], a[104:107], v[100:103], v[184:187]
ds_read_b128 a[12:15], v6 offset:35840
v_cvt_pk_bf16_f32 v119, v162, v163
v_mfma_f32_16x16x32_bf16 v[188:191], a[76:79], v[96:99], v[188:191]
v_exp_f32 v159, v83
v_mfma_f32_16x16x32_bf16 v[188:191], a[108:111], v[100:103], v[188:191]
ds_read_b128 a[16:19], v6 offset:36864
v_cvt_pk_bf16_f32 v120, v156, v157
v_mfma_f32_16x16x32_bf16 v[192:195], a[80:83], v[96:99], v[192:195]
v_exp_f32 v160, v84
v_mfma_f32_16x16x32_bf16 v[192:195], a[112:115], v[100:103], v[192:195]
ds_read_b128 a[20:23], v6 offset:37888
ds_read_b128 a[24:27], v6 offset:38912
v_mfma_f32_16x16x32_bf16 v[196:199], a[84:87], v[96:99], v[196:199]
v_exp_f32 v161, v85
v_mfma_f32_16x16x32_bf16 v[196:199], a[116:119], v[100:103], v[196:199]
buffer_load_dwordx4 v5, s[16:19], 0 offen offset:1024 sc1 lds
ds_read_b128 a[28:31], v6 offset:39936
v_mfma_f32_16x16x32_bf16 v[200:203], a[88:91], v[96:99], v[200:203]
v_exp_f32 v162, v86
v_mfma_f32_16x16x32_bf16 v[200:203], a[120:123], v[100:103], v[200:203]
ds_read_b128 a[32:35], v6 offset:40960
v_cvt_pk_bf16_f32 v121, v158, v159
v_mfma_f32_16x16x32_bf16 v[204:207], a[92:95], v[96:99], v[204:207]
v_exp_f32 v163, v87
v_mfma_f32_16x16x32_bf16 v[204:207], a[124:127], v[100:103], v[204:207]
ds_read_b128 a[36:39], v6 offset:41984
v_cvt_pk_bf16_f32 v122, v160, v161
v_mfma_f32_16x16x32_bf16 v[136:139], v[152:155], v[112:115], v[128:131]
v_exp_f32 v156, v88
v_mfma_f32_16x16x32_bf16 v[136:139], v[152:155], v[116:119], v[136:139]
buffer_load_dwordx4 a[140:143], v22, s[24:27], 0 offen offset:3584
ds_read_b128 a[40:43], v6 offset:43008
ds_read_b128 a[44:47], v6 offset:44032
v_mfma_f32_16x16x32_bf16 v[208:211], a[64:67], v[104:107], v[208:211]
v_exp_f32 v157, v89
v_mfma_f32_16x16x32_bf16 v[208:211], a[96:99], v[108:111], v[208:211]
buffer_load_dwordx4 v5, s[16:19], 0 offen offset:2048 sc1 lds
ds_read_b128 a[48:51], v6 offset:45056
v_mfma_f32_16x16x32_bf16 v[212:215], a[68:71], v[104:107], v[212:215]
v_exp_f32 v158, v90
v_mfma_f32_16x16x32_bf16 v[212:215], a[100:103], v[108:111], v[212:215]
ds_read_b128 a[52:55], v6 offset:46080
v_cvt_pk_bf16_f32 v123, v162, v163
v_mfma_f32_16x16x32_bf16 v[216:219], a[72:75], v[104:107], v[216:219]
v_exp_f32 v159, v91
v_mfma_f32_16x16x32_bf16 v[216:219], a[104:107], v[108:111], v[216:219]
ds_read_b128 a[56:59], v6 offset:47104
v_subrev_u32 v10, s52, v136
v_mfma_f32_16x16x32_bf16 v[220:223], a[76:79], v[104:107], v[220:223]
v_exp_f32 v160, v92
v_mfma_f32_16x16x32_bf16 v[220:223], a[108:111], v[108:111], v[220:223]
v_cmp_lt_u32 vcc, s53, v10
v_cvt_pk_bf16_f32 v124, v156, v157
v_mfma_f32_16x16x32_bf16 v[224:227], a[80:83], v[104:107], v[224:227]
v_exp_f32 v161, v93
v_mfma_f32_16x16x32_bf16 v[224:227], a[112:115], v[108:111], v[224:227]
buffer_load_dwordx4 v5, s[16:19], 0 offen offset:3072 sc1 lds
ds_read_b128 a[60:63], v6 offset:48128
v_mfma_f32_16x16x32_bf16 v[228:231], a[84:87], v[104:107], v[228:231]
s_cbranch_vccnz K2_TR14
K2_RT14:
v_mfma_f32_16x16x32_bf16 v[228:231], a[116:119], v[108:111], v[228:231]
v_cvt_pk_bf16_f32 v125, v158, v159
v_cvt_pk_bf16_f32 v126, v160, v161
v_mfma_f32_16x16x32_bf16 v[232:235], a[88:91], v[104:107], v[232:235]
v_exp_f32 v162, v94
v_mfma_f32_16x16x32_bf16 v[232:235], a[120:123], v[108:111], v[232:235]
v_xor_b32 v6, 0x10000, v6
v_mfma_f32_16x16x32_bf16 v[236:239], a[92:95], v[104:107], v[236:239]
v_exp_f32 v163, v95
v_mfma_f32_16x16x32_bf16 v[236:239], a[124:127], v[108:111], v[236:239]
v_cvt_pk_bf16_f32 v127, v162, v163
s_waitcnt vmcnt(16) lgkmcnt(0)
v_min3_u32 v24, v24, v25, v26
v_min_u32 v24, v24, v27
v_cmp_ne_u32 vcc, 0, v24
s_or_b64 vcc, vcc, s[96:97]
s_cmp_eq_u64 vcc, -1
s_cbranch_scc0 M_SPING2
M_SRETG2:
s_barrier
v_mfma_f32_16x16x32_bf16 v[140:143], v[152:155], v[120:123], v[132:135]
v_exp_f32 v156, v32
v_mfma_f32_16x16x32_bf16 v[140:143], v[152:155], v[124:127], v[140:143]
s_add_u32 m0, s50, 32768
v_add_u32 v4, -16384, v4
v_mfma_f32_16x16x32_bf16 v[64:67], a[0:3], a[160:163], v[144:147]
v_exp_f32 v157, v33
v_mfma_f32_16x16x32_bf16 v[64:67], a[4:7], a[164:167], v[64:67]
buffer_load_dwordx4 v4, s[28:31], 0 offen offset:0 sc1 lds
ds_read_b128 a[64:67], v6 offset:16384
v_mfma_f32_16x16x32_bf16 v[64:67], a[8:11], a[168:171], v[64:67]
v_exp_f32 v158, v34
v_mfma_f32_16x16x32_bf16 v[64:67], a[12:15], a[172:175], v[64:67]
buffer_load_dword a144, v23, s[32:35], 0 offen offset:0
ds_read_b128 a[68:71], v6 offset:17408
ds_read_b128 a[72:75], v6 offset:18432
v_mfma_f32_16x16x32_bf16 v[68:71], a[16:19], a[160:163], v[144:147]
v_exp_f32 v159, v35
v_mfma_f32_16x16x32_bf16 v[68:71], a[20:23], a[164:167], v[68:71]
ds_read_b128 a[76:79], v6 offset:19456
v_subrev_u32 v10, s52, v140
v_mfma_f32_16x16x32_bf16 v[68:71], a[24:27], a[168:171], v[68:71]
v_exp_f32 v160, v36
v_mfma_f32_16x16x32_bf16 v[68:71], a[28:31], a[172:175], v[68:71]
ds_read_b128 a[80:83], v6 offset:20480
v_cmp_lt_u32 vcc, s53, v10
v_mfma_f32_16x16x32_bf16 v[72:75], a[32:35], a[160:163], v[144:147]
v_exp_f32 v161, v37
v_mfma_f32_16x16x32_bf16 v[72:75], a[36:39], a[164:167], v[72:75]
buffer_load_dwordx4 v4, s[28:31], 0 offen offset:1024 sc1 lds
v_cvt_pk_bf16_f32 v96, v156, v157
v_mfma_f32_16x16x32_bf16 v[72:75], a[40:43], a[168:171], v[72:75]
s_cbranch_vccnz K2_TR15
K2_RT15:
v_mfma_f32_16x16x32_bf16 v[72:75], a[44:47], a[172:175], v[72:75]
buffer_load_dword a145, v23, s[32:35], 0 offen offset:1024
ds_read_b128 a[84:87], v6 offset:21504
ds_read_b128 a[88:91], v6 offset:22528
v_mfma_f32_16x16x32_bf16 v[76:79], a[48:51], a[160:163], v[144:147]
v_exp_f32 v162, v38
v_mfma_f32_16x16x32_bf16 v[76:79], a[52:55], a[164:167], v[76:79]
ds_read_b128 a[92:95], v6 offset:23552
v_cvt_pk_bf16_f32 v97, v158, v159
v_mfma_f32_16x16x32_bf16 v[76:79], a[56:59], a[168:171], v[76:79]
v_exp_f32 v163, v39
v_mfma_f32_16x16x32_bf16 v[76:79], a[60:63], a[172:175], v[76:79]
ds_read_b128 a[96:99], v6 offset:24576
ds_read_b128 a[100:103], v6 offset:25600
v_mfma_f32_16x16x32_bf16 v[80:83], a[0:3], a[176:179], v[148:151]
v_exp_f32 v156, v40
v_mfma_f32_16x16x32_bf16 v[80:83], a[4:7], a[180:183], v[80:83]
buffer_load_dwordx4 v4, s[28:31], 0 offen offset:2048 sc1 lds
v_cvt_pk_bf16_f32 v98, v160, v161
v_mfma_f32_16x16x32_bf16 v[80:83], a[8:11], a[184:187], v[80:83]
v_exp_f32 v157, v41
v_mfma_f32_16x16x32_bf16 v[80:83], a[12:15], a[188:191], v[80:83]
buffer_load_dword a146, v23, s[32:35], 0 offen offset:2048
ds_read_b128 a[104:107], v6 offset:26624
ds_read_b128 a[108:111], v6 offset:27648
v_mfma_f32_16x16x32_bf16 v[84:87], a[16:19], a[176:179], v[148:151]
v_exp_f32 v158, v42
v_mfma_f32_16x16x32_bf16 v[84:87], a[20:23], a[180:183], v[84:87]
ds_read_b128 a[112:115], v6 offset:28672
ds_read_b128 a[116:119], v6 offset:29696
v_mfma_f32_16x16x32_bf16 v[84:87], a[24:27], a[184:187], v[84:87]
v_exp_f32 v159, v43
v_mfma_f32_16x16x32_bf16 v[84:87], a[28:31], a[188:191], v[84:87]
ds_read_b128 a[120:123], v6 offset:30720
v_cvt_pk_bf16_f32 v99, v162, v163
v_mfma_f32_16x16x32_bf16 v[88:91], a[32:35], a[176:179], v[148:151]
v_exp_f32 v160, v44
v_mfma_f32_16x16x32_bf16 v[88:91], a[36:39], a[180:183], v[88:91]
buffer_load_dword a147, v23, s[32:35], 0 offen offset:3072
buffer_load_dwordx4 v4, s[28:31], 0 offen offset:3072 sc1 lds
ds_read_b128 a[124:127], v6 offset:31744
v_mfma_f32_16x16x32_bf16 v[88:91], a[40:43], a[184:187], v[88:91]
v_exp_f32 v161, v45
v_mfma_f32_16x16x32_bf16 v[88:91], a[44:47], a[188:191], v[88:91]
v_cvt_pk_bf16_f32 v100, v156, v157
v_cvt_pk_bf16_f32 v101, v158, v159
v_mfma_f32_16x16x32_bf16 v[92:95], a[48:51], a[176:179], v[148:151]
v_exp_f32 v162, v46
v_mfma_f32_16x16x32_bf16 v[92:95], a[52:55], a[180:183], v[92:95]
s_add_u32 m0, s50, 49152
v_add_u32 v5, 16384, v5
v_mfma_f32_16x16x32_bf16 v[92:95], a[56:59], a[184:187], v[92:95]
v_exp_f32 v163, v47
v_mfma_f32_16x16x32_bf16 v[92:95], a[60:63], a[188:191], v[92:95]
s_waitcnt lgkmcnt(0)
v_cvt_pk_bf16_f32 v102, v160, v161
v_mfma_f32_16x16x32_bf16 v[176:179], a[64:67], v[112:115], v[176:179]
v_exp_f32 v156, v48
v_mfma_f32_16x16x32_bf16 v[176:179], a[96:99], v[116:119], v[176:179]
buffer_load_dword a148, v29, s[32:35], 0 offen offset:0
ds_read_b128 a[0:3], v6 offset:0
ds_read_b128 a[4:7], v6 offset:1024
v_mfma_f32_16x16x32_bf16 v[180:183], a[68:71], v[112:115], v[180:183]
v_exp_f32 v157, v49
v_mfma_f32_16x16x32_bf16 v[180:183], a[100:103], v[116:119], v[180:183]
buffer_load_dwordx4 v5, s[16:19], 0 offen offset:0 sc1 lds
ds_read_b128 a[8:11], v6 offset:2048
v_mfma_f32_16x16x32_bf16 v[184:187], a[72:75], v[112:115], v[184:187]
v_exp_f32 v158, v50
v_mfma_f32_16x16x32_bf16 v[184:187], a[104:107], v[116:119], v[184:187]
ds_read_b128 a[12:15], v6 offset:3072
v_cvt_pk_bf16_f32 v103, v162, v163
v_mfma_f32_16x16x32_bf16 v[188:191], a[76:79], v[112:115], v[188:191]
v_exp_f32 v159, v51
v_mfma_f32_16x16x32_bf16 v[188:191], a[108:111], v[116:119], v[188:191]
ds_read_b128 a[16:19], v6 offset:4096
v_cvt_pk_bf16_f32 v104, v156, v157
v_mfma_f32_16x16x32_bf16 v[192:195], a[80:83], v[112:115], v[192:195]
v_exp_f32 v160, v52
v_mfma_f32_16x16x32_bf16 v[192:195], a[112:115], v[116:119], v[192:195]
buffer_load_dword a149, v29, s[32:35], 0 offen offset:1024
ds_read_b128 a[20:23], v6 offset:5120
ds_read_b128 a[24:27], v6 offset:6144
v_mfma_f32_16x16x32_bf16 v[196:199], a[84:87], v[112:115], v[196:199]
v_exp_f32 v161, v53
v_mfma_f32_16x16x32_bf16 v[196:199], a[116:119], v[116:119], v[196:199]
buffer_load_dwordx4 v5, s[16:19], 0 offen offset:1024 sc1 lds
ds_read_b128 a[28:31], v6 offset:7168
v_mfma_f32_16x16x32_bf16 v[200:203], a[88:91], v[112:115], v[200:203]
v_exp_f32 v162, v54
v_mfma_f32_16x16x32_bf16 v[200:203], a[120:123], v[116:119], v[200:203]
ds_read_b128 a[32:35], v6 offset:8192
v_cvt_pk_bf16_f32 v105, v158, v159
v_mfma_f32_16x16x32_bf16 v[204:207], a[92:95], v[112:115], v[204:207]
v_exp_f32 v163, v55
v_mfma_f32_16x16x32_bf16 v[204:207], a[124:127], v[116:119], v[204:207]
ds_read_b128 a[36:39], v6 offset:9216
v_cvt_pk_bf16_f32 v106, v160, v161
v_mfma_f32_16x16x32_bf16 v[128:131], v[152:155], v[96:99], v[136:139]
v_exp_f32 v156, v56
v_mfma_f32_16x16x32_bf16 v[128:131], v[152:155], v[100:103], v[128:131]
buffer_load_dword a150, v29, s[32:35], 0 offen offset:2048
ds_read_b128 a[40:43], v6 offset:10240
ds_read_b128 a[44:47], v6 offset:11264
v_mfma_f32_16x16x32_bf16 v[208:211], a[64:67], v[120:123], v[208:211]
v_exp_f32 v157, v57
v_mfma_f32_16x16x32_bf16 v[208:211], a[96:99], v[124:127], v[208:211]
buffer_load_dwordx4 v5, s[16:19], 0 offen offset:2048 sc1 lds
ds_read_b128 a[48:51], v6 offset:12288
v_mfma_f32_16x16x32_bf16 v[212:215], a[68:71], v[120:123], v[212:215]
v_exp_f32 v158, v58
v_mfma_f32_16x16x32_bf16 v[212:215], a[100:103], v[124:127], v[212:215]
ds_read_b128 a[52:55], v6 offset:13312
v_cvt_pk_bf16_f32 v107, v162, v163
v_mfma_f32_16x16x32_bf16 v[216:219], a[72:75], v[120:123], v[216:219]
v_exp_f32 v159, v59
v_mfma_f32_16x16x32_bf16 v[216:219], a[104:107], v[124:127], v[216:219]
ds_read_b128 a[56:59], v6 offset:14336
v_subrev_u32 v10, s52, v128
v_mfma_f32_16x16x32_bf16 v[220:223], a[76:79], v[120:123], v[220:223]
v_exp_f32 v160, v60
v_mfma_f32_16x16x32_bf16 v[220:223], a[108:111], v[124:127], v[220:223]
buffer_load_dword a151, v29, s[32:35], 0 offen offset:3072
v_cmp_lt_u32 vcc, s53, v10
v_cvt_pk_bf16_f32 v108, v156, v157
v_mfma_f32_16x16x32_bf16 v[224:227], a[80:83], v[120:123], v[224:227]
v_exp_f32 v161, v61
v_mfma_f32_16x16x32_bf16 v[224:227], a[112:115], v[124:127], v[224:227]
buffer_load_dwordx4 v5, s[16:19], 0 offen offset:3072 sc1 lds
ds_read_b128 a[60:63], v6 offset:15360
v_mfma_f32_16x16x32_bf16 v[228:231], a[84:87], v[120:123], v[228:231]
s_cbranch_vccnz K2_TR16
K2_RT16:
s_add_u32 s14, s14, -1
v_mfma_f32_16x16x32_bf16 v[228:231], a[116:119], v[124:127], v[228:231]
s_xor_b32 s50, s50, 0x10000
v_cvt_pk_bf16_f32 v109, v158, v159
v_mfma_f32_16x16x32_bf16 v[232:235], a[88:91], v[120:123], v[232:235]
v_exp_f32 v162, v62
v_mfma_f32_16x16x32_bf16 v[232:235], a[120:123], v[124:127], v[232:235]
v_cvt_pk_bf16_f32 v110, v160, v161
s_cmp_eq_u32 s14, 0
s_cselect_b32 s12, s15, s13
s_cselect_b32 s13, 131072, s13
v_mfma_f32_16x16x32_bf16 v[236:239], a[92:95], v[120:123], v[236:239]
v_exp_f32 v163, v63
v_mfma_f32_16x16x32_bf16 v[236:239], a[124:127], v[124:127], v[236:239]
v_cvt_pk_bf16_f32 v111, v162, v163
s_waitcnt vmcnt(16) lgkmcnt(0)
s_barrier
v_mfma_f32_16x16x32_bf16 v[132:135], v[152:155], v[104:107], v[140:143]
v_exp_f32 v156, v64
v_mfma_f32_16x16x32_bf16 v[132:135], v[152:155], v[108:111], v[132:135]
s_add_u32 m0, s50, 0
v_add_u32 v4, s12, v4
v_mfma_f32_16x16x32_bf16 v[32:35], a[0:3], a[160:163], v[144:147]
v_exp_f32 v157, v65
v_mfma_f32_16x16x32_bf16 v[32:35], a[4:7], a[164:167], v[32:35]
buffer_load_dwordx4 v4, s[28:31], 0 offen offset:0 sc1 lds
ds_read_b128 a[64:67], v6 offset:49152
v_mfma_f32_16x16x32_bf16 v[32:35], a[8:11], a[168:171], v[32:35]
v_exp_f32 v158, v66
v_mfma_f32_16x16x32_bf16 v[32:35], a[12:15], a[172:175], v[32:35]
buffer_load_dwordx4 a[224:227], v14, s[28:31], 0 offen offset:0 sc1
ds_read_b128 a[68:71], v6 offset:50176
ds_read_b128 a[72:75], v6 offset:51200
v_mfma_f32_16x16x32_bf16 v[36:39], a[16:19], a[160:163], v[144:147]
v_exp_f32 v159, v67
v_mfma_f32_16x16x32_bf16 v[36:39], a[20:23], a[164:167], v[36:39]
ds_read_b128 a[76:79], v6 offset:52224
v_subrev_u32 v10, s52, v132
v_mfma_f32_16x16x32_bf16 v[36:39], a[24:27], a[168:171], v[36:39]
v_exp_f32 v160, v68
v_mfma_f32_16x16x32_bf16 v[36:39], a[28:31], a[172:175], v[36:39]
buffer_load_dwordx4 a[228:231], v15, s[28:31], 0 offen offset:0 sc1
ds_read_b128 a[80:83], v6 offset:53248
v_cmp_lt_u32 vcc, s53, v10
v_mfma_f32_16x16x32_bf16 v[40:43], a[32:35], a[160:163], v[144:147]
v_exp_f32 v161, v69
v_mfma_f32_16x16x32_bf16 v[40:43], a[36:39], a[164:167], v[40:43]
buffer_load_dwordx4 v4, s[28:31], 0 offen offset:1024 sc1 lds
v_cvt_pk_bf16_f32 v112, v156, v157
v_mfma_f32_16x16x32_bf16 v[40:43], a[40:43], a[168:171], v[40:43]
s_cbranch_vccnz K2_TR17
K2_RT17:
v_mfma_f32_16x16x32_bf16 v[40:43], a[44:47], a[172:175], v[40:43]
ds_read_b128 a[84:87], v6 offset:54272
ds_read_b128 a[88:91], v6 offset:55296
v_mfma_f32_16x16x32_bf16 v[44:47], a[48:51], a[160:163], v[144:147]
v_exp_f32 v162, v70
v_mfma_f32_16x16x32_bf16 v[44:47], a[52:55], a[164:167], v[44:47]
buffer_load_dwordx4 a[232:235], v16, s[28:31], 0 offen offset:0 sc1
ds_read_b128 a[92:95], v6 offset:56320
v_cvt_pk_bf16_f32 v113, v158, v159
v_mfma_f32_16x16x32_bf16 v[44:47], a[56:59], a[168:171], v[44:47]
v_exp_f32 v163, v71
v_mfma_f32_16x16x32_bf16 v[44:47], a[60:63], a[172:175], v[44:47]
ds_read_b128 a[96:99], v6 offset:57344
ds_read_b128 a[100:103], v6 offset:58368
v_mfma_f32_16x16x32_bf16 v[48:51], a[0:3], a[176:179], v[148:151]
v_exp_f32 v156, v72
v_mfma_f32_16x16x32_bf16 v[48:51], a[4:7], a[180:183], v[48:51]
buffer_load_dwordx4 a[236:239], v17, s[28:31], 0 offen offset:0 sc1
buffer_load_dwordx4 v4, s[28:31], 0 offen offset:2048 sc1 lds
v_cvt_pk_bf16_f32 v114, v160, v161
v_mfma_f32_16x16x32_bf16 v[48:51], a[8:11], a[184:187], v[48:51]
v_exp_f32 v157, v73
v_mfma_f32_16x16x32_bf16 v[48:51], a[12:15], a[188:191], v[48:51]
ds_read_b128 a[104:107], v6 offset:59392
ds_read_b128 a[108:111], v6 offset:60416
v_mfma_f32_16x16x32_bf16 v[52:55], a[16:19], a[176:179], v[148:151]
v_exp_f32 v158, v74
v_mfma_f32_16x16x32_bf16 v[52:55], a[20:23], a[180:183], v[52:55]
ds_read_b128 a[112:115], v6 offset:61440
ds_read_b128 a[116:119], v6 offset:62464
v_mfma_f32_16x16x32_bf16 v[52:55], a[24:27], a[184:187], v[52:55]
v_exp_f32 v159, v75
v_cmp_gt_i32 s[60:61], 0, v7
v_mfma_f32_16x16x32_bf16 v[52:55], a[28:31], a[188:191], v[52:55]
ds_read_b128 a[120:123], v6 offset:63488
v_cvt_pk_bf16_f32 v115, v162, v163
v_cmp_gt_i32 s[62:63], 1, v7
v_mfma_f32_16x16x32_bf16 v[56:59], a[32:35], a[176:179], v[148:151]
v_exp_f32 v160, v76
v_cmp_gt_i32 s[64:65], 2, v7
v_mfma_f32_16x16x32_bf16 v[56:59], a[36:39], a[180:183], v[56:59]
buffer_load_dwordx4 v4, s[28:31], 0 offen offset:3072 sc1 lds
ds_read_b128 a[124:127], v6 offset:64512
v_cndmask_b32 v32, v32, v9, s[60:61]
v_mfma_f32_16x16x32_bf16 v[56:59], a[40:43], a[184:187], v[56:59]
v_exp_f32 v161, v77
v_cmp_gt_i32 s[66:67], 3, v7
v_mfma_f32_16x16x32_bf16 v[56:59], a[44:47], a[188:191], v[56:59]
v_cvt_pk_bf16_f32 v116, v156, v157
v_cvt_pk_bf16_f32 v117, v158, v159
v_cndmask_b32 v33, v33, v9, s[62:63]
v_mfma_f32_16x16x32_bf16 v[60:63], a[48:51], a[176:179], v[148:151]
v_exp_f32 v162, v78
v_cmp_gt_i32 s[60:61], 16, v7
v_mfma_f32_16x16x32_bf16 v[60:63], a[52:55], a[180:183], v[60:63]
s_add_u32 m0, s50, 16384
v_add_u32 v5, 16384, v5
v_mfma_f32_16x16x32_bf16 v[60:63], a[56:59], a[184:187], v[60:63]
v_exp_f32 v163, v79
v_cndmask_b32 v34, v34, v9, s[64:65]
v_mfma_f32_16x16x32_bf16 v[60:63], a[60:63], a[188:191], v[60:63]
s_waitcnt lgkmcnt(0)
v_cvt_pk_bf16_f32 v118, v160, v161
v_cmp_gt_i32 s[62:63], 17, v7
v_mfma_f32_16x16x32_bf16 v[176:179], a[64:67], v[96:99], v[176:179]
v_exp_f32 v156, v80
v_mfma_f32_16x16x32_bf16 v[176:179], a[96:99], v[100:103], v[176:179]
ds_read_b128 a[0:3], v6 offset:32768
ds_read_b128 a[4:7], v6 offset:33792
v_cndmask_b32 v35, v35, v9, s[66:67]
v_mfma_f32_16x16x32_bf16 v[180:183], a[68:71], v[96:99], v[180:183]
v_exp_f32 v157, v81
v_cmp_gt_i32 s[64:65], 18, v7
v_mfma_f32_16x16x32_bf16 v[180:183], a[100:103], v[100:103], v[180:183]
buffer_load_dwordx4 v5, s[16:19], 0 offen offset:0 sc1 lds
ds_read_b128 a[8:11], v6 offset:34816
v_cndmask_b32 v36, v36, v9, s[60:61]
v_mfma_f32_16x16x32_bf16 v[184:187], a[72:75], v[96:99], v[184:187]
v_exp_f32 v158, v82
v_mfma_f32_16x16x32_bf16 v[184:187], a[104:107], v[100:103], v[184:187]
ds_read_b128 a[12:15], v6 offset:35840
v_cvt_pk_bf16_f32 v119, v162, v163
v_cmp_gt_i32 s[66:67], 19, v7
v_mfma_f32_16x16x32_bf16 v[188:191], a[76:79], v[96:99], v[188:191]
v_exp_f32 v159, v83
v_cndmask_b32 v37, v37, v9, s[62:63]
v_mfma_f32_16x16x32_bf16 v[188:191], a[108:111], v[100:103], v[188:191]
ds_read_b128 a[16:19], v6 offset:36864
v_cvt_pk_bf16_f32 v120, v156, v157
v_mfma_f32_16x16x32_bf16 v[192:195], a[80:83], v[96:99], v[192:195]
v_exp_f32 v160, v84
v_cmp_gt_i32 s[60:61], 32, v7
v_mfma_f32_16x16x32_bf16 v[192:195], a[112:115], v[100:103], v[192:195]
ds_read_b128 a[20:23], v6 offset:37888
ds_read_b128 a[24:27], v6 offset:38912
v_cndmask_b32 v38, v38, v9, s[64:65]
v_mfma_f32_16x16x32_bf16 v[196:199], a[84:87], v[96:99], v[196:199]
v_exp_f32 v161, v85
v_cmp_gt_i32 s[62:63], 33, v7
v_mfma_f32_16x16x32_bf16 v[196:199], a[116:119], v[100:103], v[196:199]
buffer_load_dwordx4 v5, s[16:19], 0 offen offset:1024 sc1 lds
ds_read_b128 a[28:31], v6 offset:39936
v_mfma_f32_16x16x32_bf16 v[200:203], a[88:91], v[96:99], v[200:203]
v_exp_f32 v162, v86
v_cndmask_b32 v39, v39, v9, s[66:67]
v_mfma_f32_16x16x32_bf16 v[200:203], a[120:123], v[100:103], v[200:203]
ds_read_b128 a[32:35], v6 offset:40960
v_cvt_pk_bf16_f32 v121, v158, v159
v_cmp_gt_i32 s[64:65], 34, v7
v_mfma_f32_16x16x32_bf16 v[204:207], a[92:95], v[96:99], v[204:207]
v_exp_f32 v163, v87
v_cndmask_b32 v40, v40, v9, s[60:61]
v_mfma_f32_16x16x32_bf16 v[204:207], a[124:127], v[100:103], v[204:207]
ds_read_b128 a[36:39], v6 offset:41984
v_cvt_pk_bf16_f32 v122, v160, v161
v_mfma_f32_16x16x32_bf16 v[136:139], v[152:155], v[112:115], v[128:131]
v_exp_f32 v156, v88
v_cmp_gt_i32 s[66:67], 35, v7
v_mfma_f32_16x16x32_bf16 v[136:139], v[152:155], v[116:119], v[136:139]
ds_read_b128 a[40:43], v6 offset:43008
ds_read_b128 a[44:47], v6 offset:44032
v_cndmask_b32 v41, v41, v9, s[62:63]
v_mfma_f32_16x16x32_bf16 v[208:211], a[64:67], v[104:107], v[208:211]
v_exp_f32 v157, v89
v_mfma_f32_16x16x32_bf16 v[208:211], a[96:99], v[108:111], v[208:211]
buffer_load_dwordx4 v5, s[16:19], 0 offen offset:2048 sc1 lds
ds_read_b128 a[48:51], v6 offset:45056
v_cmp_gt_i32 s[60:61], 48, v7
v_mfma_f32_16x16x32_bf16 v[212:215], a[68:71], v[104:107], v[212:215]
v_exp_f32 v158, v90
v_cndmask_b32 v42, v42, v9, s[64:65]
v_mfma_f32_16x16x32_bf16 v[212:215], a[100:103], v[108:111], v[212:215]
ds_read_b128 a[52:55], v6 offset:46080
v_cvt_pk_bf16_f32 v123, v162, v163
v_cmp_gt_i32 s[62:63], 49, v7
v_mfma_f32_16x16x32_bf16 v[216:219], a[72:75], v[104:107], v[216:219]
v_exp_f32 v159, v91
v_mfma_f32_16x16x32_bf16 v[216:219], a[104:107], v[108:111], v[216:219]
ds_read_b128 a[56:59], v6 offset:47104
v_subrev_u32 v10, s52, v136
v_cndmask_b32 v43, v43, v9, s[66:67]
v_mfma_f32_16x16x32_bf16 v[220:223], a[76:79], v[104:107], v[220:223]
v_exp_f32 v160, v92
v_cmp_gt_i32 s[64:65], 50, v7
v_mfma_f32_16x16x32_bf16 v[220:223], a[108:111], v[108:111], v[220:223]
v_cmp_lt_u32 vcc, s53, v10
v_cvt_pk_bf16_f32 v124, v156, v157
v_mfma_f32_16x16x32_bf16 v[224:227], a[80:83], v[104:107], v[224:227]
v_exp_f32 v161, v93
v_cndmask_b32 v44, v44, v9, s[60:61]
v_mfma_f32_16x16x32_bf16 v[224:227], a[112:115], v[108:111], v[224:227]
buffer_load_dwordx4 v5, s[16:19], 0 offen offset:3072 sc1 lds
ds_read_b128 a[60:63], v6 offset:48128
v_cmp_gt_i32 s[66:67], 51, v7
v_mfma_f32_16x16x32_bf16 v[228:231], a[84:87], v[104:107], v[228:231]
s_cbranch_vccnz K2_TR18
K2_RT18:
v_cndmask_b32 v45, v45, v9, s[62:63]
s_nop 0
s_add_u32 s14, s14, -1
v_mfma_f32_16x16x32_bf16 v[228:231], a[116:119], v[108:111], v[228:231]
v_cvt_pk_bf16_f32 v125, v158, v159
v_cvt_pk_bf16_f32 v126, v160, v161
v_mfma_f32_16x16x32_bf16 v[232:235], a[88:91], v[104:107], v[232:235]
v_exp_f32 v162, v94
v_cndmask_b32 v46, v46, v9, s[64:65]
v_mfma_f32_16x16x32_bf16 v[232:235], a[120:123], v[108:111], v[232:235]
v_xor_b32 v6, 0x10000, v6
v_cndmask_b32 v47, v47, v9, s[66:67]
s_cmp_eq_u32 s14, 0
s_cselect_b32 s12, s15, s13
s_cselect_b32 s13, 131072, s13
v_mfma_f32_16x16x32_bf16 v[236:239], a[92:95], v[104:107], v[236:239]
v_exp_f32 v163, v95
v_mfma_f32_16x16x32_bf16 v[236:239], a[124:127], v[108:111], v[236:239]
v_cvt_pk_bf16_f32 v127, v162, v163
s_waitcnt vmcnt(16) lgkmcnt(0)
s_barrier
v_mfma_f32_16x16x32_bf16 v[140:143], v[152:155], v[120:123], v[132:135]
v_exp_f32 v156, v32
v_mfma_f32_16x16x32_bf16 v[140:143], v[152:155], v[124:127], v[140:143]
s_add_u32 m0, s50, 32768
v_add_u32 v4, s12, v4
v_exp_f32 v157, v33
buffer_load_dwordx4 v4, s[28:31], 0 offen offset:0 sc1 lds
ds_read_b128 a[64:67], v6 offset:16384
v_exp_f32 v158, v34
buffer_load_dwordx4 a[240:243], v14, s[28:31], 0 offen offset:1024 sc1
ds_read_b128 a[68:71], v6 offset:17408
ds_read_b128 a[72:75], v6 offset:18432
v_exp_f32 v159, v35
ds_read_b128 a[76:79], v6 offset:19456
v_subrev_u32 v10, s52, v140
v_exp_f32 v160, v36
ds_read_b128 a[80:83], v6 offset:20480
v_cmp_lt_u32 vcc, s53, v10
v_exp_f32 v161, v37
buffer_load_dwordx4 v4, s[28:31], 0 offen offset:1024 sc1 lds
v_cvt_pk_bf16_f32 v96, v156, v157
s_cbranch_vccnz K2_TR19
K2_RT19:
buffer_load_dwordx4 a[244:247], v15, s[28:31], 0 offen offset:1024 sc1
ds_read_b128 a[84:87], v6 offset:21504
ds_read_b128 a[88:91], v6 offset:22528
v_exp_f32 v162, v38
ds_read_b128 a[92:95], v6 offset:23552
v_cvt_pk_bf16_f32 v97, v158, v159
v_exp_f32 v163, v39
ds_read_b128 a[96:99], v6 offset:24576
ds_read_b128 a[100:103], v6 offset:25600
v_mfma_f32_16x16x32_bf16 v[80:83], a[0:3], a[176:179], v[148:151]
v_exp_f32 v156, v40
v_mfma_f32_16x16x32_bf16 v[80:83], a[4:7], a[180:183], v[80:83]
buffer_load_dwordx4 v4, s[28:31], 0 offen offset:2048 sc1 lds
v_cvt_pk_bf16_f32 v98, v160, v161
v_mfma_f32_16x16x32_bf16 v[80:83], a[8:11], a[184:187], v[80:83]
v_exp_f32 v157, v41
v_mfma_f32_16x16x32_bf16 v[80:83], a[12:15], a[188:191], v[80:83]
ds_read_b128 a[104:107], v6 offset:26624
ds_read_b128 a[108:111], v6 offset:27648
v_mfma_f32_16x16x32_bf16 v[84:87], a[16:19], a[176:179], v[148:151]
v_exp_f32 v158, v42
v_mfma_f32_16x16x32_bf16 v[84:87], a[20:23], a[180:183], v[84:87]
buffer_load_dwordx4 a[248:251], v16, s[28:31], 0 offen offset:1024 sc1
ds_read_b128 a[112:115], v6 offset:28672
ds_read_b128 a[116:119], v6 offset:29696
v_mfma_f32_16x16x32_bf16 v[84:87], a[24:27], a[184:187], v[84:87]
v_exp_f32 v159, v43
v_mfma_f32_16x16x32_bf16 v[84:87], a[28:31], a[188:191], v[84:87]
ds_read_b128 a[120:123], v6 offset:30720
v_cvt_pk_bf16_f32 v99, v162, v163
v_mfma_f32_16x16x32_bf16 v[88:91], a[32:35], a[176:179], v[148:151]
v_exp_f32 v160, v44
v_mfma_f32_16x16x32_bf16 v[88:91], a[36:39], a[180:183], v[88:91]
buffer_load_dwordx4 v4, s[28:31], 0 offen offset:3072 sc1 lds
ds_read_b128 a[124:127], v6 offset:31744
v_mfma_f32_16x16x32_bf16 v[88:91], a[40:43], a[184:187], v[88:91]
v_exp_f32 v161, v45
v_mfma_f32_16x16x32_bf16 v[88:91], a[44:47], a[188:191], v[88:91]
v_cvt_pk_bf16_f32 v100, v156, v157
v_cvt_pk_bf16_f32 v101, v158, v159
v_mfma_f32_16x16x32_bf16 v[92:95], a[48:51], a[176:179], v[148:151]
v_exp_f32 v162, v46
v_mfma_f32_16x16x32_bf16 v[92:95], a[52:55], a[180:183], v[92:95]
buffer_load_dwordx4 a[252:255], v17, s[28:31], 0 offen offset:1024 sc1
s_add_u32 m0, s50, 49152
v_add_u32 v5, s51, v5
v_mfma_f32_16x16x32_bf16 v[92:95], a[56:59], a[184:187], v[92:95]
v_exp_f32 v163, v47
v_mfma_f32_16x16x32_bf16 v[92:95], a[60:63], a[188:191], v[92:95]
s_waitcnt lgkmcnt(0)
v_cvt_pk_bf16_f32 v102, v160, v161
v_mfma_f32_16x16x32_bf16 v[176:179], a[64:67], v[112:115], v[176:179]
v_exp_f32 v156, v48
v_mfma_f32_16x16x32_bf16 v[176:179], a[96:99], v[116:119], v[176:179]
ds_read_b128 a[0:3], v6 offset:0
ds_read_b128 a[4:7], v6 offset:1024
v_mfma_f32_16x16x32_bf16 v[180:183], a[68:71], v[112:115], v[180:183]
v_exp_f32 v157, v49
v_mfma_f32_16x16x32_bf16 v[180:183], a[100:103], v[116:119], v[180:183]
buffer_load_dwordx4 v5, s[16:19], 0 offen offset:0 sc1 lds
ds_read_b128 a[8:11], v6 offset:2048
v_mfma_f32_16x16x32_bf16 v[184:187], a[72:75], v[112:115], v[184:187]
v_exp_f32 v158, v50
v_mfma_f32_16x16x32_bf16 v[184:187], a[104:107], v[116:119], v[184:187]
ds_read_b128 a[12:15], v6 offset:3072
v_cvt_pk_bf16_f32 v103, v162, v163
v_mfma_f32_16x16x32_bf16 v[188:191], a[76:79], v[112:115], v[188:191]
v_exp_f32 v159, v51
v_cmp_gt_i32 s[60:61], 0, v7
v_cmp_gt_i32 s[62:63], 1, v7
v_mfma_f32_16x16x32_bf16 v[188:191], a[108:111], v[116:119], v[188:191]
ds_read_b128 a[16:19], v6 offset:4096
v_cvt_pk_bf16_f32 v104, v156, v157
v_cmp_gt_i32 s[64:65], 2, v7
v_cndmask_b32 v80, v80, v9, s[60:61]
v_mfma_f32_16x16x32_bf16 v[192:195], a[80:83], v[112:115], v[192:195]
v_exp_f32 v160, v52
v_cmp_gt_i32 s[66:67], 3, v7
v_mfma_f32_16x16x32_bf16 v[192:195], a[112:115], v[116:119], v[192:195]
ds_read_b128 a[20:23], v6 offset:5120
ds_read_b128 a[24:27], v6 offset:6144
v_cndmask_b32 v81, v81, v9, s[62:63]
v_mfma_f32_16x16x32_bf16 v[196:199], a[84:87], v[112:115], v[196:199]
v_exp_f32 v161, v53
v_cmp_gt_i32 s[60:61], 16, v7
v_mfma_f32_16x16x32_bf16 v[196:199], a[116:119], v[116:119], v[196:199]
buffer_load_dwordx4 v5, s[16:19], 0 offen offset:1024 sc1 lds
ds_read_b128 a[28:31], v6 offset:7168
v_cndmask_b32 v82, v82, v9, s[64:65]
v_mfma_f32_16x16x32_bf16 v[200:203], a[88:91], v[112:115], v[200:203]
v_exp_f32 v162, v54
v_cmp_gt_i32 s[62:63], 17, v7
v_cndmask_b32 v83, v83, v9, s[66:67]
v_mfma_f32_16x16x32_bf16 v[200:203], a[120:123], v[116:119], v[200:203]
ds_read_b128 a[32:35], v6 offset:8192
v_cvt_pk_bf16_f32 v105, v158, v159
v_cmp_gt_i32 s[64:65], 18, v7
v_mfma_f32_16x16x32_bf16 v[204:207], a[92:95], v[112:115], v[204:207]
v_exp_f32 v163, v55
v_cndmask_b32 v84, v84, v9, s[60:61]
v_mfma_f32_16x16x32_bf16 v[204:207], a[124:127], v[116:119], v[204:207]
ds_read_b128 a[36:39], v6 offset:9216
v_cvt_pk_bf16_f32 v106, v160, v161
v_cmp_gt_i32 s[66:67], 19, v7
v_mfma_f32_16x16x32_bf16 v[128:131], v[152:155], v[96:99], v[136:139]
v_exp_f32 v156, v56
v_cndmask_b32 v85, v85, v9, s[62:63]
v_mfma_f32_16x16x32_bf16 v[128:131], v[152:155], v[100:103], v[128:131]
ds_read_b128 a[40:43], v6 offset:10240
ds_read_b128 a[44:47], v6 offset:11264
v_cmp_gt_i32 s[60:61], 32, v7
v_mfma_f32_16x16x32_bf16 v[208:211], a[64:67], v[120:123], v[208:211]
v_exp_f32 v157, v57
v_cndmask_b32 v86, v86, v9, s[64:65]
v_mfma_f32_16x16x32_bf16 v[208:211], a[96:99], v[124:127], v[208:211]
buffer_load_dwordx4 v5, s[16:19], 0 offen offset:2048 sc1 lds
ds_read_b128 a[48:51], v6 offset:12288
v_cmp_gt_i32 s[62:63], 33, v7
v_cndmask_b32 v87, v87, v9, s[66:67]
v_mfma_f32_16x16x32_bf16 v[212:215], a[68:71], v[120:123], v[212:215]
v_exp_f32 v158, v58
v_cmp_gt_i32 s[64:65], 34, v7
v_mfma_f32_16x16x32_bf16 v[212:215], a[100:103], v[124:127], v[212:215]
ds_read_b128 a[52:55], v6 offset:13312
v_cvt_pk_bf16_f32 v107, v162, v163
v_cndmask_b32 v88, v88, v9, s[60:61]
v_mfma_f32_16x16x32_bf16 v[216:219], a[72:75], v[120:123], v[216:219]
v_exp_f32 v159, v59
v_cmp_gt_i32 s[66:67], 35, v7
v_mfma_f32_16x16x32_bf16 v[216:219], a[104:107], v[124:127], v[216:219]
ds_read_b128 a[56:59], v6 offset:14336
v_subrev_u32 v10, s52, v128
v_cndmask_b32 v89, v89, v9, s[62:63]
v_mfma_f32_16x16x32_bf16 v[220:223], a[76:79], v[120:123], v[220:223]
v_exp_f32 v160, v60
v_cmp_gt_i32 s[60:61], 48, v7
v_mfma_f32_16x16x32_bf16 v[220:223], a[108:111], v[124:127], v[220:223]
v_cmp_lt_u32 vcc, s53, v10
v_cvt_pk_bf16_f32 v108, v156, v157
v_cndmask_b32 v90, v90, v9, s[64:65]
v_mfma_f32_16x16x32_bf16 v[224:227], a[80:83], v[120:123], v[224:227]
v_exp_f32 v161, v61
v_cmp_gt_i32 s[62:63], 49, v7
v_cndmask_b32 v91, v91, v9, s[66:67]
v_mfma_f32_16x16x32_bf16 v[224:227], a[112:115], v[124:127], v[224:227]
buffer_load_dwordx4 v5, s[16:19], 0 offen offset:3072 sc1 lds
ds_read_b128 a[60:63], v6 offset:15360
v_cmp_gt_i32 s[64:65], 50, v7
v_mfma_f32_16x16x32_bf16 v[228:231], a[84:87], v[120:123], v[228:231]
s_cbranch_vccnz K2_TR20
K2_RT20:
v_cndmask_b32 v92, v92, v9, s[60:61]
v_cmp_gt_i32 s[66:67], 51, v7
s_add_u32 s14, s14, -1
v_mfma_f32_16x16x32_bf16 v[228:231], a[116:119], v[124:127], v[228:231]
s_xor_b32 s50, s50, 0x10000
v_cvt_pk_bf16_f32 v109, v158, v159
v_cndmask_b32 v93, v93, v9, s[62:63]
v_mfma_f32_16x16x32_bf16 v[232:235], a[88:91], v[120:123], v[232:235]
v_exp_f32 v162, v62
s_nop 0
v_mfma_f32_16x16x32_bf16 v[232:235], a[120:123], v[124:127], v[232:235]
v_cvt_pk_bf16_f32 v110, v160, v161
v_cndmask_b32 v94, v94, v9, s[64:65]
v_cndmask_b32 v95, v95, v9, s[66:67]
s_cmp_eq_u32 s14, 0
s_cselect_b32 s12, s15, s13
s_cselect_b32 s13, 131072, s13
v_mfma_f32_16x16x32_bf16 v[236:239], a[92:95], v[120:123], v[236:239]
v_exp_f32 v163, v63
v_mfma_f32_16x16x32_bf16 v[236:239], a[124:127], v[124:127], v[236:239]
v_cvt_pk_bf16_f32 v111, v162, v163
s_waitcnt vmcnt(16) lgkmcnt(0)
s_barrier
v_mfma_f32_16x16x32_bf16 v[132:135], v[152:155], v[104:107], v[140:143]
ds_read_b128 a[64:67], v6 offset:49152
ds_read_b128 a[68:71], v6 offset:50176
v_mfma_f32_16x16x32_bf16 v[132:135], v[152:155], v[108:111], v[132:135]
s_add_u32 m0, s50, 0
v_add_u32 v4, s12, v4
ds_read_b128 a[72:75], v6 offset:51200
ds_read_b128 a[76:79], v6 offset:52224
buffer_load_dwordx4 v4, s[28:31], 0 offen offset:0 sc1 lds
ds_read_b128 a[80:83], v6 offset:53248
ds_read_b128 a[84:87], v6 offset:54272
ds_read_b128 a[88:91], v6 offset:55296
ds_read_b128 a[92:95], v6 offset:56320
ds_read_b128 a[96:99], v6 offset:57344
ds_read_b128 a[100:103], v6 offset:58368
ds_read_b128 a[104:107], v6 offset:59392
ds_read_b128 a[108:111], v6 offset:60416
v_subrev_u32 v10, s52, v132
ds_read_b128 a[112:115], v6 offset:61440
ds_read_b128 a[116:119], v6 offset:62464
ds_read_b128 a[120:123], v6 offset:63488
v_cmp_lt_u32 vcc, s53, v10
ds_read_b128 a[124:127], v6 offset:64512
v_add_u32 v5, -16384, v5
buffer_load_dwordx4 v4, s[28:31], 0 offen offset:1024 sc1 lds
s_cbranch_vccnz K2_TR21
K2_RT21:
buffer_load_dwordx4 a[160:163], v14, s[28:31], 0 offen offset:2048 sc1
v_mfma_f32_16x16x32_bf16 v[48:51], a[0:3], a[208:211], 0
v_exp_f32 v156, v80
v_mfma_f32_16x16x32_bf16 v[48:51], a[4:7], a[212:215], v[48:51]
buffer_load_dwordx4 a[164:167], v15, s[28:31], 0 offen offset:2048 sc1
buffer_load_dwordx4 v4, s[28:31], 0 offen offset:2048 sc1 lds
v_mfma_f32_16x16x32_bf16 v[48:51], a[8:11], a[216:219], v[48:51]
v_exp_f32 v157, v81
v_mfma_f32_16x16x32_bf16 v[48:51], a[12:15], a[220:223], v[48:51]
v_cvt_pk_bf16_f32 v120, v156, v157
v_mfma_f32_16x16x32_bf16 v[52:55], a[16:19], a[208:211], 0
v_exp_f32 v158, v82
v_mfma_f32_16x16x32_bf16 v[52:55], a[20:23], a[212:215], v[52:55]
v_mfma_f32_16x16x32_bf16 v[52:55], a[24:27], a[216:219], v[52:55]
v_exp_f32 v159, v83
v_mfma_f32_16x16x32_bf16 v[52:55], a[28:31], a[220:223], v[52:55]
v_cvt_pk_bf16_f32 v121, v158, v159
v_mfma_f32_16x16x32_bf16 v[56:59], a[32:35], a[208:211], 0
v_exp_f32 v160, v84
v_mfma_f32_16x16x32_bf16 v[56:59], a[36:39], a[212:215], v[56:59]
buffer_load_dwordx4 a[168:171], v16, s[28:31], 0 offen offset:2048 sc1
buffer_load_dwordx4 v4, s[28:31], 0 offen offset:3072 sc1 lds
v_mfma_f32_16x16x32_bf16 v[56:59], a[40:43], a[216:219], v[56:59]
v_exp_f32 v161, v85
v_mfma_f32_16x16x32_bf16 v[56:59], a[44:47], a[220:223], v[56:59]
s_add_u32 m0, s50, 16384
v_cvt_pk_bf16_f32 v122, v160, v161
v_mfma_f32_16x16x32_bf16 v[60:63], a[48:51], a[208:211], 0
v_exp_f32 v162, v86
v_mfma_f32_16x16x32_bf16 v[60:63], a[52:55], a[212:215], v[60:63]
v_mfma_f32_16x16x32_bf16 v[60:63], a[56:59], a[216:219], v[60:63]
v_exp_f32 v163, v87
v_mfma_f32_16x16x32_bf16 v[60:63], a[60:63], a[220:223], v[60:63]
buffer_load_dwordx4 a[172:175], v17, s[28:31], 0 offen offset:2048 sc1
s_waitcnt lgkmcnt(0)
v_cvt_pk_bf16_f32 v123, v162, v163
v_mfma_f32_16x16x32_bf16 v[176:179], a[64:67], v[96:99], v[176:179]
v_exp_f32 v156, v88
v_mfma_f32_16x16x32_bf16 v[176:179], a[96:99], v[100:103], v[176:179]
ds_read_b128 a[0:3], v6 offset:32768
ds_read_b128 a[4:7], v6 offset:33792
v_mfma_f32_16x16x32_bf16 v[180:183], a[68:71], v[96:99], v[180:183]
v_exp_f32 v157, v89
v_mfma_f32_16x16x32_bf16 v[180:183], a[100:103], v[100:103], v[180:183]
buffer_load_dwordx4 v5, s[16:19], 0 offen offset:0 sc1 lds
ds_read_b128 a[8:11], v6 offset:34816
v_mfma_f32_16x16x32_bf16 v[184:187], a[72:75], v[96:99], v[184:187]
v_exp_f32 v158, v90
v_mfma_f32_16x16x32_bf16 v[184:187], a[104:107], v[100:103], v[184:187]
buffer_load_dwordx4 a[176:179], v14, s[28:31], 0 offen offset:3072 sc1
ds_read_b128 a[12:15], v6 offset:35840
ds_read_b128 a[16:19], v6 offset:36864
v_mfma_f32_16x16x32_bf16 v[188:191], a[76:79], v[96:99], v[188:191]
v_exp_f32 v159, v91
v_cmp_gt_i32 s[60:61], 0, v7
v_mfma_f32_16x16x32_bf16 v[188:191], a[108:111], v[100:103], v[188:191]
ds_read_b128 a[20:23], v6 offset:37888
v_cvt_pk_bf16_f32 v124, v156, v157
v_cmp_gt_i32 s[62:63], 1, v7
v_mfma_f32_16x16x32_bf16 v[192:195], a[80:83], v[96:99], v[192:195]
v_exp_f32 v160, v92
v_mfma_f32_16x16x32_bf16 v[192:195], a[112:115], v[100:103], v[192:195]
ds_read_b128 a[24:27], v6 offset:38912
ds_read_b128 a[28:31], v6 offset:39936
v_cmp_gt_i32 s[64:65], 2, v7
v_mfma_f32_16x16x32_bf16 v[196:199], a[84:87], v[96:99], v[196:199]
v_exp_f32 v161, v93
v_mfma_f32_16x16x32_bf16 v[196:199], a[116:119], v[100:103], v[196:199]
buffer_load_dwordx4 v5, s[16:19], 0 offen offset:1024 sc1 lds
v_cvt_pk_bf16_f32 v125, v158, v159
v_mfma_f32_16x16x32_bf16 v[200:203], a[88:91], v[96:99], v[200:203]
v_exp_f32 v162, v94
v_cndmask_b32 v48, v48, v9, s[60:61]
v_mfma_f32_16x16x32_bf16 v[200:203], a[120:123], v[100:103], v[200:203]
buffer_load_dwordx4 a[180:183], v15, s[28:31], 0 offen offset:3072 sc1
ds_read_b128 a[32:35], v6 offset:40960
ds_read_b128 a[36:39], v6 offset:41984
v_mfma_f32_16x16x32_bf16 v[204:207], a[92:95], v[96:99], v[204:207]
v_exp_f32 v163, v95
v_mfma_f32_16x16x32_bf16 v[204:207], a[124:127], v[100:103], v[204:207]
ds_read_b128 a[40:43], v6 offset:43008
v_cvt_pk_bf16_f32 v126, v160, v161
ds_read_b128 a[44:47], v6 offset:44032
ds_read_b128 a[48:51], v6 offset:45056
v_cmp_gt_i32 s[66:67], 3, v7
ds_read_b128 a[52:55], v6 offset:46080
v_cvt_pk_bf16_f32 v127, v162, v163
v_mfma_f32_16x16x32_bf16 v[208:211], a[64:67], v[104:107], v[208:211]
ds_read_b128 a[56:59], v6 offset:47104
ds_read_b128 a[60:63], v6 offset:48128
v_mfma_f32_16x16x32_bf16 v[208:211], a[96:99], v[108:111], v[208:211]
buffer_load_dwordx4 a[184:187], v16, s[28:31], 0 offen offset:3072 sc1
buffer_load_dwordx4 v5, s[16:19], 0 offen offset:2048 sc1 lds
v_cndmask_b32 v49, v49, v9, s[62:63]
v_cmp_gt_i32 s[60:61], 16, v7
v_mfma_f32_16x16x32_bf16 v[212:215], a[68:71], v[104:107], v[212:215]
v_cndmask_b32 v50, v50, v9, s[64:65]
v_cmp_gt_i32 s[62:63], 17, v7
v_mfma_f32_16x16x32_bf16 v[212:215], a[100:103], v[108:111], v[212:215]
v_cndmask_b32 v51, v51, v9, s[66:67]
v_cmp_gt_i32 s[64:65], 18, v7
v_mfma_f32_16x16x32_bf16 v[216:219], a[72:75], v[104:107], v[216:219]
v_cndmask_b32 v52, v52, v9, s[60:61]
v_cmp_gt_i32 s[66:67], 19, v7
v_cndmask_b32 v53, v53, v9, s[62:63]
v_mfma_f32_16x16x32_bf16 v[216:219], a[104:107], v[108:111], v[216:219]
v_cmp_gt_i32 s[60:61], 32, v7
v_cndmask_b32 v54, v54, v9, s[64:65]
v_mfma_f32_16x16x32_bf16 v[220:223], a[76:79], v[104:107], v[220:223]
v_cmp_gt_i32 s[62:63], 33, v7
v_cndmask_b32 v55, v55, v9, s[66:67]
v_mfma_f32_16x16x32_bf16 v[220:223], a[108:111], v[108:111], v[220:223]
buffer_load_dwordx4 a[188:191], v17, s[28:31], 0 offen offset:3072 sc1
v_cmp_gt_i32 s[64:65], 34, v7
v_cndmask_b32 v56, v56, v9, s[60:61]
v_mfma_f32_16x16x32_bf16 v[224:227], a[80:83], v[104:107], v[224:227]
v_cmp_gt_i32 s[66:67], 35, v7
v_cndmask_b32 v57, v57, v9, s[62:63]
v_cmp_gt_i32 s[60:61], 48, v7
v_mfma_f32_16x16x32_bf16 v[224:227], a[112:115], v[108:111], v[224:227]
buffer_load_dwordx4 v5, s[16:19], 0 offen offset:3072 sc1 lds
v_cndmask_b32 v58, v58, v9, s[64:65]
v_mfma_f32_16x16x32_bf16 v[228:231], a[84:87], v[104:107], v[228:231]
v_cmp_gt_i32 s[62:63], 49, v7
v_cndmask_b32 v59, v59, v9, s[66:67]
s_add_u32 s14, s14, -1
v_mfma_f32_16x16x32_bf16 v[228:231], a[116:119], v[108:111], v[228:231]
v_cmp_gt_i32 s[64:65], 50, v7
v_cndmask_b32 v60, v60, v9, s[60:61]
v_cmp_gt_i32 s[66:67], 51, v7
v_mfma_f32_16x16x32_bf16 v[232:235], a[88:91], v[104:107], v[232:235]
v_xor_b32 v6, 0x10000, v6
v_cndmask_b32 v61, v61, v9, s[62:63]
v_mfma_f32_16x16x32_bf16 v[232:235], a[120:123], v[108:111], v[232:235]
s_nop 0
v_cndmask_b32 v62, v62, v9, s[64:65]
s_cmp_eq_u32 s14, 0
s_cselect_b32 s12, s15, s13
s_cselect_b32 s13, 131072, s13
v_mfma_f32_16x16x32_bf16 v[236:239], a[92:95], v[104:107], v[236:239]
v_cndmask_b32 v63, v63, v9, s[66:67]
v_mfma_f32_16x16x32_bf16 v[236:239], a[124:127], v[108:111], v[236:239]
s_waitcnt vmcnt(16) lgkmcnt(0)
s_barrier
v_mfma_f32_16x16x32_bf16 v[140:143], v[152:155], v[120:123], v[132:135]
ds_read_b128 a[64:67], v6 offset:16384
ds_read_b128 a[68:71], v6 offset:17408
v_mfma_f32_16x16x32_bf16 v[140:143], v[152:155], v[124:127], v[140:143]
s_add_u32 m0, s50, 32768
v_add_u32 v4, s12, v4
v_mfma_f32_16x16x32_bf16 v[64:67], a[0:3], a[192:195], 0
ds_read_b128 a[72:75], v6 offset:18432
ds_read_b128 a[76:79], v6 offset:19456
v_mfma_f32_16x16x32_bf16 v[64:67], a[4:7], a[196:199], v[64:67]
buffer_load_dwordx4 v4, s[28:31], 0 offen offset:0 sc1 lds
ds_read_b128 a[80:83], v6 offset:20480
v_mfma_f32_16x16x32_bf16 v[64:67], a[8:11], a[200:203], v[64:67]
ds_read_b128 a[84:87], v6 offset:21504
ds_read_b128 a[88:91], v6 offset:22528
v_mfma_f32_16x16x32_bf16 v[64:67], a[12:15], a[204:207], v[64:67]
ds_read_b128 a[92:95], v6 offset:23552
ds_read_b128 a[96:99], v6 offset:24576
v_mfma_f32_16x16x32_bf16 v[68:71], a[16:19], a[192:195], 0
ds_read_b128 a[100:103], v6 offset:25600
ds_read_b128 a[104:107], v6 offset:26624
v_mfma_f32_16x16x32_bf16 v[68:71], a[20:23], a[196:199], v[68:71]
ds_read_b128 a[108:111], v6 offset:27648
v_subrev_u32 v10, s52, v140
v_mfma_f32_16x16x32_bf16 v[68:71], a[24:27], a[200:203], v[68:71]
ds_read_b128 a[112:115], v6 offset:28672
ds_read_b128 a[116:119], v6 offset:29696
v_mfma_f32_16x16x32_bf16 v[68:71], a[28:31], a[204:207], v[68:71]
ds_read_b128 a[120:123], v6 offset:30720
v_cmp_lt_u32 vcc, s53, v10
v_mfma_f32_16x16x32_bf16 v[72:75], a[32:35], a[192:195], 0
ds_read_b128 a[124:127], v6 offset:31744
v_add_u32 v5, -16384, v5
v_mfma_f32_16x16x32_bf16 v[72:75], a[36:39], a[196:199], v[72:75]
buffer_load_dwordx4 v4, s[28:31], 0 offen offset:1024 sc1 lds
v_mfma_f32_16x16x32_bf16 v[72:75], a[40:43], a[200:203], v[72:75]
s_cbranch_vccnz K2_TR22
K2_RT22:
v_mfma_f32_16x16x32_bf16 v[72:75], a[44:47], a[204:207], v[72:75]
v_mfma_f32_16x16x32_bf16 v[76:79], a[48:51], a[192:195], 0
v_rcp_f32 v164, v128
s_nop 0
v_mul_f32 v176, v176, v164
v_mul_f32 v177, v177, v164
v_mfma_f32_16x16x32_bf16 v[76:79], a[52:55], a[196:199], v[76:79]
v_mul_f32 v178, v178, v164
v_mul_f32 v179, v179, v164
v_mul_f32 v180, v180, v164
v_mul_f32 v181, v181, v164
v_mul_f32 v182, v182, v164
v_mfma_f32_16x16x32_bf16 v[76:79], a[56:59], a[200:203], v[76:79]
v_mul_f32 v183, v183, v164
v_cvt_pk_bf16_f32 v168, v176, v177
v_cvt_pk_bf16_f32 v169, v178, v179
v_cvt_pk_bf16_f32 v170, v180, v181
v_mfma_f32_16x16x32_bf16 v[76:79], a[60:63], a[204:207], v[76:79]
v_cvt_pk_bf16_f32 v171, v182, v183
buffer_store_dwordx4 v[168:171], v11, s[28:31], s58 offen offset:0 sc1
v_mov_b32 v176, 0
v_mov_b32 v177, 0
v_mov_b32 v178, 0
v_mfma_f32_16x16x32_bf16 v[80:83], a[0:3], a[208:211], 0
v_exp_f32 v156, v48
v_mov_b32 v179, 0
v_mov_b32 v180, 0
v_mfma_f32_16x16x32_bf16 v[80:83], a[4:7], a[212:215], v[80:83]
buffer_load_dwordx4 v4, s[28:31], 0 offen offset:2048 sc1 lds
v_mov_b32 v181, 0
v_mov_b32 v182, 0
v_mov_b32 v183, 0
v_mfma_f32_16x16x32_bf16 v[80:83], a[8:11], a[216:219], v[80:83]
v_exp_f32 v157, v49
v_mul_f32 v184, v184, v164
v_mul_f32 v185, v185, v164
v_mul_f32 v186, v186, v164
v_mfma_f32_16x16x32_bf16 v[80:83], a[12:15], a[220:223], v[80:83]
v_cvt_pk_bf16_f32 v104, v156, v157
v_mul_f32 v187, v187, v164
v_mul_f32 v188, v188, v164
v_mul_f32 v189, v189, v164
v_mfma_f32_16x16x32_bf16 v[84:87], a[16:19], a[208:211], 0
v_exp_f32 v158, v50
v_mul_f32 v190, v190, v164
v_mul_f32 v191, v191, v164
v_mfma_f32_16x16x32_bf16 v[84:87], a[20:23], a[212:215], v[84:87]
v_cvt_pk_bf16_f32 v172, v184, v185
v_cvt_pk_bf16_f32 v173, v186, v187
v_cvt_pk_bf16_f32 v174, v188, v189
v_cvt_pk_bf16_f32 v175, v190, v191
buffer_store_dwordx4 v[172:175], v11, s[28:31], s58 offen offset:1024 sc1
v_mfma_f32_16x16x32_bf16 v[84:87], a[24:27], a[216:219], v[84:87]
v_exp_f32 v159, v51
v_cmp_gt_i32 s[60:61], 0, v7
v_mov_b32 v184, 0
v_mfma_f32_16x16x32_bf16 v[84:87], a[28:31], a[220:223], v[84:87]
v_cvt_pk_bf16_f32 v105, v158, v159
v_cmp_gt_i32 s[62:63], 1, v7
v_cmp_gt_i32 s[64:65], 2, v7
v_mov_b32 v185, 0
v_mfma_f32_16x16x32_bf16 v[88:91], a[32:35], a[208:211], 0
v_exp_f32 v160, v52
v_mov_b32 v186, 0
v_mov_b32 v187, 0
v_mov_b32 v188, 0
v_mfma_f32_16x16x32_bf16 v[88:91], a[36:39], a[212:215], v[88:91]
buffer_load_dwordx4 v4, s[28:31], 0 offen offset:3072 sc1 lds
v_cndmask_b32 v64, v64, v9, s[60:61]
v_mov_b32 v189, 0
v_mov_b32 v190, 0
v_mfma_f32_16x16x32_bf16 v[88:91], a[40:43], a[216:219], v[88:91]
v_exp_f32 v161, v53
v_mov_b32 v191, 0
v_mul_f32 v192, v192, v164
v_mfma_f32_16x16x32_bf16 v[88:91], a[44:47], a[220:223], v[88:91]
s_add_u32 m0, s50, 49152
v_cvt_pk_bf16_f32 v106, v160, v161
v_mul_f32 v193, v193, v164
v_mul_f32 v194, v194, v164
v_mul_f32 v195, v195, v164
v_mfma_f32_16x16x32_bf16 v[92:95], a[48:51], a[208:211], 0
v_exp_f32 v162, v54
v_mul_f32 v196, v196, v164
v_mul_f32 v197, v197, v164
v_mfma_f32_16x16x32_bf16 v[92:95], a[52:55], a[212:215], v[92:95]
v_cmp_gt_i32 s[66:67], 3, v7
v_cndmask_b32 v65, v65, v9, s[62:63]
v_mul_f32 v198, v198, v164
v_mul_f32 v199, v199, v164
v_mfma_f32_16x16x32_bf16 v[92:95], a[56:59], a[216:219], v[92:95]
v_exp_f32 v163, v55
v_cvt_pk_bf16_f32 v168, v192, v193
v_cvt_pk_bf16_f32 v169, v194, v195
v_cvt_pk_bf16_f32 v170, v196, v197
v_mfma_f32_16x16x32_bf16 v[92:95], a[60:63], a[220:223], v[92:95]
s_waitcnt lgkmcnt(0)
v_cvt_pk_bf16_f32 v107, v162, v163
v_cvt_pk_bf16_f32 v171, v198, v199
buffer_store_dwordx4 v[168:171], v11, s[28:31], s58 offen offset:2048 sc1
v_exp_f32 v156, v56
v_cmp_gt_i32 s[60:61], 16, v7
v_mov_b32 v192, 0
ds_read_b128 a[0:3], v6 offset:0
ds_read_b128 a[4:7], v6 offset:1024
v_mov_b32 v193, 0
v_mov_b32 v194, 0
v_exp_f32 v157, v57
v_mov_b32 v195, 0
v_mov_b32 v196, 0
v_mov_b32 v197, 0
buffer_load_dwordx4 v5, s[16:19], 0 offen offset:0 sc1 lds
ds_read_b128 a[8:11], v6 offset:2048
v_mov_b32 v198, 0
v_mov_b32 v199, 0
v_exp_f32 v158, v58
v_mul_f32 v200, v200, v164
v_mul_f32 v201, v201, v164
ds_read_b128 a[12:15], v6 offset:3072
ds_read_b128 a[16:19], v6 offset:4096
v_mul_f32 v202, v202, v164
v_mul_f32 v203, v203, v164
v_mul_f32 v204, v204, v164
v_exp_f32 v159, v59
v_mul_f32 v205, v205, v164
v_mul_f32 v206, v206, v164
ds_read_b128 a[20:23], v6 offset:5120
v_cvt_pk_bf16_f32 v108, v156, v157
v_mul_f32 v207, v207, v164
v_cvt_pk_bf16_f32 v172, v200, v201
v_exp_f32 v160, v60
v_cvt_pk_bf16_f32 v173, v202, v203
v_cvt_pk_bf16_f32 v174, v204, v205
v_cvt_pk_bf16_f32 v175, v206, v207
ds_read_b128 a[24:27], v6 offset:6144
ds_read_b128 a[28:31], v6 offset:7168
buffer_store_dwordx4 v[172:175], v11, s[28:31], s58 offen offset:3072 sc1
v_mov_b32 v200, 0
v_exp_f32 v161, v61
v_mov_b32 v201, 0
v_mov_b32 v202, 0
buffer_load_dwordx4 v5, s[16:19], 0 offen offset:1024 sc1 lds
v_cvt_pk_bf16_f32 v109, v158, v159
v_cndmask_b32 v66, v66, v9, s[64:65]
v_mov_b32 v203, 0
v_mov_b32 v204, 0
v_exp_f32 v162, v62
v_mov_b32 v205, 0
v_mov_b32 v206, 0
ds_read_b128 a[32:35], v6 offset:8192
ds_read_b128 a[36:39], v6 offset:9216
v_mov_b32 v207, 0
s_add_u32 s58, s58, 524288
v_exp_f32 v163, v63
v_mov_b32 v144, 0
v_mov_b32 v145, 0
v_mov_b32 v146, 0
ds_read_b128 a[40:43], v6 offset:10240
v_cvt_pk_bf16_f32 v110, v160, v161
v_mov_b32 v147, 0
v_mov_b32 v148, 0
ds_read_b128 a[44:47], v6 offset:11264
ds_read_b128 a[48:51], v6 offset:12288
v_mov_b32 v149, 0
v_mov_b32 v150, 0
ds_read_b128 a[52:55], v6 offset:13312
v_cvt_pk_bf16_f32 v111, v162, v163
v_mov_b32 v151, 0
v_mfma_f32_16x16x32_bf16 v[208:211], a[64:67], v[120:123], v[208:211]
ds_read_b128 a[56:59], v6 offset:14336
ds_read_b128 a[60:63], v6 offset:15360
v_mfma_f32_16x16x32_bf16 v[208:211], a[96:99], v[124:127], v[208:211]
buffer_load_dwordx4 v5, s[16:19], 0 offen offset:2048 sc1 lds
s_xor_b32 s50, s50, 0x10000
v_mfma_f32_16x16x32_bf16 v[212:215], a[68:71], v[120:123], v[212:215]
v_cmp_gt_i32 s[62:63], 17, v7
v_cndmask_b32 v67, v67, v9, s[66:67]
v_mfma_f32_16x16x32_bf16 v[212:215], a[100:103], v[124:127], v[212:215]
v_cmp_gt_i32 s[64:65], 18, v7
v_cndmask_b32 v68, v68, v9, s[60:61]
v_mfma_f32_16x16x32_bf16 v[216:219], a[72:75], v[120:123], v[216:219]
v_cmp_gt_i32 s[66:67], 19, v7
v_cndmask_b32 v69, v69, v9, s[62:63]
v_cmp_gt_i32 s[60:61], 32, v7
v_mfma_f32_16x16x32_bf16 v[216:219], a[104:107], v[124:127], v[216:219]
v_cndmask_b32 v70, v70, v9, s[64:65]
v_cmp_gt_i32 s[62:63], 33, v7
v_mfma_f32_16x16x32_bf16 v[220:223], a[76:79], v[120:123], v[220:223]
v_cndmask_b32 v71, v71, v9, s[66:67]
v_cmp_gt_i32 s[64:65], 34, v7
v_mfma_f32_16x16x32_bf16 v[220:223], a[108:111], v[124:127], v[220:223]
v_cndmask_b32 v72, v72, v9, s[60:61]
v_cmp_gt_i32 s[66:67], 35, v7
v_mfma_f32_16x16x32_bf16 v[224:227], a[80:83], v[120:123], v[224:227]
v_cndmask_b32 v73, v73, v9, s[62:63]
v_cmp_gt_i32 s[60:61], 48, v7
v_mfma_f32_16x16x32_bf16 v[224:227], a[112:115], v[124:127], v[224:227]
buffer_load_dwordx4 v5, s[16:19], 0 offen offset:3072 sc1 lds
v_cndmask_b32 v74, v74, v9, s[64:65]
v_mfma_f32_16x16x32_bf16 v[228:231], a[84:87], v[120:123], v[228:231]
v_cmp_gt_i32 s[62:63], 49, v7
v_cndmask_b32 v75, v75, v9, s[66:67]
s_add_u32 s14, s14, -1
v_mfma_f32_16x16x32_bf16 v[228:231], a[116:119], v[124:127], v[228:231]
v_cmp_gt_i32 s[64:65], 50, v7
v_cndmask_b32 v76, v76, v9, s[60:61]
v_mfma_f32_16x16x32_bf16 v[232:235], a[88:91], v[120:123], v[232:235]
v_cmp_gt_i32 s[66:67], 51, v7
v_cndmask_b32 v77, v77, v9, s[62:63]
v_mfma_f32_16x16x32_bf16 v[232:235], a[120:123], v[124:127], v[232:235]
s_nop 0
v_cndmask_b32 v78, v78, v9, s[64:65]
s_cmp_eq_u32 s14, 0
s_cselect_b32 s12, s15, s13
s_cselect_b32 s13, 131072, s13
v_mfma_f32_16x16x32_bf16 v[236:239], a[92:95], v[120:123], v[236:239]
v_cndmask_b32 v79, v79, v9, s[66:67]
v_mfma_f32_16x16x32_bf16 v[236:239], a[124:127], v[124:127], v[236:239]
v_rcp_f32 v165, v140
s_nop 0
v_pk_mul_f32 v[208:209], v[208:209], v[164:165] op_sel:[0,1] op_sel_hi:[1,1]
v_pk_mul_f32 v[210:211], v[210:211], v[164:165] op_sel:[0,1] op_sel_hi:[1,1]
v_pk_mul_f32 v[212:213], v[212:213], v[164:165] op_sel:[0,1] op_sel_hi:[1,1]
v_pk_mul_f32 v[214:215], v[214:215], v[164:165] op_sel:[0,1] op_sel_hi:[1,1]
v_cvt_pk_bf16_f32 v168, v208, v209
v_cvt_pk_bf16_f32 v169, v210, v211
v_cvt_pk_bf16_f32 v170, v212, v213
v_cvt_pk_bf16_f32 v171, v214, v215
buffer_store_dwordx4 v[168:171], v11, s[28:31], s58 offen offset:0 sc1
v_pk_mul_f32 v[216:217], v[216:217], v[164:165] op_sel:[0,1] op_sel_hi:[1,1]
v_pk_mul_f32 v[218:219], v[218:219], v[164:165] op_sel:[0,1] op_sel_hi:[1,1]
v_pk_mul_f32 v[220:221], v[220:221], v[164:165] op_sel:[0,1] op_sel_hi:[1,1]
v_pk_mul_f32 v[222:223], v[222:223], v[164:165] op_sel:[0,1] op_sel_hi:[1,1]
v_cvt_pk_bf16_f32 v172, v216, v217
v_cvt_pk_bf16_f32 v173, v218, v219
v_cvt_pk_bf16_f32 v174, v220, v221
v_cvt_pk_bf16_f32 v175, v222, v223
buffer_store_dwordx4 v[172:175], v11, s[28:31], s58 offen offset:1024 sc1
v_pk_mul_f32 v[224:225], v[224:225], v[164:165] op_sel:[0,1] op_sel_hi:[1,1]
v_pk_mul_f32 v[226:227], v[226:227], v[164:165] op_sel:[0,1] op_sel_hi:[1,1]
v_pk_mul_f32 v[228:229], v[228:229], v[164:165] op_sel:[0,1] op_sel_hi:[1,1]
v_pk_mul_f32 v[230:231], v[230:231], v[164:165] op_sel:[0,1] op_sel_hi:[1,1]
v_cvt_pk_bf16_f32 v168, v224, v225
v_cvt_pk_bf16_f32 v169, v226, v227
v_cvt_pk_bf16_f32 v170, v228, v229
v_cvt_pk_bf16_f32 v171, v230, v231
buffer_store_dwordx4 v[168:171], v11, s[28:31], s58 offen offset:2048 sc1
v_pk_mul_f32 v[232:233], v[232:233], v[164:165] op_sel:[0,1] op_sel_hi:[1,1]
v_pk_mul_f32 v[234:235], v[234:235], v[164:165] op_sel:[0,1] op_sel_hi:[1,1]
v_pk_mul_f32 v[236:237], v[236:237], v[164:165] op_sel:[0,1] op_sel_hi:[1,1]
v_pk_mul_f32 v[238:239], v[238:239], v[164:165] op_sel:[0,1] op_sel_hi:[1,1]
v_cvt_pk_bf16_f32 v172, v232, v233
v_cvt_pk_bf16_f32 v173, v234, v235
v_cvt_pk_bf16_f32 v174, v236, v237
v_cvt_pk_bf16_f32 v175, v238, v239
buffer_store_dwordx4 v[172:175], v11, s[28:31], s58 offen offset:3072 sc1
s_mov_b32 s58, s59
s_sub_u32 s54, s45, 1
s_cmp_eq_u32 s45, 0
s_cbranch_scc1 K2_P0
s_waitcnt vmcnt(16) lgkmcnt(0)
s_barrier
v_mfma_f32_16x16x32_bf16 v[132:135], v[152:155], v[104:107], 0
v_exp_f32 v156, v64
v_mfma_f32_16x16x32_bf16 v[132:135], v[152:155], v[108:111], v[132:135]
s_add_u32 m0, s50, 0
v_add_u32 v4, s12, v4
v_mfma_f32_16x16x32_bf16 v[32:35], a[0:3], a[192:195], v[144:147]
v_exp_f32 v157, v65
v_mfma_f32_16x16x32_bf16 v[32:35], a[4:7], a[196:199], v[32:35]
buffer_load_dwordx4 v4, s[28:31], 0 offen offset:0 sc1 lds
ds_read_b128 a[64:67], v6 offset:49152
v_mfma_f32_16x16x32_bf16 v[32:35], a[8:11], a[200:203], v[32:35]
v_exp_f32 v158, v66
v_mfma_f32_16x16x32_bf16 v[32:35], a[12:15], a[204:207], v[32:35]
ds_read_b128 a[68:71], v6 offset:50176
ds_read_b128 a[72:75], v6 offset:51200
v_mfma_f32_16x16x32_bf16 v[36:39], a[16:19], a[192:195], v[144:147]
v_exp_f32 v159, v67
v_mfma_f32_16x16x32_bf16 v[36:39], a[20:23], a[196:199], v[36:39]
ds_read_b128 a[76:79], v6 offset:52224
v_subrev_u32 v10, s52, v132
v_mfma_f32_16x16x32_bf16 v[36:39], a[24:27], a[200:203], v[36:39]
v_exp_f32 v160, v68
v_mfma_f32_16x16x32_bf16 v[36:39], a[28:31], a[204:207], v[36:39]
ds_read_b128 a[80:83], v6 offset:53248
v_cmp_lt_u32 vcc, s53, v10
v_mfma_f32_16x16x32_bf16 v[40:43], a[32:35], a[192:195], v[144:147]
v_exp_f32 v161, v69
v_mfma_f32_16x16x32_bf16 v[40:43], a[36:39], a[196:199], v[40:43]
buffer_load_dwordx4 v4, s[28:31], 0 offen offset:1024 sc1 lds
v_cvt_pk_bf16_f32 v112, v156, v157
v_mfma_f32_16x16x32_bf16 v[40:43], a[40:43], a[200:203], v[40:43]
s_cbranch_vccnz K2_TR23
K2_RT23:
v_mfma_f32_16x16x32_bf16 v[40:43], a[44:47], a[204:207], v[40:43]
ds_read_b128 a[84:87], v6 offset:54272
ds_read_b128 a[88:91], v6 offset:55296
v_mfma_f32_16x16x32_bf16 v[44:47], a[48:51], a[192:195], v[144:147]
v_exp_f32 v162, v70
v_mfma_f32_16x16x32_bf16 v[44:47], a[52:55], a[196:199], v[44:47]
ds_read_b128 a[92:95], v6 offset:56320
v_cvt_pk_bf16_f32 v113, v158, v159
v_mfma_f32_16x16x32_bf16 v[44:47], a[56:59], a[200:203], v[44:47]
v_exp_f32 v163, v71
v_mfma_f32_16x16x32_bf16 v[44:47], a[60:63], a[204:207], v[44:47]
ds_read_b128 a[96:99], v6 offset:57344
ds_read_b128 a[100:103], v6 offset:58368
v_mfma_f32_16x16x32_bf16 v[48:51], a[0:3], a[208:211], v[148:151]
v_exp_f32 v156, v72
v_mfma_f32_16x16x32_bf16 v[48:51], a[4:7], a[212:215], v[48:51]
buffer_load_dwordx4 v4, s[28:31], 0 offen offset:2048 sc1 lds
v_cvt_pk_bf16_f32 v114, v160, v161
v_mfma_f32_16x16x32_bf16 v[48:51], a[8:11], a[216:219], v[48:51]
v_exp_f32 v157, v73
v_mfma_f32_16x16x32_bf16 v[48:51], a[12:15], a[220:223], v[48:51]
ds_read_b128 a[104:107], v6 offset:59392
ds_read_b128 a[108:111], v6 offset:60416
v_mfma_f32_16x16x32_bf16 v[52:55], a[16:19], a[208:211], v[148:151]
v_exp_f32 v158, v74
v_mfma_f32_16x16x32_bf16 v[52:55], a[20:23], a[212:215], v[52:55]
ds_read_b128 a[112:115], v6 offset:61440
ds_read_b128 a[116:119], v6 offset:62464
v_mfma_f32_16x16x32_bf16 v[52:55], a[24:27], a[216:219], v[52:55]
v_exp_f32 v159, v75
v_mfma_f32_16x16x32_bf16 v[52:55], a[28:31], a[220:223], v[52:55]
ds_read_b128 a[120:123], v6 offset:63488
v_cvt_pk_bf16_f32 v115, v162, v163
v_mfma_f32_16x16x32_bf16 v[56:59], a[32:35], a[208:211], v[148:151]
v_exp_f32 v160, v76
v_mfma_f32_16x16x32_bf16 v[56:59], a[36:39], a[212:215], v[56:59]
buffer_load_dwordx4 v4, s[28:31], 0 offen offset:3072 sc1 lds
ds_read_b128 a[124:127], v6 offset:64512
v_mfma_f32_16x16x32_bf16 v[56:59], a[40:43], a[216:219], v[56:59]
v_exp_f32 v161, v77
v_mfma_f32_16x16x32_bf16 v[56:59], a[44:47], a[220:223], v[56:59]
v_cvt_pk_bf16_f32 v116, v156, v157
v_cvt_pk_bf16_f32 v117, v158, v159
v_mfma_f32_16x16x32_bf16 v[60:63], a[48:51], a[208:211], v[148:151]
v_exp_f32 v162, v78
v_mfma_f32_16x16x32_bf16 v[60:63], a[52:55], a[212:215], v[60:63]
s_add_u32 m0, s50, 16384
v_add_u32 v5, -16384, v5
v_mfma_f32_16x16x32_bf16 v[60:63], a[56:59], a[216:219], v[60:63]
v_exp_f32 v163, v79
v_mfma_f32_16x16x32_bf16 v[60:63], a[60:63], a[220:223], v[60:63]
s_waitcnt lgkmcnt(0)
v_cvt_pk_bf16_f32 v118, v160, v161
v_exp_f32 v156, v80
ds_read_b128 a[0:3], v6 offset:32768
ds_read_b128 a[4:7], v6 offset:33792
v_exp_f32 v157, v81
buffer_load_dwordx4 v5, s[16:19], 0 offen offset:0 sc1 lds
ds_read_b128 a[8:11], v6 offset:34816
v_exp_f32 v158, v82
ds_read_b128 a[12:15], v6 offset:35840
v_cvt_pk_bf16_f32 v119, v162, v163
v_exp_f32 v159, v83
ds_read_b128 a[16:19], v6 offset:36864
v_cvt_pk_bf16_f32 v120, v156, v157
v_exp_f32 v160, v84
ds_read_b128 a[20:23], v6 offset:37888
ds_read_b128 a[24:27], v6 offset:38912
v_exp_f32 v161, v85
buffer_load_dwordx4 v5, s[16:19], 0 offen offset:1024 sc1 lds
ds_read_b128 a[28:31], v6 offset:39936
v_exp_f32 v162, v86
ds_read_b128 a[32:35], v6 offset:40960
v_cvt_pk_bf16_f32 v121, v158, v159
v_exp_f32 v163, v87
ds_read_b128 a[36:39], v6 offset:41984
v_cvt_pk_bf16_f32 v122, v160, v161
v_mfma_f32_16x16x32_bf16 v[136:139], v[152:155], v[112:115], 0
v_exp_f32 v156, v88
v_mfma_f32_16x16x32_bf16 v[136:139], v[152:155], v[116:119], v[136:139]
ds_read_b128 a[40:43], v6 offset:43008
ds_read_b128 a[44:47], v6 offset:44032
v_mfma_f32_16x16x32_bf16 v[208:211], a[64:67], v[104:107], 0
v_exp_f32 v157, v89
v_mfma_f32_16x16x32_bf16 v[208:211], a[96:99], v[108:111], v[208:211]
buffer_load_dwordx4 v5, s[16:19], 0 offen offset:2048 sc1 lds
ds_read_b128 a[48:51], v6 offset:45056
v_mfma_f32_16x16x32_bf16 v[212:215], a[68:71], v[104:107], 0
v_exp_f32 v158, v90
v_mfma_f32_16x16x32_bf16 v[212:215], a[100:103], v[108:111], v[212:215]
ds_read_b128 a[52:55], v6 offset:46080
v_cvt_pk_bf16_f32 v123, v162, v163
v_mfma_f32_16x16x32_bf16 v[216:219], a[72:75], v[104:107], 0
v_exp_f32 v159, v91
v_mfma_f32_16x16x32_bf16 v[216:219], a[104:107], v[108:111], v[216:219]
ds_read_b128 a[56:59], v6 offset:47104
v_subrev_u32 v10, s52, v136
v_mfma_f32_16x16x32_bf16 v[220:223], a[76:79], v[104:107], 0
v_exp_f32 v160, v92
v_mfma_f32_16x16x32_bf16 v[220:223], a[108:111], v[108:111], v[220:223]
v_cmp_lt_u32 vcc, s53, v10
v_cvt_pk_bf16_f32 v124, v156, v157
v_mfma_f32_16x16x32_bf16 v[224:227], a[80:83], v[104:107], 0
v_exp_f32 v161, v93
v_mfma_f32_16x16x32_bf16 v[224:227], a[112:115], v[108:111], v[224:227]
buffer_load_dwordx4 v5, s[16:19], 0 offen offset:3072 sc1 lds
ds_read_b128 a[60:63], v6 offset:48128
v_mfma_f32_16x16x32_bf16 v[228:231], a[84:87], v[104:107], 0
s_cbranch_vccnz K2_TR24
K2_RT24:
s_add_u32 s14, s14, -1
v_mfma_f32_16x16x32_bf16 v[228:231], a[116:119], v[108:111], v[228:231]
v_cvt_pk_bf16_f32 v125, v158, v159
v_cvt_pk_bf16_f32 v126, v160, v161
v_mfma_f32_16x16x32_bf16 v[232:235], a[88:91], v[104:107], 0
v_exp_f32 v162, v94
v_mfma_f32_16x16x32_bf16 v[232:235], a[120:123], v[108:111], v[232:235]
v_xor_b32 v6, 0x10000, v6
s_cmp_eq_u32 s14, 0
s_cselect_b32 s12, s15, s13
s_cselect_b32 s13, 131072, s13
v_mfma_f32_16x16x32_bf16 v[236:239], a[92:95], v[104:107], 0
v_exp_f32 v163, v95
v_mfma_f32_16x16x32_bf16 v[236:239], a[124:127], v[108:111], v[236:239]
v_cvt_pk_bf16_f32 v127, v162, v163
s_branch K2_LOOPA2
.p2align 6
K2_LOOPA:
s_waitcnt vmcnt(16) lgkmcnt(0)
s_barrier
v_mfma_f32_16x16x32_bf16 v[132:135], v[152:155], v[104:107], v[140:143]
v_exp_f32 v156, v64
v_mfma_f32_16x16x32_bf16 v[132:135], v[152:155], v[108:111], v[132:135]
s_add_u32 m0, s50, 0
v_add_u32 v4, s12, v4
v_mfma_f32_16x16x32_bf16 v[32:35], a[0:3], a[192:195], v[144:147]
v_exp_f32 v157, v65
v_mfma_f32_16x16x32_bf16 v[32:35], a[4:7], a[196:199], v[32:35]
buffer_load_dwordx4 v4, s[28:31], 0 offen offset:0 sc1 lds
ds_read_b128 a[64:67], v6 offset:49152
v_mfma_f32_16x16x32_bf16 v[32:35], a[8:11], a[200:203], v[32:35]
v_exp_f32 v158, v66
v_mfma_f32_16x16x32_bf16 v[32:35], a[12:15], a[204:207], v[32:35]
ds_read_b128 a[68:71], v6 offset:50176
ds_read_b128 a[72:75], v6 offset:51200
v_mfma_f32_16x16x32_bf16 v[36:39], a[16:19], a[192:195], v[144:147]
v_exp_f32 v159, v67
v_mfma_f32_16x16x32_bf16 v[36:39], a[20:23], a[196:199], v[36:39]
ds_read_b128 a[76:79], v6 offset:52224
v_subrev_u32 v10, s52, v132
v_mfma_f32_16x16x32_bf16 v[36:39], a[24:27], a[200:203], v[36:39]
v_exp_f32 v160, v68
v_mfma_f32_16x16x32_bf16 v[36:39], a[28:31], a[204:207], v[36:39]
ds_read_b128 a[80:83], v6 offset:53248
v_cmp_lt_u32 vcc, s53, v10
v_mfma_f32_16x16x32_bf16 v[40:43], a[32:35], a[192:195], v[144:147]
v_exp_f32 v161, v69
v_mfma_f32_16x16x32_bf16 v[40:43], a[36:39], a[196:199], v[40:43]
buffer_load_dwordx4 v4, s[28:31], 0 offen offset:1024 sc1 lds
v_cvt_pk_bf16_f32 v112, v156, v157
v_mfma_f32_16x16x32_bf16 v[40:43], a[40:43], a[200:203], v[40:43]
s_cbranch_vccnz K2_TR25
K2_RT25:
v_mfma_f32_16x16x32_bf16 v[40:43], a[44:47], a[204:207], v[40:43]
ds_read_b128 a[84:87], v6 offset:54272
ds_read_b128 a[88:91], v6 offset:55296
v_mfma_f32_16x16x32_bf16 v[44:47], a[48:51], a[192:195], v[144:147]
v_exp_f32 v162, v70
v_mfma_f32_16x16x32_bf16 v[44:47], a[52:55], a[196:199], v[44:47]
ds_read_b128 a[92:95], v6 offset:56320
v_cvt_pk_bf16_f32 v113, v158, v159
v_mfma_f32_16x16x32_bf16 v[44:47], a[56:59], a[200:203], v[44:47]
v_exp_f32 v163, v71
v_mfma_f32_16x16x32_bf16 v[44:47], a[60:63], a[204:207], v[44:47]
ds_read_b128 a[96:99], v6 offset:57344
ds_read_b128 a[100:103], v6 offset:58368
v_mfma_f32_16x16x32_bf16 v[48:51], a[0:3], a[208:211], v[148:151]
v_exp_f32 v156, v72
v_mfma_f32_16x16x32_bf16 v[48:51], a[4:7], a[212:215], v[48:51]
buffer_load_dwordx4 v4, s[28:31], 0 offen offset:2048 sc1 lds
v_cvt_pk_bf16_f32 v114, v160, v161
v_mfma_f32_16x16x32_bf16 v[48:51], a[8:11], a[216:219], v[48:51]
v_exp_f32 v157, v73
v_mfma_f32_16x16x32_bf16 v[48:51], a[12:15], a[220:223], v[48:51]
ds_read_b128 a[104:107], v6 offset:59392
ds_read_b128 a[108:111], v6 offset:60416
v_mfma_f32_16x16x32_bf16 v[52:55], a[16:19], a[208:211], v[148:151]
v_exp_f32 v158, v74
v_mfma_f32_16x16x32_bf16 v[52:55], a[20:23], a[212:215], v[52:55]
ds_read_b128 a[112:115], v6 offset:61440
ds_read_b128 a[116:119], v6 offset:62464
v_mfma_f32_16x16x32_bf16 v[52:55], a[24:27], a[216:219], v[52:55]
v_exp_f32 v159, v75
v_mfma_f32_16x16x32_bf16 v[52:55], a[28:31], a[220:223], v[52:55]
ds_read_b128 a[120:123], v6 offset:63488
v_cvt_pk_bf16_f32 v115, v162, v163
v_mfma_f32_16x16x32_bf16 v[56:59], a[32:35], a[208:211], v[148:151]
v_exp_f32 v160, v76
v_mfma_f32_16x16x32_bf16 v[56:59], a[36:39], a[212:215], v[56:59]
buffer_load_dwordx4 v4, s[28:31], 0 offen offset:3072 sc1 lds
ds_read_b128 a[124:127], v6 offset:64512
v_mfma_f32_16x16x32_bf16 v[56:59], a[40:43], a[216:219], v[56:59]
v_exp_f32 v161, v77
v_mfma_f32_16x16x32_bf16 v[56:59], a[44:47], a[220:223], v[56:59]
v_cvt_pk_bf16_f32 v116, v156, v157
v_cvt_pk_bf16_f32 v117, v158, v159
v_mfma_f32_16x16x32_bf16 v[60:63], a[48:51], a[208:211], v[148:151]
v_exp_f32 v162, v78
v_mfma_f32_16x16x32_bf16 v[60:63], a[52:55], a[212:215], v[60:63]
s_add_u32 m0, s50, 16384
v_add_u32 v5, -16384, v5
v_mfma_f32_16x16x32_bf16 v[60:63], a[56:59], a[216:219], v[60:63]
v_exp_f32 v163, v79
v_mfma_f32_16x16x32_bf16 v[60:63], a[60:63], a[220:223], v[60:63]
s_waitcnt lgkmcnt(0)
v_cvt_pk_bf16_f32 v118, v160, v161
v_mfma_f32_16x16x32_bf16 v[176:179], a[64:67], v[96:99], v[176:179]
v_exp_f32 v156, v80
v_mfma_f32_16x16x32_bf16 v[176:179], a[96:99], v[100:103], v[176:179]
ds_read_b128 a[0:3], v6 offset:32768
ds_read_b128 a[4:7], v6 offset:33792
v_mfma_f32_16x16x32_bf16 v[180:183], a[68:71], v[96:99], v[180:183]
v_exp_f32 v157, v81
v_mfma_f32_16x16x32_bf16 v[180:183], a[100:103], v[100:103], v[180:183]
buffer_load_dwordx4 v5, s[16:19], 0 offen offset:0 sc1 lds
ds_read_b128 a[8:11], v6 offset:34816
v_mfma_f32_16x16x32_bf16 v[184:187], a[72:75], v[96:99], v[184:187]
v_exp_f32 v158, v82
v_mfma_f32_16x16x32_bf16 v[184:187], a[104:107], v[100:103], v[184:187]
ds_read_b128 a[12:15], v6 offset:35840
v_cvt_pk_bf16_f32 v119, v162, v163
v_mfma_f32_16x16x32_bf16 v[188:191], a[76:79], v[96:99], v[188:191]
v_exp_f32 v159, v83
v_mfma_f32_16x16x32_bf16 v[188:191], a[108:111], v[100:103], v[188:191]
ds_read_b128 a[16:19], v6 offset:36864
v_cvt_pk_bf16_f32 v120, v156, v157
v_mfma_f32_16x16x32_bf16 v[192:195], a[80:83], v[96:99], v[192:195]
v_exp_f32 v160, v84
v_mfma_f32_16x16x32_bf16 v[192:195], a[112:115], v[100:103], v[192:195]
ds_read_b128 a[20:23], v6 offset:37888
ds_read_b128 a[24:27], v6 offset:38912
v_mfma_f32_16x16x32_bf16 v[196:199], a[84:87], v[96:99], v[196:199]
v_exp_f32 v161, v85
v_mfma_f32_16x16x32_bf16 v[196:199], a[116:119], v[100:103], v[196:199]
buffer_load_dwordx4 v5, s[16:19], 0 offen offset:1024 sc1 lds
ds_read_b128 a[28:31], v6 offset:39936
v_mfma_f32_16x16x32_bf16 v[200:203], a[88:91], v[96:99], v[200:203]
v_exp_f32 v162, v86
v_mfma_f32_16x16x32_bf16 v[200:203], a[120:123], v[100:103], v[200:203]
ds_read_b128 a[32:35], v6 offset:40960
v_cvt_pk_bf16_f32 v121, v158, v159
v_mfma_f32_16x16x32_bf16 v[204:207], a[92:95], v[96:99], v[204:207]
v_exp_f32 v163, v87
v_mfma_f32_16x16x32_bf16 v[204:207], a[124:127], v[100:103], v[204:207]
ds_read_b128 a[36:39], v6 offset:41984
v_cvt_pk_bf16_f32 v122, v160, v161
v_mfma_f32_16x16x32_bf16 v[136:139], v[152:155], v[112:115], v[128:131]
v_exp_f32 v156, v88
v_mfma_f32_16x16x32_bf16 v[136:139], v[152:155], v[116:119], v[136:139]
ds_read_b128 a[40:43], v6 offset:43008
ds_read_b128 a[44:47], v6 offset:44032
v_mfma_f32_16x16x32_bf16 v[208:211], a[64:67], v[104:107], v[208:211]
v_exp_f32 v157, v89
v_mfma_f32_16x16x32_bf16 v[208:211], a[96:99], v[108:111], v[208:211]
buffer_load_dwordx4 v5, s[16:19], 0 offen offset:2048 sc1 lds
ds_read_b128 a[48:51], v6 offset:45056
v_mfma_f32_16x16x32_bf16 v[212:215], a[68:71], v[104:107], v[212:215]
v_exp_f32 v158, v90
v_mfma_f32_16x16x32_bf16 v[212:215], a[100:103], v[108:111], v[212:215]
ds_read_b128 a[52:55], v6 offset:46080
v_cvt_pk_bf16_f32 v123, v162, v163
v_mfma_f32_16x16x32_bf16 v[216:219], a[72:75], v[104:107], v[216:219]
v_exp_f32 v159, v91
v_mfma_f32_16x16x32_bf16 v[216:219], a[104:107], v[108:111], v[216:219]
ds_read_b128 a[56:59], v6 offset:47104
v_subrev_u32 v10, s52, v136
v_mfma_f32_16x16x32_bf16 v[220:223], a[76:79], v[104:107], v[220:223]
v_exp_f32 v160, v92
v_mfma_f32_16x16x32_bf16 v[220:223], a[108:111], v[108:111], v[220:223]
v_cmp_lt_u32 vcc, s53, v10
v_cvt_pk_bf16_f32 v124, v156, v157
v_mfma_f32_16x16x32_bf16 v[224:227], a[80:83], v[104:107], v[224:227]
v_exp_f32 v161, v93
v_mfma_f32_16x16x32_bf16 v[224:227], a[112:115], v[108:111], v[224:227]
buffer_load_dwordx4 v5, s[16:19], 0 offen offset:3072 sc1 lds
ds_read_b128 a[60:63], v6 offset:48128
v_mfma_f32_16x16x32_bf16 v[228:231], a[84:87], v[104:107], v[228:231]
s_cbranch_vccnz K2_TR26
K2_RT26:
s_add_u32 s14, s14, -1
v_mfma_f32_16x16x32_bf16 v[228:231], a[116:119], v[108:111], v[228:231]
v_cvt_pk_bf16_f32 v125, v158, v159
v_cvt_pk_bf16_f32 v126, v160, v161
v_mfma_f32_16x16x32_bf16 v[232:235], a[88:91], v[104:107], v[232:235]
v_exp_f32 v162, v94
v_mfma_f32_16x16x32_bf16 v[232:235], a[120:123], v[108:111], v[232:235]
v_xor_b32 v6, 0x10000, v6
s_cmp_eq_u32 s14, 0
s_cselect_b32 s12, s15, s13
s_cselect_b32 s13, 131072, s13
v_mfma_f32_16x16x32_bf16 v[236:239], a[92:95], v[104:107], v[236:239]
v_exp_f32 v163, v95
v_mfma_f32_16x16x32_bf16 v[236:239], a[124:127], v[108:111], v[236:239]
v_cvt_pk_bf16_f32 v127, v162, v163
K2_LOOPA2:
s_waitcnt vmcnt(16) lgkmcnt(0)
s_barrier
v_mfma_f32_16x16x32_bf16 v[140:143], v[152:155], v[120:123], v[132:135]
v_exp_f32 v156, v32
v_mfma_f32_16x16x32_bf16 v[140:143], v[152:155], v[124:127], v[140:143]
s_add_u32 m0, s50, 32768
v_add_u32 v4, s12, v4
v_mfma_f32_16x16x32_bf16 v[64:67], a[0:3], a[192:195], v[144:147]
v_exp_f32 v157, v33
v_mfma_f32_16x16x32_bf16 v[64:67], a[4:7], a[196:199], v[64:67]
buffer_load_dwordx4 v4, s[28:31], 0 offen offset:0 sc1 lds
ds_read_b128 a[64:67], v6 offset:16384
v_mfma_f32_16x16x32_bf16 v[64:67], a[8:11], a[200:203], v[64:67]
v_exp_f32 v158, v34
v_mfma_f32_16x16x32_bf16 v[64:67], a[12:15], a[204:207], v[64:67]
ds_read_b128 a[68:71], v6 offset:17408
ds_read_b128 a[72:75], v6 offset:18432
v_mfma_f32_16x16x32_bf16 v[68:71], a[16:19], a[192:195], v[144:147]
v_exp_f32 v159, v35
v_mfma_f32_16x16x32_bf16 v[68:71], a[20:23], a[196:199], v[68:71]
ds_read_b128 a[76:79], v6 offset:19456
v_subrev_u32 v10, s52, v140
v_mfma_f32_16x16x32_bf16 v[68:71], a[24:27], a[200:203], v[68:71]
v_exp_f32 v160, v36
v_mfma_f32_16x16x32_bf16 v[68:71], a[28:31], a[204:207], v[68:71]
ds_read_b128 a[80:83], v6 offset:20480
v_cmp_lt_u32 vcc, s53, v10
v_mfma_f32_16x16x32_bf16 v[72:75], a[32:35], a[192:195], v[144:147]
v_exp_f32 v161, v37
v_mfma_f32_16x16x32_bf16 v[72:75], a[36:39], a[196:199], v[72:75]
buffer_load_dwordx4 v4, s[28:31], 0 offen offset:1024 sc1 lds
v_cvt_pk_bf16_f32 v96, v156, v157
v_mfma_f32_16x16x32_bf16 v[72:75], a[40:43], a[200:203], v[72:75]
s_cbranch_vccnz K2_TR27
K2_RT27:
v_mfma_f32_16x16x32_bf16 v[72:75], a[44:47], a[204:207], v[72:75]
ds_read_b128 a[84:87], v6 offset:21504
ds_read_b128 a[88:91], v6 offset:22528
v_mfma_f32_16x16x32_bf16 v[76:79], a[48:51], a[192:195], v[144:147]
v_exp_f32 v162, v38
v_mfma_f32_16x16x32_bf16 v[76:79], a[52:55], a[196:199], v[76:79]
ds_read_b128 a[92:95], v6 offset:23552
v_cvt_pk_bf16_f32 v97, v158, v159
v_mfma_f32_16x16x32_bf16 v[76:79], a[56:59], a[200:203], v[76:79]
v_exp_f32 v163, v39
v_mfma_f32_16x16x32_bf16 v[76:79], a[60:63], a[204:207], v[76:79]
ds_read_b128 a[96:99], v6 offset:24576
ds_read_b128 a[100:103], v6 offset:25600
v_mfma_f32_16x16x32_bf16 v[80:83], a[0:3], a[208:211], v[148:151]
v_exp_f32 v156, v40
v_mfma_f32_16x16x32_bf16 v[80:83], a[4:7], a[212:215], v[80:83]
buffer_load_dwordx4 v4, s[28:31], 0 offen offset:2048 sc1 lds
v_cvt_pk_bf16_f32 v98, v160, v161
v_mfma_f32_16x16x32_bf16 v[80:83], a[8:11], a[216:219], v[80:83]
v_exp_f32 v157, v41
v_mfma_f32_16x16x32_bf16 v[80:83], a[12:15], a[220:223], v[80:83]
ds_read_b128 a[104:107], v6 offset:26624
ds_read_b128 a[108:111], v6 offset:27648
v_mfma_f32_16x16x32_bf16 v[84:87], a[16:19], a[208:211], v[148:151]
v_exp_f32 v158, v42
v_mfma_f32_16x16x32_bf16 v[84:87], a[20:23], a[212:215], v[84:87]
ds_read_b128 a[112:115], v6 offset:28672
ds_read_b128 a[116:119], v6 offset:29696
v_mfma_f32_16x16x32_bf16 v[84:87], a[24:27], a[216:219], v[84:87]
v_exp_f32 v159, v43
v_mfma_f32_16x16x32_bf16 v[84:87], a[28:31], a[220:223], v[84:87]
ds_read_b128 a[120:123], v6 offset:30720
v_cvt_pk_bf16_f32 v99, v162, v163
v_mfma_f32_16x16x32_bf16 v[88:91], a[32:35], a[208:211], v[148:151]
v_exp_f32 v160, v44
v_mfma_f32_16x16x32_bf16 v[88:91], a[36:39], a[212:215], v[88:91]
buffer_load_dwordx4 v4, s[28:31], 0 offen offset:3072 sc1 lds
ds_read_b128 a[124:127], v6 offset:31744
v_mfma_f32_16x16x32_bf16 v[88:91], a[40:43], a[216:219], v[88:91]
v_exp_f32 v161, v45
v_mfma_f32_16x16x32_bf16 v[88:91], a[44:47], a[220:223], v[88:91]
v_cvt_pk_bf16_f32 v100, v156, v157
v_cvt_pk_bf16_f32 v101, v158, v159
v_mfma_f32_16x16x32_bf16 v[92:95], a[48:51], a[208:211], v[148:151]
v_exp_f32 v162, v46
v_mfma_f32_16x16x32_bf16 v[92:95], a[52:55], a[212:215], v[92:95]
s_add_u32 m0, s50, 49152
v_add_u32 v5, -16384, v5
v_mfma_f32_16x16x32_bf16 v[92:95], a[56:59], a[216:219], v[92:95]
v_exp_f32 v163, v47
v_mfma_f32_16x16x32_bf16 v[92:95], a[60:63], a[220:223], v[92:95]
s_waitcnt lgkmcnt(0)
v_cvt_pk_bf16_f32 v102, v160, v161
v_mfma_f32_16x16x32_bf16 v[176:179], a[64:67], v[112:115], v[176:179]
v_exp_f32 v156, v48
v_mfma_f32_16x16x32_bf16 v[176:179], a[96:99], v[116:119], v[176:179]
ds_read_b128 a[0:3], v6 offset:0
ds_read_b128 a[4:7], v6 offset:1024
v_mfma_f32_16x16x32_bf16 v[180:183], a[68:71], v[112:115], v[180:183]
v_exp_f32 v157, v49
v_mfma_f32_16x16x32_bf16 v[180:183], a[100:103], v[116:119], v[180:183]
buffer_load_dwordx4 v5, s[16:19], 0 offen offset:0 sc1 lds
ds_read_b128 a[8:11], v6 offset:2048
v_mfma_f32_16x16x32_bf16 v[184:187], a[72:75], v[112:115], v[184:187]
v_exp_f32 v158, v50
v_mfma_f32_16x16x32_bf16 v[184:187], a[104:107], v[116:119], v[184:187]
ds_read_b128 a[12:15], v6 offset:3072
v_cvt_pk_bf16_f32 v103, v162, v163
v_mfma_f32_16x16x32_bf16 v[188:191], a[76:79], v[112:115], v[188:191]
v_exp_f32 v159, v51
v_mfma_f32_16x16x32_bf16 v[188:191], a[108:111], v[116:119], v[188:191]
ds_read_b128 a[16:19], v6 offset:4096
v_cvt_pk_bf16_f32 v104, v156, v157
v_mfma_f32_16x16x32_bf16 v[192:195], a[80:83], v[112:115], v[192:195]
v_exp_f32 v160, v52
v_mfma_f32_16x16x32_bf16 v[192:195], a[112:115], v[116:119], v[192:195]
ds_read_b128 a[20:23], v6 offset:5120
ds_read_b128 a[24:27], v6 offset:6144
v_mfma_f32_16x16x32_bf16 v[196:199], a[84:87], v[112:115], v[196:199]
v_exp_f32 v161, v53
v_mfma_f32_16x16x32_bf16 v[196:199], a[116:119], v[116:119], v[196:199]
buffer_load_dwordx4 v5, s[16:19], 0 offen offset:1024 sc1 lds
ds_read_b128 a[28:31], v6 offset:7168
v_mfma_f32_16x16x32_bf16 v[200:203], a[88:91], v[112:115], v[200:203]
v_exp_f32 v162, v54
v_mfma_f32_16x16x32_bf16 v[200:203], a[120:123], v[116:119], v[200:203]
ds_read_b128 a[32:35], v6 offset:8192
v_cvt_pk_bf16_f32 v105, v158, v159
v_mfma_f32_16x16x32_bf16 v[204:207], a[92:95], v[112:115], v[204:207]
v_exp_f32 v163, v55
v_mfma_f32_16x16x32_bf16 v[204:207], a[124:127], v[116:119], v[204:207]
ds_read_b128 a[36:39], v6 offset:9216
v_cvt_pk_bf16_f32 v106, v160, v161
v_mfma_f32_16x16x32_bf16 v[128:131], v[152:155], v[96:99], v[136:139]
v_exp_f32 v156, v56
v_mfma_f32_16x16x32_bf16 v[128:131], v[152:155], v[100:103], v[128:131]
ds_read_b128 a[40:43], v6 offset:10240
ds_read_b128 a[44:47], v6 offset:11264
v_mfma_f32_16x16x32_bf16 v[208:211], a[64:67], v[120:123], v[208:211]
v_exp_f32 v157, v57
v_mfma_f32_16x16x32_bf16 v[208:211], a[96:99], v[124:127], v[208:211]
buffer_load_dwordx4 v5, s[16:19], 0 offen offset:2048 sc1 lds
ds_read_b128 a[48:51], v6 offset:12288
v_mfma_f32_16x16x32_bf16 v[212:215], a[68:71], v[120:123], v[212:215]
v_exp_f32 v158, v58
v_mfma_f32_16x16x32_bf16 v[212:215], a[100:103], v[124:127], v[212:215]
ds_read_b128 a[52:55], v6 offset:13312
v_cvt_pk_bf16_f32 v107, v162, v163
v_mfma_f32_16x16x32_bf16 v[216:219], a[72:75], v[120:123], v[216:219]
v_exp_f32 v159, v59
v_mfma_f32_16x16x32_bf16 v[216:219], a[104:107], v[124:127], v[216:219]
ds_read_b128 a[56:59], v6 offset:14336
v_subrev_u32 v10, s52, v128
v_mfma_f32_16x16x32_bf16 v[220:223], a[76:79], v[120:123], v[220:223]
v_exp_f32 v160, v60
v_mfma_f32_16x16x32_bf16 v[220:223], a[108:111], v[124:127], v[220:223]
v_cmp_lt_u32 vcc, s53, v10
v_cvt_pk_bf16_f32 v108, v156, v157
v_mfma_f32_16x16x32_bf16 v[224:227], a[80:83], v[120:123], v[224:227]
v_exp_f32 v161, v61
v_mfma_f32_16x16x32_bf16 v[224:227], a[112:115], v[124:127], v[224:227]
buffer_load_dwordx4 v5, s[16:19], 0 offen offset:3072 sc1 lds
ds_read_b128 a[60:63], v6 offset:15360
v_mfma_f32_16x16x32_bf16 v[228:231], a[84:87], v[120:123], v[228:231]
s_cbranch_vccnz K2_TR28
K2_RT28:
s_add_u32 s14, s14, -1
v_mfma_f32_16x16x32_bf16 v[228:231], a[116:119], v[124:127], v[228:231]
s_xor_b32 s50, s50, 0x10000
v_cvt_pk_bf16_f32 v109, v158, v159
v_mfma_f32_16x16x32_bf16 v[232:235], a[88:91], v[120:123], v[232:235]
v_exp_f32 v162, v62
v_mfma_f32_16x16x32_bf16 v[232:235], a[120:123], v[124:127], v[232:235]
v_cvt_pk_bf16_f32 v110, v160, v161
s_cmp_eq_u32 s14, 0
s_cselect_b32 s12, s15, s13
s_cselect_b32 s13, 131072, s13
v_mfma_f32_16x16x32_bf16 v[236:239], a[92:95], v[120:123], v[236:239]
v_exp_f32 v163, v63
v_mfma_f32_16x16x32_bf16 v[236:239], a[124:127], v[124:127], v[236:239]
s_add_u32 s54, s54, -1
v_cvt_pk_bf16_f32 v111, v162, v163
s_cbranch_scc1 K2_LOOPA
s_lshl_b32 s64, s3, 12
s_mov_b32 s67, s70
s_lshl_b32 s47, s42, 7
s_add_u32 s51, s47, 2753536
s_sub_u32 s50, 2755456, s47
s_mov_b32 s69, 4096
s_mov_b32 s70, 8192
s_mov_b32 s71, 12288
s_mov_b32 s72, 16384
s_mov_b32 s73, 20480
s_mov_b32 s74, 24576
s_mov_b32 s75, 28672
v_mov_b32 v13, 0x40000000
s_waitcnt vmcnt(8) lgkmcnt(0)
s_barrier
buffer_store_dword v31, v30, s[28:31], s100 offen sc1
v_mfma_f32_16x16x32_bf16 v[132:135], v[152:155], v[104:107], v[140:143]
v_exp_f32 v156, v64
v_mfma_f32_16x16x32_bf16 v[132:135], v[152:155], v[108:111], v[132:135]
s_add_u32 m0, s64, 49152
s_nop 0
buffer_load_dwordx4 v14, s[28:31], s72 offen offset:0 sc1 lds
ds_read_b128 a[64:67], v6 offset:49152
ds_read_b128 a[68:71], v6 offset:50176
v_exp_f32 v157, v65
ds_read_b128 a[72:75], v6 offset:51200
ds_read_b128 a[76:79], v6 offset:52224
v_exp_f32 v158, v66
buffer_load_dwordx4 v14, s[28:31], s72 offen offset:1024 sc1 lds
ds_read_b128 a[80:83], v6 offset:53248
v_cvt_pk_bf16_f32 v112, v156, v157
v_exp_f32 v159, v67
ds_read_b128 a[84:87], v6 offset:54272
v_subrev_u32 v10, s52, v132
v_exp_f32 v160, v68
buffer_load_dwordx4 v14, s[28:31], s72 offen offset:2048 sc1 lds
ds_read_b128 a[88:91], v6 offset:55296
v_cmp_lt_u32 vcc, s53, v10
v_exp_f32 v161, v69
ds_read_b128 a[92:95], v6 offset:56320
v_cvt_pk_bf16_f32 v113, v158, v159
s_cbranch_vccnz K2_TR29
K2_RT29:
buffer_load_dwordx4 v14, s[28:31], s72 offen offset:3072 sc1 lds
ds_read_b128 a[96:99], v6 offset:57344
ds_read_b128 a[100:103], v6 offset:58368
v_exp_f32 v162, v70
ds_read_b128 a[104:107], v6 offset:59392
v_cvt_pk_bf16_f32 v114, v160, v161
v_exp_f32 v163, v71
s_add_u32 m0, s64, 81920
s_nop 0
buffer_load_dwordx4 v15, s[28:31], s72 offen offset:0 sc1 lds
ds_read_b128 a[108:111], v6 offset:60416
ds_read_b128 a[112:115], v6 offset:61440
v_exp_f32 v156, v72
ds_read_b128 a[116:119], v6 offset:62464
v_cvt_pk_bf16_f32 v115, v162, v163
v_exp_f32 v157, v73
buffer_load_dwordx4 v15, s[28:31], s72 offen offset:1024 sc1 lds
ds_read_b128 a[120:123], v6 offset:63488
ds_read_b128 a[124:127], v6 offset:64512
v_exp_f32 v158, v74
v_cvt_pk_bf16_f32 v116, v156, v157
v_exp_f32 v159, v75
buffer_load_dwordx4 v15, s[28:31], s72 offen offset:2048 sc1 lds
v_cvt_pk_bf16_f32 v117, v158, v159
v_exp_f32 v160, v76
v_exp_f32 v161, v77
buffer_load_dwordx4 v15, s[28:31], s72 offen offset:3072 sc1 lds
v_cvt_pk_bf16_f32 v118, v160, v161
v_exp_f32 v162, v78
v_exp_f32 v163, v79
buffer_load_dwordx4 a[192:195], v14, s[28:31], s69 offen offset:0 sc1
s_waitcnt lgkmcnt(0)
v_xor_b32 v6, 0x10000, v6
v_mfma_f32_16x16x32_bf16 v[176:179], a[64:67], v[96:99], v[176:179]
v_exp_f32 v156, v80
v_mfma_f32_16x16x32_bf16 v[176:179], a[96:99], v[100:103], v[176:179]
ds_read_b128 a[0:3], v6 offset:16384
ds_read_b128 a[4:7], v6 offset:17408
v_mfma_f32_16x16x32_bf16 v[180:183], a[68:71], v[96:99], v[180:183]
v_exp_f32 v157, v81
v_mfma_f32_16x16x32_bf16 v[180:183], a[100:103], v[100:103], v[180:183]
buffer_load_dwordx4 a[196:199], v15, s[28:31], s69 offen offset:0 sc1
ds_read_b128 a[8:11], v6 offset:18432
v_cvt_pk_bf16_f32 v119, v162, v163
v_mfma_f32_16x16x32_bf16 v[184:187], a[72:75], v[96:99], v[184:187]
v_exp_f32 v158, v82
v_mfma_f32_16x16x32_bf16 v[184:187], a[104:107], v[100:103], v[184:187]
ds_read_b128 a[12:15], v6 offset:19456
ds_read_b128 a[16:19], v6 offset:20480
v_mfma_f32_16x16x32_bf16 v[188:191], a[76:79], v[96:99], v[188:191]
v_exp_f32 v159, v83
v_mfma_f32_16x16x32_bf16 v[188:191], a[108:111], v[100:103], v[188:191]
buffer_load_dwordx4 a[200:203], v16, s[28:31], s69 offen offset:0 sc1
ds_read_b128 a[20:23], v6 offset:21504
v_cvt_pk_bf16_f32 v120, v156, v157
v_mfma_f32_16x16x32_bf16 v[192:195], a[80:83], v[96:99], v[192:195]
v_exp_f32 v160, v84
v_mfma_f32_16x16x32_bf16 v[192:195], a[112:115], v[100:103], v[192:195]
ds_read_b128 a[24:27], v6 offset:22528
ds_read_b128 a[28:31], v6 offset:23552
v_mfma_f32_16x16x32_bf16 v[196:199], a[84:87], v[96:99], v[196:199]
v_exp_f32 v161, v85
v_mfma_f32_16x16x32_bf16 v[196:199], a[116:119], v[100:103], v[196:199]
buffer_load_dwordx4 a[204:207], v17, s[28:31], s69 offen offset:0 sc1
ds_read_b128 a[32:35], v6 offset:24576
v_cvt_pk_bf16_f32 v121, v158, v159
v_mfma_f32_16x16x32_bf16 v[200:203], a[88:91], v[96:99], v[200:203]
v_exp_f32 v162, v86
v_mfma_f32_16x16x32_bf16 v[200:203], a[120:123], v[100:103], v[200:203]
ds_read_b128 a[36:39], v6 offset:25600
v_cvt_pk_bf16_f32 v122, v160, v161
v_mfma_f32_16x16x32_bf16 v[204:207], a[92:95], v[96:99], v[204:207]
v_exp_f32 v163, v87
v_mfma_f32_16x16x32_bf16 v[204:207], a[124:127], v[100:103], v[204:207]
buffer_load_dwordx4 a[208:211], v14, s[28:31], s69 offen offset:1024 sc1
ds_read_b128 a[40:43], v6 offset:26624
ds_read_b128 a[44:47], v6 offset:27648
v_mfma_f32_16x16x32_bf16 v[136:139], v[152:155], v[112:115], v[128:131]
v_exp_f32 v156, v88
v_mfma_f32_16x16x32_bf16 v[136:139], v[152:155], v[116:119], v[136:139]
ds_read_b128 a[48:51], v6 offset:28672
v_cvt_pk_bf16_f32 v123, v162, v163
v_mfma_f32_16x16x32_bf16 v[208:211], a[64:67], v[104:107], v[208:211]
v_exp_f32 v157, v89
v_mfma_f32_16x16x32_bf16 v[208:211], a[96:99], v[108:111], v[208:211]
buffer_load_dwordx4 a[212:215], v15, s[28:31], s69 offen offset:1024 sc1
ds_read_b128 a[52:55], v6 offset:29696
ds_read_b128 a[56:59], v6 offset:30720
v_mfma_f32_16x16x32_bf16 v[212:215], a[68:71], v[104:107], v[212:215]
v_exp_f32 v158, v90
v_mfma_f32_16x16x32_bf16 v[212:215], a[100:103], v[108:111], v[212:215]
ds_read_b128 a[60:63], v6 offset:31744
v_cvt_pk_bf16_f32 v124, v156, v157
v_mfma_f32_16x16x32_bf16 v[216:219], a[72:75], v[104:107], v[216:219]
v_exp_f32 v159, v91
v_mfma_f32_16x16x32_bf16 v[216:219], a[104:107], v[108:111], v[216:219]
buffer_load_dwordx4 a[216:219], v16, s[28:31], s69 offen offset:1024 sc1
v_subrev_u32 v10, s52, v136
v_cvt_pk_bf16_f32 v125, v158, v159
v_mfma_f32_16x16x32_bf16 v[220:223], a[76:79], v[104:107], v[220:223]
v_exp_f32 v160, v92
v_mfma_f32_16x16x32_bf16 v[220:223], a[108:111], v[108:111], v[220:223]
v_cmp_lt_u32 vcc, s53, v10
v_mfma_f32_16x16x32_bf16 v[224:227], a[80:83], v[104:107], v[224:227]
v_exp_f32 v161, v93
v_mfma_f32_16x16x32_bf16 v[224:227], a[112:115], v[108:111], v[224:227]
buffer_load_dwordx4 a[220:223], v17, s[28:31], s69 offen offset:1024 sc1
v_cvt_pk_bf16_f32 v126, v160, v161
v_mfma_f32_16x16x32_bf16 v[228:231], a[84:87], v[104:107], v[228:231]
s_cbranch_vccnz K2_TR30
K2_RT30:
v_mfma_f32_16x16x32_bf16 v[228:231], a[116:119], v[108:111], v[228:231]
v_mfma_f32_16x16x32_bf16 v[232:235], a[88:91], v[104:107], v[232:235]
v_exp_f32 v162, v94
v_mfma_f32_16x16x32_bf16 v[232:235], a[120:123], v[108:111], v[232:235]
v_mfma_f32_16x16x32_bf16 v[236:239], a[92:95], v[104:107], v[236:239]
v_exp_f32 v163, v95
v_mfma_f32_16x16x32_bf16 v[236:239], a[124:127], v[108:111], v[236:239]
v_cvt_pk_bf16_f32 v127, v162, v163
s_branch K2_T34
K2_P0:
s_lshl_b32 s64, s3, 12
s_mov_b32 s67, s70
s_lshl_b32 s47, s42, 7
s_add_u32 s51, s47, 2753536
s_sub_u32 s50, 2755456, s47
s_mov_b32 s69, 4096
s_mov_b32 s70, 8192
s_mov_b32 s71, 12288
s_mov_b32 s72, 16384
s_mov_b32 s73, 20480
s_mov_b32 s74, 24576
s_mov_b32 s75, 28672
s_waitcnt vmcnt(16) lgkmcnt(0)
s_barrier
v_mfma_f32_16x16x32_bf16 v[132:135], v[152:155], v[104:107], 0
v_exp_f32 v156, v64
v_mfma_f32_16x16x32_bf16 v[132:135], v[152:155], v[108:111], v[132:135]
s_add_u32 m0, s64, 49152
s_nop 0
buffer_load_dwordx4 v14, s[28:31], s72 offen offset:0 sc1 lds
ds_read_b128 a[64:67], v6 offset:49152
ds_read_b128 a[68:71], v6 offset:50176
v_exp_f32 v157, v65
ds_read_b128 a[72:75], v6 offset:51200
ds_read_b128 a[76:79], v6 offset:52224
v_exp_f32 v158, v66
buffer_load_dwordx4 v14, s[28:31], s72 offen offset:1024 sc1 lds
ds_read_b128 a[80:83], v6 offset:53248
v_cvt_pk_bf16_f32 v112, v156, v157
v_exp_f32 v159, v67
ds_read_b128 a[84:87], v6 offset:54272
v_subrev_u32 v10, s52, v132
v_exp_f32 v160, v68
buffer_load_dwordx4 v14, s[28:31], s72 offen offset:2048 sc1 lds
ds_read_b128 a[88:91], v6 offset:55296
v_cmp_lt_u32 vcc, s53, v10
v_exp_f32 v161, v69
ds_read_b128 a[92:95], v6 offset:56320
v_cvt_pk_bf16_f32 v113, v158, v159
s_cbranch_vccnz K2_TR31
K2_RT31:
buffer_load_dwordx4 v14, s[28:31], s72 offen offset:3072 sc1 lds
ds_read_b128 a[96:99], v6 offset:57344
ds_read_b128 a[100:103], v6 offset:58368
v_exp_f32 v162, v70
ds_read_b128 a[104:107], v6 offset:59392
v_cvt_pk_bf16_f32 v114, v160, v161
v_exp_f32 v163, v71
s_add_u32 m0, s64, 81920
s_nop 0
buffer_load_dwordx4 v15, s[28:31], s72 offen offset:0 sc1 lds
ds_read_b128 a[108:111], v6 offset:60416
ds_read_b128 a[112:115], v6 offset:61440
v_exp_f32 v156, v72
ds_read_b128 a[116:119], v6 offset:62464
v_cvt_pk_bf16_f32 v115, v162, v163
v_exp_f32 v157, v73
buffer_load_dwordx4 v15, s[28:31], s72 offen offset:1024 sc1 lds
ds_read_b128 a[120:123], v6 offset:63488
ds_read_b128 a[124:127], v6 offset:64512
v_exp_f32 v158, v74
v_cvt_pk_bf16_f32 v116, v156, v157
v_exp_f32 v159, v75
buffer_load_dwordx4 v15, s[28:31], s72 offen offset:2048 sc1 lds
v_cvt_pk_bf16_f32 v117, v158, v159
v_exp_f32 v160, v76
v_exp_f32 v161, v77
buffer_load_dwordx4 v15, s[28:31], s72 offen offset:3072 sc1 lds
v_cvt_pk_bf16_f32 v118, v160, v161
v_exp_f32 v162, v78
v_exp_f32 v163, v79
buffer_load_dwordx4 a[192:195], v14, s[28:31], s69 offen offset:0 sc1
s_waitcnt lgkmcnt(0)
v_xor_b32 v6, 0x10000, v6
v_exp_f32 v156, v80
ds_read_b128 a[0:3], v6 offset:16384
ds_read_b128 a[4:7], v6 offset:17408
v_exp_f32 v157, v81
buffer_load_dwordx4 a[196:199], v15, s[28:31], s69 offen offset:0 sc1
ds_read_b128 a[8:11], v6 offset:18432
v_cvt_pk_bf16_f32 v119, v162, v163
v_exp_f32 v158, v82
ds_read_b128 a[12:15], v6 offset:19456
ds_read_b128 a[16:19], v6 offset:20480
v_exp_f32 v159, v83
buffer_load_dwordx4 a[200:203], v16, s[28:31], s69 offen offset:0 sc1
ds_read_b128 a[20:23], v6 offset:21504
v_cvt_pk_bf16_f32 v120, v156, v157
v_exp_f32 v160, v84
ds_read_b128 a[24:27], v6 offset:22528
ds_read_b128 a[28:31], v6 offset:23552
v_exp_f32 v161, v85
buffer_load_dwordx4 a[204:207], v17, s[28:31], s69 offen offset:0 sc1
ds_read_b128 a[32:35], v6 offset:24576
v_cvt_pk_bf16_f32 v121, v158, v159
v_exp_f32 v162, v86
ds_read_b128 a[36:39], v6 offset:25600
v_cvt_pk_bf16_f32 v122, v160, v161
v_exp_f32 v163, v87
buffer_load_dwordx4 a[208:211], v14, s[28:31], s69 offen offset:1024 sc1
ds_read_b128 a[40:43], v6 offset:26624
ds_read_b128 a[44:47], v6 offset:27648
v_mfma_f32_16x16x32_bf16 v[136:139], v[152:155], v[112:115], 0
v_exp_f32 v156, v88
v_mfma_f32_16x16x32_bf16 v[136:139], v[152:155], v[116:119], v[136:139]
ds_read_b128 a[48:51], v6 offset:28672
v_cvt_pk_bf16_f32 v123, v162, v163
v_mfma_f32_16x16x32_bf16 v[208:211], a[64:67], v[104:107], 0
v_exp_f32 v157, v89
v_mfma_f32_16x16x32_bf16 v[208:211], a[96:99], v[108:111], v[208:211]
buffer_load_dwordx4 a[212:215], v15, s[28:31], s69 offen offset:1024 sc1
ds_read_b128 a[52:55], v6 offset:29696
ds_read_b128 a[56:59], v6 offset:30720
v_mfma_f32_16x16x32_bf16 v[212:215], a[68:71], v[104:107], 0
v_exp_f32 v158, v90
v_mfma_f32_16x16x32_bf16 v[212:215], a[100:103], v[108:111], v[212:215]
ds_read_b128 a[60:63], v6 offset:31744
v_cvt_pk_bf16_f32 v124, v156, v157
v_mfma_f32_16x16x32_bf16 v[216:219], a[72:75], v[104:107], 0
v_exp_f32 v159, v91
v_mfma_f32_16x16x32_bf16 v[216:219], a[104:107], v[108:111], v[216:219]
buffer_load_dwordx4 a[216:219], v16, s[28:31], s69 offen offset:1024 sc1
v_subrev_u32 v10, s52, v136
v_cvt_pk_bf16_f32 v125, v158, v159
v_mfma_f32_16x16x32_bf16 v[220:223], a[76:79], v[104:107], 0
v_exp_f32 v160, v92
v_mfma_f32_16x16x32_bf16 v[220:223], a[108:111], v[108:111], v[220:223]
v_cmp_lt_u32 vcc, s53, v10
v_mfma_f32_16x16x32_bf16 v[224:227], a[80:83], v[104:107], 0
v_exp_f32 v161, v93
v_mfma_f32_16x16x32_bf16 v[224:227], a[112:115], v[108:111], v[224:227]
buffer_load_dwordx4 a[220:223], v17, s[28:31], s69 offen offset:1024 sc1
v_cvt_pk_bf16_f32 v126, v160, v161
v_mfma_f32_16x16x32_bf16 v[228:231], a[84:87], v[104:107], 0
s_cbranch_vccnz K2_TR32
K2_RT32:
v_mfma_f32_16x16x32_bf16 v[228:231], a[116:119], v[108:111], v[228:231]
v_mfma_f32_16x16x32_bf16 v[232:235], a[88:91], v[104:107], 0
v_exp_f32 v162, v94
v_mfma_f32_16x16x32_bf16 v[232:235], a[120:123], v[108:111], v[232:235]
v_mfma_f32_16x16x32_bf16 v[236:239], a[92:95], v[104:107], 0
v_exp_f32 v163, v95
v_mfma_f32_16x16x32_bf16 v[236:239], a[124:127], v[108:111], v[236:239]
v_cvt_pk_bf16_f32 v127, v162, v163
v_mov_b32 v13, v30
s_waitcnt vmcnt(16)
K2_T34:
s_waitcnt vmcnt(63) lgkmcnt(0)
s_barrier
buffer_store_dword v31, v13, s[28:31], s100 offen sc1
v_mfma_f32_16x16x32_bf16 v[140:143], v[152:155], v[120:123], v[132:135]
v_mfma_f32_16x16x32_bf16 v[140:143], v[152:155], v[124:127], v[140:143]
s_nop 7
v_subrev_u32 v10, s52, v140
v_cmp_lt_u32 vcc, s53, v10
s_cbranch_vccnz K2_TR33
K2_RT33:
s_waitcnt lgkmcnt(0)
v_mfma_f32_16x16x32_bf16 v[176:179], a[0:3], v[112:115], v[176:179]
v_max3_u32 v240, v240, v241, v242
v_max3_u32 v240, v240, v243, v244
v_max3_u32 v240, v240, v245, v246
v_mfma_f32_16x16x32_bf16 v[176:179], a[32:35], v[116:119], v[176:179]
s_add_u32 m0, s64, 114688
s_nop 0
buffer_load_dwordx4 v16, s[28:31], s72 offen offset:0 sc1 lds
v_max3_u32 v240, v240, v247, v248
v_max3_u32 v240, v240, v249, v250
v_mfma_f32_16x16x32_bf16 v[180:183], a[4:7], v[112:115], v[180:183]
v_max3_u32 v240, v240, v251, v252
v_max3_u32 v240, v240, v253, v254
v_mfma_f32_16x16x32_bf16 v[180:183], a[36:39], v[116:119], v[180:183]
buffer_load_dwordx4 v16, s[28:31], s72 offen offset:1024 sc1 lds
v_max_u32 v240, v240, v255
v_mfma_f32_16x16x32_bf16 v[184:187], a[8:11], v[112:115], v[184:187]
s_nop 1
v_max_u32_dpp v240, v240, v240 row_ror:8 row_mask:0xf bank_mask:0xf
v_mfma_f32_16x16x32_bf16 v[184:187], a[40:43], v[116:119], v[184:187]
buffer_load_dwordx4 v16, s[28:31], s72 offen offset:2048 sc1 lds
s_nop 1
v_mfma_f32_16x16x32_bf16 v[188:191], a[12:15], v[112:115], v[188:191]
v_max_u32_dpp v240, v240, v240 row_ror:4 row_mask:0xf bank_mask:0xf
s_nop 1
v_max_u32_dpp v240, v240, v240 row_ror:2 row_mask:0xf bank_mask:0xf
v_mfma_f32_16x16x32_bf16 v[188:191], a[44:47], v[116:119], v[188:191]
buffer_load_dwordx4 v16, s[28:31], s72 offen offset:3072 sc1 lds
s_nop 1
v_mfma_f32_16x16x32_bf16 v[192:195], a[16:19], v[112:115], v[192:195]
v_max_u32_dpp v240, v240, v240 row_ror:1 row_mask:0xf bank_mask:0xf
v_mov_b32 v241, v240
v_mfma_f32_16x16x32_bf16 v[192:195], a[48:51], v[116:119], v[192:195]
s_nop 1
v_permlane16_swap_b32 v240, v241
v_mfma_f32_16x16x32_bf16 v[196:199], a[20:23], v[112:115], v[196:199]
v_max_u32 v240, v240, v241
v_mov_b32 v241, v240
v_mfma_f32_16x16x32_bf16 v[196:199], a[52:55], v[116:119], v[196:199]
s_add_u32 m0, s64, 16384
s_nop 0
buffer_load_dwordx4 v17, s[28:31], s72 offen offset:0 sc1 lds
s_nop 1
v_mfma_f32_16x16x32_bf16 v[200:203], a[24:27], v[112:115], v[200:203]
v_permlane32_swap_b32 v240, v241
v_max_u32 v240, v240, v241
v_mfma_f32_16x16x32_bf16 v[200:203], a[56:59], v[116:119], v[200:203]
buffer_load_dwordx4 v17, s[28:31], s72 offen offset:1024 sc1 lds
v_not_b32 v241, v240
v_readfirstlane_b32 s66, v240
v_mfma_f32_16x16x32_bf16 v[204:207], a[28:31], v[112:115], v[204:207]
v_bfe_u32 v242, v241, 4, 12
v_and_b32 v241, 15, v241
v_mfma_f32_16x16x32_bf16 v[204:207], a[60:63], v[116:119], v[204:207]
buffer_load_dwordx4 v17, s[28:31], s72 offen offset:2048 sc1 lds
v_lshlrev_b32 v242, 14, v242
v_lshl_add_u32 v242, v241, 4, v242
v_lshrrev_b32 v241, 2, v0
buffer_load_dwordx4 v17, s[28:31], s72 offen offset:3072 sc1 lds
v_lshl_add_u32 v242, v241, 8, v242
v_mfma_f32_16x16x32_bf16 v[208:211], a[0:3], v[120:123], v[208:211]
v_and_b32 v241, 3, v0
v_lshl_add_u32 v242, v241, 2, v242
v_mfma_f32_16x16x32_bf16 v[208:211], a[32:35], v[124:127], v[208:211]
buffer_load_dword v244, v242, s[28:31], 0 offen sc1
v_mfma_f32_16x16x32_bf16 v[212:215], a[4:7], v[120:123], v[212:215]
v_mfma_f32_16x16x32_bf16 v[212:215], a[36:39], v[124:127], v[212:215]
v_rcp_f32 v164, v136
s_nop 0
v_mfma_f32_16x16x32_bf16 v[216:219], a[8:11], v[120:123], v[216:219]
v_mul_f32 v176, v176, v164
v_mul_f32 v177, v177, v164
v_mul_f32 v178, v178, v164
v_mfma_f32_16x16x32_bf16 v[216:219], a[40:43], v[124:127], v[216:219]
v_mul_f32 v179, v179, v164
v_mul_f32 v180, v180, v164
v_mfma_f32_16x16x32_bf16 v[220:223], a[12:15], v[120:123], v[220:223]
v_mul_f32 v181, v181, v164
v_mul_f32 v182, v182, v164
v_mfma_f32_16x16x32_bf16 v[220:223], a[44:47], v[124:127], v[220:223]
v_mul_f32 v183, v183, v164
v_cvt_pk_bf16_f32 v168, v176, v177
v_cvt_pk_bf16_f32 v169, v178, v179
v_mfma_f32_16x16x32_bf16 v[224:227], a[16:19], v[120:123], v[224:227]
v_cvt_pk_bf16_f32 v170, v180, v181
v_cvt_pk_bf16_f32 v171, v182, v183
v_mfma_f32_16x16x32_bf16 v[224:227], a[48:51], v[124:127], v[224:227]
buffer_store_dwordx4 v[168:171], v11, s[28:31], s58 offen offset:0 sc1
v_mul_f32 v184, v184, v164
v_mfma_f32_16x16x32_bf16 v[228:231], a[20:23], v[120:123], v[228:231]
v_mul_f32 v185, v185, v164
v_mul_f32 v186, v186, v164
v_mfma_f32_16x16x32_bf16 v[228:231], a[52:55], v[124:127], v[228:231]
v_mul_f32 v187, v187, v164
v_mul_f32 v188, v188, v164
v_mul_f32 v189, v189, v164
v_mfma_f32_16x16x32_bf16 v[232:235], a[24:27], v[120:123], v[232:235]
v_mul_f32 v190, v190, v164
v_mul_f32 v191, v191, v164
v_mfma_f32_16x16x32_bf16 v[232:235], a[56:59], v[124:127], v[232:235]
v_cvt_pk_bf16_f32 v172, v184, v185
v_cvt_pk_bf16_f32 v173, v186, v187
v_mfma_f32_16x16x32_bf16 v[236:239], a[28:31], v[120:123], v[236:239]
v_cvt_pk_bf16_f32 v174, v188, v189
v_cvt_pk_bf16_f32 v175, v190, v191
v_mfma_f32_16x16x32_bf16 v[236:239], a[60:63], v[124:127], v[236:239]
buffer_store_dwordx4 v[172:175], v11, s[28:31], s58 offen offset:1024 sc1
v_pk_mul_f32 v[192:193], v[192:193], v[164:165] op_sel:[0,0] op_sel_hi:[1,0]
v_pk_mul_f32 v[194:195], v[194:195], v[164:165] op_sel:[0,0] op_sel_hi:[1,0]
v_pk_mul_f32 v[196:197], v[196:197], v[164:165] op_sel:[0,0] op_sel_hi:[1,0]
v_pk_mul_f32 v[198:199], v[198:199], v[164:165] op_sel:[0,0] op_sel_hi:[1,0]
v_cvt_pk_bf16_f32 v168, v192, v193
v_cvt_pk_bf16_f32 v169, v194, v195
v_cvt_pk_bf16_f32 v170, v196, v197
v_cvt_pk_bf16_f32 v171, v198, v199
buffer_store_dwordx4 v[168:171], v11, s[28:31], s58 offen offset:2048 sc1
v_pk_mul_f32 v[200:201], v[200:201], v[164:165] op_sel:[0,0] op_sel_hi:[1,0]
v_pk_mul_f32 v[202:203], v[202:203], v[164:165] op_sel:[0,0] op_sel_hi:[1,0]
v_pk_mul_f32 v[204:205], v[204:205], v[164:165] op_sel:[0,0] op_sel_hi:[1,0]
v_pk_mul_f32 v[206:207], v[206:207], v[164:165] op_sel:[0,0] op_sel_hi:[1,0]
v_cvt_pk_bf16_f32 v172, v200, v201
v_cvt_pk_bf16_f32 v173, v202, v203
v_cvt_pk_bf16_f32 v174, v204, v205
v_cvt_pk_bf16_f32 v175, v206, v207
buffer_store_dwordx4 v[172:175], v11, s[28:31], s58 offen offset:3072 sc1
s_add_u32 s58, s58, 524288
v_rcp_f32 v165, v140
s_nop 0
v_pk_mul_f32 v[208:209], v[208:209], v[164:165] op_sel:[0,1] op_sel_hi:[1,1]
v_pk_mul_f32 v[210:211], v[210:211], v[164:165] op_sel:[0,1] op_sel_hi:[1,1]
v_pk_mul_f32 v[212:213], v[212:213], v[164:165] op_sel:[0,1] op_sel_hi:[1,1]
v_pk_mul_f32 v[214:215], v[214:215], v[164:165] op_sel:[0,1] op_sel_hi:[1,1]
v_cvt_pk_bf16_f32 v168, v208, v209
v_cvt_pk_bf16_f32 v169, v210, v211
v_cvt_pk_bf16_f32 v170, v212, v213
v_cvt_pk_bf16_f32 v171, v214, v215
buffer_store_dwordx4 v[168:171], v11, s[28:31], s58 offen offset:0 sc1
v_pk_mul_f32 v[216:217], v[216:217], v[164:165] op_sel:[0,1] op_sel_hi:[1,1]
v_pk_mul_f32 v[218:219], v[218:219], v[164:165] op_sel:[0,1] op_sel_hi:[1,1]
v_pk_mul_f32 v[220:221], v[220:221], v[164:165] op_sel:[0,1] op_sel_hi:[1,1]
v_pk_mul_f32 v[222:223], v[222:223], v[164:165] op_sel:[0,1] op_sel_hi:[1,1]
v_cvt_pk_bf16_f32 v172, v216, v217
v_cvt_pk_bf16_f32 v173, v218, v219
v_cvt_pk_bf16_f32 v174, v220, v221
v_cvt_pk_bf16_f32 v175, v222, v223
buffer_store_dwordx4 v[172:175], v11, s[28:31], s58 offen offset:1024 sc1
v_pk_mul_f32 v[224:225], v[224:225], v[164:165] op_sel:[0,1] op_sel_hi:[1,1]
v_pk_mul_f32 v[226:227], v[226:227], v[164:165] op_sel:[0,1] op_sel_hi:[1,1]
v_pk_mul_f32 v[228:229], v[228:229], v[164:165] op_sel:[0,1] op_sel_hi:[1,1]
v_pk_mul_f32 v[230:231], v[230:231], v[164:165] op_sel:[0,1] op_sel_hi:[1,1]
v_cvt_pk_bf16_f32 v168, v224, v225
v_cvt_pk_bf16_f32 v169, v226, v227
v_cvt_pk_bf16_f32 v170, v228, v229
v_cvt_pk_bf16_f32 v171, v230, v231
buffer_store_dwordx4 v[168:171], v11, s[28:31], s58 offen offset:2048 sc1
v_pk_mul_f32 v[232:233], v[232:233], v[164:165] op_sel:[0,1] op_sel_hi:[1,1]
v_pk_mul_f32 v[234:235], v[234:235], v[164:165] op_sel:[0,1] op_sel_hi:[1,1]
v_pk_mul_f32 v[236:237], v[236:237], v[164:165] op_sel:[0,1] op_sel_hi:[1,1]
v_pk_mul_f32 v[238:239], v[238:239], v[164:165] op_sel:[0,1] op_sel_hi:[1,1]
v_cvt_pk_bf16_f32 v172, v232, v233
v_cvt_pk_bf16_f32 v173, v234, v235
v_cvt_pk_bf16_f32 v174, v236, v237
v_cvt_pk_bf16_f32 v175, v238, v239
buffer_store_dwordx4 v[172:175], v11, s[28:31], s58 offen offset:3072 sc1
s_mov_b32 s12, s94
s_and_b32 s13, s95, 0xffff
s_mov_b32 s14, 0x200000
s_mov_b32 s15, 0x20000
v_and_b32 v8, 15, v1
v_lshrrev_b32 v9, 4, v1
v_lshlrev_b32 v12, 10, v8
v_lshl_add_u32 v12, v9, 4, v12
s_lshl_b32 s47, s76, 1
s_sub_u32 s47, s47, 2
s_lshl_b32 s48, s67, 1
s_cmp_lt_u32 s3, 2
s_cselect_b32 s59, s48, s47
s_add_u32 s59, s59, s3
s_lshl_b32 s47, s59, 14
s_lshl_b32 s48, s77, 7
s_add_u32 s55, s47, s48
s_lshl_b32 s48, s77, 11
s_add_u32 s54, s47, s48
buffer_load_dwordx4 v[96:99], v12, s[8:11], s55 offen
buffer_load_dwordx4 v[100:103], v12, s[8:11], s55 offen offset:64
buffer_load_dwordx4 v[104:107], v3, s[28:31], s54 offen sc1
buffer_load_dwordx4 v[108:111], v3, s[28:31], s54 offen offset:1024 sc1
v_accvgpr_read_b32 v64, a128
v_accvgpr_read_b32 v65, a129
v_accvgpr_read_b32 v66, a130
v_accvgpr_read_b32 v67, a131
v_accvgpr_read_b32 v68, a132
v_accvgpr_read_b32 v69, a133
v_accvgpr_read_b32 v70, a134
v_accvgpr_read_b32 v71, a135
v_accvgpr_read_b32 v72, a136
buffer_load_dwordx4 a[80:83], v14, s[28:31], s69 offen offset:2048 sc1
v_accvgpr_read_b32 v73, a137
v_accvgpr_read_b32 v74, a138
v_accvgpr_read_b32 v75, a139
v_accvgpr_read_b32 v76, a140
v_accvgpr_read_b32 v77, a141
v_accvgpr_read_b32 v78, a142
v_accvgpr_read_b32 v79, a143
v_accvgpr_read_b32 v80, a144
v_accvgpr_read_b32 v81, a145
v_accvgpr_read_b32 v82, a146
v_accvgpr_read_b32 v83, a147
v_accvgpr_read_b32 v84, a148
v_accvgpr_read_b32 v85, a149
v_accvgpr_read_b32 v86, a150
v_accvgpr_read_b32 v87, a151
s_waitcnt vmcnt(13)
v_lshlrev_b32 v245, 16, v244
v_and_b32 v244, 0xffff0000, v244
v_lshlrev_b32 v48, 16, v64
v_and_b32 v49, 0xffff0000, v64
v_lshlrev_b32 v50, 16, v65
v_and_b32 v51, 0xffff0000, v65
v_lshlrev_b32 v52, 16, v66
v_and_b32 v53, 0xffff0000, v66
v_lshlrev_b32 v54, 16, v67
v_and_b32 v55, 0xffff0000, v67
v_mul_f32 v32, v48, v245
v_mul_f32 v33, v49, v245
v_mul_f32 v34, v50, v245
v_mul_f32 v35, v51, v245
v_mul_f32 v36, v52, v245
buffer_load_dwordx4 a[84:87], v15, s[28:31], s69 offen offset:2048 sc1
v_mul_f32 v37, v53, v245
v_mul_f32 v38, v54, v245
v_mul_f32 v39, v55, v245
v_lshlrev_b32 v48, 16, v68
v_and_b32 v49, 0xffff0000, v68
v_lshlrev_b32 v50, 16, v69
v_and_b32 v51, 0xffff0000, v69
v_lshlrev_b32 v52, 16, v70
v_and_b32 v53, 0xffff0000, v70
v_lshlrev_b32 v54, 16, v71
v_and_b32 v55, 0xffff0000, v71
v_fmac_f32 v32, v48, v244
v_fmac_f32 v33, v49, v244
v_fmac_f32 v34, v50, v244
v_fmac_f32 v35, v51, v244
v_fmac_f32 v36, v52, v244
v_fmac_f32 v37, v53, v244
v_fmac_f32 v38, v54, v244
v_fmac_f32 v39, v55, v244
v_lshlrev_b32 v48, 16, v72
v_and_b32 v49, 0xffff0000, v72
v_lshlrev_b32 v50, 16, v73
v_and_b32 v51, 0xffff0000, v73
v_lshlrev_b32 v52, 16, v74
v_and_b32 v53, 0xffff0000, v74
v_lshlrev_b32 v54, 16, v75
v_and_b32 v55, 0xffff0000, v75
v_mul_f32 v40, v48, v245
v_mul_f32 v41, v49, v245
v_mul_f32 v42, v50, v245
v_mul_f32 v43, v51, v245
buffer_load_dwordx4 a[88:91], v16, s[28:31], s69 offen offset:2048 sc1
v_mul_f32 v44, v52, v245
v_mul_f32 v45, v53, v245
v_mul_f32 v46, v54, v245
v_mul_f32 v47, v55, v245
v_lshlrev_b32 v48, 16, v76
v_and_b32 v49, 0xffff0000, v76
v_lshlrev_b32 v50, 16, v77
v_and_b32 v51, 0xffff0000, v77
v_lshlrev_b32 v52, 16, v78
v_and_b32 v53, 0xffff0000, v78
v_lshlrev_b32 v54, 16, v79
v_and_b32 v55, 0xffff0000, v79
v_fmac_f32 v40, v48, v244
v_fmac_f32 v41, v49, v244
v_fmac_f32 v42, v50, v244
v_fmac_f32 v43, v51, v244
v_fmac_f32 v44, v52, v244
v_fmac_f32 v45, v53, v244
v_fmac_f32 v46, v54, v244
v_fmac_f32 v47, v55, v244
s_nop 1
v_permlane32_swap_b32 v32, v40
v_permlane32_swap_b32 v33, v41
v_permlane32_swap_b32 v34, v42
v_permlane32_swap_b32 v35, v43
v_permlane32_swap_b32 v36, v44
v_permlane32_swap_b32 v37, v45
v_permlane32_swap_b32 v38, v46
v_permlane32_swap_b32 v39, v47
v_add_f32 v32, v32, v40
v_add_f32 v33, v33, v41
buffer_load_dwordx4 a[92:95], v17, s[28:31], s69 offen offset:2048 sc1
v_add_f32 v34, v34, v42
v_add_f32 v35, v35, v43
v_add_f32 v36, v36, v44
v_add_f32 v37, v37, v45
v_add_f32 v38, v38, v46
v_add_f32 v39, v39, v47
s_nop 1
v_permlane16_swap_b32 v32, v36
v_permlane16_swap_b32 v33, v37
v_permlane16_swap_b32 v34, v38
v_permlane16_swap_b32 v35, v39
v_add_f32 v32, v32, v36
v_add_f32 v33, v33, v37
v_add_f32 v34, v34, v38
v_add_f32 v35, v35, v39
v_add_f32_dpp v32, v32, v32 row_ror:8 row_mask:0xf bank_mask:0xf
v_add_f32_dpp v33, v33, v33 row_ror:8 row_mask:0xf bank_mask:0xf
v_add_f32_dpp v34, v34, v34 row_ror:8 row_mask:0xf bank_mask:0xf
v_add_f32_dpp v35, v35, v35 row_ror:8 row_mask:0xf bank_mask:0xf
v_add_f32_dpp v32, v32, v32 row_ror:4 row_mask:0xf bank_mask:0xf
v_add_f32_dpp v33, v33, v33 row_ror:4 row_mask:0xf bank_mask:0xf
v_add_f32_dpp v34, v34, v34 row_ror:4 row_mask:0xf bank_mask:0xf
v_add_f32_dpp v35, v35, v35 row_ror:4 row_mask:0xf bank_mask:0xf
v_add_f32_dpp v32, v32, v32 row_ror:2 row_mask:0xf bank_mask:0xf
v_add_f32_dpp v33, v33, v33 row_ror:2 row_mask:0xf bank_mask:0xf
v_add_f32_dpp v34, v34, v34 row_ror:2 row_mask:0xf bank_mask:0xf
v_add_f32_dpp v35, v35, v35 row_ror:2 row_mask:0xf bank_mask:0xf
v_add_f32_dpp v32, v32, v32 row_ror:1 row_mask:0xf bank_mask:0xf
v_add_f32_dpp v33, v33, v33 row_ror:1 row_mask:0xf bank_mask:0xf
v_add_f32_dpp v34, v34, v34 row_ror:1 row_mask:0xf bank_mask:0xf
v_add_f32_dpp v35, v35, v35 row_ror:1 row_mask:0xf bank_mask:0xf
buffer_load_dwordx4 a[96:99], v14, s[28:31], s69 offen offset:3072 sc1
v_lshrrev_b32 v10, 4, v0
v_lshlrev_b32 v10, 4, v10
v_add_u32 v10, 131072, v10
ds_write_b128 v10, v[32:35]
v_and_b32 v10, 7, v0
v_lshlrev_b32 v10, 2, v10
v_add_u32 v10, 131072, v10
s_mov_b32 s58, s66
s_not_b32 s25, s58
s_and_b32 s25, s25, 0xffff
s_lshr_b32 s26, s25, 5
s_cmp_eq_u32 s26, s76
s_cselect_b32 s27, 1, 0
s_cmp_eq_u32 s26, s67
s_cselect_b32 s27, 1, s27
v_add_u32 v6, s64, v3
buffer_load_dword v29, v2, s[28:31], s50 offen sc1
v_add_u32 v7, 0x10000, v6
buffer_load_dwordx4 a[100:103], v15, s[28:31], s69 offen offset:3072 sc1
s_waitcnt vmcnt(11) lgkmcnt(0)
s_barrier
buffer_store_dword v31, v30, s[28:31], s99 offen sc1
s_waitcnt vmcnt(2)
v_cmp_ne_u32 vcc, 0, v29
s_or_b64 vcc, vcc, s[96:97]
s_cmp_eq_u32 vcc_lo, -1
s_cbranch_scc0 M_SPINCTB
M_SRETCTB:
s_barrier
buffer_load_dwordx4 a[0:3], v18, s[28:31], 0 offen offset:0 sc1
buffer_load_dwordx4 a[4:7], v19, s[28:31], 0 offen offset:0 sc1
buffer_load_dwordx4 a[8:11], v18, s[28:31], 0 offen offset:1024 sc1
buffer_load_dwordx4 a[12:15], v19, s[28:31], 0 offen offset:1024 sc1
buffer_load_dwordx4 a[16:19], v18, s[28:31], 0 offen offset:2048 sc1
buffer_load_dwordx4 a[20:23], v19, s[28:31], 0 offen offset:2048 sc1
buffer_load_dwordx4 a[24:27], v18, s[28:31], 0 offen offset:3072 sc1
buffer_load_dwordx4 a[28:31], v19, s[28:31], 0 offen offset:3072 sc1
buffer_load_dwordx4 a[104:107], v16, s[28:31], s69 offen offset:3072 sc1
buffer_load_dwordx4 a[108:111], v17, s[28:31], s69 offen offset:3072 sc1
buffer_load_dwordx4 a[112:115], v14, s[28:31], s70 offen offset:0 sc1
buffer_load_dwordx4 a[116:119], v15, s[28:31], s70 offen offset:0 sc1
buffer_load_dwordx4 a[120:123], v16, s[28:31], s70 offen offset:0 sc1
buffer_load_dwordx4 a[124:127], v17, s[28:31], s70 offen offset:0 sc1
buffer_load_dwordx4 a[128:131], v14, s[28:31], s70 offen offset:1024 sc1
buffer_load_dwordx4 a[132:135], v15, s[28:31], s70 offen offset:1024 sc1
buffer_load_dwordx4 a[136:139], v16, s[28:31], s70 offen offset:1024 sc1
buffer_load_dwordx4 a[140:143], v17, s[28:31], s70 offen offset:1024 sc1
buffer_load_dwordx4 a[144:147], v14, s[28:31], s70 offen offset:2048 sc1
buffer_load_dwordx4 a[148:151], v15, s[28:31], s70 offen offset:2048 sc1
buffer_load_dwordx4 a[152:155], v16, s[28:31], s70 offen offset:2048 sc1
buffer_load_dwordx4 a[156:159], v17, s[28:31], s70 offen offset:2048 sc1
buffer_load_dwordx4 a[32:35], v18, s[28:31], s69 offen offset:0 sc1
buffer_load_dwordx4 a[36:39], v19, s[28:31], s69 offen offset:0 sc1
buffer_load_dwordx4 a[40:43], v18, s[28:31], s69 offen offset:1024 sc1
buffer_load_dwordx4 a[44:47], v19, s[28:31], s69 offen offset:1024 sc1
buffer_load_dwordx4 a[48:51], v18, s[28:31], s69 offen offset:2048 sc1
buffer_load_dwordx4 a[52:55], v19, s[28:31], s69 offen offset:2048 sc1
buffer_load_dwordx4 a[56:59], v18, s[28:31], s69 offen offset:3072 sc1
buffer_load_dwordx4 a[60:63], v19, s[28:31], s69 offen offset:3072 sc1
s_waitcnt vmcnt(28)
v_mfma_f32_16x16x32_bf16 v[128:131], a[224:227], a[0:3], 0
buffer_load_dwordx4 a[64:67], v18, s[28:31], s70 offen offset:0 sc1
ds_read_b32 v32, v10 offset:0
v_mfma_f32_16x16x32_bf16 v[144:147], a[224:227], a[4:7], 0
buffer_load_dwordx4 a[68:71], v19, s[28:31], s70 offen offset:0 sc1
ds_read_b32 v36, v10 offset:32
v_mfma_f32_16x16x32_bf16 v[132:135], a[228:231], a[0:3], 0
ds_read_b32 v33, v10 offset:64
ds_read_b32 v37, v10 offset:96
v_mfma_f32_16x16x32_bf16 v[148:151], a[228:231], a[4:7], 0
ds_read_b32 v34, v10 offset:128
ds_read_b32 v38, v10 offset:160
v_mfma_f32_16x16x32_bf16 v[136:139], a[232:235], a[0:3], 0
ds_read_b32 v35, v10 offset:192
ds_read_b32 v39, v10 offset:224
v_mfma_f32_16x16x32_bf16 v[152:155], a[232:235], a[4:7], 0
s_waitcnt lgkmcnt(0)
v_mfma_f32_16x16x32_bf16 v[140:143], a[236:239], a[0:3], 0
v_add_f32 v32, v32, v33
v_add_f32 v34, v34, v35
v_mfma_f32_16x16x32_bf16 v[156:159], a[236:239], a[4:7], 0
s_waitcnt vmcnt(28)
v_mfma_f32_16x16x32_bf16 v[128:131], a[240:243], a[8:11], v[128:131]
buffer_load_dwordx4 a[72:75], v18, s[28:31], s70 offen offset:1024 sc1
v_add_f32 v32, v32, v34
v_mfma_f32_16x16x32_bf16 v[144:147], a[240:243], a[12:15], v[144:147]
buffer_load_dwordx4 a[76:79], v19, s[28:31], s70 offen offset:1024 sc1
v_cvt_pk_bf16_f32 v32, v32, v32
v_mfma_f32_16x16x32_bf16 v[132:135], a[244:247], a[8:11], v[132:135]
v_and_b32 v32, 0xffff0000, v32
v_add_f32 v36, v36, v37
v_mfma_f32_16x16x32_bf16 v[148:151], a[244:247], a[12:15], v[148:151]
v_add_f32 v38, v38, v39
v_add_f32 v36, v36, v38
v_mfma_f32_16x16x32_bf16 v[136:139], a[248:251], a[8:11], v[136:139]
v_cvt_pk_bf16_f32 v36, v36, v36
v_and_b32 v36, 0xffff0000, v36
v_mfma_f32_16x16x32_bf16 v[152:155], a[248:251], a[12:15], v[152:155]
v_mul_f32 v33, 0xbfb8aa3b, v32
v_mfma_f32_16x16x32_bf16 v[140:143], a[252:255], a[8:11], v[140:143]
v_exp_f32 v33, v33
v_mfma_f32_16x16x32_bf16 v[156:159], a[252:255], a[12:15], v[156:159]
s_nop 0
s_waitcnt vmcnt(28)
v_mfma_f32_16x16x32_bf16 v[128:131], a[160:163], a[16:19], v[128:131]
buffer_load_dwordx4 a[0:3], v18, s[28:31], s70 offen offset:2048 sc1
v_add_f32 v33, 1.0, v33
v_mfma_f32_16x16x32_bf16 v[144:147], a[160:163], a[20:23], v[144:147]
buffer_load_dwordx4 a[4:7], v19, s[28:31], s70 offen offset:2048 sc1
v_mfma_f32_16x16x32_bf16 v[132:135], a[164:167], a[16:19], v[132:135]
v_rcp_f32 v33, v33
v_mfma_f32_16x16x32_bf16 v[148:151], a[164:167], a[20:23], v[148:151]
s_nop 0
v_mul_f32 v32, v32, v33
v_mfma_f32_16x16x32_bf16 v[136:139], a[168:171], a[16:19], v[136:139]
v_cvt_pk_bf16_f32 v32, v32, v32
v_and_b32 v32, 0xffff0000, v32
v_mfma_f32_16x16x32_bf16 v[152:155], a[168:171], a[20:23], v[152:155]
v_mul_f32 v32, v32, v36
v_cvt_pk_bf16_f32 v32, v32, v32
v_mfma_f32_16x16x32_bf16 v[140:143], a[172:175], a[16:19], v[140:143]
v_and_b32 v32, 0xffff0000, v32
s_nop 0
v_mfma_f32_16x16x32_bf16 v[156:159], a[172:175], a[20:23], v[156:159]
v_readlane_b32 s16, v32, 0
s_waitcnt vmcnt(28)
v_mfma_f32_16x16x32_bf16 v[128:131], a[176:179], a[24:27], v[128:131]
buffer_load_dwordx4 a[8:11], v18, s[28:31], s71 offen offset:0 sc1
v_readlane_b32 s17, v32, 1
v_mfma_f32_16x16x32_bf16 v[144:147], a[176:179], a[28:31], v[144:147]
buffer_load_dwordx4 a[12:15], v19, s[28:31], s71 offen offset:0 sc1
v_readlane_b32 s18, v32, 2
v_mfma_f32_16x16x32_bf16 v[132:135], a[180:183], a[24:27], v[132:135]
v_readlane_b32 s19, v32, 3
v_readlane_b32 s20, v32, 4
v_mfma_f32_16x16x32_bf16 v[148:151], a[180:183], a[28:31], v[148:151]
v_readlane_b32 s21, v32, 5
v_readlane_b32 s22, v32, 6
v_mfma_f32_16x16x32_bf16 v[136:139], a[184:187], a[24:27], v[136:139]
v_readlane_b32 s23, v32, 7
v_lshlrev_b32 v48, 16, v80
v_mfma_f32_16x16x32_bf16 v[152:155], a[184:187], a[28:31], v[152:155]
v_and_b32 v49, 0xffff0000, v80
v_mul_f32 v40, s16, v48
v_mfma_f32_16x16x32_bf16 v[140:143], a[188:191], a[24:27], v[140:143]
v_mul_f32 v41, s16, v49
v_lshlrev_b32 v48, 16, v81
v_mfma_f32_16x16x32_bf16 v[156:159], a[188:191], a[28:31], v[156:159]
s_waitcnt vmcnt(14)
v_mfma_f32_16x16x32_bf16 v[128:131], a[192:195], a[32:35], v[128:131]
buffer_load_dwordx4 a[16:19], v18, s[28:31], s71 offen offset:1024 sc1
v_and_b32 v49, 0xffff0000, v81
v_mfma_f32_16x16x32_bf16 v[144:147], a[192:195], a[36:39], v[144:147]
buffer_load_dwordx4 a[20:23], v19, s[28:31], s71 offen offset:1024 sc1
v_fmac_f32 v40, s17, v48
v_mfma_f32_16x16x32_bf16 v[132:135], a[196:199], a[32:35], v[132:135]
v_fmac_f32 v41, s17, v49
v_lshlrev_b32 v48, 16, v82
v_mfma_f32_16x16x32_bf16 v[148:151], a[196:199], a[36:39], v[148:151]
v_and_b32 v49, 0xffff0000, v82
v_fmac_f32 v40, s18, v48
v_mfma_f32_16x16x32_bf16 v[136:139], a[200:203], a[32:35], v[136:139]
v_fmac_f32 v41, s18, v49
v_lshlrev_b32 v48, 16, v83
v_mfma_f32_16x16x32_bf16 v[152:155], a[200:203], a[36:39], v[152:155]
v_and_b32 v49, 0xffff0000, v83
v_mfma_f32_16x16x32_bf16 v[140:143], a[204:207], a[32:35], v[140:143]
v_fmac_f32 v40, s19, v48
v_fmac_f32 v41, s19, v49
v_mfma_f32_16x16x32_bf16 v[156:159], a[204:207], a[36:39], v[156:159]
s_waitcnt vmcnt(14)
v_mfma_f32_16x16x32_bf16 v[128:131], a[208:211], a[40:43], v[128:131]
buffer_load_dwordx4 a[24:27], v18, s[28:31], s71 offen offset:2048 sc1
v_lshlrev_b32 v48, 16, v84
v_mfma_f32_16x16x32_bf16 v[144:147], a[208:211], a[44:47], v[144:147]
buffer_load_dwordx4 a[28:31], v19, s[28:31], s71 offen offset:2048 sc1
v_and_b32 v49, 0xffff0000, v84
v_mfma_f32_16x16x32_bf16 v[132:135], a[212:215], a[40:43], v[132:135]
v_fmac_f32 v40, s20, v48
v_fmac_f32 v41, s20, v49
v_mfma_f32_16x16x32_bf16 v[148:151], a[212:215], a[44:47], v[148:151]
v_lshlrev_b32 v48, 16, v85
v_and_b32 v49, 0xffff0000, v85
v_mfma_f32_16x16x32_bf16 v[136:139], a[216:219], a[40:43], v[136:139]
v_fmac_f32 v40, s21, v48
v_fmac_f32 v41, s21, v49
v_mfma_f32_16x16x32_bf16 v[152:155], a[216:219], a[44:47], v[152:155]
v_lshlrev_b32 v48, 16, v86
v_mfma_f32_16x16x32_bf16 v[140:143], a[220:223], a[40:43], v[140:143]
v_and_b32 v49, 0xffff0000, v86
v_fmac_f32 v40, s22, v48
v_mfma_f32_16x16x32_bf16 v[156:159], a[220:223], a[44:47], v[156:159]
s_waitcnt vmcnt(14)
v_mfma_f32_16x16x32_bf16 v[128:131], a[80:83], a[48:51], v[128:131]
buffer_load_dwordx4 a[32:35], v18, s[28:31], s71 offen offset:3072 sc1
v_fmac_f32 v41, s22, v49
v_mfma_f32_16x16x32_bf16 v[144:147], a[80:83], a[52:55], v[144:147]
buffer_load_dwordx4 a[36:39], v19, s[28:31], s71 offen offset:3072 sc1
v_lshlrev_b32 v48, 16, v87
v_mfma_f32_16x16x32_bf16 v[132:135], a[84:87], a[48:51], v[132:135]
v_and_b32 v49, 0xffff0000, v87
v_fmac_f32 v40, s23, v48
v_mfma_f32_16x16x32_bf16 v[148:151], a[84:87], a[52:55], v[148:151]
v_fmac_f32 v41, s23, v49
v_lshrrev_b32 v10, 5, v0
v_mfma_f32_16x16x32_bf16 v[136:139], a[88:91], a[48:51], v[136:139]
v_and_b32 v11, 31, v0
v_lshlrev_b32 v11, 3, v11
v_mfma_f32_16x16x32_bf16 v[152:155], a[88:91], a[52:55], v[152:155]
v_lshl_add_u32 v10, v10, 16, v11
s_lshl_b32 s79, s2, 8
v_mfma_f32_16x16x32_bf16 v[140:143], a[92:95], a[48:51], v[140:143]
s_add_u32 s79, s79, 2162688
buffer_store_dwordx2 v[40:41], v10, s[28:31], s79 offen sc1
v_mfma_f32_16x16x32_bf16 v[156:159], a[92:95], a[52:55], v[156:159]
s_waitcnt vmcnt(15)
buffer_load_dword v29, v2, s[28:31], s51 offen sc1
v_mfma_f32_16x16x32_bf16 v[128:131], a[96:99], a[56:59], v[128:131]
buffer_load_dwordx4 a[40:43], v18, s[28:31], s72 offen offset:0 sc1
v_lshlrev_b32 v48, 16, v96
v_mfma_f32_16x16x32_bf16 v[144:147], a[96:99], a[60:63], v[144:147]
buffer_load_dwordx4 a[44:47], v19, s[28:31], s72 offen offset:0 sc1
v_and_b32 v49, 0xffff0000, v96
v_mfma_f32_16x16x32_bf16 v[132:135], a[100:103], a[56:59], v[132:135]
v_lshlrev_b32 v50, 16, v97
v_and_b32 v51, 0xffff0000, v97
v_mfma_f32_16x16x32_bf16 v[148:151], a[100:103], a[60:63], v[148:151]
v_lshlrev_b32 v52, 16, v98
v_and_b32 v53, 0xffff0000, v98
v_mfma_f32_16x16x32_bf16 v[136:139], a[104:107], a[56:59], v[136:139]
v_lshlrev_b32 v54, 16, v99
v_mfma_f32_16x16x32_bf16 v[152:155], a[104:107], a[60:63], v[152:155]
v_and_b32 v55, 0xffff0000, v99
v_lshlrev_b32 v56, 16, v100
v_mfma_f32_16x16x32_bf16 v[140:143], a[108:111], a[56:59], v[140:143]
v_and_b32 v57, 0xffff0000, v100
v_mfma_f32_16x16x32_bf16 v[156:159], a[108:111], a[60:63], v[156:159]
s_waitcnt vmcnt(16)
v_mfma_f32_16x16x32_bf16 v[128:131], a[112:115], a[64:67], v[128:131]
buffer_load_dwordx4 a[48:51], v18, s[28:31], s72 offen offset:1024 sc1
v_lshlrev_b32 v58, 16, v101
v_mfma_f32_16x16x32_bf16 v[144:147], a[112:115], a[68:71], v[144:147]
buffer_load_dwordx4 a[52:55], v19, s[28:31], s72 offen offset:1024 sc1
v_and_b32 v59, 0xffff0000, v101
v_mfma_f32_16x16x32_bf16 v[132:135], a[116:119], a[64:67], v[132:135]
v_lshlrev_b32 v60, 16, v102
v_and_b32 v61, 0xffff0000, v102
v_mfma_f32_16x16x32_bf16 v[148:151], a[116:119], a[68:71], v[148:151]
v_lshlrev_b32 v62, 16, v103
v_and_b32 v63, 0xffff0000, v103
v_mfma_f32_16x16x32_bf16 v[136:139], a[120:123], a[64:67], v[136:139]
v_lshlrev_b32 v80, 16, v104
v_and_b32 v81, 0xffff0000, v104
v_mfma_f32_16x16x32_bf16 v[152:155], a[120:123], a[68:71], v[152:155]
v_lshlrev_b32 v82, 16, v105
v_mfma_f32_16x16x32_bf16 v[140:143], a[124:127], a[64:67], v[140:143]
v_and_b32 v83, 0xffff0000, v105
v_lshlrev_b32 v84, 16, v106
v_mfma_f32_16x16x32_bf16 v[156:159], a[124:127], a[68:71], v[156:159]
s_waitcnt vmcnt(16)
v_mfma_f32_16x16x32_bf16 v[128:131], a[128:131], a[72:75], v[128:131]
buffer_load_dwordx4 a[56:59], v18, s[28:31], s72 offen offset:2048 sc1
v_and_b32 v85, 0xffff0000, v106
v_mfma_f32_16x16x32_bf16 v[144:147], a[128:131], a[76:79], v[144:147]
buffer_load_dwordx4 a[60:63], v19, s[28:31], s72 offen offset:2048 sc1
v_lshlrev_b32 v86, 16, v107
v_mfma_f32_16x16x32_bf16 v[132:135], a[132:135], a[72:75], v[132:135]
v_and_b32 v87, 0xffff0000, v107
v_lshlrev_b32 v88, 16, v108
v_mfma_f32_16x16x32_bf16 v[148:151], a[132:135], a[76:79], v[148:151]
v_and_b32 v89, 0xffff0000, v108
v_lshlrev_b32 v90, 16, v109
v_mfma_f32_16x16x32_bf16 v[136:139], a[136:139], a[72:75], v[136:139]
v_and_b32 v91, 0xffff0000, v109
v_lshlrev_b32 v92, 16, v110
v_mfma_f32_16x16x32_bf16 v[152:155], a[136:139], a[76:79], v[152:155]
v_and_b32 v93, 0xffff0000, v110
v_mfma_f32_16x16x32_bf16 v[140:143], a[140:143], a[72:75], v[140:143]
v_lshlrev_b32 v94, 16, v111
v_and_b32 v95, 0xffff0000, v111
v_mfma_f32_16x16x32_bf16 v[156:159], a[140:143], a[76:79], v[156:159]
s_waitcnt vmcnt(16)
v_mfma_f32_16x16x32_bf16 v[128:131], a[144:147], a[0:3], v[128:131]
buffer_load_dwordx4 a[64:67], v18, s[28:31], s72 offen offset:3072 sc1
ds_read_b128 v[96:99], v7 offset:0
v_mfma_f32_16x16x32_bf16 v[144:147], a[144:147], a[4:7], v[144:147]
buffer_load_dwordx4 a[68:71], v19, s[28:31], s72 offen offset:3072 sc1
ds_read_b128 v[100:103], v7 offset:32768
v_mfma_f32_16x16x32_bf16 v[132:135], a[148:151], a[0:3], v[132:135]
ds_read_b128 v[104:107], v6 offset:0
ds_read_b128 v[108:111], v6 offset:32768
v_mfma_f32_16x16x32_bf16 v[148:151], a[148:151], a[4:7], v[148:151]
v_mul_f32 v64, 0xbfb8aa3b, v80
v_mul_f32 v65, 0xbfb8aa3b, v81
v_mfma_f32_16x16x32_bf16 v[136:139], a[152:155], a[0:3], v[136:139]
v_mul_f32 v66, 0xbfb8aa3b, v82
v_mul_f32 v67, 0xbfb8aa3b, v83
v_mfma_f32_16x16x32_bf16 v[152:155], a[152:155], a[4:7], v[152:155]
v_mul_f32 v68, 0xbfb8aa3b, v84
v_mfma_f32_16x16x32_bf16 v[140:143], a[156:159], a[0:3], v[140:143]
v_mul_f32 v69, 0xbfb8aa3b, v85
v_mul_f32 v70, 0xbfb8aa3b, v86
v_mfma_f32_16x16x32_bf16 v[156:159], a[156:159], a[4:7], v[156:159]
s_waitcnt vmcnt(8)
v_cmp_ne_u32 vcc, 0, v29
s_or_b64 vcc, vcc, s[96:97]
s_cmp_eq_u32 vcc_lo, -1
s_cbranch_scc0 M_SPINCTA
M_SRETCTA:
s_barrier
buffer_store_dword v31, v30, s[28:31], s101 offen sc1
s_waitcnt vmcnt(17) lgkmcnt(0)
v_mfma_f32_16x16x32_bf16 v[128:131], v[96:99], a[8:11], v[128:131]
buffer_load_dwordx4 a[72:75], v20, s[28:31], 0 offen offset:0 sc1
ds_read_b128 v[112:115], v7 offset:1024
v_mfma_f32_16x16x32_bf16 v[144:147], v[96:99], a[12:15], v[144:147]
buffer_load_dwordx4 a[76:79], v21, s[28:31], 0 offen offset:0 sc1
ds_read_b128 v[116:119], v7 offset:33792
v_mfma_f32_16x16x32_bf16 v[132:135], v[100:103], a[8:11], v[132:135]
ds_read_b128 v[120:123], v6 offset:1024
ds_read_b128 v[124:127], v6 offset:33792
v_mfma_f32_16x16x32_bf16 v[148:151], v[100:103], a[12:15], v[148:151]
v_mul_f32 v71, 0xbfb8aa3b, v87
v_mul_f32 v72, 0xbfb8aa3b, v88
v_mfma_f32_16x16x32_bf16 v[136:139], v[104:107], a[8:11], v[136:139]
v_mul_f32 v73, 0xbfb8aa3b, v89
v_mul_f32 v74, 0xbfb8aa3b, v90
v_mfma_f32_16x16x32_bf16 v[152:155], v[104:107], a[12:15], v[152:155]
v_mul_f32 v75, 0xbfb8aa3b, v91
v_mfma_f32_16x16x32_bf16 v[140:143], v[108:111], a[8:11], v[140:143]
v_mul_f32 v76, 0xbfb8aa3b, v92
v_mul_f32 v77, 0xbfb8aa3b, v93
v_mfma_f32_16x16x32_bf16 v[156:159], v[108:111], a[12:15], v[156:159]
s_waitcnt vmcnt(17) lgkmcnt(0)
v_mfma_f32_16x16x32_bf16 v[128:131], v[112:115], a[16:19], v[128:131]
buffer_load_dwordx4 a[0:3], v20, s[28:31], 0 offen offset:1024 sc1
ds_read_b128 v[96:99], v7 offset:2048
v_mul_f32 v78, 0xbfb8aa3b, v94
v_mul_f32 v79, 0xbfb8aa3b, v95
v_mfma_f32_16x16x32_bf16 v[144:147], v[112:115], a[20:23], v[144:147]
buffer_load_dwordx4 a[4:7], v21, s[28:31], 0 offen offset:1024 sc1
ds_read_b128 v[100:103], v7 offset:34816
v_mfma_f32_16x16x32_bf16 v[132:135], v[116:119], a[16:19], v[132:135]
ds_read_b128 v[104:107], v6 offset:2048
ds_read_b128 v[108:111], v6 offset:34816
v_mfma_f32_16x16x32_bf16 v[148:151], v[116:119], a[20:23], v[148:151]
v_exp_f32 v64, v64
v_exp_f32 v65, v65
v_mfma_f32_16x16x32_bf16 v[136:139], v[120:123], a[16:19], v[136:139]
v_exp_f32 v66, v66
v_mfma_f32_16x16x32_bf16 v[152:155], v[120:123], a[20:23], v[152:155]
v_exp_f32 v67, v67
v_mfma_f32_16x16x32_bf16 v[140:143], v[124:127], a[16:19], v[140:143]
v_exp_f32 v68, v68
v_mfma_f32_16x16x32_bf16 v[156:159], v[124:127], a[20:23], v[156:159]
v_exp_f32 v69, v69
s_waitcnt vmcnt(17) lgkmcnt(0)
v_mfma_f32_16x16x32_bf16 v[128:131], v[96:99], a[24:27], v[128:131]
buffer_load_dwordx4 a[8:11], v20, s[28:31], 0 offen offset:2048 sc1
ds_read_b128 v[112:115], v7 offset:3072
v_exp_f32 v70, v70
v_mfma_f32_16x16x32_bf16 v[144:147], v[96:99], a[28:31], v[144:147]
buffer_load_dwordx4 a[12:15], v21, s[28:31], 0 offen offset:2048 sc1
ds_read_b128 v[116:119], v7 offset:35840
v_mfma_f32_16x16x32_bf16 v[132:135], v[100:103], a[24:27], v[132:135]
ds_read_b128 v[120:123], v6 offset:3072
ds_read_b128 v[124:127], v6 offset:35840
v_mfma_f32_16x16x32_bf16 v[148:151], v[100:103], a[28:31], v[148:151]
v_exp_f32 v71, v71
v_exp_f32 v72, v72
v_mfma_f32_16x16x32_bf16 v[136:139], v[104:107], a[24:27], v[136:139]
v_exp_f32 v73, v73
v_mfma_f32_16x16x32_bf16 v[152:155], v[104:107], a[28:31], v[152:155]
v_exp_f32 v74, v74
v_mfma_f32_16x16x32_bf16 v[140:143], v[108:111], a[24:27], v[140:143]
v_exp_f32 v75, v75
v_mfma_f32_16x16x32_bf16 v[156:159], v[108:111], a[28:31], v[156:159]
v_exp_f32 v76, v76
s_waitcnt vmcnt(17) lgkmcnt(0)
v_mfma_f32_16x16x32_bf16 v[128:131], v[112:115], a[32:35], v[128:131]
buffer_load_dwordx4 a[16:19], v20, s[28:31], 0 offen offset:3072 sc1
ds_read_b128 v[96:99], v6 offset:49152
v_mfma_f32_16x16x32_bf16 v[144:147], v[112:115], a[36:39], v[144:147]
buffer_load_dwordx4 a[20:23], v21, s[28:31], 0 offen offset:3072 sc1
ds_read_b128 v[100:103], v7 offset:16384
v_mfma_f32_16x16x32_bf16 v[132:135], v[116:119], a[32:35], v[132:135]
ds_read_b128 v[104:107], v7 offset:49152
ds_read_b128 v[108:111], v6 offset:16384
v_mfma_f32_16x16x32_bf16 v[148:151], v[116:119], a[36:39], v[148:151]
v_exp_f32 v77, v77
v_mfma_f32_16x16x32_bf16 v[136:139], v[120:123], a[32:35], v[136:139]
v_exp_f32 v78, v78
v_mfma_f32_16x16x32_bf16 v[152:155], v[120:123], a[36:39], v[152:155]
v_exp_f32 v79, v79
v_add_f32 v64, 1.0, v64
v_mfma_f32_16x16x32_bf16 v[140:143], v[124:127], a[32:35], v[140:143]
v_add_f32 v65, 1.0, v65
v_add_f32 v66, 1.0, v66
v_add_f32 v67, 1.0, v67
v_mfma_f32_16x16x32_bf16 v[156:159], v[124:127], a[36:39], v[156:159]
v_add_f32 v68, 1.0, v68
s_waitcnt vmcnt(15) lgkmcnt(0)
v_mfma_f32_16x16x32_bf16 v[128:131], v[96:99], a[40:43], v[128:131]
buffer_load_dwordx4 a[24:27], v20, s[28:31], s69 offen offset:0 sc1
ds_read_b128 v[112:115], v6 offset:50176
v_mfma_f32_16x16x32_bf16 v[144:147], v[96:99], a[44:47], v[144:147]
buffer_load_dwordx4 a[28:31], v21, s[28:31], s69 offen offset:0 sc1
ds_read_b128 v[116:119], v7 offset:17408
v_mfma_f32_16x16x32_bf16 v[132:135], v[100:103], a[40:43], v[132:135]
ds_read_b128 v[120:123], v7 offset:50176
ds_read_b128 v[124:127], v6 offset:17408
v_mfma_f32_16x16x32_bf16 v[148:151], v[100:103], a[44:47], v[148:151]
v_add_f32 v69, 1.0, v69
v_add_f32 v70, 1.0, v70
v_mfma_f32_16x16x32_bf16 v[136:139], v[104:107], a[40:43], v[136:139]
v_add_f32 v71, 1.0, v71
v_add_f32 v72, 1.0, v72
v_mfma_f32_16x16x32_bf16 v[152:155], v[104:107], a[44:47], v[152:155]
v_add_f32 v73, 1.0, v73
v_mfma_f32_16x16x32_bf16 v[140:143], v[108:111], a[40:43], v[140:143]
v_add_f32 v74, 1.0, v74
v_add_f32 v75, 1.0, v75
v_mfma_f32_16x16x32_bf16 v[156:159], v[108:111], a[44:47], v[156:159]
s_waitcnt vmcnt(15) lgkmcnt(0)
v_mfma_f32_16x16x32_bf16 v[128:131], v[112:115], a[48:51], v[128:131]
buffer_load_dwordx4 a[32:35], v20, s[28:31], s69 offen offset:1024 sc1
ds_read_b128 v[96:99], v6 offset:51200
v_add_f32 v76, 1.0, v76
v_mfma_f32_16x16x32_bf16 v[144:147], v[112:115], a[52:55], v[144:147]
buffer_load_dwordx4 a[36:39], v21, s[28:31], s69 offen offset:1024 sc1
ds_read_b128 v[100:103], v7 offset:18432
v_add_f32 v77, 1.0, v77
v_mfma_f32_16x16x32_bf16 v[132:135], v[116:119], a[48:51], v[132:135]
ds_read_b128 v[104:107], v7 offset:51200
ds_read_b128 v[108:111], v6 offset:18432
v_mfma_f32_16x16x32_bf16 v[148:151], v[116:119], a[52:55], v[148:151]
v_add_f32 v78, 1.0, v78
v_add_f32 v79, 1.0, v79
v_mfma_f32_16x16x32_bf16 v[136:139], v[120:123], a[48:51], v[136:139]
v_rcp_f32 v64, v64
v_mfma_f32_16x16x32_bf16 v[152:155], v[120:123], a[52:55], v[152:155]
v_rcp_f32 v65, v65
v_mfma_f32_16x16x32_bf16 v[140:143], v[124:127], a[48:51], v[140:143]
v_rcp_f32 v66, v66
v_mfma_f32_16x16x32_bf16 v[156:159], v[124:127], a[52:55], v[156:159]
v_rcp_f32 v67, v67
s_waitcnt vmcnt(15) lgkmcnt(0)
v_mfma_f32_16x16x32_bf16 v[128:131], v[96:99], a[56:59], v[128:131]
buffer_load_dwordx4 a[40:43], v20, s[28:31], s69 offen offset:2048 sc1
ds_read_b128 v[112:115], v6 offset:52224
v_rcp_f32 v68, v68
v_mfma_f32_16x16x32_bf16 v[144:147], v[96:99], a[60:63], v[144:147]
buffer_load_dwordx4 a[44:47], v21, s[28:31], s69 offen offset:2048 sc1
ds_read_b128 v[116:119], v7 offset:19456
v_mfma_f32_16x16x32_bf16 v[132:135], v[100:103], a[56:59], v[132:135]
ds_read_b128 v[120:123], v7 offset:52224
ds_read_b128 v[124:127], v6 offset:19456
v_mfma_f32_16x16x32_bf16 v[148:151], v[100:103], a[60:63], v[148:151]
v_rcp_f32 v69, v69
v_rcp_f32 v70, v70
v_mfma_f32_16x16x32_bf16 v[136:139], v[104:107], a[56:59], v[136:139]
v_rcp_f32 v71, v71
v_mfma_f32_16x16x32_bf16 v[152:155], v[104:107], a[60:63], v[152:155]
v_rcp_f32 v72, v72
v_mfma_f32_16x16x32_bf16 v[140:143], v[108:111], a[56:59], v[140:143]
v_rcp_f32 v73, v73
v_mfma_f32_16x16x32_bf16 v[156:159], v[108:111], a[60:63], v[156:159]
v_rcp_f32 v74, v74
s_waitcnt vmcnt(15) lgkmcnt(0)
v_mfma_f32_16x16x32_bf16 v[128:131], v[112:115], a[64:67], v[128:131]
buffer_load_dwordx4 a[48:51], v20, s[28:31], s69 offen offset:3072 sc1
v_mfma_f32_16x16x32_bf16 v[144:147], v[112:115], a[68:71], v[144:147]
buffer_load_dwordx4 a[52:55], v21, s[28:31], s69 offen offset:3072 sc1
v_mfma_f32_16x16x32_bf16 v[132:135], v[116:119], a[64:67], v[132:135]
v_rcp_f32 v75, v75
v_mfma_f32_16x16x32_bf16 v[148:151], v[116:119], a[68:71], v[148:151]
v_rcp_f32 v76, v76
v_mfma_f32_16x16x32_bf16 v[136:139], v[120:123], a[64:67], v[136:139]
v_rcp_f32 v77, v77
v_mfma_f32_16x16x32_bf16 v[152:155], v[120:123], a[68:71], v[152:155]
v_rcp_f32 v78, v78
v_mfma_f32_16x16x32_bf16 v[140:143], v[124:127], a[64:67], v[140:143]
v_rcp_f32 v79, v79
v_mfma_f32_16x16x32_bf16 v[156:159], v[124:127], a[68:71], v[156:159]
v_mul_f32 v64, v80, v64
v_mul_f32 v65, v81, v65
s_waitcnt vmcnt(14)
v_mfma_f32_16x16x32_bf16 v[160:163], a[224:227], a[72:75], 0
buffer_load_dwordx4 a[56:59], v20, s[28:31], s70 offen offset:0 sc1
v_mul_f32 v66, v82, v66
v_mfma_f32_16x16x32_bf16 v[176:179], a[224:227], a[76:79], 0
buffer_load_dwordx4 a[60:63], v21, s[28:31], s70 offen offset:0 sc1
v_mul_f32 v67, v83, v67
v_mfma_f32_16x16x32_bf16 v[164:167], a[228:231], a[72:75], 0
v_mul_f32 v68, v84, v68
v_mfma_f32_16x16x32_bf16 v[180:183], a[228:231], a[76:79], 0
v_mul_f32 v69, v85, v69
v_mul_f32 v70, v86, v70
v_mfma_f32_16x16x32_bf16 v[168:171], a[232:235], a[72:75], 0
v_mul_f32 v71, v87, v71
v_mfma_f32_16x16x32_bf16 v[184:187], a[232:235], a[76:79], 0
v_mul_f32 v72, v88, v72
v_mfma_f32_16x16x32_bf16 v[172:175], a[236:239], a[72:75], 0
v_mul_f32 v73, v89, v73
v_mfma_f32_16x16x32_bf16 v[188:191], a[236:239], a[76:79], 0
s_waitcnt vmcnt(14)
v_mfma_f32_16x16x32_bf16 v[160:163], a[240:243], a[0:3], v[160:163]
buffer_load_dwordx4 a[224:227], v14, s[28:31], s70 offen offset:3072 sc1
v_mul_f32 v74, v90, v74
v_mfma_f32_16x16x32_bf16 v[176:179], a[240:243], a[4:7], v[176:179]
buffer_load_dwordx4 a[228:231], v15, s[28:31], s70 offen offset:3072 sc1
v_mul_f32 v75, v91, v75
v_mfma_f32_16x16x32_bf16 v[164:167], a[244:247], a[0:3], v[164:167]
buffer_load_dwordx4 a[64:67], v20, s[28:31], s70 offen offset:1024 sc1
v_mul_f32 v76, v92, v76
v_mfma_f32_16x16x32_bf16 v[180:183], a[244:247], a[4:7], v[180:183]
buffer_load_dwordx4 a[68:71], v21, s[28:31], s70 offen offset:1024 sc1
v_mfma_f32_16x16x32_bf16 v[168:171], a[248:251], a[0:3], v[168:171]
v_mul_f32 v77, v93, v77
v_mfma_f32_16x16x32_bf16 v[184:187], a[248:251], a[4:7], v[184:187]
v_mul_f32 v78, v94, v78
v_mul_f32 v79, v95, v79
v_mfma_f32_16x16x32_bf16 v[172:175], a[252:255], a[0:3], v[172:175]
v_cvt_pk_bf16_f32 v32, v64, v65
v_mfma_f32_16x16x32_bf16 v[188:191], a[252:255], a[4:7], v[188:191]
s_waitcnt vmcnt(16)
v_mfma_f32_16x16x32_bf16 v[160:163], a[160:163], a[8:11], v[160:163]
buffer_load_dwordx4 a[232:235], v16, s[28:31], s70 offen offset:3072 sc1
v_cvt_pk_bf16_f32 v33, v66, v67
v_mfma_f32_16x16x32_bf16 v[176:179], a[160:163], a[12:15], v[176:179]
buffer_load_dwordx4 a[236:239], v17, s[28:31], s70 offen offset:3072 sc1
v_cvt_pk_bf16_f32 v34, v68, v69
v_mfma_f32_16x16x32_bf16 v[164:167], a[164:167], a[8:11], v[164:167]
buffer_load_dwordx4 a[72:75], v20, s[28:31], s70 offen offset:2048 sc1
v_cvt_pk_bf16_f32 v35, v70, v71
v_mfma_f32_16x16x32_bf16 v[180:183], a[164:167], a[12:15], v[180:183]
buffer_load_dwordx4 a[76:79], v21, s[28:31], s70 offen offset:2048 sc1
v_cvt_pk_bf16_f32 v36, v72, v73
v_mfma_f32_16x16x32_bf16 v[168:171], a[168:171], a[8:11], v[168:171]
v_cvt_pk_bf16_f32 v37, v74, v75
v_mfma_f32_16x16x32_bf16 v[184:187], a[168:171], a[12:15], v[184:187]
v_cvt_pk_bf16_f32 v38, v76, v77
v_cvt_pk_bf16_f32 v39, v78, v79
v_mfma_f32_16x16x32_bf16 v[172:175], a[172:175], a[8:11], v[172:175]
v_lshlrev_b32 v64, 16, v32
v_mfma_f32_16x16x32_bf16 v[188:191], a[172:175], a[12:15], v[188:191]
s_waitcnt vmcnt(18)
v_mfma_f32_16x16x32_bf16 v[160:163], a[176:179], a[16:19], v[160:163]
buffer_load_dwordx4 a[240:243], v14, s[28:31], s73 offen offset:0 sc1
v_and_b32 v65, 0xffff0000, v32
v_mfma_f32_16x16x32_bf16 v[176:179], a[176:179], a[20:23], v[176:179]
buffer_load_dwordx4 a[0:3], v20, s[28:31], s71 offen offset:0 sc1
v_lshlrev_b32 v66, 16, v33
v_mfma_f32_16x16x32_bf16 v[164:167], a[180:183], a[16:19], v[164:167]
buffer_load_dwordx4 a[4:7], v21, s[28:31], s71 offen offset:0 sc1
v_mfma_f32_16x16x32_bf16 v[180:183], a[180:183], a[20:23], v[180:183]
v_and_b32 v67, 0xffff0000, v33
v_lshlrev_b32 v68, 16, v34
v_mfma_f32_16x16x32_bf16 v[168:171], a[184:187], a[16:19], v[168:171]
v_and_b32 v69, 0xffff0000, v34
v_mfma_f32_16x16x32_bf16 v[184:187], a[184:187], a[20:23], v[184:187]
v_lshlrev_b32 v70, 16, v35
v_mfma_f32_16x16x32_bf16 v[172:175], a[188:191], a[16:19], v[172:175]
v_and_b32 v71, 0xffff0000, v35
v_mfma_f32_16x16x32_bf16 v[188:191], a[188:191], a[20:23], v[188:191]
s_waitcnt vmcnt(19)
v_mfma_f32_16x16x32_bf16 v[160:163], a[192:195], a[24:27], v[160:163]
buffer_load_dwordx4 a[244:247], v15, s[28:31], s73 offen offset:0 sc1
v_lshlrev_b32 v72, 16, v36
v_mfma_f32_16x16x32_bf16 v[176:179], a[192:195], a[28:31], v[176:179]
buffer_load_dwordx4 a[248:251], v16, s[28:31], s73 offen offset:0 sc1
v_and_b32 v73, 0xffff0000, v36
v_mfma_f32_16x16x32_bf16 v[164:167], a[196:199], a[24:27], v[164:167]
buffer_load_dwordx4 a[8:11], v20, s[28:31], s71 offen offset:1024 sc1
v_lshlrev_b32 v74, 16, v37
v_mfma_f32_16x16x32_bf16 v[180:183], a[196:199], a[28:31], v[180:183]
buffer_load_dwordx4 a[12:15], v21, s[28:31], s71 offen offset:1024 sc1
v_and_b32 v75, 0xffff0000, v37
v_mfma_f32_16x16x32_bf16 v[168:171], a[200:203], a[24:27], v[168:171]
v_lshlrev_b32 v76, 16, v38
v_mfma_f32_16x16x32_bf16 v[184:187], a[200:203], a[28:31], v[184:187]
v_and_b32 v77, 0xffff0000, v38
v_lshlrev_b32 v78, 16, v39
v_mfma_f32_16x16x32_bf16 v[172:175], a[204:207], a[24:27], v[172:175]
v_and_b32 v79, 0xffff0000, v39
v_mfma_f32_16x16x32_bf16 v[188:191], a[204:207], a[28:31], v[188:191]
s_waitcnt vmcnt(21)
s_mov_b32 s54, 2756608
buffer_load_dwordx4 v[24:27], v28, s[28:31], s54 offen sc1
v_mfma_f32_16x16x32_bf16 v[160:163], a[208:211], a[32:35], v[160:163]
buffer_load_dwordx4 a[252:255], v17, s[28:31], s73 offen offset:0 sc1
v_mfma_f32_16x16x32_bf16 v[176:179], a[208:211], a[36:39], v[176:179]
buffer_load_dwordx4 a[160:163], v14, s[28:31], s73 offen offset:1024 sc1
v_mfma_f32_16x16x32_bf16 v[164:167], a[212:215], a[32:35], v[164:167]
buffer_load_dwordx4 a[16:19], v20, s[28:31], s71 offen offset:2048 sc1
v_mfma_f32_16x16x32_bf16 v[180:183], a[212:215], a[36:39], v[180:183]
buffer_load_dwordx4 a[20:23], v21, s[28:31], s71 offen offset:2048 sc1
v_mfma_f32_16x16x32_bf16 v[168:171], a[216:219], a[32:35], v[168:171]
v_mfma_f32_16x16x32_bf16 v[184:187], a[216:219], a[36:39], v[184:187]
v_mfma_f32_16x16x32_bf16 v[172:175], a[220:223], a[32:35], v[172:175]
v_mfma_f32_16x16x32_bf16 v[188:191], a[220:223], a[36:39], v[188:191]
s_waitcnt vmcnt(24)
v_mfma_f32_16x16x32_bf16 v[160:163], a[80:83], a[40:43], v[160:163]
buffer_load_dwordx4 a[164:167], v15, s[28:31], s73 offen offset:1024 sc1
v_mfma_f32_16x16x32_bf16 v[176:179], a[80:83], a[44:47], v[176:179]
buffer_load_dwordx4 a[24:27], v20, s[28:31], s71 offen offset:3072 sc1
v_mfma_f32_16x16x32_bf16 v[164:167], a[84:87], a[40:43], v[164:167]
buffer_load_dwordx4 a[28:31], v21, s[28:31], s71 offen offset:3072 sc1
v_mfma_f32_16x16x32_bf16 v[180:183], a[84:87], a[44:47], v[180:183]
v_mfma_f32_16x16x32_bf16 v[168:171], a[88:91], a[40:43], v[168:171]
v_mfma_f32_16x16x32_bf16 v[184:187], a[88:91], a[44:47], v[184:187]
v_mfma_f32_16x16x32_bf16 v[172:175], a[92:95], a[40:43], v[172:175]
v_mfma_f32_16x16x32_bf16 v[188:191], a[92:95], a[44:47], v[188:191]
s_waitcnt vmcnt(25)
v_mfma_f32_16x16x32_bf16 v[160:163], a[96:99], a[48:51], v[160:163]
buffer_load_dwordx4 a[168:171], v16, s[28:31], s73 offen offset:1024 sc1
v_mfma_f32_16x16x32_bf16 v[176:179], a[96:99], a[52:55], v[176:179]
buffer_load_dwordx4 a[172:175], v17, s[28:31], s73 offen offset:1024 sc1
v_mfma_f32_16x16x32_bf16 v[164:167], a[100:103], a[48:51], v[164:167]
buffer_load_dwordx4 a[32:35], v20, s[28:31], s72 offen offset:0 sc1
v_mfma_f32_16x16x32_bf16 v[180:183], a[100:103], a[52:55], v[180:183]
buffer_load_dwordx4 a[36:39], v21, s[28:31], s72 offen offset:0 sc1
v_mfma_f32_16x16x32_bf16 v[168:171], a[104:107], a[48:51], v[168:171]
v_mfma_f32_16x16x32_bf16 v[184:187], a[104:107], a[52:55], v[184:187]
v_mfma_f32_16x16x32_bf16 v[172:175], a[108:111], a[48:51], v[172:175]
v_mfma_f32_16x16x32_bf16 v[188:191], a[108:111], a[52:55], v[188:191]
s_waitcnt vmcnt(27)
v_mfma_f32_16x16x32_bf16 v[160:163], a[112:115], a[56:59], v[160:163]
buffer_load_dwordx4 a[176:179], v14, s[28:31], s73 offen offset:2048 sc1
v_mfma_f32_16x16x32_bf16 v[176:179], a[112:115], a[60:63], v[176:179]
buffer_load_dwordx4 a[40:43], v20, s[28:31], s72 offen offset:1024 sc1
v_mfma_f32_16x16x32_bf16 v[164:167], a[116:119], a[56:59], v[164:167]
buffer_load_dwordx4 a[44:47], v21, s[28:31], s72 offen offset:1024 sc1
v_mfma_f32_16x16x32_bf16 v[180:183], a[116:119], a[60:63], v[180:183]
v_mfma_f32_16x16x32_bf16 v[168:171], a[120:123], a[56:59], v[168:171]
v_mfma_f32_16x16x32_bf16 v[184:187], a[120:123], a[60:63], v[184:187]
v_mfma_f32_16x16x32_bf16 v[172:175], a[124:127], a[56:59], v[172:175]
v_mfma_f32_16x16x32_bf16 v[188:191], a[124:127], a[60:63], v[188:191]
s_waitcnt vmcnt(26)
v_mfma_f32_16x16x32_bf16 v[160:163], a[128:131], a[64:67], v[160:163]
buffer_load_dwordx4 a[180:183], v15, s[28:31], s73 offen offset:2048 sc1
v_mfma_f32_16x16x32_bf16 v[176:179], a[128:131], a[68:71], v[176:179]
buffer_load_dwordx4 a[184:187], v16, s[28:31], s73 offen offset:2048 sc1
v_mfma_f32_16x16x32_bf16 v[164:167], a[132:135], a[64:67], v[164:167]
buffer_load_dwordx4 a[48:51], v20, s[28:31], s72 offen offset:2048 sc1
v_mfma_f32_16x16x32_bf16 v[180:183], a[132:135], a[68:71], v[180:183]
buffer_load_dwordx4 a[52:55], v21, s[28:31], s72 offen offset:2048 sc1
v_mfma_f32_16x16x32_bf16 v[168:171], a[136:139], a[64:67], v[168:171]
v_mfma_f32_16x16x32_bf16 v[184:187], a[136:139], a[68:71], v[184:187]
v_mfma_f32_16x16x32_bf16 v[172:175], a[140:143], a[64:67], v[172:175]
v_mfma_f32_16x16x32_bf16 v[188:191], a[140:143], a[68:71], v[188:191]
s_waitcnt vmcnt(26)
v_mfma_f32_16x16x32_bf16 v[160:163], a[144:147], a[72:75], v[160:163]
buffer_load_dwordx4 a[188:191], v17, s[28:31], s73 offen offset:2048 sc1
ds_read_b128 v[96:99], v7 offset:0
v_mfma_f32_16x16x32_bf16 v[176:179], a[144:147], a[76:79], v[176:179]
buffer_load_dwordx4 a[192:195], v14, s[28:31], s73 offen offset:3072 sc1
ds_read_b128 v[100:103], v7 offset:32768
v_mfma_f32_16x16x32_bf16 v[164:167], a[148:151], a[72:75], v[164:167]
buffer_load_dwordx4 a[56:59], v20, s[28:31], s72 offen offset:3072 sc1
ds_read_b128 v[104:107], v6 offset:0
v_mfma_f32_16x16x32_bf16 v[180:183], a[148:151], a[76:79], v[180:183]
buffer_load_dwordx4 a[60:63], v21, s[28:31], s72 offen offset:3072 sc1
ds_read_b128 v[108:111], v6 offset:32768
v_mfma_f32_16x16x32_bf16 v[168:171], a[152:155], a[72:75], v[168:171]
v_mfma_f32_16x16x32_bf16 v[184:187], a[152:155], a[76:79], v[184:187]
v_mfma_f32_16x16x32_bf16 v[172:175], a[156:159], a[72:75], v[172:175]
v_mfma_f32_16x16x32_bf16 v[188:191], a[156:159], a[76:79], v[188:191]
s_waitcnt vmcnt(27) lgkmcnt(0)
v_mfma_f32_16x16x32_bf16 v[160:163], v[96:99], a[0:3], v[160:163]
buffer_load_dwordx4 a[196:199], v15, s[28:31], s73 offen offset:3072 sc1
ds_read_b128 v[112:115], v7 offset:1024
v_mfma_f32_16x16x32_bf16 v[176:179], v[96:99], a[4:7], v[176:179]
buffer_load_dwordx4 a[64:67], v18, s[28:31], s70 offen offset:3072 sc1
ds_read_b128 v[116:119], v7 offset:33792
v_mfma_f32_16x16x32_bf16 v[164:167], v[100:103], a[0:3], v[164:167]
buffer_load_dwordx4 a[68:71], v19, s[28:31], s70 offen offset:3072 sc1
ds_read_b128 v[120:123], v6 offset:1024
v_mfma_f32_16x16x32_bf16 v[180:183], v[100:103], a[4:7], v[180:183]
ds_read_b128 v[124:127], v6 offset:33792
v_mfma_f32_16x16x32_bf16 v[168:171], v[104:107], a[0:3], v[168:171]
v_mfma_f32_16x16x32_bf16 v[184:187], v[104:107], a[4:7], v[184:187]
v_mfma_f32_16x16x32_bf16 v[172:175], v[108:111], a[0:3], v[172:175]
v_mfma_f32_16x16x32_bf16 v[188:191], v[108:111], a[4:7], v[188:191]
s_waitcnt vmcnt(26) lgkmcnt(0)
v_mfma_f32_16x16x32_bf16 v[160:163], v[112:115], a[8:11], v[160:163]
buffer_load_dwordx4 a[200:203], v16, s[28:31], s73 offen offset:3072 sc1
ds_read_b128 v[96:99], v7 offset:2048
v_mfma_f32_16x16x32_bf16 v[176:179], v[112:115], a[12:15], v[176:179]
buffer_load_dwordx4 a[204:207], v17, s[28:31], s73 offen offset:3072 sc1
ds_read_b128 v[100:103], v7 offset:34816
v_mfma_f32_16x16x32_bf16 v[164:167], v[116:119], a[8:11], v[164:167]
buffer_load_dwordx4 a[72:75], v20, s[28:31], s70 offen offset:3072 sc1
ds_read_b128 v[104:107], v6 offset:2048
v_mfma_f32_16x16x32_bf16 v[180:183], v[116:119], a[12:15], v[180:183]
buffer_load_dwordx4 a[76:79], v21, s[28:31], s70 offen offset:3072 sc1
ds_read_b128 v[108:111], v6 offset:34816
v_mfma_f32_16x16x32_bf16 v[168:171], v[120:123], a[8:11], v[168:171]
v_mfma_f32_16x16x32_bf16 v[184:187], v[120:123], a[12:15], v[184:187]
v_mfma_f32_16x16x32_bf16 v[172:175], v[124:127], a[8:11], v[172:175]
v_mfma_f32_16x16x32_bf16 v[188:191], v[124:127], a[12:15], v[188:191]
s_waitcnt vmcnt(25) lgkmcnt(0)
v_mfma_f32_16x16x32_bf16 v[160:163], v[96:99], a[16:19], v[160:163]
buffer_load_dwordx4 a[208:211], v14, s[28:31], s74 offen offset:0 sc1
ds_read_b128 v[112:115], v7 offset:3072
v_mfma_f32_16x16x32_bf16 v[176:179], v[96:99], a[20:23], v[176:179]
buffer_load_dwordx4 a[212:215], v15, s[28:31], s74 offen offset:0 sc1
ds_read_b128 v[116:119], v7 offset:35840
v_mfma_f32_16x16x32_bf16 v[164:167], v[100:103], a[16:19], v[164:167]
buffer_load_dwordx4 a[0:3], v18, s[28:31], s73 offen offset:0 sc1
ds_read_b128 v[120:123], v6 offset:3072
v_mfma_f32_16x16x32_bf16 v[180:183], v[100:103], a[20:23], v[180:183]
buffer_load_dwordx4 a[4:7], v19, s[28:31], s73 offen offset:0 sc1
ds_read_b128 v[124:127], v6 offset:35840
v_mfma_f32_16x16x32_bf16 v[168:171], v[104:107], a[16:19], v[168:171]
v_mfma_f32_16x16x32_bf16 v[184:187], v[104:107], a[20:23], v[184:187]
v_mfma_f32_16x16x32_bf16 v[172:175], v[108:111], a[16:19], v[172:175]
v_mfma_f32_16x16x32_bf16 v[188:191], v[108:111], a[20:23], v[188:191]
s_waitcnt vmcnt(26) lgkmcnt(0)
s_cmp_eq_u32 s27, 0
s_cbranch_scc1 K3_NOY0
v_min3_u32 v24, v24, v25, v26
v_min_u32 v24, v24, v27
v_cmp_ne_u32 vcc, 0, v24
s_or_b64 vcc, vcc, s[96:97]
s_cmp_eq_u64 vcc, -1
s_cbranch_scc0 M_SPINFFN
M_SRETFFN:
s_barrier
s_lshl_b32 s47, s77, 16
s_lshl_b32 s48, s3, 14
s_add_u32 s47, s47, s48
s_add_u32 s47, s47, 2162688
buffer_load_dwordx4 v[192:195], v3, s[28:31], s47 offen offset:0 sc1
buffer_load_dwordx4 v[196:199], v3, s[28:31], s47 offen offset:1024 sc1
buffer_load_dwordx4 v[200:203], v3, s[28:31], s47 offen offset:2048 sc1
buffer_load_dwordx4 v[204:207], v3, s[28:31], s47 offen offset:3072 sc1
s_add_u32 s47, s47, 4096
buffer_load_dwordx4 v[208:211], v3, s[28:31], s47 offen offset:0 sc1
buffer_load_dwordx4 v[212:215], v3, s[28:31], s47 offen offset:1024 sc1
buffer_load_dwordx4 v[216:219], v3, s[28:31], s47 offen offset:2048 sc1
buffer_load_dwordx4 v[220:223], v3, s[28:31], s47 offen offset:3072 sc1
s_add_u32 s47, s47, 4096
buffer_load_dwordx4 v[224:227], v3, s[28:31], s47 offen offset:0 sc1
buffer_load_dwordx4 v[228:231], v3, s[28:31], s47 offen offset:1024 sc1
buffer_load_dwordx4 v[232:235], v3, s[28:31], s47 offen offset:2048 sc1
buffer_load_dwordx4 v[236:239], v3, s[28:31], s47 offen offset:3072 sc1
s_add_u32 s47, s47, 4096
buffer_load_dwordx4 v[240:243], v3, s[28:31], s47 offen offset:0 sc1
buffer_load_dwordx4 v[244:247], v3, s[28:31], s47 offen offset:1024 sc1
buffer_load_dwordx4 v[248:251], v3, s[28:31], s47 offen offset:2048 sc1
buffer_load_dwordx4 v[252:255], v3, s[28:31], s47 offen offset:3072 sc1
s_add_u32 s47, s47, 4096
K3_NOY0:
v_mfma_f32_16x16x32_bf16 v[160:163], v[112:115], a[24:27], v[160:163]
buffer_load_dwordx4 a[216:219], v16, s[28:31], s74 offen offset:0 sc1
ds_read_b128 v[96:99], v6 offset:49152
v_mfma_f32_16x16x32_bf16 v[176:179], v[112:115], a[28:31], v[176:179]
buffer_load_dwordx4 a[8:11], v20, s[28:31], s73 offen offset:0 sc1
ds_read_b128 v[100:103], v7 offset:16384
v_mfma_f32_16x16x32_bf16 v[164:167], v[116:119], a[24:27], v[164:167]
buffer_load_dwordx4 a[12:15], v21, s[28:31], s73 offen offset:0 sc1
ds_read_b128 v[104:107], v7 offset:49152
v_mfma_f32_16x16x32_bf16 v[180:183], v[116:119], a[28:31], v[180:183]
ds_read_b128 v[108:111], v6 offset:16384
v_mfma_f32_16x16x32_bf16 v[168:171], v[120:123], a[24:27], v[168:171]
v_mfma_f32_16x16x32_bf16 v[184:187], v[120:123], a[28:31], v[184:187]
v_mfma_f32_16x16x32_bf16 v[172:175], v[124:127], a[24:27], v[172:175]
v_mfma_f32_16x16x32_bf16 v[188:191], v[124:127], a[28:31], v[188:191]
s_waitcnt vmcnt(25) lgkmcnt(0)
v_mfma_f32_16x16x32_bf16 v[160:163], v[96:99], a[32:35], v[160:163]
buffer_load_dwordx4 a[220:223], v17, s[28:31], s74 offen offset:0 sc1
ds_read_b128 v[112:115], v6 offset:50176
v_mfma_f32_16x16x32_bf16 v[176:179], v[96:99], a[36:39], v[176:179]
buffer_load_dwordx4 a[80:83], v14, s[28:31], s74 offen offset:1024 sc1
ds_read_b128 v[116:119], v7 offset:17408
v_mfma_f32_16x16x32_bf16 v[164:167], v[100:103], a[32:35], v[164:167]
buffer_load_dwordx4 a[16:19], v18, s[28:31], s73 offen offset:1024 sc1
ds_read_b128 v[120:123], v7 offset:50176
v_mfma_f32_16x16x32_bf16 v[180:183], v[100:103], a[36:39], v[180:183]
buffer_load_dwordx4 a[20:23], v19, s[28:31], s73 offen offset:1024 sc1
ds_read_b128 v[124:127], v6 offset:17408
v_mfma_f32_16x16x32_bf16 v[168:171], v[104:107], a[32:35], v[168:171]
v_mfma_f32_16x16x32_bf16 v[184:187], v[104:107], a[36:39], v[184:187]
v_mfma_f32_16x16x32_bf16 v[172:175], v[108:111], a[32:35], v[172:175]
v_mfma_f32_16x16x32_bf16 v[188:191], v[108:111], a[36:39], v[188:191]
s_waitcnt vmcnt(26) lgkmcnt(0)
v_mfma_f32_16x16x32_bf16 v[160:163], v[112:115], a[40:43], v[160:163]
buffer_load_dwordx4 a[84:87], v15, s[28:31], s74 offen offset:1024 sc1
ds_read_b128 v[96:99], v6 offset:51200
v_mfma_f32_16x16x32_bf16 v[176:179], v[112:115], a[44:47], v[176:179]
buffer_load_dwordx4 a[24:27], v20, s[28:31], s73 offen offset:1024 sc1
ds_read_b128 v[100:103], v7 offset:18432
v_mfma_f32_16x16x32_bf16 v[164:167], v[116:119], a[40:43], v[164:167]
buffer_load_dwordx4 a[28:31], v21, s[28:31], s73 offen offset:1024 sc1
ds_read_b128 v[104:107], v7 offset:51200
v_mfma_f32_16x16x32_bf16 v[180:183], v[116:119], a[44:47], v[180:183]
ds_read_b128 v[108:111], v6 offset:18432
v_mfma_f32_16x16x32_bf16 v[168:171], v[120:123], a[40:43], v[168:171]
v_mfma_f32_16x16x32_bf16 v[184:187], v[120:123], a[44:47], v[184:187]
v_mfma_f32_16x16x32_bf16 v[172:175], v[124:127], a[40:43], v[172:175]
v_mfma_f32_16x16x32_bf16 v[188:191], v[124:127], a[44:47], v[188:191]
s_waitcnt vmcnt(25) lgkmcnt(0)
v_mfma_f32_16x16x32_bf16 v[160:163], v[96:99], a[48:51], v[160:163]
buffer_load_dwordx4 a[88:91], v16, s[28:31], s74 offen offset:1024 sc1
ds_read_b128 v[112:115], v6 offset:52224
v_mfma_f32_16x16x32_bf16 v[176:179], v[96:99], a[52:55], v[176:179]
buffer_load_dwordx4 a[92:95], v17, s[28:31], s74 offen offset:1024 sc1
ds_read_b128 v[116:119], v7 offset:19456
v_mfma_f32_16x16x32_bf16 v[164:167], v[100:103], a[48:51], v[164:167]
buffer_load_dwordx4 a[32:35], v18, s[28:31], s73 offen offset:2048 sc1
ds_read_b128 v[120:123], v7 offset:52224
v_mfma_f32_16x16x32_bf16 v[180:183], v[100:103], a[52:55], v[180:183]
buffer_load_dwordx4 a[36:39], v19, s[28:31], s73 offen offset:2048 sc1
ds_read_b128 v[124:127], v6 offset:19456
v_mfma_f32_16x16x32_bf16 v[168:171], v[104:107], a[48:51], v[168:171]
v_mfma_f32_16x16x32_bf16 v[184:187], v[104:107], a[52:55], v[184:187]
v_mfma_f32_16x16x32_bf16 v[172:175], v[108:111], a[48:51], v[172:175]
v_mfma_f32_16x16x32_bf16 v[188:191], v[108:111], a[52:55], v[188:191]
s_waitcnt vmcnt(25) lgkmcnt(0)
v_mfma_f32_16x16x32_bf16 v[160:163], v[112:115], a[56:59], v[160:163]
buffer_load_dwordx4 a[96:99], v14, s[28:31], s74 offen offset:2048 sc1
v_mfma_f32_16x16x32_bf16 v[176:179], v[112:115], a[60:63], v[176:179]
buffer_load_dwordx4 a[100:103], v15, s[28:31], s74 offen offset:2048 sc1
v_mfma_f32_16x16x32_bf16 v[164:167], v[116:119], a[56:59], v[164:167]
buffer_load_dwordx4 a[40:43], v20, s[28:31], s73 offen offset:2048 sc1
v_mfma_f32_16x16x32_bf16 v[180:183], v[116:119], a[60:63], v[180:183]
buffer_load_dwordx4 a[44:47], v21, s[28:31], s73 offen offset:2048 sc1
v_mfma_f32_16x16x32_bf16 v[168:171], v[120:123], a[56:59], v[168:171]
v_mfma_f32_16x16x32_bf16 v[184:187], v[120:123], a[60:63], v[184:187]
v_mfma_f32_16x16x32_bf16 v[172:175], v[124:127], a[56:59], v[172:175]
v_mfma_f32_16x16x32_bf16 v[188:191], v[124:127], a[60:63], v[188:191]
s_waitcnt vmcnt(26)
v_mfma_f32_16x16x32_bf16 v[128:131], a[224:227], a[64:67], v[128:131]
buffer_load_dwordx4 a[104:107], v16, s[28:31], s74 offen offset:2048 sc1
v_mfma_f32_16x16x32_bf16 v[144:147], a[224:227], a[68:71], v[144:147]
buffer_load_dwordx4 a[48:51], v18, s[28:31], s73 offen offset:3072 sc1
v_mfma_f32_16x16x32_bf16 v[132:135], a[228:231], a[64:67], v[132:135]
buffer_load_dwordx4 a[52:55], v19, s[28:31], s73 offen offset:3072 sc1
v_mfma_f32_16x16x32_bf16 v[148:151], a[228:231], a[68:71], v[148:151]
v_mfma_f32_16x16x32_bf16 v[136:139], a[232:235], a[64:67], v[136:139]
v_mfma_f32_16x16x32_bf16 v[152:155], a[232:235], a[68:71], v[152:155]
v_mfma_f32_16x16x32_bf16 v[140:143], a[236:239], a[64:67], v[140:143]
v_mfma_f32_16x16x32_bf16 v[156:159], a[236:239], a[68:71], v[156:159]
s_waitcnt vmcnt(25)
v_mfma_f32_16x16x32_bf16 v[160:163], a[224:227], a[72:75], v[160:163]
buffer_load_dwordx4 a[108:111], v17, s[28:31], s74 offen offset:2048 sc1
v_mfma_f32_16x16x32_bf16 v[176:179], a[224:227], a[76:79], v[176:179]
buffer_load_dwordx4 a[112:115], v14, s[28:31], s74 offen offset:3072 sc1
v_mfma_f32_16x16x32_bf16 v[164:167], a[228:231], a[72:75], v[164:167]
buffer_load_dwordx4 a[56:59], v20, s[28:31], s73 offen offset:3072 sc1
v_mfma_f32_16x16x32_bf16 v[180:183], a[228:231], a[76:79], v[180:183]
buffer_load_dwordx4 a[60:63], v21, s[28:31], s73 offen offset:3072 sc1
v_mfma_f32_16x16x32_bf16 v[168:171], a[232:235], a[72:75], v[168:171]
v_mfma_f32_16x16x32_bf16 v[184:187], a[232:235], a[76:79], v[184:187]
v_mfma_f32_16x16x32_bf16 v[172:175], a[236:239], a[72:75], v[172:175]
v_mfma_f32_16x16x32_bf16 v[188:191], a[236:239], a[76:79], v[188:191]
s_waitcnt vmcnt(25)
v_mfma_f32_16x16x32_bf16 v[128:131], a[240:243], a[0:3], v[128:131]
buffer_load_dwordx4 a[116:119], v15, s[28:31], s74 offen offset:3072 sc1
v_mfma_f32_16x16x32_bf16 v[144:147], a[240:243], a[4:7], v[144:147]
buffer_load_dwordx4 a[120:123], v16, s[28:31], s74 offen offset:3072 sc1
v_mfma_f32_16x16x32_bf16 v[132:135], a[244:247], a[0:3], v[132:135]
buffer_load_dwordx4 a[64:67], v18, s[28:31], s74 offen offset:0 sc1
v_mfma_f32_16x16x32_bf16 v[148:151], a[244:247], a[4:7], v[148:151]
buffer_load_dwordx4 a[68:71], v19, s[28:31], s74 offen offset:0 sc1
v_mfma_f32_16x16x32_bf16 v[136:139], a[248:251], a[0:3], v[136:139]
v_mfma_f32_16x16x32_bf16 v[152:155], a[248:251], a[4:7], v[152:155]
v_mfma_f32_16x16x32_bf16 v[140:143], a[252:255], a[0:3], v[140:143]
v_mfma_f32_16x16x32_bf16 v[156:159], a[252:255], a[4:7], v[156:159]
s_waitcnt vmcnt(26)
v_mfma_f32_16x16x32_bf16 v[160:163], a[240:243], a[8:11], v[160:163]
buffer_load_dwordx4 a[124:127], v17, s[28:31], s74 offen offset:3072 sc1
v_mfma_f32_16x16x32_bf16 v[176:179], a[240:243], a[12:15], v[176:179]
buffer_load_dwordx4 a[72:75], v20, s[28:31], s74 offen offset:0 sc1
v_mfma_f32_16x16x32_bf16 v[164:167], a[244:247], a[8:11], v[164:167]
buffer_load_dwordx4 a[76:79], v21, s[28:31], s74 offen offset:0 sc1
v_mfma_f32_16x16x32_bf16 v[180:183], a[244:247], a[12:15], v[180:183]
v_mfma_f32_16x16x32_bf16 v[168:171], a[248:251], a[8:11], v[168:171]
v_mfma_f32_16x16x32_bf16 v[184:187], a[248:251], a[12:15], v[184:187]
v_mfma_f32_16x16x32_bf16 v[172:175], a[252:255], a[8:11], v[172:175]
v_mfma_f32_16x16x32_bf16 v[188:191], a[252:255], a[12:15], v[188:191]
s_waitcnt vmcnt(25)
v_mfma_f32_16x16x32_bf16 v[128:131], a[160:163], a[16:19], v[128:131]
buffer_load_dwordx4 a[128:131], v14, s[28:31], s75 offen offset:0 sc1
v_mfma_f32_16x16x32_bf16 v[144:147], a[160:163], a[20:23], v[144:147]
buffer_load_dwordx4 a[132:135], v15, s[28:31], s75 offen offset:0 sc1
v_mfma_f32_16x16x32_bf16 v[132:135], a[164:167], a[16:19], v[132:135]
buffer_load_dwordx4 a[0:3], v18, s[28:31], s74 offen offset:1024 sc1
v_mfma_f32_16x16x32_bf16 v[148:151], a[164:167], a[20:23], v[148:151]
buffer_load_dwordx4 a[4:7], v19, s[28:31], s74 offen offset:1024 sc1
v_mfma_f32_16x16x32_bf16 v[136:139], a[168:171], a[16:19], v[136:139]
v_mfma_f32_16x16x32_bf16 v[152:155], a[168:171], a[20:23], v[152:155]
v_mfma_f32_16x16x32_bf16 v[140:143], a[172:175], a[16:19], v[140:143]
v_mfma_f32_16x16x32_bf16 v[156:159], a[172:175], a[20:23], v[156:159]
s_waitcnt vmcnt(26)
v_mfma_f32_16x16x32_bf16 v[160:163], a[160:163], a[24:27], v[160:163]
buffer_load_dwordx4 a[136:139], v16, s[28:31], s75 offen offset:0 sc1
v_mfma_f32_16x16x32_bf16 v[176:179], a[160:163], a[28:31], v[176:179]
buffer_load_dwordx4 a[8:11], v20, s[28:31], s74 offen offset:1024 sc1
v_mfma_f32_16x16x32_bf16 v[164:167], a[164:167], a[24:27], v[164:167]
buffer_load_dwordx4 a[12:15], v21, s[28:31], s74 offen offset:1024 sc1
v_mfma_f32_16x16x32_bf16 v[180:183], a[164:167], a[28:31], v[180:183]
v_mfma_f32_16x16x32_bf16 v[168:171], a[168:171], a[24:27], v[168:171]
v_mfma_f32_16x16x32_bf16 v[184:187], a[168:171], a[28:31], v[184:187]
v_mfma_f32_16x16x32_bf16 v[172:175], a[172:175], a[24:27], v[172:175]
v_mfma_f32_16x16x32_bf16 v[188:191], a[172:175], a[28:31], v[188:191]
s_waitcnt vmcnt(25)
s_cmp_eq_u32 s27, 0
s_cbranch_scc1 K3_NOY1
v_add_f32 v192, v192, v224
v_add_f32 v193, v193, v225
v_add_f32 v194, v194, v226
v_add_f32 v195, v195, v227
v_add_f32 v196, v196, v228
v_add_f32 v197, v197, v229
v_add_f32 v198, v198, v230
v_add_f32 v199, v199, v231
v_add_f32 v200, v200, v232
v_add_f32 v201, v201, v233
v_add_f32 v202, v202, v234
v_add_f32 v203, v203, v235
v_add_f32 v204, v204, v236
v_add_f32 v205, v205, v237
v_add_f32 v206, v206, v238
v_add_f32 v207, v207, v239
v_add_f32 v208, v208, v240
v_add_f32 v209, v209, v241
v_add_f32 v210, v210, v242
v_add_f32 v211, v211, v243
v_add_f32 v212, v212, v244
v_add_f32 v213, v213, v245
v_add_f32 v214, v214, v246
v_add_f32 v215, v215, v247
v_add_f32 v216, v216, v248
v_add_f32 v217, v217, v249
v_add_f32 v218, v218, v250
v_add_f32 v219, v219, v251
v_add_f32 v220, v220, v252
v_add_f32 v221, v221, v253
v_add_f32 v222, v222, v254
v_add_f32 v223, v223, v255
v_add_f32 v192, v192, v208
v_add_f32 v193, v193, v209
v_add_f32 v194, v194, v210
v_add_f32 v195, v195, v211
v_add_f32 v196, v196, v212
v_add_f32 v197, v197, v213
v_add_f32 v198, v198, v214
v_add_f32 v199, v199, v215
v_add_f32 v200, v200, v216
v_add_f32 v201, v201, v217
v_add_f32 v202, v202, v218
v_add_f32 v203, v203, v219
v_add_f32 v204, v204, v220
v_add_f32 v205, v205, v221
v_add_f32 v206, v206, v222
v_add_f32 v207, v207, v223
v_add_f32 v192, v192, v200
v_add_f32 v193, v193, v201
v_add_f32 v194, v194, v202
v_add_f32 v195, v195, v203
v_add_f32 v196, v196, v204
v_add_f32 v197, v197, v205
v_add_f32 v198, v198, v206
v_add_f32 v199, v199, v207
v_add_f32 v192, v192, v196
v_add_f32 v193, v193, v197
v_add_f32 v194, v194, v198
v_add_f32 v195, v195, v199
v_mov_b32 v196, v192
v_mov_b32 v197, v193
v_mov_b32 v198, v194
v_mov_b32 v199, v195
v_permlane16_swap_b32 v192, v196
v_permlane16_swap_b32 v193, v197
v_permlane16_swap_b32 v194, v198
v_permlane16_swap_b32 v195, v199
v_add_f32 v192, v192, v196
v_add_f32 v193, v193, v197
v_add_f32 v194, v194, v198
v_add_f32 v195, v195, v199
v_mov_b32 v196, v192
v_mov_b32 v197, v193
v_mov_b32 v198, v194
v_mov_b32 v199, v195
v_permlane32_swap_b32 v192, v196
v_permlane32_swap_b32 v193, v197
v_permlane32_swap_b32 v194, v198
v_permlane32_swap_b32 v195, v199
v_add_f32 v192, v192, v196
v_add_f32 v193, v193, v197
v_add_f32 v194, v194, v198
v_add_f32 v195, v195, v199
s_lshl_b32 s47, s3, 8
s_add_u32 s47, s47, 132096
v_lshlrev_b32 v22, 4, v8
v_add_u32 v22, s47, v22
ds_write_b128 v22, v[192:195]
s_waitcnt lgkmcnt(0)
K3_NOY1:
v_mfma_f32_16x16x32_bf16 v[128:131], a[176:179], a[32:35], v[128:131]
buffer_load_dwordx4 a[140:143], v17, s[28:31], s75 offen offset:0 sc1
v_mfma_f32_16x16x32_bf16 v[144:147], a[176:179], a[36:39], v[144:147]
buffer_load_dwordx4 a[144:147], v14, s[28:31], s75 offen offset:1024 sc1
v_mfma_f32_16x16x32_bf16 v[132:135], a[180:183], a[32:35], v[132:135]
buffer_load_dwordx4 a[16:19], v18, s[28:31], s74 offen offset:2048 sc1
v_mfma_f32_16x16x32_bf16 v[148:151], a[180:183], a[36:39], v[148:151]
buffer_load_dwordx4 a[20:23], v19, s[28:31], s74 offen offset:2048 sc1
v_mfma_f32_16x16x32_bf16 v[136:139], a[184:187], a[32:35], v[136:139]
v_mfma_f32_16x16x32_bf16 v[152:155], a[184:187], a[36:39], v[152:155]
v_mfma_f32_16x16x32_bf16 v[140:143], a[188:191], a[32:35], v[140:143]
v_mfma_f32_16x16x32_bf16 v[156:159], a[188:191], a[36:39], v[156:159]
s_waitcnt vmcnt(25)
v_mfma_f32_16x16x32_bf16 v[160:163], a[176:179], a[40:43], v[160:163]
buffer_load_dwordx4 a[148:151], v15, s[28:31], s75 offen offset:1024 sc1
v_mfma_f32_16x16x32_bf16 v[176:179], a[176:179], a[44:47], v[176:179]
buffer_load_dwordx4 a[152:155], v16, s[28:31], s75 offen offset:1024 sc1
v_mfma_f32_16x16x32_bf16 v[164:167], a[180:183], a[40:43], v[164:167]
buffer_load_dwordx4 a[24:27], v20, s[28:31], s74 offen offset:2048 sc1
v_mfma_f32_16x16x32_bf16 v[180:183], a[180:183], a[44:47], v[180:183]
buffer_load_dwordx4 a[28:31], v21, s[28:31], s74 offen offset:2048 sc1
v_mfma_f32_16x16x32_bf16 v[168:171], a[184:187], a[40:43], v[168:171]
v_mfma_f32_16x16x32_bf16 v[184:187], a[184:187], a[44:47], v[184:187]
v_mfma_f32_16x16x32_bf16 v[172:175], a[188:191], a[40:43], v[172:175]
v_mfma_f32_16x16x32_bf16 v[188:191], a[188:191], a[44:47], v[188:191]
s_waitcnt vmcnt(26)
s_barrier
s_lshr_b32 s26, s25, 4
s_cmp_eq_u32 s26, s59
s_cbranch_scc0 K3_NOY3
v_lshlrev_b32 v22, 5, v9
v_add_u32 v22, 132096, v22
ds_read_b128 v[192:195], v22 offset:0
ds_read_b128 v[196:199], v22 offset:16
ds_read_b128 v[200:203], v22 offset:128
ds_read_b128 v[204:207], v22 offset:144
ds_read_b128 v[208:211], v22 offset:256
ds_read_b128 v[212:215], v22 offset:272
ds_read_b128 v[216:219], v22 offset:384
ds_read_b128 v[220:223], v22 offset:400
ds_read_b128 v[224:227], v22 offset:512
ds_read_b128 v[228:231], v22 offset:528
ds_read_b128 v[232:235], v22 offset:640
ds_read_b128 v[236:239], v22 offset:656
ds_read_b128 v[240:243], v22 offset:768
ds_read_b128 v[244:247], v22 offset:784
ds_read_b128 v[248:251], v22 offset:896
ds_read_b128 v[252:255], v22 offset:912
s_lshr_b32 s26, s58, 31
s_sub_u32 s26, s26, 1
s_or_b32 s26, s26, 0x80000000
s_xor_b32 s26, s26, s58
s_and_b32 s26, s26, 0xffff0000
v_mov_b32 v23, s26
v_mul_f32 v23, 0xbfb8aa3b, v23
v_exp_f32 v23, v23
s_nop 0
v_add_f32 v23, 1.0, v23
v_rcp_f32 v23, v23
s_nop 0
v_cvt_pk_bf16_f32 v23, v23, v23
v_and_b32 v23, 0xffff0000, v23
s_and_b32 s26, s25, 15
v_cmp_eq_u32 vcc, s26, v8
s_waitcnt lgkmcnt(0)
v_add_f32 v192, v192, v208
v_add_f32 v224, v224, v240
v_add_f32 v192, v192, v224
v_cvt_pk_bf16_f32 v192, v192, v192
v_and_b32 v192, 0xffff0000, v192
v_mul_f32 v192, v192, v23
v_cvt_pk_bf16_f32 v192, v192, v192
v_and_b32 v192, 0xffff0000, v192
v_add_f32 v192, v80, v192
v_cvt_pk_bf16_f32 v192, v192, v192
v_and_b32 v192, 0xffff0000, v192
v_cndmask_b32 v80, v80, v192, vcc
v_add_f32 v193, v193, v209
v_add_f32 v225, v225, v241
v_add_f32 v193, v193, v225
v_cvt_pk_bf16_f32 v193, v193, v193
v_and_b32 v193, 0xffff0000, v193
v_mul_f32 v193, v193, v23
v_cvt_pk_bf16_f32 v193, v193, v193
v_and_b32 v193, 0xffff0000, v193
v_add_f32 v193, v81, v193
v_cvt_pk_bf16_f32 v193, v193, v193
v_and_b32 v193, 0xffff0000, v193
v_cndmask_b32 v81, v81, v193, vcc
v_add_f32 v194, v194, v210
v_add_f32 v226, v226, v242
v_add_f32 v194, v194, v226
v_cvt_pk_bf16_f32 v194, v194, v194
v_and_b32 v194, 0xffff0000, v194
v_mul_f32 v194, v194, v23
v_cvt_pk_bf16_f32 v194, v194, v194
v_and_b32 v194, 0xffff0000, v194
v_add_f32 v194, v82, v194
v_cvt_pk_bf16_f32 v194, v194, v194
v_and_b32 v194, 0xffff0000, v194
v_cndmask_b32 v82, v82, v194, vcc
v_add_f32 v195, v195, v211
v_add_f32 v227, v227, v243
v_add_f32 v195, v195, v227
v_cvt_pk_bf16_f32 v195, v195, v195
v_and_b32 v195, 0xffff0000, v195
v_mul_f32 v195, v195, v23
v_cvt_pk_bf16_f32 v195, v195, v195
v_and_b32 v195, 0xffff0000, v195
v_add_f32 v195, v83, v195
v_cvt_pk_bf16_f32 v195, v195, v195
v_and_b32 v195, 0xffff0000, v195
v_cndmask_b32 v83, v83, v195, vcc
v_add_f32 v196, v196, v212
v_add_f32 v228, v228, v244
v_add_f32 v196, v196, v228
v_cvt_pk_bf16_f32 v196, v196, v196
v_and_b32 v196, 0xffff0000, v196
v_mul_f32 v196, v196, v23
v_cvt_pk_bf16_f32 v196, v196, v196
v_and_b32 v196, 0xffff0000, v196
v_add_f32 v196, v84, v196
v_cvt_pk_bf16_f32 v196, v196, v196
v_and_b32 v196, 0xffff0000, v196
v_cndmask_b32 v84, v84, v196, vcc
v_add_f32 v197, v197, v213
v_add_f32 v229, v229, v245
v_add_f32 v197, v197, v229
v_cvt_pk_bf16_f32 v197, v197, v197
v_and_b32 v197, 0xffff0000, v197
v_mul_f32 v197, v197, v23
v_cvt_pk_bf16_f32 v197, v197, v197
v_and_b32 v197, 0xffff0000, v197
v_add_f32 v197, v85, v197
v_cvt_pk_bf16_f32 v197, v197, v197
v_and_b32 v197, 0xffff0000, v197
v_cndmask_b32 v85, v85, v197, vcc
v_add_f32 v198, v198, v214
v_add_f32 v230, v230, v246
v_add_f32 v198, v198, v230
v_cvt_pk_bf16_f32 v198, v198, v198
v_and_b32 v198, 0xffff0000, v198
v_mul_f32 v198, v198, v23
v_cvt_pk_bf16_f32 v198, v198, v198
v_and_b32 v198, 0xffff0000, v198
v_add_f32 v198, v86, v198
v_cvt_pk_bf16_f32 v198, v198, v198
v_and_b32 v198, 0xffff0000, v198
v_cndmask_b32 v86, v86, v198, vcc
v_add_f32 v199, v199, v215
v_add_f32 v231, v231, v247
v_add_f32 v199, v199, v231
v_cvt_pk_bf16_f32 v199, v199, v199
v_and_b32 v199, 0xffff0000, v199
v_mul_f32 v199, v199, v23
v_cvt_pk_bf16_f32 v199, v199, v199
v_and_b32 v199, 0xffff0000, v199
v_add_f32 v199, v87, v199
v_cvt_pk_bf16_f32 v199, v199, v199
v_and_b32 v199, 0xffff0000, v199
v_cndmask_b32 v87, v87, v199, vcc
v_add_f32 v200, v200, v216
v_add_f32 v232, v232, v248
v_add_f32 v200, v200, v232
v_cvt_pk_bf16_f32 v200, v200, v200
v_and_b32 v200, 0xffff0000, v200
v_mul_f32 v200, v200, v23
v_cvt_pk_bf16_f32 v200, v200, v200
v_and_b32 v200, 0xffff0000, v200
v_add_f32 v200, v88, v200
v_cvt_pk_bf16_f32 v200, v200, v200
v_and_b32 v200, 0xffff0000, v200
v_cndmask_b32 v88, v88, v200, vcc
v_add_f32 v201, v201, v217
v_add_f32 v233, v233, v249
v_add_f32 v201, v201, v233
v_cvt_pk_bf16_f32 v201, v201, v201
v_and_b32 v201, 0xffff0000, v201
v_mul_f32 v201, v201, v23
v_cvt_pk_bf16_f32 v201, v201, v201
v_and_b32 v201, 0xffff0000, v201
v_add_f32 v201, v89, v201
v_cvt_pk_bf16_f32 v201, v201, v201
v_and_b32 v201, 0xffff0000, v201
v_cndmask_b32 v89, v89, v201, vcc
v_add_f32 v202, v202, v218
v_add_f32 v234, v234, v250
v_add_f32 v202, v202, v234
v_cvt_pk_bf16_f32 v202, v202, v202
v_and_b32 v202, 0xffff0000, v202
v_mul_f32 v202, v202, v23
v_cvt_pk_bf16_f32 v202, v202, v202
v_and_b32 v202, 0xffff0000, v202
v_add_f32 v202, v90, v202
v_cvt_pk_bf16_f32 v202, v202, v202
v_and_b32 v202, 0xffff0000, v202
v_cndmask_b32 v90, v90, v202, vcc
v_add_f32 v203, v203, v219
v_add_f32 v235, v235, v251
v_add_f32 v203, v203, v235
v_cvt_pk_bf16_f32 v203, v203, v203
v_and_b32 v203, 0xffff0000, v203
v_mul_f32 v203, v203, v23
v_cvt_pk_bf16_f32 v203, v203, v203
v_and_b32 v203, 0xffff0000, v203
v_add_f32 v203, v91, v203
v_cvt_pk_bf16_f32 v203, v203, v203
v_and_b32 v203, 0xffff0000, v203
v_cndmask_b32 v91, v91, v203, vcc
v_add_f32 v204, v204, v220
v_add_f32 v236, v236, v252
v_add_f32 v204, v204, v236
v_cvt_pk_bf16_f32 v204, v204, v204
v_and_b32 v204, 0xffff0000, v204
v_mul_f32 v204, v204, v23
v_cvt_pk_bf16_f32 v204, v204, v204
v_and_b32 v204, 0xffff0000, v204
v_add_f32 v204, v92, v204
v_cvt_pk_bf16_f32 v204, v204, v204
v_and_b32 v204, 0xffff0000, v204
v_cndmask_b32 v92, v92, v204, vcc
v_add_f32 v205, v205, v221
v_add_f32 v237, v237, v253
v_add_f32 v205, v205, v237
v_cvt_pk_bf16_f32 v205, v205, v205
v_and_b32 v205, 0xffff0000, v205
v_mul_f32 v205, v205, v23
v_cvt_pk_bf16_f32 v205, v205, v205
v_and_b32 v205, 0xffff0000, v205
v_add_f32 v205, v93, v205
v_cvt_pk_bf16_f32 v205, v205, v205
v_and_b32 v205, 0xffff0000, v205
v_cndmask_b32 v93, v93, v205, vcc
v_add_f32 v206, v206, v222
v_add_f32 v238, v238, v254
v_add_f32 v206, v206, v238
v_cvt_pk_bf16_f32 v206, v206, v206
v_and_b32 v206, 0xffff0000, v206
v_mul_f32 v206, v206, v23
v_cvt_pk_bf16_f32 v206, v206, v206
v_and_b32 v206, 0xffff0000, v206
v_add_f32 v206, v94, v206
v_cvt_pk_bf16_f32 v206, v206, v206
v_and_b32 v206, 0xffff0000, v206
v_cndmask_b32 v94, v94, v206, vcc
v_add_f32 v207, v207, v223
v_add_f32 v239, v239, v255
v_add_f32 v207, v207, v239
v_cvt_pk_bf16_f32 v207, v207, v207
v_and_b32 v207, 0xffff0000, v207
v_mul_f32 v207, v207, v23
v_cvt_pk_bf16_f32 v207, v207, v207
v_and_b32 v207, 0xffff0000, v207
v_add_f32 v207, v95, v207
v_cvt_pk_bf16_f32 v207, v207, v207
v_and_b32 v207, 0xffff0000, v207
v_cndmask_b32 v95, v95, v207, vcc
v_mul_f32 v64, 0xbfb8aa3b, v80
v_mul_f32 v65, 0xbfb8aa3b, v81
v_mul_f32 v66, 0xbfb8aa3b, v82
v_mul_f32 v67, 0xbfb8aa3b, v83
v_mul_f32 v68, 0xbfb8aa3b, v84
v_mul_f32 v69, 0xbfb8aa3b, v85
v_mul_f32 v70, 0xbfb8aa3b, v86
v_mul_f32 v71, 0xbfb8aa3b, v87
v_mul_f32 v72, 0xbfb8aa3b, v88
v_mul_f32 v73, 0xbfb8aa3b, v89
v_mul_f32 v74, 0xbfb8aa3b, v90
v_mul_f32 v75, 0xbfb8aa3b, v91
v_mul_f32 v76, 0xbfb8aa3b, v92
v_mul_f32 v77, 0xbfb8aa3b, v93
v_mul_f32 v78, 0xbfb8aa3b, v94
v_mul_f32 v79, 0xbfb8aa3b, v95
v_exp_f32 v64, v64
v_exp_f32 v65, v65
v_exp_f32 v66, v66
v_exp_f32 v67, v67
v_exp_f32 v68, v68
v_exp_f32 v69, v69
v_exp_f32 v70, v70
v_exp_f32 v71, v71
v_exp_f32 v72, v72
v_exp_f32 v73, v73
v_exp_f32 v74, v74
v_exp_f32 v75, v75
v_exp_f32 v76, v76
v_exp_f32 v77, v77
v_exp_f32 v78, v78
v_exp_f32 v79, v79
v_add_f32 v64, 1.0, v64
v_add_f32 v65, 1.0, v65
v_add_f32 v66, 1.0, v66
v_add_f32 v67, 1.0, v67
v_add_f32 v68, 1.0, v68
v_add_f32 v69, 1.0, v69
v_add_f32 v70, 1.0, v70
v_add_f32 v71, 1.0, v71
v_add_f32 v72, 1.0, v72
v_add_f32 v73, 1.0, v73
v_add_f32 v74, 1.0, v74
v_add_f32 v75, 1.0, v75
v_add_f32 v76, 1.0, v76
v_add_f32 v77, 1.0, v77
v_add_f32 v78, 1.0, v78
v_add_f32 v79, 1.0, v79
v_rcp_f32 v64, v64
v_rcp_f32 v65, v65
v_rcp_f32 v66, v66
v_rcp_f32 v67, v67
v_rcp_f32 v68, v68
v_rcp_f32 v69, v69
v_rcp_f32 v70, v70
v_rcp_f32 v71, v71
v_rcp_f32 v72, v72
v_rcp_f32 v73, v73
v_rcp_f32 v74, v74
v_rcp_f32 v75, v75
v_rcp_f32 v76, v76
v_rcp_f32 v77, v77
v_rcp_f32 v78, v78
v_rcp_f32 v79, v79
v_mul_f32 v64, v80, v64
v_mul_f32 v65, v81, v65
v_mul_f32 v66, v82, v66
v_mul_f32 v67, v83, v67
v_mul_f32 v68, v84, v68
v_mul_f32 v69, v85, v69
v_mul_f32 v70, v86, v70
v_mul_f32 v71, v87, v71
v_mul_f32 v72, v88, v72
v_mul_f32 v73, v89, v73
v_mul_f32 v74, v90, v74
v_mul_f32 v75, v91, v75
v_mul_f32 v76, v92, v76
v_mul_f32 v77, v93, v77
v_mul_f32 v78, v94, v78
v_mul_f32 v79, v95, v79
v_cvt_pk_bf16_f32 v32, v64, v65
v_cvt_pk_bf16_f32 v33, v66, v67
v_cvt_pk_bf16_f32 v34, v68, v69
v_cvt_pk_bf16_f32 v35, v70, v71
v_cvt_pk_bf16_f32 v36, v72, v73
v_cvt_pk_bf16_f32 v37, v74, v75
v_cvt_pk_bf16_f32 v38, v76, v77
v_cvt_pk_bf16_f32 v39, v78, v79
v_lshlrev_b32 v64, 16, v32
v_and_b32 v65, 0xffff0000, v32
v_lshlrev_b32 v66, 16, v33
v_and_b32 v67, 0xffff0000, v33
v_lshlrev_b32 v68, 16, v34
v_and_b32 v69, 0xffff0000, v34
v_lshlrev_b32 v70, 16, v35
v_and_b32 v71, 0xffff0000, v35
v_lshlrev_b32 v72, 16, v36
v_and_b32 v73, 0xffff0000, v36
v_lshlrev_b32 v74, 16, v37
v_and_b32 v75, 0xffff0000, v37
v_lshlrev_b32 v76, 16, v38
v_and_b32 v77, 0xffff0000, v38
v_lshlrev_b32 v78, 16, v39
v_and_b32 v79, 0xffff0000, v39
K3_NOY3:
v_mfma_f32_16x16x32_bf16 v[128:131], a[192:195], a[48:51], v[128:131]
buffer_load_dwordx4 a[156:159], v17, s[28:31], s75 offen offset:1024 sc1
v_mfma_f32_16x16x32_bf16 v[144:147], a[192:195], a[52:55], v[144:147]
buffer_load_dwordx4 a[32:35], v18, s[28:31], s74 offen offset:3072 sc1
v_mfma_f32_16x16x32_bf16 v[132:135], a[196:199], a[48:51], v[132:135]
buffer_load_dwordx4 a[36:39], v19, s[28:31], s74 offen offset:3072 sc1
v_mfma_f32_16x16x32_bf16 v[148:151], a[196:199], a[52:55], v[148:151]
v_mfma_f32_16x16x32_bf16 v[136:139], a[200:203], a[48:51], v[136:139]
v_mfma_f32_16x16x32_bf16 v[152:155], a[200:203], a[52:55], v[152:155]
v_mfma_f32_16x16x32_bf16 v[140:143], a[204:207], a[48:51], v[140:143]
v_mfma_f32_16x16x32_bf16 v[156:159], a[204:207], a[52:55], v[156:159]
s_waitcnt vmcnt(25)
v_mfma_f32_16x16x32_bf16 v[160:163], a[192:195], a[56:59], v[160:163]
buffer_load_dwordx4 a[224:227], v14, s[28:31], s75 offen offset:2048 sc1
v_mfma_f32_16x16x32_bf16 v[176:179], a[192:195], a[60:63], v[176:179]
buffer_load_dwordx4 a[228:231], v15, s[28:31], s75 offen offset:2048 sc1
v_mfma_f32_16x16x32_bf16 v[164:167], a[196:199], a[56:59], v[164:167]
buffer_load_dwordx4 a[40:43], v20, s[28:31], s74 offen offset:3072 sc1
v_mfma_f32_16x16x32_bf16 v[180:183], a[196:199], a[60:63], v[180:183]
buffer_load_dwordx4 a[44:47], v21, s[28:31], s74 offen offset:3072 sc1
v_mfma_f32_16x16x32_bf16 v[168:171], a[200:203], a[56:59], v[168:171]
v_mfma_f32_16x16x32_bf16 v[184:187], a[200:203], a[60:63], v[184:187]
v_mfma_f32_16x16x32_bf16 v[172:175], a[204:207], a[56:59], v[172:175]
v_mfma_f32_16x16x32_bf16 v[188:191], a[204:207], a[60:63], v[188:191]
s_waitcnt vmcnt(25)
v_mfma_f32_16x16x32_bf16 v[128:131], a[208:211], a[64:67], v[128:131]
buffer_load_dwordx4 a[232:235], v16, s[28:31], s75 offen offset:2048 sc1
v_mfma_f32_16x16x32_bf16 v[144:147], a[208:211], a[68:71], v[144:147]
buffer_load_dwordx4 a[236:239], v17, s[28:31], s75 offen offset:2048 sc1
v_mfma_f32_16x16x32_bf16 v[132:135], a[212:215], a[64:67], v[132:135]
buffer_load_dwordx4 a[48:51], v18, s[28:31], s75 offen offset:0 sc1
v_mfma_f32_16x16x32_bf16 v[148:151], a[212:215], a[68:71], v[148:151]
buffer_load_dwordx4 a[52:55], v19, s[28:31], s75 offen offset:0 sc1
v_mfma_f32_16x16x32_bf16 v[136:139], a[216:219], a[64:67], v[136:139]
v_mfma_f32_16x16x32_bf16 v[152:155], a[216:219], a[68:71], v[152:155]
v_mfma_f32_16x16x32_bf16 v[140:143], a[220:223], a[64:67], v[140:143]
v_mfma_f32_16x16x32_bf16 v[156:159], a[220:223], a[68:71], v[156:159]
s_waitcnt vmcnt(26)
v_mfma_f32_16x16x32_bf16 v[160:163], a[208:211], a[72:75], v[160:163]
buffer_load_dwordx4 a[240:243], v14, s[28:31], s75 offen offset:3072 sc1
v_mfma_f32_16x16x32_bf16 v[176:179], a[208:211], a[76:79], v[176:179]
buffer_load_dwordx4 a[56:59], v20, s[28:31], s75 offen offset:0 sc1
v_mfma_f32_16x16x32_bf16 v[164:167], a[212:215], a[72:75], v[164:167]
buffer_load_dwordx4 a[60:63], v21, s[28:31], s75 offen offset:0 sc1
v_mfma_f32_16x16x32_bf16 v[180:183], a[212:215], a[76:79], v[180:183]
v_mfma_f32_16x16x32_bf16 v[168:171], a[216:219], a[72:75], v[168:171]
v_mfma_f32_16x16x32_bf16 v[184:187], a[216:219], a[76:79], v[184:187]
v_mfma_f32_16x16x32_bf16 v[172:175], a[220:223], a[72:75], v[172:175]
v_mfma_f32_16x16x32_bf16 v[188:191], a[220:223], a[76:79], v[188:191]
s_waitcnt vmcnt(25)
v_mfma_f32_16x16x32_bf16 v[128:131], a[80:83], a[0:3], v[128:131]
buffer_load_dwordx4 a[244:247], v15, s[28:31], s75 offen offset:3072 sc1
v_mfma_f32_16x16x32_bf16 v[144:147], a[80:83], a[4:7], v[144:147]
buffer_load_dwordx4 a[248:251], v16, s[28:31], s75 offen offset:3072 sc1
v_mfma_f32_16x16x32_bf16 v[132:135], a[84:87], a[0:3], v[132:135]
buffer_load_dwordx4 a[64:67], v18, s[28:31], s75 offen offset:1024 sc1
v_mfma_f32_16x16x32_bf16 v[148:151], a[84:87], a[4:7], v[148:151]
buffer_load_dwordx4 a[68:71], v19, s[28:31], s75 offen offset:1024 sc1
v_mfma_f32_16x16x32_bf16 v[136:139], a[88:91], a[0:3], v[136:139]
v_mfma_f32_16x16x32_bf16 v[152:155], a[88:91], a[4:7], v[152:155]
v_mfma_f32_16x16x32_bf16 v[140:143], a[92:95], a[0:3], v[140:143]
v_mfma_f32_16x16x32_bf16 v[156:159], a[92:95], a[4:7], v[156:159]
s_waitcnt vmcnt(26)
v_mfma_f32_16x16x32_bf16 v[160:163], a[80:83], a[8:11], v[160:163]
buffer_load_dwordx4 a[252:255], v17, s[28:31], s75 offen offset:3072 sc1
v_mfma_f32_16x16x32_bf16 v[176:179], a[80:83], a[12:15], v[176:179]
buffer_load_dwordx4 a[72:75], v20, s[28:31], s75 offen offset:1024 sc1
v_mfma_f32_16x16x32_bf16 v[164:167], a[84:87], a[8:11], v[164:167]
buffer_load_dwordx4 a[76:79], v21, s[28:31], s75 offen offset:1024 sc1
v_mfma_f32_16x16x32_bf16 v[180:183], a[84:87], a[12:15], v[180:183]
v_mfma_f32_16x16x32_bf16 v[168:171], a[88:91], a[8:11], v[168:171]
v_mfma_f32_16x16x32_bf16 v[184:187], a[88:91], a[12:15], v[184:187]
v_mfma_f32_16x16x32_bf16 v[172:175], a[92:95], a[8:11], v[172:175]
v_mfma_f32_16x16x32_bf16 v[188:191], a[92:95], a[12:15], v[188:191]
s_waitcnt vmcnt(25)
v_mfma_f32_16x16x32_bf16 v[128:131], a[96:99], a[16:19], v[128:131]
buffer_load_dwordx4 a[0:3], v18, s[28:31], s75 offen offset:2048 sc1
v_mfma_f32_16x16x32_bf16 v[144:147], a[96:99], a[20:23], v[144:147]
buffer_load_dwordx4 a[4:7], v19, s[28:31], s75 offen offset:2048 sc1
v_mfma_f32_16x16x32_bf16 v[132:135], a[100:103], a[16:19], v[132:135]
v_mfma_f32_16x16x32_bf16 v[148:151], a[100:103], a[20:23], v[148:151]
v_mfma_f32_16x16x32_bf16 v[136:139], a[104:107], a[16:19], v[136:139]
v_mfma_f32_16x16x32_bf16 v[152:155], a[104:107], a[20:23], v[152:155]
v_mfma_f32_16x16x32_bf16 v[140:143], a[108:111], a[16:19], v[140:143]
v_mfma_f32_16x16x32_bf16 v[156:159], a[108:111], a[20:23], v[156:159]
s_waitcnt vmcnt(23)
v_mfma_f32_16x16x32_bf16 v[160:163], a[96:99], a[24:27], v[160:163]
buffer_load_dwordx4 a[8:11], v20, s[28:31], s75 offen offset:2048 sc1
v_mfma_f32_16x16x32_bf16 v[176:179], a[96:99], a[28:31], v[176:179]
buffer_load_dwordx4 a[12:15], v21, s[28:31], s75 offen offset:2048 sc1
v_mfma_f32_16x16x32_bf16 v[164:167], a[100:103], a[24:27], v[164:167]
v_mfma_f32_16x16x32_bf16 v[180:183], a[100:103], a[28:31], v[180:183]
v_mfma_f32_16x16x32_bf16 v[168:171], a[104:107], a[24:27], v[168:171]
v_mfma_f32_16x16x32_bf16 v[184:187], a[104:107], a[28:31], v[184:187]
v_mfma_f32_16x16x32_bf16 v[172:175], a[108:111], a[24:27], v[172:175]
v_mfma_f32_16x16x32_bf16 v[188:191], a[108:111], a[28:31], v[188:191]
s_waitcnt vmcnt(22)
v_mfma_f32_16x16x32_bf16 v[128:131], a[112:115], a[32:35], v[128:131]
buffer_load_dwordx4 a[16:19], v18, s[28:31], s75 offen offset:3072 sc1
v_mfma_f32_16x16x32_bf16 v[144:147], a[112:115], a[36:39], v[144:147]
buffer_load_dwordx4 a[20:23], v19, s[28:31], s75 offen offset:3072 sc1
v_mfma_f32_16x16x32_bf16 v[132:135], a[116:119], a[32:35], v[132:135]
v_mfma_f32_16x16x32_bf16 v[148:151], a[116:119], a[36:39], v[148:151]
v_mfma_f32_16x16x32_bf16 v[136:139], a[120:123], a[32:35], v[136:139]
v_mfma_f32_16x16x32_bf16 v[152:155], a[120:123], a[36:39], v[152:155]
v_mfma_f32_16x16x32_bf16 v[140:143], a[124:127], a[32:35], v[140:143]
v_mfma_f32_16x16x32_bf16 v[156:159], a[124:127], a[36:39], v[156:159]
s_waitcnt vmcnt(20)
v_mfma_f32_16x16x32_bf16 v[160:163], a[112:115], a[40:43], v[160:163]
buffer_load_dwordx4 a[24:27], v20, s[28:31], s75 offen offset:3072 sc1
v_mfma_f32_16x16x32_bf16 v[176:179], a[112:115], a[44:47], v[176:179]
buffer_load_dwordx4 a[28:31], v21, s[28:31], s75 offen offset:3072 sc1
v_mfma_f32_16x16x32_bf16 v[164:167], a[116:119], a[40:43], v[164:167]
v_mfma_f32_16x16x32_bf16 v[180:183], a[116:119], a[44:47], v[180:183]
v_mfma_f32_16x16x32_bf16 v[168:171], a[120:123], a[40:43], v[168:171]
v_mfma_f32_16x16x32_bf16 v[184:187], a[120:123], a[44:47], v[184:187]
v_mfma_f32_16x16x32_bf16 v[172:175], a[124:127], a[40:43], v[172:175]
v_mfma_f32_16x16x32_bf16 v[188:191], a[124:127], a[44:47], v[188:191]
s_waitcnt vmcnt(18)
v_mfma_f32_16x16x32_bf16 v[128:131], a[128:131], a[48:51], v[128:131]
v_mfma_f32_16x16x32_bf16 v[144:147], a[128:131], a[52:55], v[144:147]
v_mfma_f32_16x16x32_bf16 v[132:135], a[132:135], a[48:51], v[132:135]
v_mfma_f32_16x16x32_bf16 v[148:151], a[132:135], a[52:55], v[148:151]
v_mfma_f32_16x16x32_bf16 v[136:139], a[136:139], a[48:51], v[136:139]
v_mfma_f32_16x16x32_bf16 v[152:155], a[136:139], a[52:55], v[152:155]
v_mfma_f32_16x16x32_bf16 v[140:143], a[140:143], a[48:51], v[140:143]
v_mfma_f32_16x16x32_bf16 v[156:159], a[140:143], a[52:55], v[156:159]
s_waitcnt vmcnt(15)
v_mfma_f32_16x16x32_bf16 v[160:163], a[128:131], a[56:59], v[160:163]
v_mfma_f32_16x16x32_bf16 v[176:179], a[128:131], a[60:63], v[176:179]
v_mfma_f32_16x16x32_bf16 v[164:167], a[132:135], a[56:59], v[164:167]
v_mfma_f32_16x16x32_bf16 v[180:183], a[132:135], a[60:63], v[180:183]
v_mfma_f32_16x16x32_bf16 v[168:171], a[136:139], a[56:59], v[168:171]
v_mfma_f32_16x16x32_bf16 v[184:187], a[136:139], a[60:63], v[184:187]
v_mfma_f32_16x16x32_bf16 v[172:175], a[140:143], a[56:59], v[172:175]
v_mfma_f32_16x16x32_bf16 v[188:191], a[140:143], a[60:63], v[188:191]
s_waitcnt vmcnt(11)
v_mfma_f32_16x16x32_bf16 v[128:131], a[144:147], a[64:67], v[128:131]
v_mfma_f32_16x16x32_bf16 v[144:147], a[144:147], a[68:71], v[144:147]
v_mfma_f32_16x16x32_bf16 v[132:135], a[148:151], a[64:67], v[132:135]
v_mfma_f32_16x16x32_bf16 v[148:151], a[148:151], a[68:71], v[148:151]
v_mfma_f32_16x16x32_bf16 v[136:139], a[152:155], a[64:67], v[136:139]
v_mfma_f32_16x16x32_bf16 v[152:155], a[152:155], a[68:71], v[152:155]
v_mfma_f32_16x16x32_bf16 v[140:143], a[156:159], a[64:67], v[140:143]
v_mfma_f32_16x16x32_bf16 v[156:159], a[156:159], a[68:71], v[156:159]
s_waitcnt vmcnt(8)
v_mfma_f32_16x16x32_bf16 v[160:163], a[144:147], a[72:75], v[160:163]
v_mfma_f32_16x16x32_bf16 v[176:179], a[144:147], a[76:79], v[176:179]
v_mfma_f32_16x16x32_bf16 v[164:167], a[148:151], a[72:75], v[164:167]
v_mfma_f32_16x16x32_bf16 v[180:183], a[148:151], a[76:79], v[180:183]
v_mfma_f32_16x16x32_bf16 v[168:171], a[152:155], a[72:75], v[168:171]
v_mfma_f32_16x16x32_bf16 v[184:187], a[152:155], a[76:79], v[184:187]
v_mfma_f32_16x16x32_bf16 v[172:175], a[156:159], a[72:75], v[172:175]
v_mfma_f32_16x16x32_bf16 v[188:191], a[156:159], a[76:79], v[188:191]
s_waitcnt vmcnt(6)
v_mfma_f32_16x16x32_bf16 v[128:131], a[224:227], a[0:3], v[128:131]
v_mfma_f32_16x16x32_bf16 v[144:147], a[224:227], a[4:7], v[144:147]
v_mfma_f32_16x16x32_bf16 v[132:135], a[228:231], a[0:3], v[132:135]
v_mfma_f32_16x16x32_bf16 v[148:151], a[228:231], a[4:7], v[148:151]
v_mfma_f32_16x16x32_bf16 v[136:139], a[232:235], a[0:3], v[136:139]
v_mfma_f32_16x16x32_bf16 v[152:155], a[232:235], a[4:7], v[152:155]
v_mfma_f32_16x16x32_bf16 v[140:143], a[236:239], a[0:3], v[140:143]
v_mfma_f32_16x16x32_bf16 v[156:159], a[236:239], a[4:7], v[156:159]
s_waitcnt vmcnt(4)
v_mfma_f32_16x16x32_bf16 v[160:163], a[224:227], a[8:11], v[160:163]
v_mfma_f32_16x16x32_bf16 v[176:179], a[224:227], a[12:15], v[176:179]
v_mfma_f32_16x16x32_bf16 v[164:167], a[228:231], a[8:11], v[164:167]
v_mfma_f32_16x16x32_bf16 v[180:183], a[228:231], a[12:15], v[180:183]
v_mfma_f32_16x16x32_bf16 v[168:171], a[232:235], a[8:11], v[168:171]
v_mfma_f32_16x16x32_bf16 v[184:187], a[232:235], a[12:15], v[184:187]
v_mfma_f32_16x16x32_bf16 v[172:175], a[236:239], a[8:11], v[172:175]
v_mfma_f32_16x16x32_bf16 v[188:191], a[236:239], a[12:15], v[188:191]
s_waitcnt vmcnt(2)
v_mfma_f32_16x16x32_bf16 v[128:131], a[240:243], a[16:19], v[128:131]
s_lshl_b32 s47, s3, 14
v_add_u32 v25, s47, v3
v_mfma_f32_16x16x32_bf16 v[144:147], a[240:243], a[20:23], v[144:147]
v_mfma_f32_16x16x32_bf16 v[132:135], a[244:247], a[16:19], v[132:135]
v_mfma_f32_16x16x32_bf16 v[148:151], a[244:247], a[20:23], v[148:151]
v_mfma_f32_16x16x32_bf16 v[136:139], a[248:251], a[16:19], v[136:139]
v_mfma_f32_16x16x32_bf16 v[152:155], a[248:251], a[20:23], v[152:155]
v_mfma_f32_16x16x32_bf16 v[140:143], a[252:255], a[16:19], v[140:143]
v_mfma_f32_16x16x32_bf16 v[156:159], a[252:255], a[20:23], v[156:159]
s_waitcnt vmcnt(0)
v_mfma_f32_16x16x32_bf16 v[160:163], a[240:243], a[24:27], v[160:163]
v_mfma_f32_16x16x32_bf16 v[176:179], a[240:243], a[28:31], v[176:179]
v_mfma_f32_16x16x32_bf16 v[164:167], a[244:247], a[24:27], v[164:167]
v_mfma_f32_16x16x32_bf16 v[180:183], a[244:247], a[28:31], v[180:183]
ds_write_b128 v6, v[128:131] offset:0
ds_write_b128 v6, v[144:147] offset:16384
v_mfma_f32_16x16x32_bf16 v[168:171], a[248:251], a[24:27], v[168:171]
ds_write_b128 v6, v[132:135] offset:1024
ds_write_b128 v6, v[148:151] offset:17408
v_mfma_f32_16x16x32_bf16 v[184:187], a[248:251], a[28:31], v[184:187]
ds_write_b128 v6, v[136:139] offset:2048
ds_write_b128 v6, v[152:155] offset:18432
v_mfma_f32_16x16x32_bf16 v[172:175], a[252:255], a[24:27], v[172:175]
ds_write_b128 v6, v[140:143] offset:3072
ds_write_b128 v6, v[156:159] offset:19456
v_mfma_f32_16x16x32_bf16 v[188:191], a[252:255], a[28:31], v[188:191]
ds_write_b128 v6, v[160:163] offset:32768
ds_write_b128 v6, v[176:179] offset:49152
ds_write_b128 v6, v[164:167] offset:33792
ds_write_b128 v6, v[180:183] offset:50176
ds_write_b128 v6, v[168:171] offset:34816
ds_write_b128 v6, v[184:187] offset:51200
ds_write_b128 v6, v[172:175] offset:35840
s_nop 0
ds_write_b128 v6, v[188:191] offset:52224
s_waitcnt lgkmcnt(0)
s_barrier
ds_read_b128 v[128:131], v25 offset:0
ds_read_b128 v[132:135], v25 offset:1024
ds_read_b128 v[136:139], v25 offset:2048
ds_read_b128 v[140:143], v25 offset:3072
ds_read_b128 v[144:147], v25 offset:4096
ds_read_b128 v[148:151], v25 offset:5120
ds_read_b128 v[152:155], v25 offset:6144
ds_read_b128 v[156:159], v25 offset:7168
ds_read_b128 v[160:163], v25 offset:8192
ds_read_b128 v[164:167], v25 offset:9216
ds_read_b128 v[168:171], v25 offset:10240
ds_read_b128 v[172:175], v25 offset:11264
ds_read_b128 v[176:179], v25 offset:12288
ds_read_b128 v[180:183], v25 offset:13312
ds_read_b128 v[184:187], v25 offset:14336
ds_read_b128 v[188:191], v25 offset:15360
s_waitcnt lgkmcnt(8)
v_pk_add_f32 v[128:129], v[128:129], v[144:145]
v_pk_add_f32 v[130:131], v[130:131], v[146:147]
v_pk_add_f32 v[132:133], v[132:133], v[148:149]
v_pk_add_f32 v[134:135], v[134:135], v[150:151]
v_pk_add_f32 v[136:137], v[136:137], v[152:153]
v_pk_add_f32 v[138:139], v[138:139], v[154:155]
v_pk_add_f32 v[140:141], v[140:141], v[156:157]
v_pk_add_f32 v[142:143], v[142:143], v[158:159]
s_waitcnt lgkmcnt(0)
v_pk_add_f32 v[160:161], v[160:161], v[176:177]
v_pk_add_f32 v[162:163], v[162:163], v[178:179]
v_pk_add_f32 v[164:165], v[164:165], v[180:181]
v_pk_add_f32 v[166:167], v[166:167], v[182:183]
v_pk_add_f32 v[168:169], v[168:169], v[184:185]
v_pk_add_f32 v[170:171], v[170:171], v[186:187]
v_pk_add_f32 v[172:173], v[172:173], v[188:189]
v_pk_add_f32 v[174:175], v[174:175], v[190:191]
v_pk_add_f32 v[128:129], v[128:129], v[160:161]
v_pk_add_f32 v[130:131], v[130:131], v[162:163]
v_pk_add_f32 v[132:133], v[132:133], v[164:165]
v_pk_add_f32 v[134:135], v[134:135], v[166:167]
v_pk_add_f32 v[136:137], v[136:137], v[168:169]
v_pk_add_f32 v[138:139], v[138:139], v[170:171]
v_pk_add_f32 v[140:141], v[140:141], v[172:173]
v_pk_add_f32 v[142:143], v[142:143], v[174:175]
v_cvt_pk_bf16_f32 v32, v128, v129
v_cvt_pk_bf16_f32 v33, v130, v131
v_cvt_pk_bf16_f32 v34, v132, v133
v_cvt_pk_bf16_f32 v35, v134, v135
v_cvt_pk_bf16_f32 v36, v136, v137
v_cvt_pk_bf16_f32 v37, v138, v139
v_cvt_pk_bf16_f32 v38, v140, v141
v_cvt_pk_bf16_f32 v39, v142, v143
v_lshlrev_b32 v128, 16, v32
v_and_b32 v129, 0xffff0000, v32
v_lshlrev_b32 v130, 16, v33
v_and_b32 v131, 0xffff0000, v33
v_lshlrev_b32 v132, 16, v34
v_and_b32 v133, 0xffff0000, v34
v_lshlrev_b32 v134, 16, v35
v_and_b32 v135, 0xffff0000, v35
v_lshlrev_b32 v136, 16, v36
v_and_b32 v137, 0xffff0000, v36
v_lshlrev_b32 v138, 16, v37
v_and_b32 v139, 0xffff0000, v37
v_lshlrev_b32 v140, 16, v38
v_and_b32 v141, 0xffff0000, v38
v_lshlrev_b32 v142, 16, v39
v_and_b32 v143, 0xffff0000, v39
v_pk_mul_f32 v[128:129], v[128:129], v[64:65]
v_pk_mul_f32 v[130:131], v[130:131], v[66:67]
v_pk_mul_f32 v[132:133], v[132:133], v[68:69]
v_pk_mul_f32 v[134:135], v[134:135], v[70:71]
v_pk_mul_f32 v[136:137], v[136:137], v[72:73]
v_pk_mul_f32 v[138:139], v[138:139], v[74:75]
v_pk_mul_f32 v[140:141], v[140:141], v[76:77]
v_pk_mul_f32 v[142:143], v[142:143], v[78:79]
v_cvt_pk_bf16_f32 v32, v128, v129
v_cvt_pk_bf16_f32 v33, v130, v131
v_cvt_pk_bf16_f32 v34, v132, v133
v_cvt_pk_bf16_f32 v35, v134, v135
v_cvt_pk_bf16_f32 v36, v136, v137
v_cvt_pk_bf16_f32 v37, v138, v139
v_cvt_pk_bf16_f32 v38, v140, v141
v_cvt_pk_bf16_f32 v39, v142, v143
v_lshlrev_b32 v128, 16, v32
v_and_b32 v129, 0xffff0000, v32
v_lshlrev_b32 v130, 16, v33
v_and_b32 v131, 0xffff0000, v33
v_lshlrev_b32 v132, 16, v34
v_and_b32 v133, 0xffff0000, v34
v_lshlrev_b32 v134, 16, v35
v_and_b32 v135, 0xffff0000, v35
v_lshlrev_b32 v136, 16, v36
v_and_b32 v137, 0xffff0000, v36
v_lshlrev_b32 v138, 16, v37
v_and_b32 v139, 0xffff0000, v37
v_lshlrev_b32 v140, 16, v38
v_and_b32 v141, 0xffff0000, v38
v_lshlrev_b32 v142, 16, v39
v_and_b32 v143, 0xffff0000, v39
v_pk_add_f32 v[128:129], v[48:49], v[128:129]
v_pk_add_f32 v[130:131], v[50:51], v[130:131]
v_pk_add_f32 v[132:133], v[52:53], v[132:133]
v_pk_add_f32 v[134:135], v[54:55], v[134:135]
v_pk_add_f32 v[136:137], v[56:57], v[136:137]
v_pk_add_f32 v[138:139], v[58:59], v[138:139]
v_pk_add_f32 v[140:141], v[60:61], v[140:141]
v_pk_add_f32 v[142:143], v[62:63], v[142:143]
v_cvt_pk_bf16_f32 v32, v128, v129
v_cvt_pk_bf16_f32 v33, v130, v131
v_cvt_pk_bf16_f32 v34, v132, v133
v_cvt_pk_bf16_f32 v35, v134, v135
v_cvt_pk_bf16_f32 v36, v136, v137
v_cvt_pk_bf16_f32 v37, v138, v139
v_cvt_pk_bf16_f32 v38, v140, v141
v_cvt_pk_bf16_f32 v39, v142, v143
buffer_store_dwordx4 v[32:35], v12, s[12:15], s55 offen sc1
buffer_store_dwordx4 v[36:39], v12, s[12:15], s55 offen offset:64 sc1
M_END:
s_endpgm
K2_TR0:
s_mov_b32 s55, 0
s_call_b64 s[56:57], K2_SLOW00
s_branch K2_RT0
K2_TR1:
s_mov_b32 s55, 0
s_call_b64 s[56:57], K2_SLOW01
s_branch K2_RT1
K2_TR2:
s_mov_b32 s55, 0
s_call_b64 s[56:57], K2_SLOW10
s_branch K2_RT2
K2_TR3:
s_mov_b32 s55, 0
s_call_b64 s[56:57], K2_SLOW11
s_branch K2_RT3
K2_TR4:
s_mov_b32 s55, 0
s_call_b64 s[56:57], K2_SLOW00
s_branch K2_RT4
K2_TR5:
s_mov_b32 s55, 0
s_call_b64 s[56:57], K2_SLOW01
s_branch K2_RT5
K2_TR6:
s_mov_b32 s55, 0
s_call_b64 s[56:57], K2_SLOW10
s_branch K2_RT6
K2_TR7:
s_mov_b32 s55, 0
s_call_b64 s[56:57], K2_SLOW11
s_branch K2_RT7
K2_TR8:
s_mov_b32 s55, 0
s_call_b64 s[56:57], K2_SLOW00
s_branch K2_RT8
K2_TR9:
s_mov_b32 s55, 0
s_call_b64 s[56:57], K2_SLOW01
s_branch K2_RT9
K2_TR10:
s_mov_b32 s55, 0
s_call_b64 s[56:57], K2_SLOW10
s_branch K2_RT10
K2_TR11:
s_mov_b32 s55, 0
s_call_b64 s[56:57], K2_SLOW11
s_branch K2_RT11
K2_TR12:
s_mov_b32 s55, 0
s_call_b64 s[56:57], K2_SLOW00
s_branch K2_RT12
K2_TR13:
s_mov_b32 s55, 0
s_call_b64 s[56:57], K2_SLOW01
s_branch K2_RT13
K2_TR14:
s_mov_b32 s55, 0
s_call_b64 s[56:57], K2_SLOW10
s_branch K2_RT14
K2_TR15:
s_mov_b32 s55, 0
s_call_b64 s[56:57], K2_SLOW11
s_branch K2_RT15
K2_TR16:
s_mov_b32 s55, 0
s_call_b64 s[56:57], K2_SLOW00
s_branch K2_RT16
K2_TR17:
s_mov_b32 s55, 0
s_call_b64 s[56:57], K2_SLOW01
s_branch K2_RT17
K2_TR18:
s_mov_b32 s55, 0
s_call_b64 s[56:57], K2_SLOW10
s_branch K2_RT18
K2_TR19:
s_mov_b32 s55, 0
s_call_b64 s[56:57], K2_SLOW11
s_branch K2_RT19
K2_TR20:
s_mov_b32 s55, 0
s_call_b64 s[56:57], K2_SLOW00
s_branch K2_RT20
K2_TR21:
s_mov_b32 s55, 0
s_call_b64 s[56:57], K2_SLOW01
s_branch K2_RT21
K2_TR22:
s_mov_b32 s55, 1
s_call_b64 s[56:57], K2_SLOW11
s_branch K2_RT22
K2_TR23:
s_mov_b32 s55, 2
s_call_b64 s[56:57], K2_SLOW01
s_branch K2_RT23
K2_TR24:
s_mov_b32 s55, 2
s_call_b64 s[56:57], K2_SLOW10
s_branch K2_RT24
K2_TR25:
s_mov_b32 s55, 0
s_call_b64 s[56:57], K2_SLOW01
s_branch K2_RT25
K2_TR26:
s_mov_b32 s55, 0
s_call_b64 s[56:57], K2_SLOW10
s_branch K2_RT26
K2_TR27:
s_mov_b32 s55, 0
s_call_b64 s[56:57], K2_SLOW11
s_branch K2_RT27
K2_TR28:
s_mov_b32 s55, 0
s_call_b64 s[56:57], K2_SLOW00
s_branch K2_RT28
K2_TR29:
s_mov_b32 s55, 0
s_call_b64 s[56:57], K2_SLOW01
s_branch K2_RT29
K2_TR30:
s_mov_b32 s55, 0
s_call_b64 s[56:57], K2_SLOW10
s_branch K2_RT30
K2_TR31:
s_mov_b32 s55, 2
s_call_b64 s[56:57], K2_SLOW01
s_branch K2_RT31
K2_TR32:
s_mov_b32 s55, 2
s_call_b64 s[56:57], K2_SLOW10
s_branch K2_RT32
K2_TR33:
s_mov_b32 s55, 0
s_call_b64 s[56:57], K2_SLOW11
s_branch K2_RT33
K2_SLOW00:
s_nop 15
v_max3_f32 v164, v32, v33, v34
v_max3_f32 v164, v164, v35, v36
v_max3_f32 v164, v164, v37, v38
v_max3_f32 v164, v164, v39, v40
v_max3_f32 v164, v164, v41, v42
v_max3_f32 v164, v164, v43, v44
v_max3_f32 v164, v164, v45, v46
v_max_f32 v164, v164, v47
v_mov_b32 v165, v164
s_nop 1
v_permlane16_swap_b32 v164, v165
v_max_f32 v164, v164, v165
v_mov_b32 v165, v164
s_nop 1
v_permlane32_swap_b32 v164, v165
v_max_f32 v164, v164, v165
v_mov_b32 v168, v136
s_bitcmp1_b32 s55, 1
s_cbranch_scc0 K2_SL00a
v_mov_b32 v168, 0
K2_SL00a:
v_log_f32 v165, v168
s_nop 0
v_max_f32 v166, v164, v165
v_sub_f32 v167, 0, v166
v_min_f32 v167, 0x42fc0000, v167
v_exp_f32 v167, v167
v_sub_f32 v32, v32, v166
v_sub_f32 v33, v33, v166
v_sub_f32 v34, v34, v166
v_sub_f32 v35, v35, v166
v_sub_f32 v36, v36, v166
v_sub_f32 v37, v37, v166
v_sub_f32 v38, v38, v166
v_sub_f32 v39, v39, v166
v_sub_f32 v40, v40, v166
v_sub_f32 v41, v41, v166
v_sub_f32 v42, v42, v166
v_sub_f32 v43, v43, v166
v_sub_f32 v44, v44, v166
v_sub_f32 v45, v45, v166
v_sub_f32 v46, v46, v166
v_sub_f32 v47, v47, v166
v_exp_f32 v170, v32
v_exp_f32 v171, v33
s_nop 0
v_cvt_pk_bf16_f32 v96, v170, v171
v_exp_f32 v170, v34
v_exp_f32 v171, v35
s_nop 0
v_cvt_pk_bf16_f32 v97, v170, v171
v_exp_f32 v170, v36
v_exp_f32 v171, v37
s_nop 0
v_cvt_pk_bf16_f32 v98, v170, v171
v_exp_f32 v170, v38
v_exp_f32 v171, v39
s_nop 0
v_cvt_pk_bf16_f32 v99, v170, v171
v_exp_f32 v170, v40
v_exp_f32 v171, v41
s_nop 0
v_cvt_pk_bf16_f32 v100, v170, v171
v_exp_f32 v170, v42
v_exp_f32 v171, v43
s_nop 0
v_cvt_pk_bf16_f32 v101, v170, v171
v_exp_f32 v170, v44
v_exp_f32 v171, v45
s_nop 0
v_cvt_pk_bf16_f32 v102, v170, v171
v_exp_f32 v170, v46
v_exp_f32 v171, v47
s_nop 0
v_cvt_pk_bf16_f32 v103, v170, v171
v_sub_f32 v144, v144, v166
v_sub_f32 v145, v145, v166
v_sub_f32 v146, v146, v166
v_sub_f32 v147, v147, v166
v_mul_f32 v128, v168, v167
v_mul_f32 v129, v168, v167
v_mul_f32 v130, v168, v167
v_mul_f32 v131, v168, v167
s_bitcmp1_b32 s55, 0
s_cbranch_scc1 K2_SL00b
v_sub_f32 v64, v64, v166
v_sub_f32 v65, v65, v166
v_sub_f32 v66, v66, v166
v_sub_f32 v67, v67, v166
v_sub_f32 v68, v68, v166
v_sub_f32 v69, v69, v166
v_sub_f32 v70, v70, v166
v_sub_f32 v71, v71, v166
v_sub_f32 v72, v72, v166
v_sub_f32 v73, v73, v166
v_sub_f32 v74, v74, v166
v_sub_f32 v75, v75, v166
v_sub_f32 v76, v76, v166
v_sub_f32 v77, v77, v166
v_sub_f32 v78, v78, v166
v_sub_f32 v79, v79, v166
K2_SL00b:
s_bitcmp1_b32 s55, 1
s_cbranch_scc1 K2_SL00c
v_mul_f32 v176, v176, v167
v_mul_f32 v177, v177, v167
v_mul_f32 v178, v178, v167
v_mul_f32 v179, v179, v167
v_mul_f32 v180, v180, v167
v_mul_f32 v181, v181, v167
v_mul_f32 v182, v182, v167
v_mul_f32 v183, v183, v167
v_mul_f32 v184, v184, v167
v_mul_f32 v185, v185, v167
v_mul_f32 v186, v186, v167
v_mul_f32 v187, v187, v167
v_mul_f32 v188, v188, v167
v_mul_f32 v189, v189, v167
v_mul_f32 v190, v190, v167
v_mul_f32 v191, v191, v167
v_mul_f32 v192, v192, v167
v_mul_f32 v193, v193, v167
v_mul_f32 v194, v194, v167
v_mul_f32 v195, v195, v167
v_mul_f32 v196, v196, v167
v_mul_f32 v197, v197, v167
v_mul_f32 v198, v198, v167
v_mul_f32 v199, v199, v167
v_mul_f32 v200, v200, v167
v_mul_f32 v201, v201, v167
v_mul_f32 v202, v202, v167
v_mul_f32 v203, v203, v167
v_mul_f32 v204, v204, v167
v_mul_f32 v205, v205, v167
v_mul_f32 v206, v206, v167
v_mul_f32 v207, v207, v167
K2_SL00c:
s_nop 1
v_mfma_f32_16x16x32_bf16 v[128:131], v[152:155], v[96:99], v[128:131]
v_mfma_f32_16x16x32_bf16 v[128:131], v[152:155], v[100:103], v[128:131]
s_nop 7
s_setpc_b64 s[56:57]
K2_SLOW01:
s_nop 15
v_max3_f32 v164, v48, v49, v50
v_max3_f32 v164, v164, v51, v52
v_max3_f32 v164, v164, v53, v54
v_max3_f32 v164, v164, v55, v56
v_max3_f32 v164, v164, v57, v58
v_max3_f32 v164, v164, v59, v60
v_max3_f32 v164, v164, v61, v62
v_max_f32 v164, v164, v63
v_mov_b32 v165, v164
s_nop 1
v_permlane16_swap_b32 v164, v165
v_max_f32 v164, v164, v165
v_mov_b32 v165, v164
s_nop 1
v_permlane32_swap_b32 v164, v165
v_max_f32 v164, v164, v165
v_mov_b32 v168, v140
s_bitcmp1_b32 s55, 1
s_cbranch_scc0 K2_SL01a
v_mov_b32 v168, 0
K2_SL01a:
v_log_f32 v165, v168
s_nop 0
v_max_f32 v166, v164, v165
v_sub_f32 v167, 0, v166
v_min_f32 v167, 0x42fc0000, v167
v_exp_f32 v167, v167
v_sub_f32 v48, v48, v166
v_sub_f32 v49, v49, v166
v_sub_f32 v50, v50, v166
v_sub_f32 v51, v51, v166
v_sub_f32 v52, v52, v166
v_sub_f32 v53, v53, v166
v_sub_f32 v54, v54, v166
v_sub_f32 v55, v55, v166
v_sub_f32 v56, v56, v166
v_sub_f32 v57, v57, v166
v_sub_f32 v58, v58, v166
v_sub_f32 v59, v59, v166
v_sub_f32 v60, v60, v166
v_sub_f32 v61, v61, v166
v_sub_f32 v62, v62, v166
v_sub_f32 v63, v63, v166
v_exp_f32 v170, v48
v_exp_f32 v171, v49
s_nop 0
v_cvt_pk_bf16_f32 v104, v170, v171
v_exp_f32 v170, v50
v_exp_f32 v171, v51
s_nop 0
v_cvt_pk_bf16_f32 v105, v170, v171
v_exp_f32 v170, v52
v_exp_f32 v171, v53
s_nop 0
v_cvt_pk_bf16_f32 v106, v170, v171
v_exp_f32 v170, v54
v_exp_f32 v171, v55
s_nop 0
v_cvt_pk_bf16_f32 v107, v170, v171
v_exp_f32 v170, v56
v_exp_f32 v171, v57
s_nop 0
v_cvt_pk_bf16_f32 v108, v170, v171
v_exp_f32 v170, v58
v_exp_f32 v171, v59
s_nop 0
v_cvt_pk_bf16_f32 v109, v170, v171
v_exp_f32 v170, v60
v_exp_f32 v171, v61
s_nop 0
v_cvt_pk_bf16_f32 v110, v170, v171
v_exp_f32 v170, v62
v_exp_f32 v171, v63
s_nop 0
v_cvt_pk_bf16_f32 v111, v170, v171
v_sub_f32 v148, v148, v166
v_sub_f32 v149, v149, v166
v_sub_f32 v150, v150, v166
v_sub_f32 v151, v151, v166
v_mul_f32 v132, v168, v167
v_mul_f32 v133, v168, v167
v_mul_f32 v134, v168, v167
v_mul_f32 v135, v168, v167
s_bitcmp1_b32 s55, 0
s_cbranch_scc1 K2_SL01b
v_sub_f32 v80, v80, v166
v_sub_f32 v81, v81, v166
v_sub_f32 v82, v82, v166
v_sub_f32 v83, v83, v166
v_sub_f32 v84, v84, v166
v_sub_f32 v85, v85, v166
v_sub_f32 v86, v86, v166
v_sub_f32 v87, v87, v166
v_sub_f32 v88, v88, v166
v_sub_f32 v89, v89, v166
v_sub_f32 v90, v90, v166
v_sub_f32 v91, v91, v166
v_sub_f32 v92, v92, v166
v_sub_f32 v93, v93, v166
v_sub_f32 v94, v94, v166
v_sub_f32 v95, v95, v166
K2_SL01b:
s_bitcmp1_b32 s55, 1
s_cbranch_scc1 K2_SL01c
v_mul_f32 v208, v208, v167
v_mul_f32 v209, v209, v167
v_mul_f32 v210, v210, v167
v_mul_f32 v211, v211, v167
v_mul_f32 v212, v212, v167
v_mul_f32 v213, v213, v167
v_mul_f32 v214, v214, v167
v_mul_f32 v215, v215, v167
v_mul_f32 v216, v216, v167
v_mul_f32 v217, v217, v167
v_mul_f32 v218, v218, v167
v_mul_f32 v219, v219, v167
v_mul_f32 v220, v220, v167
v_mul_f32 v221, v221, v167
v_mul_f32 v222, v222, v167
v_mul_f32 v223, v223, v167
v_mul_f32 v224, v224, v167
v_mul_f32 v225, v225, v167
v_mul_f32 v226, v226, v167
v_mul_f32 v227, v227, v167
v_mul_f32 v228, v228, v167
v_mul_f32 v229, v229, v167
v_mul_f32 v230, v230, v167
v_mul_f32 v231, v231, v167
v_mul_f32 v232, v232, v167
v_mul_f32 v233, v233, v167
v_mul_f32 v234, v234, v167
v_mul_f32 v235, v235, v167
v_mul_f32 v236, v236, v167
v_mul_f32 v237, v237, v167
v_mul_f32 v238, v238, v167
v_mul_f32 v239, v239, v167
K2_SL01c:
s_nop 1
v_mfma_f32_16x16x32_bf16 v[132:135], v[152:155], v[104:107], v[132:135]
v_mfma_f32_16x16x32_bf16 v[132:135], v[152:155], v[108:111], v[132:135]
s_nop 7
s_setpc_b64 s[56:57]
K2_SLOW10:
s_nop 15
v_max3_f32 v164, v64, v65, v66
v_max3_f32 v164, v164, v67, v68
v_max3_f32 v164, v164, v69, v70
v_max3_f32 v164, v164, v71, v72
v_max3_f32 v164, v164, v73, v74
v_max3_f32 v164, v164, v75, v76
v_max3_f32 v164, v164, v77, v78
v_max_f32 v164, v164, v79
v_mov_b32 v165, v164
s_nop 1
v_permlane16_swap_b32 v164, v165
v_max_f32 v164, v164, v165
v_mov_b32 v165, v164
s_nop 1
v_permlane32_swap_b32 v164, v165
v_max_f32 v164, v164, v165
v_mov_b32 v168, v128
s_bitcmp1_b32 s55, 1
s_cbranch_scc0 K2_SL10a
v_mov_b32 v168, 0
K2_SL10a:
v_log_f32 v165, v168
s_nop 0
v_max_f32 v166, v164, v165
v_sub_f32 v167, 0, v166
v_min_f32 v167, 0x42fc0000, v167
v_exp_f32 v167, v167
v_sub_f32 v64, v64, v166
v_sub_f32 v65, v65, v166
v_sub_f32 v66, v66, v166
v_sub_f32 v67, v67, v166
v_sub_f32 v68, v68, v166
v_sub_f32 v69, v69, v166
v_sub_f32 v70, v70, v166
v_sub_f32 v71, v71, v166
v_sub_f32 v72, v72, v166
v_sub_f32 v73, v73, v166
v_sub_f32 v74, v74, v166
v_sub_f32 v75, v75, v166
v_sub_f32 v76, v76, v166
v_sub_f32 v77, v77, v166
v_sub_f32 v78, v78, v166
v_sub_f32 v79, v79, v166
v_exp_f32 v170, v64
v_exp_f32 v171, v65
s_nop 0
v_cvt_pk_bf16_f32 v112, v170, v171
v_exp_f32 v170, v66
v_exp_f32 v171, v67
s_nop 0
v_cvt_pk_bf16_f32 v113, v170, v171
v_exp_f32 v170, v68
v_exp_f32 v171, v69
s_nop 0
v_cvt_pk_bf16_f32 v114, v170, v171
v_exp_f32 v170, v70
v_exp_f32 v171, v71
s_nop 0
v_cvt_pk_bf16_f32 v115, v170, v171
v_exp_f32 v170, v72
v_exp_f32 v171, v73
s_nop 0
v_cvt_pk_bf16_f32 v116, v170, v171
v_exp_f32 v170, v74
v_exp_f32 v171, v75
s_nop 0
v_cvt_pk_bf16_f32 v117, v170, v171
v_exp_f32 v170, v76
v_exp_f32 v171, v77
s_nop 0
v_cvt_pk_bf16_f32 v118, v170, v171
v_exp_f32 v170, v78
v_exp_f32 v171, v79
s_nop 0
v_cvt_pk_bf16_f32 v119, v170, v171
v_sub_f32 v144, v144, v166
v_sub_f32 v145, v145, v166
v_sub_f32 v146, v146, v166
v_sub_f32 v147, v147, v166
v_mul_f32 v136, v168, v167
v_mul_f32 v137, v168, v167
v_mul_f32 v138, v168, v167
v_mul_f32 v139, v168, v167
s_bitcmp1_b32 s55, 0
s_cbranch_scc1 K2_SL10b
v_sub_f32 v32, v32, v166
v_sub_f32 v33, v33, v166
v_sub_f32 v34, v34, v166
v_sub_f32 v35, v35, v166
v_sub_f32 v36, v36, v166
v_sub_f32 v37, v37, v166
v_sub_f32 v38, v38, v166
v_sub_f32 v39, v39, v166
v_sub_f32 v40, v40, v166
v_sub_f32 v41, v41, v166
v_sub_f32 v42, v42, v166
v_sub_f32 v43, v43, v166
v_sub_f32 v44, v44, v166
v_sub_f32 v45, v45, v166
v_sub_f32 v46, v46, v166
v_sub_f32 v47, v47, v166
K2_SL10b:
s_bitcmp1_b32 s55, 1
s_cbranch_scc1 K2_SL10c
v_mul_f32 v176, v176, v167
v_mul_f32 v177, v177, v167
v_mul_f32 v178, v178, v167
v_mul_f32 v179, v179, v167
v_mul_f32 v180, v180, v167
v_mul_f32 v181, v181, v167
v_mul_f32 v182, v182, v167
v_mul_f32 v183, v183, v167
v_mul_f32 v184, v184, v167
v_mul_f32 v185, v185, v167
v_mul_f32 v186, v186, v167
v_mul_f32 v187, v187, v167
v_mul_f32 v188, v188, v167
v_mul_f32 v189, v189, v167
v_mul_f32 v190, v190, v167
v_mul_f32 v191, v191, v167
v_mul_f32 v192, v192, v167
v_mul_f32 v193, v193, v167
v_mul_f32 v194, v194, v167
v_mul_f32 v195, v195, v167
v_mul_f32 v196, v196, v167
v_mul_f32 v197, v197, v167
v_mul_f32 v198, v198, v167
v_mul_f32 v199, v199, v167
v_mul_f32 v200, v200, v167
v_mul_f32 v201, v201, v167
v_mul_f32 v202, v202, v167
v_mul_f32 v203, v203, v167
v_mul_f32 v204, v204, v167
v_mul_f32 v205, v205, v167
v_mul_f32 v206, v206, v167
v_mul_f32 v207, v207, v167
K2_SL10c:
s_nop 1
v_mfma_f32_16x16x32_bf16 v[136:139], v[152:155], v[112:115], v[136:139]
v_mfma_f32_16x16x32_bf16 v[136:139], v[152:155], v[116:119], v[136:139]
s_nop 7
s_setpc_b64 s[56:57]
K2_SLOW11:
s_nop 15
v_max3_f32 v164, v80, v81, v82
v_max3_f32 v164, v164, v83, v84
v_max3_f32 v164, v164, v85, v86
v_max3_f32 v164, v164, v87, v88
v_max3_f32 v164, v164, v89, v90
v_max3_f32 v164, v164, v91, v92
v_max3_f32 v164, v164, v93, v94
v_max_f32 v164, v164, v95
v_mov_b32 v165, v164
s_nop 1
v_permlane16_swap_b32 v164, v165
v_max_f32 v164, v164, v165
v_mov_b32 v165, v164
s_nop 1
v_permlane32_swap_b32 v164, v165
v_max_f32 v164, v164, v165
v_mov_b32 v168, v132
s_bitcmp1_b32 s55, 1
s_cbranch_scc0 K2_SL11a
v_mov_b32 v168, 0
K2_SL11a:
v_log_f32 v165, v168
s_nop 0
v_max_f32 v166, v164, v165
v_sub_f32 v167, 0, v166
v_min_f32 v167, 0x42fc0000, v167
v_exp_f32 v167, v167
v_sub_f32 v80, v80, v166
v_sub_f32 v81, v81, v166
v_sub_f32 v82, v82, v166
v_sub_f32 v83, v83, v166
v_sub_f32 v84, v84, v166
v_sub_f32 v85, v85, v166
v_sub_f32 v86, v86, v166
v_sub_f32 v87, v87, v166
v_sub_f32 v88, v88, v166
v_sub_f32 v89, v89, v166
v_sub_f32 v90, v90, v166
v_sub_f32 v91, v91, v166
v_sub_f32 v92, v92, v166
v_sub_f32 v93, v93, v166
v_sub_f32 v94, v94, v166
v_sub_f32 v95, v95, v166
v_exp_f32 v170, v80
v_exp_f32 v171, v81
s_nop 0
v_cvt_pk_bf16_f32 v120, v170, v171
v_exp_f32 v170, v82
v_exp_f32 v171, v83
s_nop 0
v_cvt_pk_bf16_f32 v121, v170, v171
v_exp_f32 v170, v84
v_exp_f32 v171, v85
s_nop 0
v_cvt_pk_bf16_f32 v122, v170, v171
v_exp_f32 v170, v86
v_exp_f32 v171, v87
s_nop 0
v_cvt_pk_bf16_f32 v123, v170, v171
v_exp_f32 v170, v88
v_exp_f32 v171, v89
s_nop 0
v_cvt_pk_bf16_f32 v124, v170, v171
v_exp_f32 v170, v90
v_exp_f32 v171, v91
s_nop 0
v_cvt_pk_bf16_f32 v125, v170, v171
v_exp_f32 v170, v92
v_exp_f32 v171, v93
s_nop 0
v_cvt_pk_bf16_f32 v126, v170, v171
v_exp_f32 v170, v94
v_exp_f32 v171, v95
s_nop 0
v_cvt_pk_bf16_f32 v127, v170, v171
v_sub_f32 v148, v148, v166
v_sub_f32 v149, v149, v166
v_sub_f32 v150, v150, v166
v_sub_f32 v151, v151, v166
v_mul_f32 v140, v168, v167
v_mul_f32 v141, v168, v167
v_mul_f32 v142, v168, v167
v_mul_f32 v143, v168, v167
s_bitcmp1_b32 s55, 0
s_cbranch_scc1 K2_SL11b
v_sub_f32 v48, v48, v166
v_sub_f32 v49, v49, v166
v_sub_f32 v50, v50, v166
v_sub_f32 v51, v51, v166
v_sub_f32 v52, v52, v166
v_sub_f32 v53, v53, v166
v_sub_f32 v54, v54, v166
v_sub_f32 v55, v55, v166
v_sub_f32 v56, v56, v166
v_sub_f32 v57, v57, v166
v_sub_f32 v58, v58, v166
v_sub_f32 v59, v59, v166
v_sub_f32 v60, v60, v166
v_sub_f32 v61, v61, v166
v_sub_f32 v62, v62, v166
v_sub_f32 v63, v63, v166
K2_SL11b:
s_bitcmp1_b32 s55, 1
s_cbranch_scc1 K2_SL11c
v_mul_f32 v208, v208, v167
v_mul_f32 v209, v209, v167
v_mul_f32 v210, v210, v167
v_mul_f32 v211, v211, v167
v_mul_f32 v212, v212, v167
v_mul_f32 v213, v213, v167
v_mul_f32 v214, v214, v167
v_mul_f32 v215, v215, v167
v_mul_f32 v216, v216, v167
v_mul_f32 v217, v217, v167
v_mul_f32 v218, v218, v167
v_mul_f32 v219, v219, v167
v_mul_f32 v220, v220, v167
v_mul_f32 v221, v221, v167
v_mul_f32 v222, v222, v167
v_mul_f32 v223, v223, v167
v_mul_f32 v224, v224, v167
v_mul_f32 v225, v225, v167
v_mul_f32 v226, v226, v167
v_mul_f32 v227, v227, v167
v_mul_f32 v228, v228, v167
v_mul_f32 v229, v229, v167
v_mul_f32 v230, v230, v167
v_mul_f32 v231, v231, v167
v_mul_f32 v232, v232, v167
v_mul_f32 v233, v233, v167
v_mul_f32 v234, v234, v167
v_mul_f32 v235, v235, v167
v_mul_f32 v236, v236, v167
v_mul_f32 v237, v237, v167
v_mul_f32 v238, v238, v167
v_mul_f32 v239, v239, v167
K2_SL11c:
s_nop 1
v_mfma_f32_16x16x32_bf16 v[140:143], v[152:155], v[120:123], v[140:143]
v_mfma_f32_16x16x32_bf16 v[140:143], v[152:155], v[124:127], v[140:143]
s_nop 7
s_setpc_b64 s[56:57]
M_SPINLNK:
s_mov_b32 s47, 100000
M_SPLLNK:
s_sleep 8
buffer_load_dword v28, v2, s[36:39], 0 offen sc1
s_waitcnt vmcnt(0)
v_and_b32 v29, 0x10101010, v28
v_cmp_eq_u32 vcc, 0x10101010, v29
s_or_b64 vcc, vcc, s[96:97]
s_cmp_eq_u64 vcc, -1
s_cbranch_scc1 M_SRETLNK
s_add_u32 s47, s47, -1
s_cbranch_scc1 M_SPLLNK
s_branch M_SRETLNK
M_SPINLNV:
s_mov_b32 s47, 100000
M_SPLLNV:
s_sleep 8
buffer_load_dword v28, v2, s[36:39], 0 offen sc1
s_waitcnt vmcnt(0)
v_and_b32 v29, 0x10101010, v28
v_cmp_eq_u32 vcc, 0x10101010, v29
s_or_b64 vcc, vcc, s[96:97]
s_cmp_eq_u64 vcc, -1
s_cbranch_scc1 M_SRETLNV
s_add_u32 s47, s47, -1
s_cbranch_scc1 M_SPLLNV
s_branch M_SRETLNV
M_SPINKVE:
s_mov_b32 s47, 100000
M_SPLKVE:
s_sleep 8
buffer_load_dword v28, v2, s[28:31], s71 offen sc1
s_waitcnt vmcnt(0)
v_cmp_ne_u32 vcc, 0, v28
s_or_b64 vcc, vcc, s[96:97]
s_and_b32 s46, vcc_lo, 0x3
s_cmp_eq_u32 s46, 0x3
s_cbranch_scc1 M_SRETKVE
s_add_u32 s47, s47, -1
s_cbranch_scc1 M_SPLKVE
s_branch M_SRETKVE
M_SPINKVL:
s_mov_b32 s47, 100000
M_SPLKVL:
s_sleep 8
buffer_load_dword v28, v2, s[28:31], s71 offen sc1
s_waitcnt vmcnt(0)
v_cmp_ne_u32 vcc, 0, v28
s_or_b64 vcc, vcc, s[96:97]
s_and_b32 s46, vcc_lo, 0x3
s_cmp_eq_u32 s46, 0x3
s_cbranch_scc1 M_SRETKVL
s_add_u32 s47, s47, -1
s_cbranch_scc1 M_SPLKVL
s_branch M_SRETKVL
M_SPINKVA:
s_mov_b32 s47, 100000
M_SPLKVA:
s_sleep 8
buffer_load_dword v28, v2, s[28:31], s71 offen sc1
s_waitcnt vmcnt(0)
v_cmp_ne_u32 vcc, 0, v28
s_or_b64 vcc, vcc, s[96:97]
s_and_b32 s46, vcc_lo, 0xff
s_cmp_eq_u32 s46, 0xff
s_cbranch_scc1 M_SRETKVA
s_add_u32 s47, s47, -1
s_cbranch_scc1 M_SPLKVA
s_branch M_SRETKVA
M_SPING2:
s_mov_b32 s47, 100000
M_SPLG2:
s_sleep 8
buffer_load_dwordx4 v[24:27], v28, s[28:31], s69 offen sc1
s_waitcnt vmcnt(0)
v_min3_u32 v24, v24, v25, v26
v_min_u32 v24, v24, v27
v_cmp_ne_u32 vcc, 0, v24
s_or_b64 vcc, vcc, s[96:97]
s_cmp_eq_u64 vcc, -1
s_cbranch_scc1 M_SRETG2
s_add_u32 s47, s47, -1
s_cbranch_scc1 M_SPLG2
s_branch M_SRETG2
M_SPINCTB:
s_mov_b32 s47, 100000
M_SPLCTB:
s_sleep 8
buffer_load_dword v29, v2, s[28:31], s50 offen sc1
s_waitcnt vmcnt(0)
v_cmp_ne_u32 vcc, 0, v29
s_or_b64 vcc, vcc, s[96:97]
s_cmp_eq_u32 vcc_lo, -1
s_cbranch_scc1 M_SRETCTB
s_add_u32 s47, s47, -1
s_cbranch_scc1 M_SPLCTB
s_branch M_SRETCTB
M_SPINCTA:
s_mov_b32 s47, 100000
M_SPLCTA:
s_sleep 8
buffer_load_dword v29, v2, s[28:31], s51 offen sc1
s_waitcnt vmcnt(0)
v_cmp_ne_u32 vcc, 0, v29
s_or_b64 vcc, vcc, s[96:97]
s_cmp_eq_u32 vcc_lo, -1
s_cbranch_scc1 M_SRETCTA
s_add_u32 s47, s47, -1
s_cbranch_scc1 M_SPLCTA
s_branch M_SRETCTA
M_SPINFFN:
s_mov_b32 s47, 100000
M_SPLFFN:
s_sleep 8
buffer_load_dwordx4 v[24:27], v28, s[28:31], s54 offen sc1
s_waitcnt vmcnt(0)
v_min3_u32 v24, v24, v25, v26
v_min_u32 v24, v24, v27
v_cmp_ne_u32 vcc, 0, v24
s_or_b64 vcc, vcc, s[96:97]
s_cmp_eq_u64 vcc, -1
s_cbranch_scc1 M_SRETFFN
s_add_u32 s47, s47, -1
s_cbranch_scc1 M_SPLFFN
s_branch M_SRETFFN
M_CODE_END:
.section .rodata,"a"
.p2align 6
.amdhsa_kernel recurrent_scan__compressed_kv_cla__moe_arch_mod__prompt_kernel
  .amdhsa_next_free_vgpr 512
  .amdhsa_next_free_sgpr 102
  .amdhsa_accum_offset 256
  .amdhsa_group_segment_fixed_size 0
  .amdhsa_kernarg_size 112
  .amdhsa_user_sgpr_count 2
  .amdhsa_user_sgpr_kernarg_segment_ptr 1
  .amdhsa_system_sgpr_workgroup_id_x 1
.end_amdhsa_kernel
```
